```python
import torch

def _softmax(x, axis=-1):
    return torch.softmax(x, dim=axis)

def _gelu(x):
    return torch.nn.functional.gelu(x, approximate='tanh')

def _silu(x):
    return torch.nn.functional.silu(x)

def _sigmoid(x):
    return torch.sigmoid(x)

def _layernorm(x, axis=-1, eps=1e-05):
    m = x.mean(dim=axis, keepdim=True)
    v = x.var(dim=axis, keepdim=True, unbiased=False)
    return (x - m) / torch.sqrt(v + eps)

def _scatter_add(tgt, idx, src, axis=0):
    return tgt.clone().index_add_(axis, idx, src)

def _segment_sum(src, seg, n):
    out = torch.zeros((n,) + src.shape[1:], dtype=src.dtype)
    return out.index_add_(0, seg, src)

def _pad(x, pw):
    flat = tuple((v for pair in reversed(pw) for v in pair))
    return torch.nn.functional.pad(x, flat)
kernel_name = 'gated_mix__memory_aug_recurrent_mem_tr__spectral_gfnet__prompt'

def setup_inputs():

    _w = lambda a: (lambda t: t.to(torch.bfloat16) if t.is_floating_point() else t)(torch.as_tensor(a))

    def _A_setup():
        B, S, Dm = (1, 2048, 1024)
        H, Dh = (32, 128)
        M, seg = (8, 32)
        seg = min(seg, S)
        S = S // seg * seg
        return {'x': _w((lambda *s: torch.randn(*s, dtype=torch.bfloat16) * 0.05)(B, S, Dm)), 'mem0': _w((lambda *s: torch.randn(*s, dtype=torch.bfloat16) * 0.4)(B, M, Dm)), 'Wq': _w((lambda *s: torch.randn(*s, dtype=torch.bfloat16) * 6.4)(Dm, H, Dh) * Dm ** (-0.5)), 'Wk': _w((lambda *s: torch.randn(*s, dtype=torch.bfloat16) * 6.4)(Dm, H, Dh) * Dm ** (-0.5)), 'Wv': _w((lambda *s: torch.randn(*s, dtype=torch.bfloat16) * 0.4)(Dm, H, Dh) * Dm ** (-0.5)), 'Wo': _w((lambda *s: torch.randn(*s, dtype=torch.bfloat16) * 0.4)(H, Dh, Dm) * (H * Dh) ** (-0.5)), 'seg_len': seg}
    _A_in = _A_setup()

    def _B_setup():
        B, S, D = (1, 2048, 1024)
        Df = D // 2 + 1
        return {'x': _w((lambda *s: torch.randn(*s, dtype=torch.bfloat16) * 0.05)(B, S, D)), 'w_r': _w((lambda *s: torch.randn(*s, dtype=torch.bfloat16) * 3.2)(S, Df) * 0.02), 'w_i': _w((lambda *s: torch.randn(*s, dtype=torch.bfloat16) * 3.2)(S, Df) * 0.02)}
    _B_in = _B_setup()
    return {'A_x': _A_in['x'], 'A_mem0': _A_in['mem0'], 'A_Wq': _A_in['Wq'], 'A_Wk': _A_in['Wk'], 'A_Wv': _A_in['Wv'], 'A_Wo': _A_in['Wo'], 'A_seg_len': _A_in['seg_len'], 'B_x': _B_in['x'], 'B_w_r': _B_in['w_r'], 'B_w_i': _B_in['w_i'], 'gate_w': _w((lambda *s: torch.randn(*s, dtype=torch.bfloat16) * 0.05)(1024) * 16.0)}

def reference(A_x, A_mem0, A_Wq, A_Wk, A_Wv, A_Wo, A_seg_len, B_x, B_w_r, B_w_i, gate_w):

    def _A_ref(x, mem0, Wq, Wk, Wv, Wo, seg_len):
        B, S, Dm = x.shape
        H, Dh = (Wq.shape[1], Wq.shape[2])
        M = mem0.shape[1]
        scale = Dh ** (-0.5)
        n_seg = S // seg_len
        L = M + seg_len
        idx = torch.arange(L)
        mask = (idx[:, None] < M) | (idx[:, None] >= idx[None, :])
        mem = mem0
        outs = []
        for s in range(n_seg):
            xs = x[:, s * seg_len:(s + 1) * seg_len, :].clone()
            h = torch.concatenate([mem, xs], axis=1)
            q = torch.einsum('btd,dhe->bhte', h, Wq)
            k = torch.einsum('btd,dhe->bhte', h, Wk)
            v = torch.einsum('btd,dhe->bhte', h, Wv)
            scores = torch.einsum('bhqe,bhke->bhqk', q, k) * scale
            scores = torch.where(mask[None, None], scores, -1000000000.0)
            p = _softmax(scores, axis=-1)
            o = torch.einsum('bhqk,bhke->bhqe', p, v)
            o = torch.einsum('bhte,hed->btd', o, Wo)
            mem = o[:, :M, :].clone()
            outs.append(o[:, M:, :])
        return torch.concatenate(outs, axis=1)

    def _B_ref(x, w_r, w_i):
        B, S, D = x.shape
        X = (lambda x, axes=(-2, -1): torch.fft.rfft2(x.float(), dim=axes))(x, axes=(-2, -1))
        W = w_r + 1j * w_i
        X = X * W
        y = (lambda x, s, axes=(-2, -1): torch.fft.irfft2(x, s=s, dim=axes).to(torch.bfloat16))(X, (S, D), axes=(-2, -1))
        return y
    x = A_x
    g = _sigmoid((x * gate_w).sum(-1, keepdims=True))
    a = _A_ref(x, A_mem0, A_Wq, A_Wk, A_Wv, A_Wo, A_seg_len)
    b = _B_ref(x, B_w_r, B_w_i)
    return g * a + (1 - g) * b
```

```asm
; @launch grid=(256,1,1) block=(512,1,1) lds=147584
.amdgcn_target "amdgcn-amd-amdhsa--gfx950"
.text
.globl gated_mix__memory_aug_recurrent_mem_tr__spectral_gfnet__prompt_kernel
.p2align 8
.type gated_mix__memory_aug_recurrent_mem_tr__spectral_gfnet__prompt_kernel,@function
gated_mix__memory_aug_recurrent_mem_tr__spectral_gfnet__prompt_kernel:
    s_cmp_ge_u32 s2, 256
    s_cbranch_scc1 K_EXIT
    s_load_dwordx4 s[4:7], s[0:1], 96
    s_waitcnt lgkmcnt(0)
    s_mov_b32 s16, s4
    s_and_b32 s17, s5, 0xffff
    s_mov_b32 s18, 256
    s_mov_b32 s19, 0x20000
    s_mov_b32 s8, s6
    s_and_b32 s9, s7, 0xffff
    s_mov_b32 s10, 266338304
    s_mov_b32 s11, 0x20000
    s_mov_b32 s44, s6
    s_mov_b32 s45, s7
    s_cmp_lg_u32 s2, 0
    s_cbranch_scc1 K_NP
    v_readfirstlane_b32 s3, v0
    s_nop 3
    s_cmp_lg_u32 s3, 0
    s_cbranch_scc1 K_PW
    s_mov_b32 s4, 0
    s_getreg_b32 s3, hwreg(HW_REG_XCC_ID)
    s_xor_b32 s3, s3, 0
    s_and_b32 s3, s3, 4
    v_mov_b32 v50, -1
    s_mov_b64 exec, 1
    s_add_u32 s5, s4, 8192
    s_mov_b32 s6, 0
    s_mov_b32 s7, 0
    s_mov_b32 s56, 0
    .p2align 6
PB_L:
    buffer_store_dword v50, off, s[8:11], s4 sc1
    buffer_store_dword v50, off, s[8:11], s5 sc1
    s_waitcnt vmcnt(1)
    s_memtime s[52:53]
    s_waitcnt vmcnt(0)
    s_memtime s[54:55]
    s_xor_b32 s4, s4, 0x2000
    s_xor_b32 s5, s5, 0x2000
    s_waitcnt lgkmcnt(0)
    s_sub_u32 s52, s54, s52
    s_min_u32 s52, s52, 300
    s_mul_i32 s52, s52, s56
    s_add_u32 s6, s6, s52
    s_add_u32 s7, s7, 1
    s_bitcmp1_b32 s7, 0
    s_cselect_b32 s56, -1, 1
    s_cbranch_scc0 PB_L
    s_cmp_ge_u32 s7, 17
    s_cbranch_scc1 PB_D
    s_abs_i32 s57, s6
    s_cmp_lt_u32 s57, 150
    s_cbranch_scc1 PB_L
PB_D:
    s_cmp_lt_i32 s6, 0
    s_cselect_b32 s5, 4, 0
    s_xor_b32 s5, s5, s3
    s_lshl_b32 s5, s5, 19
    s_add_u32 s5, s5, 1
    v_mov_b32 v50, s5
    buffer_store_dword v50, off, s[16:19], 0 offset:72 sc1
    s_mov_b64 exec, -1
K_PW:
    s_barrier
K_NP:
    s_sub_u32 s4, s2, 8
    s_and_b32 s5, s4, 0xffffffe4
    s_cbranch_scc1 CC_Y
    s_and_b32 s5, s4, 3
    s_bfe_u32 s6, s4, 0x10003
    s_lshl_b32 s6, s6, 2
    s_add_u32 s5, s5, s6
    s_lshl_b32 s5, s5, 13
    s_lshr_b32 s4, s4, 4
    s_lshl_b32 s4, s4, 21
    s_add_u32 s4, s4, s5
    s_add_u32 s4, s4, 124780544
    v_lshlrev_b32 v50, 4, v0
    v_mov_b32 v52, 0
    v_mov_b32 v53, 0
    v_mov_b32 v54, 0
    v_mov_b32 v55, 0
    buffer_store_dwordx4 v[52:55], v50, s[8:11], s4 offen sc1
    v_mov_b32 v50, 1
    s_waitcnt vmcnt(0)
    s_barrier
    v_cmp_eq_u32 vcc, 128, v0
    s_and_saveexec_b64 s[4:5], vcc
    s_cbranch_execz CC_X
    buffer_atomic_add v50, off, s[16:19], 0 offset:76 sc1
CC_X:
    s_mov_b64 exec, s[4:5]
CC_Y:
    s_getpc_b64 s[4:5]
K_PC:
    s_sub_u32 s4, s4, K_PC-gated_mix__memory_aug_recurrent_mem_tr__spectral_gfnet__prompt_kernel
    s_subb_u32 s5, s5, 0
    s_lshr_b32 s6, s2, 3
    v_subrev_u32 v1, 64, v0
    v_lshl_add_u32 v1, v1, 5, s6
    v_lshlrev_b32 v1, 7, v1
    v_cmp_gt_u32 vcc, G_TABLE_END-gated_mix__memory_aug_recurrent_mem_tr__spectral_gfnet__prompt_kernel, v1
    s_and_saveexec_b64 s[6:7], vcc
    s_cbranch_execz K_NW
    global_load_dword v60, v1, s[4:5]
K_NW:
    s_mov_b64 exec, s[6:7]
    s_getreg_b32 s3, hwreg(HW_REG_XCC_ID)
    s_and_b32 s3, s3, 7
    s_xor_b32 s3, s3, 0
    s_mov_b32 s26, 300000
    v_cmp_eq_u32 vcc, 0, v0
    s_and_saveexec_b64 s[4:5], vcc
    s_cbranch_execz TK_W
    v_mov_b32 v1, 1
    v_mov_b32 v2, 1
    s_and_b32 s33, s3, 3
    s_lshl_b32 s33, s33, 2
    s_and_b32 s38, s3, 4
    s_lshl_b32 s38, s38, 5
    s_add_u32 s33, s33, s38
    buffer_atomic_add v1, off, s[16:19], s33 sc0 sc1
    s_waitcnt vmcnt(0)
    v_readfirstlane_b32 s38, v1
    s_lshl_b32 s33, s3, 5
    s_nop 2
    s_add_u32 s20, s33, s38
    s_cmp_lt_u32 s38, 32
    s_cbranch_scc1 TK_HAVE
    v_mov_b32 v1, 1
    buffer_atomic_add v1, off, s[16:19], 0 offset:36 sc0 sc1
TK_ALL:
    buffer_load_dwordx4 v[4:7], off, s[16:19], 0 sc1
    buffer_load_dwordx4 v[8:11], off, s[16:19], 0 offset:128 sc1
    s_sub_u32 s26, s26, 1
    s_cbranch_scc1 K_FAIL
    s_waitcnt vmcnt(0)
    v_add3_u32 v3, v4, v5, v6
    v_add3_u32 v3, v3, v7, v8
    v_add3_u32 v3, v3, v9, v10
    v_add_u32 v3, v3, v11
    v_cmp_gt_u32 vcc, 0x100, v3
    s_cbranch_vccnz TK_ALL
    v_readfirstlane_b32 s38, v1
    v_readfirstlane_b32 s33, v4
    s_nop 3
    s_min_u32 s33, s33, 32
    s_add_u32 s20, s33, s38
    s_sub_u32 s38, s20, 32
    s_add_u32 s20, s20, 0
    s_cmp_lt_i32 s38, 0
    s_cbranch_scc1 TK_LEFT
    v_readfirstlane_b32 s33, v5
    s_nop 3
    s_min_u32 s33, s33, 32
    s_add_u32 s20, s33, s38
    s_sub_u32 s38, s20, 32
    s_add_u32 s20, s20, 32
    s_cmp_lt_i32 s38, 0
    s_cbranch_scc1 TK_LEFT
    v_readfirstlane_b32 s33, v6
    s_nop 3
    s_min_u32 s33, s33, 32
    s_add_u32 s20, s33, s38
    s_sub_u32 s38, s20, 32
    s_add_u32 s20, s20, 64
    s_cmp_lt_i32 s38, 0
    s_cbranch_scc1 TK_LEFT
    v_readfirstlane_b32 s33, v7
    s_nop 3
    s_min_u32 s33, s33, 32
    s_add_u32 s20, s33, s38
    s_sub_u32 s38, s20, 32
    s_add_u32 s20, s20, 96
    s_cmp_lt_i32 s38, 0
    s_cbranch_scc1 TK_LEFT
    v_readfirstlane_b32 s33, v8
    s_nop 3
    s_min_u32 s33, s33, 32
    s_add_u32 s20, s33, s38
    s_sub_u32 s38, s20, 32
    s_add_u32 s20, s20, 128
    s_cmp_lt_i32 s38, 0
    s_cbranch_scc1 TK_LEFT
    v_readfirstlane_b32 s33, v9
    s_nop 3
    s_min_u32 s33, s33, 32
    s_add_u32 s20, s33, s38
    s_sub_u32 s38, s20, 32
    s_add_u32 s20, s20, 160
    s_cmp_lt_i32 s38, 0
    s_cbranch_scc1 TK_LEFT
    v_readfirstlane_b32 s33, v10
    s_nop 3
    s_min_u32 s33, s33, 32
    s_add_u32 s20, s33, s38
    s_sub_u32 s38, s20, 32
    s_add_u32 s20, s20, 192
    s_cmp_lt_i32 s38, 0
    s_cbranch_scc1 TK_LEFT
    v_readfirstlane_b32 s33, v11
    s_nop 3
    s_min_u32 s33, s33, 32
    s_add_u32 s20, s33, s38
    s_sub_u32 s38, s20, 32
    s_add_u32 s20, s20, 224
    s_cmp_lt_i32 s38, 0
    s_cbranch_scc1 TK_LEFT
TK_LEFT:
    s_and_b32 s20, s20, 255
    s_or_b32 s20, s20, 0x10000
TK_HAVE:
    v_mov_b32 v1, s20
    v_mov_b32 v2, 0
    s_waitcnt vmcnt(0)
    ds_write_b32 v2, v1
TK_W:
    s_mov_b64 exec, s[4:5]
    s_waitcnt lgkmcnt(0)
    s_barrier
    v_mov_b32 v2, 0
    ds_read_b32 v1, v2
    s_waitcnt lgkmcnt(0)
    v_readfirstlane_b32 s20, v1
    s_barrier
    s_and_b32 s51, s20, 0x10000
    s_and_b32 s20, s20, 255
    s_xor_b32 s20, s20, 24
    s_cmp_lt_u32 s20, 128
    s_cbranch_scc0 G_ENTRY
    v_lshrrev_b32 v1, 6, v0
    v_and_b32 v0, 63, v0
    s_lshr_b32 s21, s20, 5
    v_readfirstlane_b32 s24, v1
    s_xor_b32 s22, s20, 0
    s_and_b32 s22, s22, 31
    s_mov_b32 s25, 0
    s_mov_b32 s26, 300000
    s_mov_b32 s40, 1040356334
    s_mov_b32 s41, 3187839982
    s_mov_b32 s31, 0x05040100
    s_mov_b32 s42, 0x07060302
    s_and_b32 s49, s24, 3
    v_and_b32 v28, 15, v0
    v_lshrrev_b32 v29, 4, v0
    v_mov_b32 v1, 0x4444
    v_mov_b32 v6, 0xeeee
    v_cmp_lt_u32 vcc, 7, v28
    s_nop 1
    v_cndmask_b32 v1, v1, v6, vcc
    s_mov_b32 s43, 0
    s_mov_b32 s36, 0
    s_mov_b32 s37, 2105344
    v_and_b32 v6, 1, v29
    v_lshlrev_b32 v6, 2, v6
    v_lshrrev_b32 v30, 1, v29
    v_lshl_add_u32 v6, v30, 4, v6
    s_lshl_b32 s33, s49, 8
    v_add_u32 v6, s33, v6
    s_cmp_lt_u32 s24, 4
    s_cbranch_scc1 R_Q
    v_lshlrev_b32 v6, 13, v6
    v_lshl_add_u32 v5, v28, 2, v6
    s_load_dwordx2 s[4:5], s[0:1], 16
    s_xor_b32 s38, s20, 0
    s_lshl_b32 s38, s38, 6
    v_add_u32 v6, s38, v5
    s_waitcnt lgkmcnt(0)
    s_mov_b32 s12, s4
    s_and_b32 s13, s5, 0xffff
    s_mov_b32 s14, 8388608
    s_mov_b32 s15, 0x20000
    s_mov_b32 s33, 0
    s_mov_b32 s38, 8192
    buffer_load_dword v64, v6, s[12:15], s33 offen nt
    buffer_load_dword v72, v6, s[12:15], s38 offen nt
    s_mov_b32 s33, 65536
    s_mov_b32 s38, 73728
    buffer_load_dword v65, v6, s[12:15], s33 offen nt
    buffer_load_dword v73, v6, s[12:15], s38 offen nt
    s_mov_b32 s33, 16384
    s_mov_b32 s38, 24576
    buffer_load_dword v66, v6, s[12:15], s33 offen nt
    buffer_load_dword v74, v6, s[12:15], s38 offen nt
    s_mov_b32 s33, 81920
    s_mov_b32 s38, 90112
    buffer_load_dword v67, v6, s[12:15], s33 offen nt
    buffer_load_dword v75, v6, s[12:15], s38 offen nt
    s_mov_b32 s33, 262144
    s_mov_b32 s38, 270336
    buffer_load_dword v68, v6, s[12:15], s33 offen nt
    buffer_load_dword v76, v6, s[12:15], s38 offen nt
    s_mov_b32 s33, 327680
    s_mov_b32 s38, 335872
    buffer_load_dword v69, v6, s[12:15], s33 offen nt
    buffer_load_dword v77, v6, s[12:15], s38 offen nt
    s_mov_b32 s33, 278528
    s_mov_b32 s38, 286720
    buffer_load_dword v70, v6, s[12:15], s33 offen nt
    buffer_load_dword v78, v6, s[12:15], s38 offen nt
    s_mov_b32 s33, 344064
    s_mov_b32 s38, 352256
    buffer_load_dword v71, v6, s[12:15], s33 offen nt
    buffer_load_dword v79, v6, s[12:15], s38 offen nt
    s_waitcnt vmcnt(44)
    s_mov_b32 s33, 524288
    s_mov_b32 s38, 532480
    buffer_load_dword v112, v6, s[12:15], s33 offen nt
    buffer_load_dword v120, v6, s[12:15], s38 offen nt
    s_mov_b32 s33, 589824
    s_mov_b32 s38, 598016
    buffer_load_dword v113, v6, s[12:15], s33 offen nt
    buffer_load_dword v121, v6, s[12:15], s38 offen nt
    s_mov_b32 s33, 540672
    s_mov_b32 s38, 548864
    buffer_load_dword v114, v6, s[12:15], s33 offen nt
    buffer_load_dword v122, v6, s[12:15], s38 offen nt
    s_mov_b32 s33, 606208
    s_mov_b32 s38, 614400
    buffer_load_dword v115, v6, s[12:15], s33 offen nt
    buffer_load_dword v123, v6, s[12:15], s38 offen nt
    s_mov_b32 s33, 786432
    s_mov_b32 s38, 794624
    buffer_load_dword v116, v6, s[12:15], s33 offen nt
    buffer_load_dword v124, v6, s[12:15], s38 offen nt
    s_mov_b32 s33, 851968
    s_mov_b32 s38, 860160
    buffer_load_dword v117, v6, s[12:15], s33 offen nt
    buffer_load_dword v125, v6, s[12:15], s38 offen nt
    s_mov_b32 s33, 802816
    s_mov_b32 s38, 811008
    buffer_load_dword v118, v6, s[12:15], s33 offen nt
    buffer_load_dword v126, v6, s[12:15], s38 offen nt
    s_mov_b32 s33, 868352
    s_mov_b32 s38, 876544
    buffer_load_dword v119, v6, s[12:15], s33 offen nt
    buffer_load_dword v127, v6, s[12:15], s38 offen nt
    s_waitcnt vmcnt(44)
    s_mov_b32 s33, 1048576
    s_mov_b32 s38, 1056768
    buffer_load_dword v160, v6, s[12:15], s33 offen nt
    buffer_load_dword v168, v6, s[12:15], s38 offen nt
    s_mov_b32 s33, 1114112
    s_mov_b32 s38, 1122304
    buffer_load_dword v161, v6, s[12:15], s33 offen nt
    buffer_load_dword v169, v6, s[12:15], s38 offen nt
    s_mov_b32 s33, 1064960
    s_mov_b32 s38, 1073152
    buffer_load_dword v162, v6, s[12:15], s33 offen nt
    buffer_load_dword v170, v6, s[12:15], s38 offen nt
    s_mov_b32 s33, 1130496
    s_mov_b32 s38, 1138688
    buffer_load_dword v163, v6, s[12:15], s33 offen nt
    buffer_load_dword v171, v6, s[12:15], s38 offen nt
    s_mov_b32 s33, 1310720
    s_mov_b32 s38, 1318912
    buffer_load_dword v164, v6, s[12:15], s33 offen nt
    buffer_load_dword v172, v6, s[12:15], s38 offen nt
    s_mov_b32 s33, 1376256
    s_mov_b32 s38, 1384448
    buffer_load_dword v165, v6, s[12:15], s33 offen nt
    buffer_load_dword v173, v6, s[12:15], s38 offen nt
    s_mov_b32 s33, 1327104
    s_mov_b32 s38, 1335296
    buffer_load_dword v166, v6, s[12:15], s33 offen nt
    buffer_load_dword v174, v6, s[12:15], s38 offen nt
    s_mov_b32 s33, 1392640
    s_mov_b32 s38, 1400832
    buffer_load_dword v167, v6, s[12:15], s33 offen nt
    buffer_load_dword v175, v6, s[12:15], s38 offen nt
    s_waitcnt vmcnt(44)
    s_mov_b32 s33, 1572864
    s_mov_b32 s38, 1581056
    buffer_load_dword v208, v6, s[12:15], s33 offen nt
    buffer_load_dword v216, v6, s[12:15], s38 offen nt
    s_mov_b32 s33, 1638400
    s_mov_b32 s38, 1646592
    buffer_load_dword v209, v6, s[12:15], s33 offen nt
    buffer_load_dword v217, v6, s[12:15], s38 offen nt
    s_mov_b32 s33, 1589248
    s_mov_b32 s38, 1597440
    buffer_load_dword v210, v6, s[12:15], s33 offen nt
    buffer_load_dword v218, v6, s[12:15], s38 offen nt
    s_mov_b32 s33, 1654784
    s_mov_b32 s38, 1662976
    buffer_load_dword v211, v6, s[12:15], s33 offen nt
    buffer_load_dword v219, v6, s[12:15], s38 offen nt
    s_mov_b32 s33, 1835008
    s_mov_b32 s38, 1843200
    buffer_load_dword v212, v6, s[12:15], s33 offen nt
    buffer_load_dword v220, v6, s[12:15], s38 offen nt
    s_mov_b32 s33, 1900544
    s_mov_b32 s38, 1908736
    buffer_load_dword v213, v6, s[12:15], s33 offen nt
    buffer_load_dword v221, v6, s[12:15], s38 offen nt
    s_mov_b32 s33, 1851392
    s_mov_b32 s38, 1859584
    buffer_load_dword v214, v6, s[12:15], s33 offen nt
    buffer_load_dword v222, v6, s[12:15], s38 offen nt
    s_mov_b32 s33, 1916928
    s_mov_b32 s38, 1925120
    buffer_load_dword v215, v6, s[12:15], s33 offen nt
    buffer_load_dword v223, v6, s[12:15], s38 offen nt
    s_waitcnt vmcnt(44)
    s_load_dwordx2 s[4:5], s[0:1], 24
    s_xor_b32 s38, s20, 0
    s_lshl_b32 s38, s38, 6
    v_add_u32 v6, s38, v5
    s_waitcnt lgkmcnt(0)
    s_mov_b32 s12, s4
    s_and_b32 s13, s5, 0xffff
    s_mov_b32 s14, 8388608
    s_mov_b32 s15, 0x20000
    s_mov_b32 s33, 0
    s_mov_b32 s38, 8192
    buffer_load_dword v80, v6, s[12:15], s33 offen
    buffer_load_dword v88, v6, s[12:15], s38 offen
    s_mov_b32 s33, 65536
    s_mov_b32 s38, 73728
    buffer_load_dword v81, v6, s[12:15], s33 offen
    buffer_load_dword v89, v6, s[12:15], s38 offen
    s_mov_b32 s33, 16384
    s_mov_b32 s38, 24576
    buffer_load_dword v82, v6, s[12:15], s33 offen
    buffer_load_dword v90, v6, s[12:15], s38 offen
    s_mov_b32 s33, 81920
    s_mov_b32 s38, 90112
    buffer_load_dword v83, v6, s[12:15], s33 offen
    buffer_load_dword v91, v6, s[12:15], s38 offen
    s_mov_b32 s33, 262144
    s_mov_b32 s38, 270336
    buffer_load_dword v84, v6, s[12:15], s33 offen
    buffer_load_dword v92, v6, s[12:15], s38 offen
    s_mov_b32 s33, 327680
    s_mov_b32 s38, 335872
    buffer_load_dword v85, v6, s[12:15], s33 offen
    buffer_load_dword v93, v6, s[12:15], s38 offen
    s_mov_b32 s33, 278528
    s_mov_b32 s38, 286720
    buffer_load_dword v86, v6, s[12:15], s33 offen
    buffer_load_dword v94, v6, s[12:15], s38 offen
    s_mov_b32 s33, 344064
    s_mov_b32 s38, 352256
    buffer_load_dword v87, v6, s[12:15], s33 offen
    buffer_load_dword v95, v6, s[12:15], s38 offen
    s_waitcnt vmcnt(44)
    s_mov_b32 s33, 524288
    s_mov_b32 s38, 532480
    buffer_load_dword v128, v6, s[12:15], s33 offen
    buffer_load_dword v136, v6, s[12:15], s38 offen
    s_mov_b32 s33, 589824
    s_mov_b32 s38, 598016
    buffer_load_dword v129, v6, s[12:15], s33 offen
    buffer_load_dword v137, v6, s[12:15], s38 offen
    s_mov_b32 s33, 540672
    s_mov_b32 s38, 548864
    buffer_load_dword v130, v6, s[12:15], s33 offen
    buffer_load_dword v138, v6, s[12:15], s38 offen
    s_mov_b32 s33, 606208
    s_mov_b32 s38, 614400
    buffer_load_dword v131, v6, s[12:15], s33 offen
    buffer_load_dword v139, v6, s[12:15], s38 offen
    s_mov_b32 s33, 786432
    s_mov_b32 s38, 794624
    buffer_load_dword v132, v6, s[12:15], s33 offen
    buffer_load_dword v140, v6, s[12:15], s38 offen
    s_mov_b32 s33, 851968
    s_mov_b32 s38, 860160
    buffer_load_dword v133, v6, s[12:15], s33 offen
    buffer_load_dword v141, v6, s[12:15], s38 offen
    s_mov_b32 s33, 802816
    s_mov_b32 s38, 811008
    buffer_load_dword v134, v6, s[12:15], s33 offen
    buffer_load_dword v142, v6, s[12:15], s38 offen
    s_mov_b32 s33, 868352
    s_mov_b32 s38, 876544
    buffer_load_dword v135, v6, s[12:15], s33 offen
    buffer_load_dword v143, v6, s[12:15], s38 offen
    s_waitcnt vmcnt(44)
    s_mov_b32 s33, 1048576
    s_mov_b32 s38, 1056768
    buffer_load_dword v176, v6, s[12:15], s33 offen
    buffer_load_dword v184, v6, s[12:15], s38 offen
    s_mov_b32 s33, 1114112
    s_mov_b32 s38, 1122304
    buffer_load_dword v177, v6, s[12:15], s33 offen
    buffer_load_dword v185, v6, s[12:15], s38 offen
    s_mov_b32 s33, 1064960
    s_mov_b32 s38, 1073152
    buffer_load_dword v178, v6, s[12:15], s33 offen
    buffer_load_dword v186, v6, s[12:15], s38 offen
    s_mov_b32 s33, 1130496
    s_mov_b32 s38, 1138688
    buffer_load_dword v179, v6, s[12:15], s33 offen
    buffer_load_dword v187, v6, s[12:15], s38 offen
    s_mov_b32 s33, 1310720
    s_mov_b32 s38, 1318912
    buffer_load_dword v180, v6, s[12:15], s33 offen
    buffer_load_dword v188, v6, s[12:15], s38 offen
    s_mov_b32 s33, 1376256
    s_mov_b32 s38, 1384448
    buffer_load_dword v181, v6, s[12:15], s33 offen
    buffer_load_dword v189, v6, s[12:15], s38 offen
    s_mov_b32 s33, 1327104
    s_mov_b32 s38, 1335296
    buffer_load_dword v182, v6, s[12:15], s33 offen
    buffer_load_dword v190, v6, s[12:15], s38 offen
    s_mov_b32 s33, 1392640
    s_mov_b32 s38, 1400832
    buffer_load_dword v183, v6, s[12:15], s33 offen
    buffer_load_dword v191, v6, s[12:15], s38 offen
    s_waitcnt vmcnt(44)
    s_mov_b32 s33, 1572864
    s_mov_b32 s38, 1581056
    buffer_load_dword v224, v6, s[12:15], s33 offen
    buffer_load_dword v232, v6, s[12:15], s38 offen
    s_mov_b32 s33, 1638400
    s_mov_b32 s38, 1646592
    buffer_load_dword v225, v6, s[12:15], s33 offen
    buffer_load_dword v233, v6, s[12:15], s38 offen
    s_mov_b32 s33, 1589248
    s_mov_b32 s38, 1597440
    buffer_load_dword v226, v6, s[12:15], s33 offen
    buffer_load_dword v234, v6, s[12:15], s38 offen
    s_mov_b32 s33, 1654784
    s_mov_b32 s38, 1662976
    buffer_load_dword v227, v6, s[12:15], s33 offen
    buffer_load_dword v235, v6, s[12:15], s38 offen
    s_mov_b32 s33, 1835008
    s_mov_b32 s38, 1843200
    buffer_load_dword v228, v6, s[12:15], s33 offen
    buffer_load_dword v236, v6, s[12:15], s38 offen
    s_mov_b32 s33, 1900544
    s_mov_b32 s38, 1908736
    buffer_load_dword v229, v6, s[12:15], s33 offen
    buffer_load_dword v237, v6, s[12:15], s38 offen
    s_mov_b32 s33, 1851392
    s_mov_b32 s38, 1859584
    buffer_load_dword v230, v6, s[12:15], s33 offen
    buffer_load_dword v238, v6, s[12:15], s38 offen
    s_mov_b32 s33, 1916928
    s_mov_b32 s38, 1925120
    buffer_load_dword v231, v6, s[12:15], s33 offen
    buffer_load_dword v239, v6, s[12:15], s38 offen
    s_waitcnt vmcnt(44)
    s_load_dwordx2 s[4:5], s[0:1], 32
    s_xor_b32 s38, s20, 0
    s_lshl_b32 s38, s38, 6
    v_add_u32 v6, s38, v5
    s_waitcnt lgkmcnt(0)
    s_mov_b32 s12, s4
    s_and_b32 s13, s5, 0xffff
    s_mov_b32 s14, 8388608
    s_mov_b32 s15, 0x20000
    s_mov_b32 s33, 0
    s_mov_b32 s38, 8192
    buffer_load_dword v96, v6, s[12:15], s33 offen
    buffer_load_dword v104, v6, s[12:15], s38 offen
    s_mov_b32 s33, 65536
    s_mov_b32 s38, 73728
    buffer_load_dword v97, v6, s[12:15], s33 offen
    buffer_load_dword v105, v6, s[12:15], s38 offen
    s_mov_b32 s33, 16384
    s_mov_b32 s38, 24576
    buffer_load_dword v98, v6, s[12:15], s33 offen
    buffer_load_dword v106, v6, s[12:15], s38 offen
    s_mov_b32 s33, 81920
    s_mov_b32 s38, 90112
    buffer_load_dword v99, v6, s[12:15], s33 offen
    buffer_load_dword v107, v6, s[12:15], s38 offen
    s_mov_b32 s33, 262144
    s_mov_b32 s38, 270336
    buffer_load_dword v100, v6, s[12:15], s33 offen
    buffer_load_dword v108, v6, s[12:15], s38 offen
    s_mov_b32 s33, 327680
    s_mov_b32 s38, 335872
    buffer_load_dword v101, v6, s[12:15], s33 offen
    buffer_load_dword v109, v6, s[12:15], s38 offen
    s_mov_b32 s33, 278528
    s_mov_b32 s38, 286720
    buffer_load_dword v102, v6, s[12:15], s33 offen
    buffer_load_dword v110, v6, s[12:15], s38 offen
    s_mov_b32 s33, 344064
    s_mov_b32 s38, 352256
    buffer_load_dword v103, v6, s[12:15], s33 offen
    buffer_load_dword v111, v6, s[12:15], s38 offen
    s_waitcnt vmcnt(44)
    s_mov_b32 s33, 524288
    s_mov_b32 s38, 532480
    buffer_load_dword v144, v6, s[12:15], s33 offen
    buffer_load_dword v152, v6, s[12:15], s38 offen
    s_mov_b32 s33, 589824
    s_mov_b32 s38, 598016
    buffer_load_dword v145, v6, s[12:15], s33 offen
    buffer_load_dword v153, v6, s[12:15], s38 offen
    s_mov_b32 s33, 540672
    s_mov_b32 s38, 548864
    buffer_load_dword v146, v6, s[12:15], s33 offen
    buffer_load_dword v154, v6, s[12:15], s38 offen
    s_mov_b32 s33, 606208
    s_mov_b32 s38, 614400
    buffer_load_dword v147, v6, s[12:15], s33 offen
    buffer_load_dword v155, v6, s[12:15], s38 offen
    s_mov_b32 s33, 786432
    s_mov_b32 s38, 794624
    buffer_load_dword v148, v6, s[12:15], s33 offen
    buffer_load_dword v156, v6, s[12:15], s38 offen
    s_mov_b32 s33, 851968
    s_mov_b32 s38, 860160
    buffer_load_dword v149, v6, s[12:15], s33 offen
    buffer_load_dword v157, v6, s[12:15], s38 offen
    s_mov_b32 s33, 802816
    s_mov_b32 s38, 811008
    buffer_load_dword v150, v6, s[12:15], s33 offen
    buffer_load_dword v158, v6, s[12:15], s38 offen
    s_mov_b32 s33, 868352
    s_mov_b32 s38, 876544
    buffer_load_dword v151, v6, s[12:15], s33 offen
    buffer_load_dword v159, v6, s[12:15], s38 offen
    s_waitcnt vmcnt(44)
    s_mov_b32 s33, 1048576
    s_mov_b32 s38, 1056768
    buffer_load_dword v192, v6, s[12:15], s33 offen
    buffer_load_dword v200, v6, s[12:15], s38 offen
    s_mov_b32 s33, 1114112
    s_mov_b32 s38, 1122304
    buffer_load_dword v193, v6, s[12:15], s33 offen
    buffer_load_dword v201, v6, s[12:15], s38 offen
    s_mov_b32 s33, 1064960
    s_mov_b32 s38, 1073152
    buffer_load_dword v194, v6, s[12:15], s33 offen
    buffer_load_dword v202, v6, s[12:15], s38 offen
    s_mov_b32 s33, 1130496
    s_mov_b32 s38, 1138688
    buffer_load_dword v195, v6, s[12:15], s33 offen
    buffer_load_dword v203, v6, s[12:15], s38 offen
    s_mov_b32 s33, 1310720
    s_mov_b32 s38, 1318912
    buffer_load_dword v196, v6, s[12:15], s33 offen
    buffer_load_dword v204, v6, s[12:15], s38 offen
    s_mov_b32 s33, 1376256
    s_mov_b32 s38, 1384448
    buffer_load_dword v197, v6, s[12:15], s33 offen
    buffer_load_dword v205, v6, s[12:15], s38 offen
    s_mov_b32 s33, 1327104
    s_mov_b32 s38, 1335296
    buffer_load_dword v198, v6, s[12:15], s33 offen
    buffer_load_dword v206, v6, s[12:15], s38 offen
    s_mov_b32 s33, 1392640
    s_mov_b32 s38, 1400832
    buffer_load_dword v199, v6, s[12:15], s33 offen
    buffer_load_dword v207, v6, s[12:15], s38 offen
    s_waitcnt vmcnt(44)
    s_mov_b32 s33, 1572864
    s_mov_b32 s38, 1581056
    buffer_load_dword v240, v6, s[12:15], s33 offen
    buffer_load_dword v248, v6, s[12:15], s38 offen
    s_mov_b32 s33, 1638400
    s_mov_b32 s38, 1646592
    buffer_load_dword v241, v6, s[12:15], s33 offen
    buffer_load_dword v249, v6, s[12:15], s38 offen
    s_mov_b32 s33, 1589248
    s_mov_b32 s38, 1597440
    buffer_load_dword v242, v6, s[12:15], s33 offen
    buffer_load_dword v250, v6, s[12:15], s38 offen
    s_mov_b32 s33, 1654784
    s_mov_b32 s38, 1662976
    buffer_load_dword v243, v6, s[12:15], s33 offen
    buffer_load_dword v251, v6, s[12:15], s38 offen
    s_mov_b32 s33, 1835008
    s_mov_b32 s38, 1843200
    buffer_load_dword v244, v6, s[12:15], s33 offen
    buffer_load_dword v252, v6, s[12:15], s38 offen
    s_mov_b32 s33, 1900544
    s_mov_b32 s38, 1908736
    buffer_load_dword v245, v6, s[12:15], s33 offen
    buffer_load_dword v253, v6, s[12:15], s38 offen
    s_mov_b32 s33, 1851392
    s_mov_b32 s38, 1859584
    buffer_load_dword v246, v6, s[12:15], s33 offen
    buffer_load_dword v254, v6, s[12:15], s38 offen
    s_mov_b32 s33, 1916928
    s_mov_b32 s38, 1925120
    buffer_load_dword v247, v6, s[12:15], s33 offen
    buffer_load_dword v255, v6, s[12:15], s38 offen
    s_waitcnt vmcnt(44)
    v_mov_b32 v12, -1
    v_mov_b32 v13, -1
    v_mov_b32 v14, -1
    v_mov_b32 v15, -1
    s_lshl_b32 s33, s21, 1
    s_lshr_b32 s38, s49, 1
    s_add_u32 s33, s33, s38
    s_lshl_b32 s33, s33, 14
    s_and_b32 s38, s49, 1
    s_lshl_b32 s38, s38, 12
    s_add_u32 s33, s33, s38
    s_add_u32 s33, s33, 1048576
    v_lshl_add_u32 v2, v0, 4, s33
    v_bfe_u32 v31, v0, 1, 2
    v_lshlrev_b32 v31, 2, v31
    v_bfe_u32 v30, v0, 3, 1
    v_lshl_add_u32 v31, v30, 1, v31
    v_and_b32 v30, 1, v0
    v_add_u32 v31, v31, v30
    v_and_b32 v30, 1, v29
    v_lshlrev_b32 v3, 11, v30
    v_lshrrev_b32 v30, 1, v29
    v_lshl_add_u32 v3, v30, 8, v3
    v_lshl_add_u32 v3, v31, 4, v3
    s_lshl_b32 s33, s49, 9
    v_add_u32 v3, s33, v3
    v_lshrrev_b32 v30, 2, v28
    v_lshlrev_b32 v30, 1, v30
    v_and_b32 v5, 1, v28
    v_add_u32 v30, v30, v5
    v_and_b32 v5, 2, v28
    v_lshl_add_u32 v30, v5, 2, v30
    v_and_b32 v5, 1, v30
    v_lshlrev_b32 v5, 4, v5
    v_mov_b32 v20, 0x3f80
    v_lshlrev_b32 v5, v5, v20
    v_lshrrev_b32 v20, 1, v30
    v_cmp_eq_u32 vcc, 0, v20
    s_nop 1
    v_cndmask_b32 v16, 0, v5, vcc
    v_cmp_eq_u32 vcc, 1, v20
    s_nop 1
    v_cndmask_b32 v17, 0, v5, vcc
    v_cmp_eq_u32 vcc, 2, v20
    s_nop 1
    v_cndmask_b32 v18, 0, v5, vcc
    v_cmp_eq_u32 vcc, 3, v20
    s_nop 1
    v_cndmask_b32 v19, 0, v5, vcc
    s_lshr_b32 s27, s20, 4
    s_lshl_b32 s27, s27, 14
    s_and_b32 s38, s20, 15
    s_lshl_b32 s38, s38, 9
    s_add_u32 s27, s27, s38
    s_xor_b32 s30, s27, 0
    s_lshr_b32 s28, s20, 3
    s_lshl_b32 s28, s28, 14
    s_and_b32 s38, s20, 4
    s_lshl_b32 s38, s38, 10
    s_add_u32 s28, s28, s38
    s_and_b32 s38, s20, 3
    s_lshl_b32 s38, s38, 10
    s_add_u32 s28, s28, s38
    s_cmp_lt_u32 s49, 2
    s_cselect_b32 s35, 0, 0
    s_xor_b32 s35, s35, s20
    s_lshr_b32 s39, s35, 3
    s_lshl_b32 s39, s39, 14
    s_and_b32 s38, s35, 7
    s_lshl_b32 s38, s38, 10
    s_add_u32 s39, s39, s38
    s_lshl_b32 s38, s49, 6
    s_add_u32 s39, s39, s38
    v_lshl_add_u32 v7, v29, 4, s39
    v_lshrrev_b32 v30, 2, v28
    v_lshl_add_u32 v7, v30, 8, v7
    v_and_b32 v30, 3, v28
    v_lshl_add_u32 v7, v30, 2, v7
    s_lshl_b32 s33, s49, 11
    v_lshl_add_u32 v4, v0, 4, s33
    v_lshl_add_u32 v8, v0, 4, s28
    s_cmp_eq_u32 s49, 1
    s_cbranch_scc0 RP_A2
    v_and_b32 v30, 31, v0
    s_add_u32 s33, s30, 1048576
    s_add_u32 s38, s27, 1572864
    v_lshl_add_u32 v8, v30, 4, s33
    v_lshl_add_u32 v30, v30, 4, s38
    v_cmp_lt_u32 vcc, 31, v0
    s_nop 1
    v_cndmask_b32 v8, v8, v30, vcc
RP_A2:
    s_waitcnt vmcnt(0)
    s_barrier
    v_perm_b32 v6, v72, v64, s31
    v_perm_b32 v72, v72, v64, s42
    v_mov_b32 v64, v6
    v_perm_b32 v6, v73, v65, s31
    v_perm_b32 v73, v73, v65, s42
    v_mov_b32 v65, v6
    v_perm_b32 v6, v74, v66, s31
    v_perm_b32 v74, v74, v66, s42
    v_mov_b32 v66, v6
    v_perm_b32 v6, v75, v67, s31
    v_perm_b32 v75, v75, v67, s42
    v_mov_b32 v67, v6
    v_perm_b32 v6, v76, v68, s31
    v_perm_b32 v76, v76, v68, s42
    v_mov_b32 v68, v6
    v_perm_b32 v6, v77, v69, s31
    v_perm_b32 v77, v77, v69, s42
    v_mov_b32 v69, v6
    v_perm_b32 v6, v78, v70, s31
    v_perm_b32 v78, v78, v70, s42
    v_mov_b32 v70, v6
    v_perm_b32 v6, v79, v71, s31
    v_perm_b32 v79, v79, v71, s42
    v_mov_b32 v71, v6
    v_perm_b32 v6, v120, v112, s31
    v_perm_b32 v120, v120, v112, s42
    v_mov_b32 v112, v6
    v_perm_b32 v6, v121, v113, s31
    v_perm_b32 v121, v121, v113, s42
    v_mov_b32 v113, v6
    v_perm_b32 v6, v122, v114, s31
    v_perm_b32 v122, v122, v114, s42
    v_mov_b32 v114, v6
    v_perm_b32 v6, v123, v115, s31
    v_perm_b32 v123, v123, v115, s42
    v_mov_b32 v115, v6
    v_perm_b32 v6, v124, v116, s31
    v_perm_b32 v124, v124, v116, s42
    v_mov_b32 v116, v6
    v_perm_b32 v6, v125, v117, s31
    v_perm_b32 v125, v125, v117, s42
    v_mov_b32 v117, v6
    v_perm_b32 v6, v126, v118, s31
    v_perm_b32 v126, v126, v118, s42
    v_mov_b32 v118, v6
    v_perm_b32 v6, v127, v119, s31
    v_perm_b32 v127, v127, v119, s42
    v_mov_b32 v119, v6
    v_perm_b32 v6, v168, v160, s31
    v_perm_b32 v168, v168, v160, s42
    v_mov_b32 v160, v6
    v_perm_b32 v6, v169, v161, s31
    v_perm_b32 v169, v169, v161, s42
    v_mov_b32 v161, v6
    v_perm_b32 v6, v170, v162, s31
    v_perm_b32 v170, v170, v162, s42
    v_mov_b32 v162, v6
    v_perm_b32 v6, v171, v163, s31
    v_perm_b32 v171, v171, v163, s42
    v_mov_b32 v163, v6
    v_perm_b32 v6, v172, v164, s31
    v_perm_b32 v172, v172, v164, s42
    v_mov_b32 v164, v6
    v_perm_b32 v6, v173, v165, s31
    v_perm_b32 v173, v173, v165, s42
    v_mov_b32 v165, v6
    v_perm_b32 v6, v174, v166, s31
    v_perm_b32 v174, v174, v166, s42
    v_mov_b32 v166, v6
    v_perm_b32 v6, v175, v167, s31
    v_perm_b32 v175, v175, v167, s42
    v_mov_b32 v167, v6
    v_perm_b32 v6, v216, v208, s31
    v_perm_b32 v216, v216, v208, s42
    v_mov_b32 v208, v6
    v_perm_b32 v6, v217, v209, s31
    v_perm_b32 v217, v217, v209, s42
    v_mov_b32 v209, v6
    v_perm_b32 v6, v218, v210, s31
    v_perm_b32 v218, v218, v210, s42
    v_mov_b32 v210, v6
    v_perm_b32 v6, v219, v211, s31
    v_perm_b32 v219, v219, v211, s42
    v_mov_b32 v211, v6
    v_perm_b32 v6, v220, v212, s31
    v_perm_b32 v220, v220, v212, s42
    v_mov_b32 v212, v6
    v_perm_b32 v6, v221, v213, s31
    v_perm_b32 v221, v221, v213, s42
    v_mov_b32 v213, v6
    v_perm_b32 v6, v222, v214, s31
    v_perm_b32 v222, v222, v214, s42
    v_mov_b32 v214, v6
    v_perm_b32 v6, v223, v215, s31
    v_perm_b32 v223, v223, v215, s42
    v_mov_b32 v215, v6
    v_perm_b32 v6, v88, v80, s31
    v_perm_b32 v88, v88, v80, s42
    v_mov_b32 v80, v6
    v_perm_b32 v6, v89, v81, s31
    v_perm_b32 v89, v89, v81, s42
    v_mov_b32 v81, v6
    v_perm_b32 v6, v90, v82, s31
    v_perm_b32 v90, v90, v82, s42
    v_mov_b32 v82, v6
    v_perm_b32 v6, v91, v83, s31
    v_perm_b32 v91, v91, v83, s42
    v_mov_b32 v83, v6
    v_perm_b32 v6, v92, v84, s31
    v_perm_b32 v92, v92, v84, s42
    v_mov_b32 v84, v6
    v_perm_b32 v6, v93, v85, s31
    v_perm_b32 v93, v93, v85, s42
    v_mov_b32 v85, v6
    v_perm_b32 v6, v94, v86, s31
    v_perm_b32 v94, v94, v86, s42
    v_mov_b32 v86, v6
    v_perm_b32 v6, v95, v87, s31
    v_perm_b32 v95, v95, v87, s42
    v_mov_b32 v87, v6
    v_perm_b32 v6, v136, v128, s31
    v_perm_b32 v136, v136, v128, s42
    v_mov_b32 v128, v6
    v_perm_b32 v6, v137, v129, s31
    v_perm_b32 v137, v137, v129, s42
    v_mov_b32 v129, v6
    v_perm_b32 v6, v138, v130, s31
    v_perm_b32 v138, v138, v130, s42
    v_mov_b32 v130, v6
    v_perm_b32 v6, v139, v131, s31
    v_perm_b32 v139, v139, v131, s42
    v_mov_b32 v131, v6
    v_perm_b32 v6, v140, v132, s31
    v_perm_b32 v140, v140, v132, s42
    v_mov_b32 v132, v6
    v_perm_b32 v6, v141, v133, s31
    v_perm_b32 v141, v141, v133, s42
    v_mov_b32 v133, v6
    v_perm_b32 v6, v142, v134, s31
    v_perm_b32 v142, v142, v134, s42
    v_mov_b32 v134, v6
    v_perm_b32 v6, v143, v135, s31
    v_perm_b32 v143, v143, v135, s42
    v_mov_b32 v135, v6
    v_perm_b32 v6, v184, v176, s31
    v_perm_b32 v184, v184, v176, s42
    v_mov_b32 v176, v6
    v_perm_b32 v6, v185, v177, s31
    v_perm_b32 v185, v185, v177, s42
    v_mov_b32 v177, v6
    v_perm_b32 v6, v186, v178, s31
    v_perm_b32 v186, v186, v178, s42
    v_mov_b32 v178, v6
    v_perm_b32 v6, v187, v179, s31
    v_perm_b32 v187, v187, v179, s42
    v_mov_b32 v179, v6
    v_perm_b32 v6, v188, v180, s31
    v_perm_b32 v188, v188, v180, s42
    v_mov_b32 v180, v6
    v_perm_b32 v6, v189, v181, s31
    v_perm_b32 v189, v189, v181, s42
    v_mov_b32 v181, v6
    v_perm_b32 v6, v190, v182, s31
    v_perm_b32 v190, v190, v182, s42
    v_mov_b32 v182, v6
    v_perm_b32 v6, v191, v183, s31
    v_perm_b32 v191, v191, v183, s42
    v_mov_b32 v183, v6
    v_perm_b32 v6, v232, v224, s31
    v_perm_b32 v232, v232, v224, s42
    v_mov_b32 v224, v6
    v_perm_b32 v6, v233, v225, s31
    v_perm_b32 v233, v233, v225, s42
    v_mov_b32 v225, v6
    v_perm_b32 v6, v234, v226, s31
    v_perm_b32 v234, v234, v226, s42
    v_mov_b32 v226, v6
    v_perm_b32 v6, v235, v227, s31
    v_perm_b32 v235, v235, v227, s42
    v_mov_b32 v227, v6
    v_perm_b32 v6, v236, v228, s31
    v_perm_b32 v236, v236, v228, s42
    v_mov_b32 v228, v6
    v_perm_b32 v6, v237, v229, s31
    v_perm_b32 v237, v237, v229, s42
    v_mov_b32 v229, v6
    v_perm_b32 v6, v238, v230, s31
    v_perm_b32 v238, v238, v230, s42
    v_mov_b32 v230, v6
    v_perm_b32 v6, v239, v231, s31
    v_perm_b32 v239, v239, v231, s42
    v_mov_b32 v231, v6
    v_perm_b32 v6, v104, v96, s31
    v_perm_b32 v104, v104, v96, s42
    v_mov_b32 v96, v6
    v_perm_b32 v6, v105, v97, s31
    v_perm_b32 v105, v105, v97, s42
    v_mov_b32 v97, v6
    v_perm_b32 v6, v106, v98, s31
    v_perm_b32 v106, v106, v98, s42
    v_mov_b32 v98, v6
    v_perm_b32 v6, v107, v99, s31
    v_perm_b32 v107, v107, v99, s42
    v_mov_b32 v99, v6
    v_perm_b32 v6, v108, v100, s31
    v_perm_b32 v108, v108, v100, s42
    v_mov_b32 v100, v6
    v_perm_b32 v6, v109, v101, s31
    v_perm_b32 v109, v109, v101, s42
    v_mov_b32 v101, v6
    v_perm_b32 v6, v110, v102, s31
    v_perm_b32 v110, v110, v102, s42
    v_mov_b32 v102, v6
    v_perm_b32 v6, v111, v103, s31
    v_perm_b32 v111, v111, v103, s42
    v_mov_b32 v103, v6
    v_perm_b32 v6, v152, v144, s31
    v_perm_b32 v152, v152, v144, s42
    v_mov_b32 v144, v6
    v_perm_b32 v6, v153, v145, s31
    v_perm_b32 v153, v153, v145, s42
    v_mov_b32 v145, v6
    v_perm_b32 v6, v154, v146, s31
    v_perm_b32 v154, v154, v146, s42
    v_mov_b32 v146, v6
    v_perm_b32 v6, v155, v147, s31
    v_perm_b32 v155, v155, v147, s42
    v_mov_b32 v147, v6
    v_perm_b32 v6, v156, v148, s31
    v_perm_b32 v156, v156, v148, s42
    v_mov_b32 v148, v6
    v_perm_b32 v6, v157, v149, s31
    v_perm_b32 v157, v157, v149, s42
    v_mov_b32 v149, v6
    v_perm_b32 v6, v158, v150, s31
    v_perm_b32 v158, v158, v150, s42
    v_mov_b32 v150, v6
    v_perm_b32 v6, v159, v151, s31
    v_perm_b32 v159, v159, v151, s42
    v_mov_b32 v151, v6
    v_perm_b32 v6, v200, v192, s31
    v_perm_b32 v200, v200, v192, s42
    v_mov_b32 v192, v6
    v_perm_b32 v6, v201, v193, s31
    v_perm_b32 v201, v201, v193, s42
    v_mov_b32 v193, v6
    v_perm_b32 v6, v202, v194, s31
    v_perm_b32 v202, v202, v194, s42
    v_mov_b32 v194, v6
    v_perm_b32 v6, v203, v195, s31
    v_perm_b32 v203, v203, v195, s42
    v_mov_b32 v195, v6
    v_perm_b32 v6, v204, v196, s31
    v_perm_b32 v204, v204, v196, s42
    v_mov_b32 v196, v6
    v_perm_b32 v6, v205, v197, s31
    v_perm_b32 v205, v205, v197, s42
    v_mov_b32 v197, v6
    v_perm_b32 v6, v206, v198, s31
    v_perm_b32 v206, v206, v198, s42
    v_mov_b32 v198, v6
    v_perm_b32 v6, v207, v199, s31
    v_perm_b32 v207, v207, v199, s42
    v_mov_b32 v199, v6
    v_perm_b32 v6, v248, v240, s31
    v_perm_b32 v248, v248, v240, s42
    v_mov_b32 v240, v6
    v_perm_b32 v6, v249, v241, s31
    v_perm_b32 v249, v249, v241, s42
    v_mov_b32 v241, v6
    v_perm_b32 v6, v250, v242, s31
    v_perm_b32 v250, v250, v242, s42
    v_mov_b32 v242, v6
    v_perm_b32 v6, v251, v243, s31
    v_perm_b32 v251, v251, v243, s42
    v_mov_b32 v243, v6
    v_perm_b32 v6, v252, v244, s31
    v_perm_b32 v252, v252, v244, s42
    v_mov_b32 v244, v6
    v_perm_b32 v6, v253, v245, s31
    v_perm_b32 v253, v253, v245, s42
    v_mov_b32 v245, v6
    v_perm_b32 v6, v254, v246, s31
    v_perm_b32 v254, v254, v246, s42
    v_mov_b32 v246, v6
    v_perm_b32 v6, v255, v247, s31
    v_perm_b32 v255, v255, v247, s42
    v_mov_b32 v247, v6
    v_mov_b32 v9, 0
    s_and_b32 s38, s35, 4
    s_lshr_b32 s35, s35, 3
    s_lshl_b32 s35, s35, 14
    s_mul_i32 s38, s38, 3072
    s_add_u32 s35, s35, s38
    s_add_u32 s35, s35, 54525952
    s_mov_b32 s47, 0
    s_barrier
    v_mov_b32 v24, 16384
    ds_read_b64 v[24:25], v24
    s_waitcnt lgkmcnt(0)
    v_readfirstlane_b32 s51, v24
    v_readfirstlane_b32 s43, v25
    s_nop 3
    s_and_b32 s43, s43, 2097152
    s_add_u32 s8, s44, s43
    s_addc_u32 s9, s45, 0
    s_and_b32 s9, s9, 0xffff
    s_and_b32 s27, s25, 3
    s_lshl_b32 s27, s27, 17
    s_add_u32 s27, s27, s36
    s_and_b32 s28, s25, 3
    s_lshl_b32 s28, s28, 18
    s_add_u32 s28, s28, s37
    s_cmp_lg_u32 s51, 0
    s_cbranch_scc1 RPs_LOOP
RPf_LOOP:
    s_nop 15
RPf_RETRY:
    buffer_load_dwordx4 v[24:27], v2, s[8:11], s27 offen offset:0 sc1
    v_mov_b32 v40, 0
    v_mov_b32 v41, 0
    v_mov_b32 v42, 0
    v_mov_b32 v43, 0
    v_mov_b32 v44, 0
    v_mov_b32 v45, 0
    v_mov_b32 v46, 0
    v_mov_b32 v47, 0
    s_nop 5
    buffer_load_dwordx4 v[28:31], v2, s[8:11], s27 offen offset:1024 sc1
    v_mov_b32 v48, 0
    v_mov_b32 v49, 0
    v_mov_b32 v50, 0
    v_mov_b32 v51, 0
    v_mov_b32 v52, 0
    v_mov_b32 v53, 0
    v_mov_b32 v54, 0
    v_mov_b32 v55, 0
    s_nop 5
    buffer_load_dwordx4 v[32:35], v2, s[8:11], s27 offen offset:2048 sc1
    v_mov_b32 v56, 0
    v_mov_b32 v57, 0
    v_mov_b32 v58, 0
    v_mov_b32 v59, 0
    v_mov_b32 v60, 0
    v_mov_b32 v61, 0
    v_mov_b32 v62, 0
    v_mov_b32 v63, 0
    s_nop 5
    buffer_load_dwordx4 v[36:39], v2, s[8:11], s27 offen offset:3072 sc1
RPGf_S0123:
    s_waitcnt vmcnt(3)
    v_cmp_eq_u32 vcc, -1, v27
    s_cbranch_vccnz RPGf_S0123_F
RPGf_S0123_OK:
    v_smfmac_f32_16x16x64_bf16 v[40:43], v[24:27], v[64:71], v1
    s_waitcnt vmcnt(2)
    v_cmp_eq_u32 vcc, -1, v31
    v_smfmac_f32_16x16x64_bf16 v[44:47], v[24:27], v[72:79], v1
    v_max_u32 v5, v24, v25
    v_max_u32 v6, v26, v27
    v_smfmac_f32_16x16x64_bf16 v[48:51], v[24:27], v[80:87], v1
    s_cbranch_vccnz RPGf_S0123_T
    v_smfmac_f32_16x16x64_bf16 v[52:55], v[24:27], v[88:95], v1
RPGf_S123_OK:
    v_smfmac_f32_16x16x64_bf16 v[40:43], v[28:31], v[112:119], v1
    s_waitcnt vmcnt(1)
    v_cmp_eq_u32 vcc, -1, v35
    v_smfmac_f32_16x16x64_bf16 v[44:47], v[28:31], v[120:127], v1
    v_max3_u32 v5, v5, v28, v29
    v_max3_u32 v6, v6, v30, v31
    v_smfmac_f32_16x16x64_bf16 v[48:51], v[28:31], v[128:135], v1
    s_cbranch_vccnz RPGf_S123_T
    v_smfmac_f32_16x16x64_bf16 v[52:55], v[28:31], v[136:143], v1
RPGf_S23_OK:
    v_smfmac_f32_16x16x64_bf16 v[40:43], v[32:35], v[160:167], v1
    s_waitcnt vmcnt(0)
    v_cmp_eq_u32 vcc, -1, v39
    v_smfmac_f32_16x16x64_bf16 v[44:47], v[32:35], v[168:175], v1
    v_max3_u32 v5, v5, v32, v33
    v_max3_u32 v6, v6, v34, v35
    v_smfmac_f32_16x16x64_bf16 v[48:51], v[32:35], v[176:183], v1
    s_cbranch_vccnz RPGf_S23_T
    v_smfmac_f32_16x16x64_bf16 v[52:55], v[32:35], v[184:191], v1
RPGf_S3_OK:
    v_smfmac_f32_16x16x64_bf16 v[40:43], v[36:39], v[208:215], v1
    v_max3_u32 v5, v5, v36, v37
    v_max3_u32 v6, v6, v38, v39
    v_smfmac_f32_16x16x64_bf16 v[44:47], v[36:39], v[216:223], v1
    v_smfmac_f32_16x16x64_bf16 v[48:51], v[36:39], v[224:231], v1
    v_smfmac_f32_16x16x64_bf16 v[52:55], v[36:39], v[232:239], v1
RPGf_DONE:
    v_max_u32 v5, v5, v6
    v_cmp_eq_u32 vcc, -1, v5
    v_cvt_pk_bf16_f32 v40, v40, v44
    v_cvt_pk_bf16_f32 v41, v41, v45
    v_cvt_pk_bf16_f32 v42, v42, v46
    v_cvt_pk_bf16_f32 v43, v43, v47
    ds_write_b128 v3, v[40:43] offset:0
    s_cbranch_vccnz RPf_RX
    v_smfmac_f32_16x16x64_bf16 v[56:59], v[24:27], v[96:103], v1
    v_cvt_pk_bf16_f32 v48, v48, v52
    v_cvt_pk_bf16_f32 v49, v49, v53
    v_cvt_pk_bf16_f32 v50, v50, v54
    v_cvt_pk_bf16_f32 v51, v51, v55
    ds_write_b128 v3, v[48:51] offset:4096
    v_smfmac_f32_16x16x64_bf16 v[60:63], v[24:27], v[104:111], v1
    v_smfmac_f32_16x16x64_bf16 v[56:59], v[28:31], v[144:151], v1
    v_smfmac_f32_16x16x64_bf16 v[60:63], v[28:31], v[152:159], v1
    s_waitcnt lgkmcnt(0)
    s_barrier
    ds_read_b128 v[40:43], v4 offset:0
    ds_read_b128 v[44:47], v4 offset:1024
    s_waitcnt lgkmcnt(1)
    v_mfma_f32_16x16x32_bf16 v[20:23], v[16:19], v[40:43], 0
    s_waitcnt lgkmcnt(0)
    v_mfma_f32_16x16x32_bf16 v[20:23], v[16:19], v[44:47], v[20:23]
    v_smfmac_f32_16x16x64_bf16 v[56:59], v[32:35], v[192:199], v1
    v_smfmac_f32_16x16x64_bf16 v[60:63], v[32:35], v[200:207], v1
    s_nop 1
    v_cvt_pk_bf16_f32 v10, v20, v21
    v_min_u32 v10, -2, v10
    buffer_store_dword v10, v7, s[8:11], s28 offen
    v_smfmac_f32_16x16x64_bf16 v[56:59], v[36:39], v[240:247], v1
    v_smfmac_f32_16x16x64_bf16 v[60:63], v[36:39], v[248:255], v1
    s_nop 7
    v_cvt_pk_bf16_f32 v48, v56, v60
    v_cvt_pk_bf16_f32 v49, v57, v61
    v_cvt_pk_bf16_f32 v50, v58, v62
    v_cvt_pk_bf16_f32 v51, v59, v63
    ds_write_b128 v3, v[48:51] offset:8192
    s_waitcnt lgkmcnt(0)
    s_barrier
    s_add_u32 s29, s25, 3
    s_and_b32 s29, s29, 3
    s_lshl_b32 s29, s29, 18
    s_add_u32 s29, s29, s37
    s_add_u32 s33, s25, 3
    s_and_b32 s33, s33, 3
    s_lshl_b32 s33, s33, 17
    s_add_u32 s33, s33, s36
    s_cmp_eq_u32 s49, 1
    s_cselect_b32 s29, s33, s29
    s_add_u32 s25, s25, 1
    s_and_b32 s27, s25, 3
    s_lshl_b32 s27, s27, 17
    s_add_u32 s27, s27, s36
    s_and_b32 s28, s25, 3
    s_lshl_b32 s28, s28, 18
    s_add_u32 s28, s28, s37
    s_cmp_ge_u32 s25, 64
    s_cbranch_scc1 RPf_FIN
    s_barrier
    s_cmp_ge_u32 s49, 2
    s_cbranch_scc1 RPf_NOARM
    buffer_store_dwordx4 v[12:15], v8, s[8:11], s29 offen
    s_branch RPf_NOCP
RPf_NOARM:
    s_lshr_b32 s33, s35, 8
    s_xor_b32 s33, s33, s36
    s_and_b32 s33, s33, 0x2000
    s_add_u32 s33, s33, s35
    buffer_store_dword v10, v7, s[8:11], s33 offen sc1
    s_add_u32 s35, s35, 524288
RPf_NOCP:
    s_add_u32 s38, s25, 0
    s_and_b32 s39, s38, 71
    s_or_b32 s39, s39, s49
    s_cbranch_scc1 RPf_NOKV
    s_lshr_b32 s38, s38, 3
    s_mul_i32 s39, s21, 8
    s_add_u32 s38, s38, s39
    s_lshl_b32 s38, s38, 7
    s_add_u32 s38, s38, 124780544
    buffer_load_dword v6, off, s[8:11], s38 sc1
    s_barrier
RPf_KV:
    s_waitcnt vmcnt(0)
    v_cmp_gt_u32 vcc, 32, v6
    s_cbranch_vccz RPf_KVOK
    s_sleep 2
    buffer_load_dword v6, off, s[8:11], s38 sc1
    s_sub_u32 s26, s26, 1
    s_cbranch_scc1 K_FAIL
    s_branch RPf_KV
RPf_NOKV:
    s_barrier
RPf_KVOK:
    s_waitcnt vmcnt(0)
    s_barrier
    s_barrier
    s_cmp_lg_u32 s47, 0
    s_barrier
    s_branch RPf_LOOP
RPf_FIN:
    s_cmp_lt_u32 s49, 2
    s_cbranch_scc1 RP_END
    s_lshr_b32 s33, s35, 8
    s_xor_b32 s33, s33, s36
    s_and_b32 s33, s33, 0x2000
    s_add_u32 s33, s33, s35
    buffer_store_dword v10, v7, s[8:11], s33 offen sc1
    s_add_u32 s35, s35, 524288
    s_waitcnt vmcnt(0)
    s_branch RP_END
RPf_RX:
    s_sub_u32 s26, s26, 1
    s_cbranch_scc1 K_FAIL
    s_waitcnt vmcnt(0) lgkmcnt(0)
    s_nop 4
    s_branch RPf_RETRY
RQ_PADP0:
    s_branch RQ_PADP1
RPGf_S123:
    s_waitcnt vmcnt(2)
    v_cmp_eq_u32 vcc, -1, v31
    s_cbranch_vccnz RPGf_S123_F
    s_branch RPGf_S123_OK
RQ_PADP1:
    s_branch RQ_PADP2
RPGf_S23:
    s_waitcnt vmcnt(1)
    v_cmp_eq_u32 vcc, -1, v35
    s_cbranch_vccnz RPGf_S23_F
    s_branch RPGf_S23_OK
RQ_PADP2:
    s_branch RQ_PADP3
RPGf_S0123_T:
    v_smfmac_f32_16x16x64_bf16 v[52:55], v[24:27], v[88:95], v1
    s_branch RPGf_S123_F
RQ_PADP3:
    s_branch RQ_PADP4
RPGf_S123_T:
    v_smfmac_f32_16x16x64_bf16 v[52:55], v[28:31], v[136:143], v1
    s_branch RPGf_S23_F
RQ_PADP4:
    s_branch RQ_PADP5
RPGf_S23_T:
    v_smfmac_f32_16x16x64_bf16 v[52:55], v[32:35], v[184:191], v1
    s_branch RPGf_S3_F
RQ_PADP5:
    s_branch RQ_PADP6
RPGf_S0123_F:
    buffer_load_dwordx4 v[24:27], v2, s[8:11], s27 offen offset:0 sc1
    s_sub_u32 s26, s26, 1
    s_cbranch_scc1 K_FAIL
    s_branch RPGf_S1230
RQ_PADP6:
    s_branch RQ_PADP7
RPGf_S123_F:
    buffer_load_dwordx4 v[28:31], v2, s[8:11], s27 offen offset:1024 sc1
    s_sub_u32 s26, s26, 1
    s_cbranch_scc1 K_FAIL
    s_branch RPGf_S231
RQ_PADP7:
    s_branch RQ_PADP8
RPGf_S23_F:
    buffer_load_dwordx4 v[32:35], v2, s[8:11], s27 offen offset:2048 sc1
    s_sub_u32 s26, s26, 1
    s_cbranch_scc1 K_FAIL
    s_branch RPGf_S32
RQ_PADP8:
    s_branch RQ_PADP9
RPGf_S3_F:
    buffer_load_dwordx4 v[36:39], v2, s[8:11], s27 offen offset:3072 sc1
    s_sub_u32 s26, s26, 1
    s_cbranch_scc1 K_FAIL
    s_nop 10
    buffer_load_dwordx4 v[36:39], v2, s[8:11], s27 offen offset:3072 sc1
    s_nop 10
    buffer_load_dwordx4 v[36:39], v2, s[8:11], s27 offen offset:3072 sc1
    s_nop 10
    buffer_load_dwordx4 v[36:39], v2, s[8:11], s27 offen offset:3072 sc1
RPGf_S3_L:
    s_waitcnt vmcnt(3)
    v_max3_u32 v11, v36, v37, v38
    v_max_u32 v11, v11, v39
    v_cmp_eq_u32 vcc, -1, v11
    s_cbranch_vccz RPGf_S3_OK
    buffer_load_dwordx4 v[36:39], v2, s[8:11], s27 offen offset:3072 sc1
    s_sub_u32 s26, s26, 1
    s_cbranch_scc1 K_FAIL
    s_branch RPGf_S3_L
RQ_PADP9:
    s_branch RQ_PADP10
RPGf_S1230:
    s_waitcnt vmcnt(3)
    v_cmp_eq_u32 vcc, -1, v31
    s_cbranch_vccnz RPGf_S1230_F
RPGf_S1230_OK:
    v_smfmac_f32_16x16x64_bf16 v[40:43], v[28:31], v[112:119], v1
    s_waitcnt vmcnt(2)
    v_cmp_eq_u32 vcc, -1, v35
    v_smfmac_f32_16x16x64_bf16 v[44:47], v[28:31], v[120:127], v1
    v_max_u32 v5, v28, v29
    v_max_u32 v6, v30, v31
    v_smfmac_f32_16x16x64_bf16 v[48:51], v[28:31], v[128:135], v1
    s_cbranch_vccnz RPGf_S1230_T
    v_smfmac_f32_16x16x64_bf16 v[52:55], v[28:31], v[136:143], v1
    s_branch RPGf_S230_OK
RQ_PADP10:
    s_branch RQ_PADP11
RPGf_S1230_T:
    v_smfmac_f32_16x16x64_bf16 v[52:55], v[28:31], v[136:143], v1
    s_branch RPGf_S230_F
RQ_PADP11:
    s_branch RQ_PADP12
RPGf_S1230_F:
    buffer_load_dwordx4 v[28:31], v2, s[8:11], s27 offen offset:1024 sc1
    s_sub_u32 s26, s26, 1
    s_cbranch_scc1 K_FAIL
    s_branch RPGf_S2301
RQ_PADP12:
    s_branch RQ_PADP13
RPGf_S231:
    s_waitcnt vmcnt(2)
    v_cmp_eq_u32 vcc, -1, v35
    s_cbranch_vccnz RPGf_S231_F
RPGf_S231_OK:
    v_smfmac_f32_16x16x64_bf16 v[40:43], v[32:35], v[160:167], v1
    s_waitcnt vmcnt(1)
    v_cmp_eq_u32 vcc, -1, v39
    v_smfmac_f32_16x16x64_bf16 v[44:47], v[32:35], v[168:175], v1
    v_max3_u32 v5, v5, v32, v33
    v_max3_u32 v6, v6, v34, v35
    v_smfmac_f32_16x16x64_bf16 v[48:51], v[32:35], v[176:183], v1
    s_cbranch_vccnz RPGf_S231_T
    v_smfmac_f32_16x16x64_bf16 v[52:55], v[32:35], v[184:191], v1
    s_branch RPGf_S31_OK
RQ_PADP13:
    s_branch RQ_PADP14
RPGf_S231_T:
    v_smfmac_f32_16x16x64_bf16 v[52:55], v[32:35], v[184:191], v1
    s_branch RPGf_S31_F
RQ_PADP14:
    s_branch RQ_PADP15
RPGf_S231_F:
    buffer_load_dwordx4 v[32:35], v2, s[8:11], s27 offen offset:2048 sc1
    s_sub_u32 s26, s26, 1
    s_cbranch_scc1 K_FAIL
    s_branch RPGf_S312
RQ_PADP15:
    s_branch RQ_PADP16
RPGf_S32:
    s_waitcnt vmcnt(1)
    v_cmp_eq_u32 vcc, -1, v39
    s_cbranch_vccnz RPGf_S32_F
RPGf_S32_OK:
    v_smfmac_f32_16x16x64_bf16 v[40:43], v[36:39], v[208:215], v1
    s_waitcnt vmcnt(0)
    v_cmp_eq_u32 vcc, -1, v35
    v_smfmac_f32_16x16x64_bf16 v[44:47], v[36:39], v[216:223], v1
    v_max3_u32 v5, v5, v36, v37
    v_max3_u32 v6, v6, v38, v39
    v_smfmac_f32_16x16x64_bf16 v[48:51], v[36:39], v[224:231], v1
    s_cbranch_vccnz RPGf_S32_T
    v_smfmac_f32_16x16x64_bf16 v[52:55], v[36:39], v[232:239], v1
    s_branch RPGf_S2_OK
RQ_PADP16:
    s_branch RQ_PADP17
RPGf_S32_T:
    v_smfmac_f32_16x16x64_bf16 v[52:55], v[36:39], v[232:239], v1
    s_branch RPGf_S2_F
RQ_PADP17:
    s_branch RQ_PADP18
RPGf_S32_F:
    buffer_load_dwordx4 v[36:39], v2, s[8:11], s27 offen offset:3072 sc1
    s_sub_u32 s26, s26, 1
    s_cbranch_scc1 K_FAIL
    s_branch RPGf_S23
RQ_PADP18:
    s_branch RQ_PADP19
RPGf_S230:
    s_waitcnt vmcnt(2)
    v_cmp_eq_u32 vcc, -1, v35
    s_cbranch_vccnz RPGf_S230_F
RPGf_S230_OK:
    v_smfmac_f32_16x16x64_bf16 v[40:43], v[32:35], v[160:167], v1
    s_waitcnt vmcnt(1)
    v_cmp_eq_u32 vcc, -1, v39
    v_smfmac_f32_16x16x64_bf16 v[44:47], v[32:35], v[168:175], v1
    v_max3_u32 v5, v5, v32, v33
    v_max3_u32 v6, v6, v34, v35
    v_smfmac_f32_16x16x64_bf16 v[48:51], v[32:35], v[176:183], v1
    s_cbranch_vccnz RPGf_S230_T
    v_smfmac_f32_16x16x64_bf16 v[52:55], v[32:35], v[184:191], v1
    s_branch RPGf_S30_OK
RQ_PADP19:
    s_branch RQ_PADP20
RPGf_S230_T:
    v_smfmac_f32_16x16x64_bf16 v[52:55], v[32:35], v[184:191], v1
    s_branch RPGf_S30_F
RQ_PADP20:
    s_branch RQ_PADP21
RPGf_S230_F:
    buffer_load_dwordx4 v[32:35], v2, s[8:11], s27 offen offset:2048 sc1
    s_sub_u32 s26, s26, 1
    s_cbranch_scc1 K_FAIL
    s_branch RPGf_S302
RQ_PADP21:
    s_branch RQ_PADP22
RPGf_S2301:
    s_waitcnt vmcnt(3)
    v_cmp_eq_u32 vcc, -1, v35
    s_cbranch_vccnz RPGf_S2301_F
RPGf_S2301_OK:
    v_smfmac_f32_16x16x64_bf16 v[40:43], v[32:35], v[160:167], v1
    s_waitcnt vmcnt(2)
    v_cmp_eq_u32 vcc, -1, v39
    v_smfmac_f32_16x16x64_bf16 v[44:47], v[32:35], v[168:175], v1
    v_max_u32 v5, v32, v33
    v_max_u32 v6, v34, v35
    v_smfmac_f32_16x16x64_bf16 v[48:51], v[32:35], v[176:183], v1
    s_cbranch_vccnz RPGf_S2301_T
    v_smfmac_f32_16x16x64_bf16 v[52:55], v[32:35], v[184:191], v1
    s_branch RPGf_S301_OK
RQ_PADP22:
    s_branch RQ_PADP23
RPGf_S2301_T:
    v_smfmac_f32_16x16x64_bf16 v[52:55], v[32:35], v[184:191], v1
    s_branch RPGf_S301_F
RQ_PADP23:
    s_branch RQ_PADP24
RPGf_S2301_F:
    buffer_load_dwordx4 v[32:35], v2, s[8:11], s27 offen offset:2048 sc1
    s_sub_u32 s26, s26, 1
    s_cbranch_scc1 K_FAIL
    s_branch RPGf_S3012
RQ_PADP24:
    s_branch RQ_PADP25
RPGf_S31:
    s_waitcnt vmcnt(1)
    v_cmp_eq_u32 vcc, -1, v39
    s_cbranch_vccnz RPGf_S31_F
RPGf_S31_OK:
    v_smfmac_f32_16x16x64_bf16 v[40:43], v[36:39], v[208:215], v1
    s_waitcnt vmcnt(0)
    v_cmp_eq_u32 vcc, -1, v31
    v_smfmac_f32_16x16x64_bf16 v[44:47], v[36:39], v[216:223], v1
    v_max3_u32 v5, v5, v36, v37
    v_max3_u32 v6, v6, v38, v39
    v_smfmac_f32_16x16x64_bf16 v[48:51], v[36:39], v[224:231], v1
    s_cbranch_vccnz RPGf_S31_T
    v_smfmac_f32_16x16x64_bf16 v[52:55], v[36:39], v[232:239], v1
    s_branch RPGf_S1_OK
RQ_PADP25:
    s_branch RQ_PADP26
RPGf_S31_T:
    v_smfmac_f32_16x16x64_bf16 v[52:55], v[36:39], v[232:239], v1
    s_branch RPGf_S1_F
RQ_PADP26:
    s_branch RQ_PADP27
RPGf_S31_F:
    buffer_load_dwordx4 v[36:39], v2, s[8:11], s27 offen offset:3072 sc1
    s_sub_u32 s26, s26, 1
    s_cbranch_scc1 K_FAIL
    s_branch RPGf_S13
RQ_PADP27:
    s_branch RQ_PADP28
RPGf_S312:
    s_waitcnt vmcnt(2)
    v_cmp_eq_u32 vcc, -1, v39
    s_cbranch_vccnz RPGf_S312_F
RPGf_S312_OK:
    v_smfmac_f32_16x16x64_bf16 v[40:43], v[36:39], v[208:215], v1
    s_waitcnt vmcnt(1)
    v_cmp_eq_u32 vcc, -1, v31
    v_smfmac_f32_16x16x64_bf16 v[44:47], v[36:39], v[216:223], v1
    v_max3_u32 v5, v5, v36, v37
    v_max3_u32 v6, v6, v38, v39
    v_smfmac_f32_16x16x64_bf16 v[48:51], v[36:39], v[224:231], v1
    s_cbranch_vccnz RPGf_S312_T
    v_smfmac_f32_16x16x64_bf16 v[52:55], v[36:39], v[232:239], v1
    s_branch RPGf_S12_OK
RQ_PADP28:
    s_branch RQ_PADP29
RPGf_S312_T:
    v_smfmac_f32_16x16x64_bf16 v[52:55], v[36:39], v[232:239], v1
    s_branch RPGf_S12_F
RQ_PADP29:
    s_branch RQ_PADP30
RPGf_S312_F:
    buffer_load_dwordx4 v[36:39], v2, s[8:11], s27 offen offset:3072 sc1
    s_sub_u32 s26, s26, 1
    s_cbranch_scc1 K_FAIL
    s_branch RPGf_S123
RQ_PADP30:
    s_branch RQ_PADP31
RPGf_S2_OK:
    v_smfmac_f32_16x16x64_bf16 v[40:43], v[32:35], v[160:167], v1
    v_max3_u32 v5, v5, v32, v33
    v_max3_u32 v6, v6, v34, v35
    v_smfmac_f32_16x16x64_bf16 v[44:47], v[32:35], v[168:175], v1
    v_smfmac_f32_16x16x64_bf16 v[48:51], v[32:35], v[176:183], v1
    v_smfmac_f32_16x16x64_bf16 v[52:55], v[32:35], v[184:191], v1
    s_branch RPGf_DONE
RQ_PADP31:
    s_branch RQ_PADP32
RPGf_S2_F:
    buffer_load_dwordx4 v[32:35], v2, s[8:11], s27 offen offset:2048 sc1
    s_sub_u32 s26, s26, 1
    s_cbranch_scc1 K_FAIL
    s_nop 10
    buffer_load_dwordx4 v[32:35], v2, s[8:11], s27 offen offset:2048 sc1
    s_nop 10
    buffer_load_dwordx4 v[32:35], v2, s[8:11], s27 offen offset:2048 sc1
    s_nop 10
    buffer_load_dwordx4 v[32:35], v2, s[8:11], s27 offen offset:2048 sc1
RPGf_S2_L:
    s_waitcnt vmcnt(3)
    v_max3_u32 v11, v32, v33, v34
    v_max_u32 v11, v11, v35
    v_cmp_eq_u32 vcc, -1, v11
    s_cbranch_vccz RPGf_S2_OK
    buffer_load_dwordx4 v[32:35], v2, s[8:11], s27 offen offset:2048 sc1
    s_sub_u32 s26, s26, 1
    s_cbranch_scc1 K_FAIL
    s_branch RPGf_S2_L
RQ_PADP32:
    s_branch RQ_PADP33
RPGf_S30:
    s_waitcnt vmcnt(1)
    v_cmp_eq_u32 vcc, -1, v39
    s_cbranch_vccnz RPGf_S30_F
RPGf_S30_OK:
    v_smfmac_f32_16x16x64_bf16 v[40:43], v[36:39], v[208:215], v1
    s_waitcnt vmcnt(0)
    v_cmp_eq_u32 vcc, -1, v27
    v_smfmac_f32_16x16x64_bf16 v[44:47], v[36:39], v[216:223], v1
    v_max3_u32 v5, v5, v36, v37
    v_max3_u32 v6, v6, v38, v39
    v_smfmac_f32_16x16x64_bf16 v[48:51], v[36:39], v[224:231], v1
    s_cbranch_vccnz RPGf_S30_T
    v_smfmac_f32_16x16x64_bf16 v[52:55], v[36:39], v[232:239], v1
    s_branch RPGf_S0_OK
RQ_PADP33:
    s_branch RQ_PADP34
RPGf_S30_T:
    v_smfmac_f32_16x16x64_bf16 v[52:55], v[36:39], v[232:239], v1
    s_branch RPGf_S0_F
RQ_PADP34:
    s_branch RQ_PADP35
RPGf_S30_F:
    buffer_load_dwordx4 v[36:39], v2, s[8:11], s27 offen offset:3072 sc1
    s_sub_u32 s26, s26, 1
    s_cbranch_scc1 K_FAIL
    s_branch RPGf_S03
RQ_PADP35:
    s_branch RQ_PADP36
RPGf_S302:
    s_waitcnt vmcnt(2)
    v_cmp_eq_u32 vcc, -1, v39
    s_cbranch_vccnz RPGf_S302_F
RPGf_S302_OK:
    v_smfmac_f32_16x16x64_bf16 v[40:43], v[36:39], v[208:215], v1
    s_waitcnt vmcnt(1)
    v_cmp_eq_u32 vcc, -1, v27
    v_smfmac_f32_16x16x64_bf16 v[44:47], v[36:39], v[216:223], v1
    v_max3_u32 v5, v5, v36, v37
    v_max3_u32 v6, v6, v38, v39
    v_smfmac_f32_16x16x64_bf16 v[48:51], v[36:39], v[224:231], v1
    s_cbranch_vccnz RPGf_S302_T
    v_smfmac_f32_16x16x64_bf16 v[52:55], v[36:39], v[232:239], v1
    s_branch RPGf_S02_OK
RQ_PADP36:
    s_branch RQ_PADP37
RPGf_S302_T:
    v_smfmac_f32_16x16x64_bf16 v[52:55], v[36:39], v[232:239], v1
    s_branch RPGf_S02_F
RQ_PADP37:
    s_branch RQ_PADP38
RPGf_S302_F:
    buffer_load_dwordx4 v[36:39], v2, s[8:11], s27 offen offset:3072 sc1
    s_sub_u32 s26, s26, 1
    s_cbranch_scc1 K_FAIL
    s_branch RPGf_S023
RQ_PADP38:
    s_branch RQ_PADP39
RPGf_S301:
    s_waitcnt vmcnt(2)
    v_cmp_eq_u32 vcc, -1, v39
    s_cbranch_vccnz RPGf_S301_F
RPGf_S301_OK:
    v_smfmac_f32_16x16x64_bf16 v[40:43], v[36:39], v[208:215], v1
    s_waitcnt vmcnt(1)
    v_cmp_eq_u32 vcc, -1, v27
    v_smfmac_f32_16x16x64_bf16 v[44:47], v[36:39], v[216:223], v1
    v_max3_u32 v5, v5, v36, v37
    v_max3_u32 v6, v6, v38, v39
    v_smfmac_f32_16x16x64_bf16 v[48:51], v[36:39], v[224:231], v1
    s_cbranch_vccnz RPGf_S301_T
    v_smfmac_f32_16x16x64_bf16 v[52:55], v[36:39], v[232:239], v1
    s_branch RPGf_S01_OK
RQ_PADP39:
    s_branch RQ_PADP40
RPGf_S301_T:
    v_smfmac_f32_16x16x64_bf16 v[52:55], v[36:39], v[232:239], v1
    s_branch RPGf_S01_F
RQ_PADP40:
    s_branch RQ_PADP41
RPGf_S301_F:
    buffer_load_dwordx4 v[36:39], v2, s[8:11], s27 offen offset:3072 sc1
    s_sub_u32 s26, s26, 1
    s_cbranch_scc1 K_FAIL
    s_branch RPGf_S013
RQ_PADP41:
    s_branch RQ_PADP42
RPGf_S3012:
    s_waitcnt vmcnt(3)
    v_cmp_eq_u32 vcc, -1, v39
    s_cbranch_vccnz RPGf_S3012_F
RPGf_S3012_OK:
    v_smfmac_f32_16x16x64_bf16 v[40:43], v[36:39], v[208:215], v1
    s_waitcnt vmcnt(2)
    v_cmp_eq_u32 vcc, -1, v27
    v_smfmac_f32_16x16x64_bf16 v[44:47], v[36:39], v[216:223], v1
    v_max_u32 v5, v36, v37
    v_max_u32 v6, v38, v39
    v_smfmac_f32_16x16x64_bf16 v[48:51], v[36:39], v[224:231], v1
    s_cbranch_vccnz RPGf_S3012_T
    v_smfmac_f32_16x16x64_bf16 v[52:55], v[36:39], v[232:239], v1
    s_branch RPGf_S012_OK
RQ_PADP42:
    s_branch RQ_PADP43
RPGf_S3012_T:
    v_smfmac_f32_16x16x64_bf16 v[52:55], v[36:39], v[232:239], v1
    s_branch RPGf_S012_F
RQ_PADP43:
    s_branch RQ_PADP44
RPGf_S3012_F:
    buffer_load_dwordx4 v[36:39], v2, s[8:11], s27 offen offset:3072 sc1
    s_sub_u32 s26, s26, 1
    s_cbranch_scc1 K_FAIL
    s_branch RPGf_S0123
RQ_PADP44:
    s_branch RQ_PADP45
RPGf_S1_OK:
    v_smfmac_f32_16x16x64_bf16 v[40:43], v[28:31], v[112:119], v1
    v_max3_u32 v5, v5, v28, v29
    v_max3_u32 v6, v6, v30, v31
    v_smfmac_f32_16x16x64_bf16 v[44:47], v[28:31], v[120:127], v1
    v_smfmac_f32_16x16x64_bf16 v[48:51], v[28:31], v[128:135], v1
    v_smfmac_f32_16x16x64_bf16 v[52:55], v[28:31], v[136:143], v1
    s_branch RPGf_DONE
RQ_PADP45:
    s_branch RQ_PADP46
RPGf_S1_F:
    buffer_load_dwordx4 v[28:31], v2, s[8:11], s27 offen offset:1024 sc1
    s_sub_u32 s26, s26, 1
    s_cbranch_scc1 K_FAIL
    s_nop 10
    buffer_load_dwordx4 v[28:31], v2, s[8:11], s27 offen offset:1024 sc1
    s_nop 10
    buffer_load_dwordx4 v[28:31], v2, s[8:11], s27 offen offset:1024 sc1
    s_nop 10
    buffer_load_dwordx4 v[28:31], v2, s[8:11], s27 offen offset:1024 sc1
RPGf_S1_L:
    s_waitcnt vmcnt(3)
    v_max3_u32 v11, v28, v29, v30
    v_max_u32 v11, v11, v31
    v_cmp_eq_u32 vcc, -1, v11
    s_cbranch_vccz RPGf_S1_OK
    buffer_load_dwordx4 v[28:31], v2, s[8:11], s27 offen offset:1024 sc1
    s_sub_u32 s26, s26, 1
    s_cbranch_scc1 K_FAIL
    s_branch RPGf_S1_L
RQ_PADP46:
    s_branch RQ_PADP47
RPGf_S13:
    s_waitcnt vmcnt(1)
    v_cmp_eq_u32 vcc, -1, v31
    s_cbranch_vccnz RPGf_S13_F
RPGf_S13_OK:
    v_smfmac_f32_16x16x64_bf16 v[40:43], v[28:31], v[112:119], v1
    s_waitcnt vmcnt(0)
    v_cmp_eq_u32 vcc, -1, v39
    v_smfmac_f32_16x16x64_bf16 v[44:47], v[28:31], v[120:127], v1
    v_max3_u32 v5, v5, v28, v29
    v_max3_u32 v6, v6, v30, v31
    v_smfmac_f32_16x16x64_bf16 v[48:51], v[28:31], v[128:135], v1
    s_cbranch_vccnz RPGf_S13_T
    v_smfmac_f32_16x16x64_bf16 v[52:55], v[28:31], v[136:143], v1
    s_branch RPGf_S3_OK
RQ_PADP47:
    s_branch RQ_PADP48
RPGf_S13_T:
    v_smfmac_f32_16x16x64_bf16 v[52:55], v[28:31], v[136:143], v1
    s_branch RPGf_S3_F
RQ_PADP48:
    s_branch RQ_PADP49
RPGf_S13_F:
    buffer_load_dwordx4 v[28:31], v2, s[8:11], s27 offen offset:1024 sc1
    s_sub_u32 s26, s26, 1
    s_cbranch_scc1 K_FAIL
    s_branch RPGf_S31
RQ_PADP49:
    s_branch RQ_PADP50
RPGf_S12:
    s_waitcnt vmcnt(1)
    v_cmp_eq_u32 vcc, -1, v31
    s_cbranch_vccnz RPGf_S12_F
RPGf_S12_OK:
    v_smfmac_f32_16x16x64_bf16 v[40:43], v[28:31], v[112:119], v1
    s_waitcnt vmcnt(0)
    v_cmp_eq_u32 vcc, -1, v35
    v_smfmac_f32_16x16x64_bf16 v[44:47], v[28:31], v[120:127], v1
    v_max3_u32 v5, v5, v28, v29
    v_max3_u32 v6, v6, v30, v31
    v_smfmac_f32_16x16x64_bf16 v[48:51], v[28:31], v[128:135], v1
    s_cbranch_vccnz RPGf_S12_T
    v_smfmac_f32_16x16x64_bf16 v[52:55], v[28:31], v[136:143], v1
    s_branch RPGf_S2_OK
RQ_PADP50:
    s_branch RQ_PADP51
RPGf_S12_T:
    v_smfmac_f32_16x16x64_bf16 v[52:55], v[28:31], v[136:143], v1
    s_branch RPGf_S2_F
RQ_PADP51:
    s_branch RQ_PADP52
RPGf_S12_F:
    buffer_load_dwordx4 v[28:31], v2, s[8:11], s27 offen offset:1024 sc1
    s_sub_u32 s26, s26, 1
    s_cbranch_scc1 K_FAIL
    s_branch RPGf_S21
RQ_PADP52:
    s_branch RQ_PADP53
RPGf_S0_OK:
    v_smfmac_f32_16x16x64_bf16 v[40:43], v[24:27], v[64:71], v1
    v_max3_u32 v5, v5, v24, v25
    v_max3_u32 v6, v6, v26, v27
    v_smfmac_f32_16x16x64_bf16 v[44:47], v[24:27], v[72:79], v1
    v_smfmac_f32_16x16x64_bf16 v[48:51], v[24:27], v[80:87], v1
    v_smfmac_f32_16x16x64_bf16 v[52:55], v[24:27], v[88:95], v1
    s_branch RPGf_DONE
RQ_PADP53:
    s_branch RQ_PADP54
RPGf_S0_F:
    buffer_load_dwordx4 v[24:27], v2, s[8:11], s27 offen offset:0 sc1
    s_sub_u32 s26, s26, 1
    s_cbranch_scc1 K_FAIL
    s_nop 10
    buffer_load_dwordx4 v[24:27], v2, s[8:11], s27 offen offset:0 sc1
    s_nop 10
    buffer_load_dwordx4 v[24:27], v2, s[8:11], s27 offen offset:0 sc1
    s_nop 10
    buffer_load_dwordx4 v[24:27], v2, s[8:11], s27 offen offset:0 sc1
RPGf_S0_L:
    s_waitcnt vmcnt(3)
    v_max3_u32 v11, v24, v25, v26
    v_max_u32 v11, v11, v27
    v_cmp_eq_u32 vcc, -1, v11
    s_cbranch_vccz RPGf_S0_OK
    buffer_load_dwordx4 v[24:27], v2, s[8:11], s27 offen offset:0 sc1
    s_sub_u32 s26, s26, 1
    s_cbranch_scc1 K_FAIL
    s_branch RPGf_S0_L
RQ_PADP54:
    s_branch RQ_PADP55
RPGf_S03:
    s_waitcnt vmcnt(1)
    v_cmp_eq_u32 vcc, -1, v27
    s_cbranch_vccnz RPGf_S03_F
RPGf_S03_OK:
    v_smfmac_f32_16x16x64_bf16 v[40:43], v[24:27], v[64:71], v1
    s_waitcnt vmcnt(0)
    v_cmp_eq_u32 vcc, -1, v39
    v_smfmac_f32_16x16x64_bf16 v[44:47], v[24:27], v[72:79], v1
    v_max3_u32 v5, v5, v24, v25
    v_max3_u32 v6, v6, v26, v27
    v_smfmac_f32_16x16x64_bf16 v[48:51], v[24:27], v[80:87], v1
    s_cbranch_vccnz RPGf_S03_T
    v_smfmac_f32_16x16x64_bf16 v[52:55], v[24:27], v[88:95], v1
    s_branch RPGf_S3_OK
RQ_PADP55:
    s_branch RQ_PADP56
RPGf_S03_T:
    v_smfmac_f32_16x16x64_bf16 v[52:55], v[24:27], v[88:95], v1
    s_branch RPGf_S3_F
RQ_PADP56:
    s_branch RQ_PADP57
RPGf_S03_F:
    buffer_load_dwordx4 v[24:27], v2, s[8:11], s27 offen offset:0 sc1
    s_sub_u32 s26, s26, 1
    s_cbranch_scc1 K_FAIL
    s_branch RPGf_S30
RQ_PADP57:
    s_branch RQ_PADP58
RPGf_S02:
    s_waitcnt vmcnt(1)
    v_cmp_eq_u32 vcc, -1, v27
    s_cbranch_vccnz RPGf_S02_F
RPGf_S02_OK:
    v_smfmac_f32_16x16x64_bf16 v[40:43], v[24:27], v[64:71], v1
    s_waitcnt vmcnt(0)
    v_cmp_eq_u32 vcc, -1, v35
    v_smfmac_f32_16x16x64_bf16 v[44:47], v[24:27], v[72:79], v1
    v_max3_u32 v5, v5, v24, v25
    v_max3_u32 v6, v6, v26, v27
    v_smfmac_f32_16x16x64_bf16 v[48:51], v[24:27], v[80:87], v1
    s_cbranch_vccnz RPGf_S02_T
    v_smfmac_f32_16x16x64_bf16 v[52:55], v[24:27], v[88:95], v1
    s_branch RPGf_S2_OK
RQ_PADP58:
    s_branch RQ_PADP59
RPGf_S02_T:
    v_smfmac_f32_16x16x64_bf16 v[52:55], v[24:27], v[88:95], v1
    s_branch RPGf_S2_F
RQ_PADP59:
    s_branch RQ_PADP60
RPGf_S02_F:
    buffer_load_dwordx4 v[24:27], v2, s[8:11], s27 offen offset:0 sc1
    s_sub_u32 s26, s26, 1
    s_cbranch_scc1 K_FAIL
    s_branch RPGf_S20
RQ_PADP60:
    s_branch RQ_PADP61
RPGf_S023:
    s_waitcnt vmcnt(2)
    v_cmp_eq_u32 vcc, -1, v27
    s_cbranch_vccnz RPGf_S023_F
RPGf_S023_OK:
    v_smfmac_f32_16x16x64_bf16 v[40:43], v[24:27], v[64:71], v1
    s_waitcnt vmcnt(1)
    v_cmp_eq_u32 vcc, -1, v35
    v_smfmac_f32_16x16x64_bf16 v[44:47], v[24:27], v[72:79], v1
    v_max3_u32 v5, v5, v24, v25
    v_max3_u32 v6, v6, v26, v27
    v_smfmac_f32_16x16x64_bf16 v[48:51], v[24:27], v[80:87], v1
    s_cbranch_vccnz RPGf_S023_T
    v_smfmac_f32_16x16x64_bf16 v[52:55], v[24:27], v[88:95], v1
    s_branch RPGf_S23_OK
RQ_PADP61:
    s_branch RQ_PADP62
RPGf_S023_T:
    v_smfmac_f32_16x16x64_bf16 v[52:55], v[24:27], v[88:95], v1
    s_branch RPGf_S23_F
RQ_PADP62:
    s_branch RQ_PADP63
RPGf_S023_F:
    buffer_load_dwordx4 v[24:27], v2, s[8:11], s27 offen offset:0 sc1
    s_sub_u32 s26, s26, 1
    s_cbranch_scc1 K_FAIL
    s_branch RPGf_S230
RQ_PADP63:
    s_branch RQ_PADP64
RPGf_S01:
    s_waitcnt vmcnt(1)
    v_cmp_eq_u32 vcc, -1, v27
    s_cbranch_vccnz RPGf_S01_F
RPGf_S01_OK:
    v_smfmac_f32_16x16x64_bf16 v[40:43], v[24:27], v[64:71], v1
    s_waitcnt vmcnt(0)
    v_cmp_eq_u32 vcc, -1, v31
    v_smfmac_f32_16x16x64_bf16 v[44:47], v[24:27], v[72:79], v1
    v_max3_u32 v5, v5, v24, v25
    v_max3_u32 v6, v6, v26, v27
    v_smfmac_f32_16x16x64_bf16 v[48:51], v[24:27], v[80:87], v1
    s_cbranch_vccnz RPGf_S01_T
    v_smfmac_f32_16x16x64_bf16 v[52:55], v[24:27], v[88:95], v1
    s_branch RPGf_S1_OK
RQ_PADP64:
    s_branch RQ_PADP65
RPGf_S01_T:
    v_smfmac_f32_16x16x64_bf16 v[52:55], v[24:27], v[88:95], v1
    s_branch RPGf_S1_F
RQ_PADP65:
    s_branch RQ_PADP66
RPGf_S01_F:
    buffer_load_dwordx4 v[24:27], v2, s[8:11], s27 offen offset:0 sc1
    s_sub_u32 s26, s26, 1
    s_cbranch_scc1 K_FAIL
    s_branch RPGf_S10
RQ_PADP66:
    s_branch RQ_PADP67
RPGf_S013:
    s_waitcnt vmcnt(2)
    v_cmp_eq_u32 vcc, -1, v27
    s_cbranch_vccnz RPGf_S013_F
RPGf_S013_OK:
    v_smfmac_f32_16x16x64_bf16 v[40:43], v[24:27], v[64:71], v1
    s_waitcnt vmcnt(1)
    v_cmp_eq_u32 vcc, -1, v31
    v_smfmac_f32_16x16x64_bf16 v[44:47], v[24:27], v[72:79], v1
    v_max3_u32 v5, v5, v24, v25
    v_max3_u32 v6, v6, v26, v27
    v_smfmac_f32_16x16x64_bf16 v[48:51], v[24:27], v[80:87], v1
    s_cbranch_vccnz RPGf_S013_T
    v_smfmac_f32_16x16x64_bf16 v[52:55], v[24:27], v[88:95], v1
    s_branch RPGf_S13_OK
RQ_PADP67:
    s_branch RQ_PADP68
RPGf_S013_T:
    v_smfmac_f32_16x16x64_bf16 v[52:55], v[24:27], v[88:95], v1
    s_branch RPGf_S13_F
RQ_PADP68:
    s_branch RQ_PADP69
RPGf_S013_F:
    buffer_load_dwordx4 v[24:27], v2, s[8:11], s27 offen offset:0 sc1
    s_sub_u32 s26, s26, 1
    s_cbranch_scc1 K_FAIL
    s_branch RPGf_S130
RQ_PADP69:
    s_branch RQ_PADP70
RPGf_S012:
    s_waitcnt vmcnt(2)
    v_cmp_eq_u32 vcc, -1, v27
    s_cbranch_vccnz RPGf_S012_F
RPGf_S012_OK:
    v_smfmac_f32_16x16x64_bf16 v[40:43], v[24:27], v[64:71], v1
    s_waitcnt vmcnt(1)
    v_cmp_eq_u32 vcc, -1, v31
    v_smfmac_f32_16x16x64_bf16 v[44:47], v[24:27], v[72:79], v1
    v_max3_u32 v5, v5, v24, v25
    v_max3_u32 v6, v6, v26, v27
    v_smfmac_f32_16x16x64_bf16 v[48:51], v[24:27], v[80:87], v1
    s_cbranch_vccnz RPGf_S012_T
    v_smfmac_f32_16x16x64_bf16 v[52:55], v[24:27], v[88:95], v1
    s_branch RPGf_S12_OK
RQ_PADP70:
    s_branch RQ_PADP71
RPGf_S012_T:
    v_smfmac_f32_16x16x64_bf16 v[52:55], v[24:27], v[88:95], v1
    s_branch RPGf_S12_F
RQ_PADP71:
    s_branch RQ_PADP72
RPGf_S012_F:
    buffer_load_dwordx4 v[24:27], v2, s[8:11], s27 offen offset:0 sc1
    s_sub_u32 s26, s26, 1
    s_cbranch_scc1 K_FAIL
    s_branch RPGf_S120
RQ_PADP72:
    s_branch RQ_PADP73
RPGf_S21:
    s_waitcnt vmcnt(1)
    v_cmp_eq_u32 vcc, -1, v35
    s_cbranch_vccnz RPGf_S21_F
RPGf_S21_OK:
    v_smfmac_f32_16x16x64_bf16 v[40:43], v[32:35], v[160:167], v1
    s_waitcnt vmcnt(0)
    v_cmp_eq_u32 vcc, -1, v31
    v_smfmac_f32_16x16x64_bf16 v[44:47], v[32:35], v[168:175], v1
    v_max3_u32 v5, v5, v32, v33
    v_max3_u32 v6, v6, v34, v35
    v_smfmac_f32_16x16x64_bf16 v[48:51], v[32:35], v[176:183], v1
    s_cbranch_vccnz RPGf_S21_T
    v_smfmac_f32_16x16x64_bf16 v[52:55], v[32:35], v[184:191], v1
    s_branch RPGf_S1_OK
RQ_PADP73:
    s_branch RQ_PADP74
RPGf_S21_T:
    v_smfmac_f32_16x16x64_bf16 v[52:55], v[32:35], v[184:191], v1
    s_branch RPGf_S1_F
RQ_PADP74:
    s_branch RQ_PADP75
RPGf_S21_F:
    buffer_load_dwordx4 v[32:35], v2, s[8:11], s27 offen offset:2048 sc1
    s_sub_u32 s26, s26, 1
    s_cbranch_scc1 K_FAIL
    s_branch RPGf_S12
RQ_PADP75:
    s_branch RQ_PADP76
RPGf_S20:
    s_waitcnt vmcnt(1)
    v_cmp_eq_u32 vcc, -1, v35
    s_cbranch_vccnz RPGf_S20_F
RPGf_S20_OK:
    v_smfmac_f32_16x16x64_bf16 v[40:43], v[32:35], v[160:167], v1
    s_waitcnt vmcnt(0)
    v_cmp_eq_u32 vcc, -1, v27
    v_smfmac_f32_16x16x64_bf16 v[44:47], v[32:35], v[168:175], v1
    v_max3_u32 v5, v5, v32, v33
    v_max3_u32 v6, v6, v34, v35
    v_smfmac_f32_16x16x64_bf16 v[48:51], v[32:35], v[176:183], v1
    s_cbranch_vccnz RPGf_S20_T
    v_smfmac_f32_16x16x64_bf16 v[52:55], v[32:35], v[184:191], v1
    s_branch RPGf_S0_OK
RQ_PADP76:
    s_branch RQ_PADP77
RPGf_S20_T:
    v_smfmac_f32_16x16x64_bf16 v[52:55], v[32:35], v[184:191], v1
    s_branch RPGf_S0_F
RQ_PADP77:
    s_branch RQ_PADP78
RPGf_S20_F:
    buffer_load_dwordx4 v[32:35], v2, s[8:11], s27 offen offset:2048 sc1
    s_sub_u32 s26, s26, 1
    s_cbranch_scc1 K_FAIL
    s_branch RPGf_S02
RQ_PADP78:
    s_branch RQ_PADP79
RPGf_S10:
    s_waitcnt vmcnt(1)
    v_cmp_eq_u32 vcc, -1, v31
    s_cbranch_vccnz RPGf_S10_F
RPGf_S10_OK:
    v_smfmac_f32_16x16x64_bf16 v[40:43], v[28:31], v[112:119], v1
    s_waitcnt vmcnt(0)
    v_cmp_eq_u32 vcc, -1, v27
    v_smfmac_f32_16x16x64_bf16 v[44:47], v[28:31], v[120:127], v1
    v_max3_u32 v5, v5, v28, v29
    v_max3_u32 v6, v6, v30, v31
    v_smfmac_f32_16x16x64_bf16 v[48:51], v[28:31], v[128:135], v1
    s_cbranch_vccnz RPGf_S10_T
    v_smfmac_f32_16x16x64_bf16 v[52:55], v[28:31], v[136:143], v1
    s_branch RPGf_S0_OK
RQ_PADP79:
    s_branch RQ_PADP80
RPGf_S10_T:
    v_smfmac_f32_16x16x64_bf16 v[52:55], v[28:31], v[136:143], v1
    s_branch RPGf_S0_F
RQ_PADP80:
    s_branch RQ_PADP81
RPGf_S10_F:
    buffer_load_dwordx4 v[28:31], v2, s[8:11], s27 offen offset:1024 sc1
    s_sub_u32 s26, s26, 1
    s_cbranch_scc1 K_FAIL
    s_branch RPGf_S01
RQ_PADP81:
    s_branch RQ_PADP82
RPGf_S130:
    s_waitcnt vmcnt(2)
    v_cmp_eq_u32 vcc, -1, v31
    s_cbranch_vccnz RPGf_S130_F
RPGf_S130_OK:
    v_smfmac_f32_16x16x64_bf16 v[40:43], v[28:31], v[112:119], v1
    s_waitcnt vmcnt(1)
    v_cmp_eq_u32 vcc, -1, v39
    v_smfmac_f32_16x16x64_bf16 v[44:47], v[28:31], v[120:127], v1
    v_max3_u32 v5, v5, v28, v29
    v_max3_u32 v6, v6, v30, v31
    v_smfmac_f32_16x16x64_bf16 v[48:51], v[28:31], v[128:135], v1
    s_cbranch_vccnz RPGf_S130_T
    v_smfmac_f32_16x16x64_bf16 v[52:55], v[28:31], v[136:143], v1
    s_branch RPGf_S30_OK
RQ_PADP82:
    s_branch RQ_PADP83
RPGf_S130_T:
    v_smfmac_f32_16x16x64_bf16 v[52:55], v[28:31], v[136:143], v1
    s_branch RPGf_S30_F
RQ_PADP83:
    s_branch RQ_PADP84
RPGf_S130_F:
    buffer_load_dwordx4 v[28:31], v2, s[8:11], s27 offen offset:1024 sc1
    s_sub_u32 s26, s26, 1
    s_cbranch_scc1 K_FAIL
    s_branch RPGf_S301
RQ_PADP84:
    s_branch RQ_PADP85
RPGf_S120:
    s_waitcnt vmcnt(2)
    v_cmp_eq_u32 vcc, -1, v31
    s_cbranch_vccnz RPGf_S120_F
RPGf_S120_OK:
    v_smfmac_f32_16x16x64_bf16 v[40:43], v[28:31], v[112:119], v1
    s_waitcnt vmcnt(1)
    v_cmp_eq_u32 vcc, -1, v35
    v_smfmac_f32_16x16x64_bf16 v[44:47], v[28:31], v[120:127], v1
    v_max3_u32 v5, v5, v28, v29
    v_max3_u32 v6, v6, v30, v31
    v_smfmac_f32_16x16x64_bf16 v[48:51], v[28:31], v[128:135], v1
    s_cbranch_vccnz RPGf_S120_T
    v_smfmac_f32_16x16x64_bf16 v[52:55], v[28:31], v[136:143], v1
    s_branch RPGf_S20_OK
RQ_PADP85:
    s_branch RQ_PADP86
RPGf_S120_T:
    v_smfmac_f32_16x16x64_bf16 v[52:55], v[28:31], v[136:143], v1
    s_branch RPGf_S20_F
RQ_PADP86:
    s_branch RQ_PADP87
RPGf_S120_F:
    buffer_load_dwordx4 v[28:31], v2, s[8:11], s27 offen offset:1024 sc1
    s_sub_u32 s26, s26, 1
    s_cbranch_scc1 K_FAIL
    s_branch RPGf_S201
RQ_PADP87:
    s_branch RQ_PADP88
RPGf_S201:
    s_waitcnt vmcnt(2)
    v_cmp_eq_u32 vcc, -1, v35
    s_cbranch_vccnz RPGf_S201_F
RPGf_S201_OK:
    v_smfmac_f32_16x16x64_bf16 v[40:43], v[32:35], v[160:167], v1
    s_waitcnt vmcnt(1)
    v_cmp_eq_u32 vcc, -1, v27
    v_smfmac_f32_16x16x64_bf16 v[44:47], v[32:35], v[168:175], v1
    v_max3_u32 v5, v5, v32, v33
    v_max3_u32 v6, v6, v34, v35
    v_smfmac_f32_16x16x64_bf16 v[48:51], v[32:35], v[176:183], v1
    s_cbranch_vccnz RPGf_S201_T
    v_smfmac_f32_16x16x64_bf16 v[52:55], v[32:35], v[184:191], v1
    s_branch RPGf_S01_OK
RQ_PADP88:
    s_branch RQ_PADP89
RPGf_S201_T:
    v_smfmac_f32_16x16x64_bf16 v[52:55], v[32:35], v[184:191], v1
    s_branch RPGf_S01_F
RQ_PADP89:
    s_branch RQ_PADP90
RPGf_S201_F:
    buffer_load_dwordx4 v[32:35], v2, s[8:11], s27 offen offset:2048 sc1
    s_sub_u32 s26, s26, 1
    s_cbranch_scc1 K_FAIL
    s_branch RPGf_S012
RQ_PADP90:
    s_branch RQ_PADP91
RQ_PADP91:
    s_branch RQ_PADRET
RPs_LOOP:
    s_nop 15
RPs_RETRY:
    buffer_load_dwordx4 v[24:27], v2, s[8:11], s27 offen offset:0 sc1
    v_mov_b32 v40, 0
    v_mov_b32 v41, 0
    v_mov_b32 v42, 0
    v_mov_b32 v43, 0
    v_mov_b32 v44, 0
    v_mov_b32 v45, 0
    v_mov_b32 v46, 0
    v_mov_b32 v47, 0
    s_nop 5
    buffer_load_dwordx4 v[28:31], v2, s[8:11], s27 offen offset:1024 sc1
    v_mov_b32 v48, 0
    v_mov_b32 v49, 0
    v_mov_b32 v50, 0
    v_mov_b32 v51, 0
    v_mov_b32 v52, 0
    v_mov_b32 v53, 0
    v_mov_b32 v54, 0
    v_mov_b32 v55, 0
    s_nop 5
    buffer_load_dwordx4 v[32:35], v2, s[8:11], s27 offen offset:2048 sc1
    v_mov_b32 v56, 0
    v_mov_b32 v57, 0
    v_mov_b32 v58, 0
    v_mov_b32 v59, 0
    v_mov_b32 v60, 0
    v_mov_b32 v61, 0
    v_mov_b32 v62, 0
    v_mov_b32 v63, 0
    s_nop 5
    buffer_load_dwordx4 v[36:39], v2, s[8:11], s27 offen offset:3072 sc1
RPGs_S0123:
    s_waitcnt vmcnt(3)
    v_cmp_eq_u32 vcc, -1, v27
    s_cbranch_vccnz RPGs_S0123_F
RPGs_S0123_OK:
    v_smfmac_f32_16x16x64_bf16 v[40:43], v[24:27], v[64:71], v1
    s_waitcnt vmcnt(2)
    v_cmp_eq_u32 vcc, -1, v31
    v_smfmac_f32_16x16x64_bf16 v[44:47], v[24:27], v[72:79], v1
    v_max_u32 v5, v24, v25
    v_max_u32 v6, v26, v27
    v_smfmac_f32_16x16x64_bf16 v[48:51], v[24:27], v[80:87], v1
    s_cbranch_vccnz RPGs_S0123_T
    v_smfmac_f32_16x16x64_bf16 v[52:55], v[24:27], v[88:95], v1
RPGs_S123_OK:
    v_smfmac_f32_16x16x64_bf16 v[40:43], v[28:31], v[112:119], v1
    s_waitcnt vmcnt(1)
    v_cmp_eq_u32 vcc, -1, v35
    v_smfmac_f32_16x16x64_bf16 v[44:47], v[28:31], v[120:127], v1
    v_max3_u32 v5, v5, v28, v29
    v_max3_u32 v6, v6, v30, v31
    v_smfmac_f32_16x16x64_bf16 v[48:51], v[28:31], v[128:135], v1
    s_cbranch_vccnz RPGs_S123_T
    v_smfmac_f32_16x16x64_bf16 v[52:55], v[28:31], v[136:143], v1
RPGs_S23_OK:
    v_smfmac_f32_16x16x64_bf16 v[40:43], v[32:35], v[160:167], v1
    s_waitcnt vmcnt(0)
    v_cmp_eq_u32 vcc, -1, v39
    v_smfmac_f32_16x16x64_bf16 v[44:47], v[32:35], v[168:175], v1
    v_max3_u32 v5, v5, v32, v33
    v_max3_u32 v6, v6, v34, v35
    v_smfmac_f32_16x16x64_bf16 v[48:51], v[32:35], v[176:183], v1
    s_cbranch_vccnz RPGs_S23_T
    v_smfmac_f32_16x16x64_bf16 v[52:55], v[32:35], v[184:191], v1
RPGs_S3_OK:
    v_smfmac_f32_16x16x64_bf16 v[40:43], v[36:39], v[208:215], v1
    v_max3_u32 v5, v5, v36, v37
    v_max3_u32 v6, v6, v38, v39
    v_smfmac_f32_16x16x64_bf16 v[44:47], v[36:39], v[216:223], v1
    v_smfmac_f32_16x16x64_bf16 v[48:51], v[36:39], v[224:231], v1
    v_smfmac_f32_16x16x64_bf16 v[52:55], v[36:39], v[232:239], v1
RPGs_DONE:
    v_max_u32 v5, v5, v6
    v_cmp_eq_u32 vcc, -1, v5
    v_cvt_pk_bf16_f32 v40, v40, v44
    v_cvt_pk_bf16_f32 v41, v41, v45
    v_cvt_pk_bf16_f32 v42, v42, v46
    v_cvt_pk_bf16_f32 v43, v43, v47
    ds_write_b128 v3, v[40:43] offset:0
    s_cbranch_vccnz RPs_RX
    v_smfmac_f32_16x16x64_bf16 v[56:59], v[24:27], v[96:103], v1
    v_cvt_pk_bf16_f32 v48, v48, v52
    v_cvt_pk_bf16_f32 v49, v49, v53
    v_cvt_pk_bf16_f32 v50, v50, v54
    v_cvt_pk_bf16_f32 v51, v51, v55
    ds_write_b128 v3, v[48:51] offset:4096
    v_smfmac_f32_16x16x64_bf16 v[60:63], v[24:27], v[104:111], v1
    v_smfmac_f32_16x16x64_bf16 v[56:59], v[28:31], v[144:151], v1
    v_smfmac_f32_16x16x64_bf16 v[60:63], v[28:31], v[152:159], v1
    s_waitcnt lgkmcnt(0)
    s_barrier
    ds_read_b128 v[40:43], v4 offset:0
    ds_read_b128 v[44:47], v4 offset:1024
    s_waitcnt lgkmcnt(1)
    v_mfma_f32_16x16x32_bf16 v[20:23], v[16:19], v[40:43], 0
    s_waitcnt lgkmcnt(0)
    v_mfma_f32_16x16x32_bf16 v[20:23], v[16:19], v[44:47], v[20:23]
    v_smfmac_f32_16x16x64_bf16 v[56:59], v[32:35], v[192:199], v1
    v_smfmac_f32_16x16x64_bf16 v[60:63], v[32:35], v[200:207], v1
    s_nop 1
    v_cvt_pk_bf16_f32 v10, v20, v21
    v_min_u32 v10, -2, v10
    buffer_store_dword v10, v7, s[8:11], s28 offen sc1
    v_smfmac_f32_16x16x64_bf16 v[56:59], v[36:39], v[240:247], v1
    v_smfmac_f32_16x16x64_bf16 v[60:63], v[36:39], v[248:255], v1
    s_nop 7
    v_cvt_pk_bf16_f32 v48, v56, v60
    v_cvt_pk_bf16_f32 v49, v57, v61
    v_cvt_pk_bf16_f32 v50, v58, v62
    v_cvt_pk_bf16_f32 v51, v59, v63
    ds_write_b128 v3, v[48:51] offset:8192
    s_waitcnt lgkmcnt(0)
    s_barrier
    s_add_u32 s29, s25, 3
    s_and_b32 s29, s29, 3
    s_lshl_b32 s29, s29, 18
    s_add_u32 s29, s29, s37
    s_add_u32 s33, s25, 3
    s_and_b32 s33, s33, 3
    s_lshl_b32 s33, s33, 17
    s_add_u32 s33, s33, s36
    s_cmp_eq_u32 s49, 1
    s_cselect_b32 s29, s33, s29
    s_add_u32 s25, s25, 1
    s_and_b32 s27, s25, 3
    s_lshl_b32 s27, s27, 17
    s_add_u32 s27, s27, s36
    s_and_b32 s28, s25, 3
    s_lshl_b32 s28, s28, 18
    s_add_u32 s28, s28, s37
    s_cmp_ge_u32 s25, 64
    s_cbranch_scc1 RPs_FIN
    s_barrier
    s_cmp_ge_u32 s49, 2
    s_cbranch_scc1 RPs_NOARM
    buffer_store_dwordx4 v[12:15], v8, s[8:11], s29 offen sc1
    s_branch RPs_NOCP
RPs_NOARM:
    s_lshr_b32 s33, s35, 8
    s_xor_b32 s33, s33, s36
    s_and_b32 s33, s33, 0x2000
    s_add_u32 s33, s33, s35
    buffer_store_dword v10, v7, s[8:11], s33 offen sc1
    s_add_u32 s35, s35, 524288
RPs_NOCP:
    s_add_u32 s38, s25, 0
    s_and_b32 s39, s38, 71
    s_or_b32 s39, s39, s49
    s_cbranch_scc1 RPs_NOKV
    s_lshr_b32 s38, s38, 3
    s_mul_i32 s39, s21, 8
    s_add_u32 s38, s38, s39
    s_lshl_b32 s38, s38, 7
    s_add_u32 s38, s38, 124780544
    buffer_load_dword v6, off, s[8:11], s38 sc1
    s_barrier
RPs_KV:
    s_waitcnt vmcnt(0)
    v_cmp_gt_u32 vcc, 32, v6
    s_cbranch_vccz RPs_KVOK
    s_sleep 2
    buffer_load_dword v6, off, s[8:11], s38 sc1
    s_sub_u32 s26, s26, 1
    s_cbranch_scc1 K_FAIL
    s_branch RPs_KV
RPs_NOKV:
    s_barrier
RPs_KVOK:
    s_waitcnt vmcnt(0)
    s_barrier
    s_barrier
    s_cmp_lg_u32 s47, 0
    s_barrier
    s_branch RPs_LOOP
RPs_FIN:
    s_cmp_lt_u32 s49, 2
    s_cbranch_scc1 RP_END
    s_lshr_b32 s33, s35, 8
    s_xor_b32 s33, s33, s36
    s_and_b32 s33, s33, 0x2000
    s_add_u32 s33, s33, s35
    buffer_store_dword v10, v7, s[8:11], s33 offen sc1
    s_add_u32 s35, s35, 524288
    s_waitcnt vmcnt(0)
    s_branch RP_END
RPs_RX:
    s_sub_u32 s26, s26, 1
    s_cbranch_scc1 K_FAIL
    s_waitcnt vmcnt(0) lgkmcnt(0)
    s_nop 4
    s_branch RPs_RETRY
RPGs_S123:
    s_waitcnt vmcnt(2)
    v_cmp_eq_u32 vcc, -1, v31
    s_cbranch_vccnz RPGs_S123_F
    s_branch RPGs_S123_OK
RPGs_S23:
    s_waitcnt vmcnt(1)
    v_cmp_eq_u32 vcc, -1, v35
    s_cbranch_vccnz RPGs_S23_F
    s_branch RPGs_S23_OK
RPGs_S0123_T:
    v_smfmac_f32_16x16x64_bf16 v[52:55], v[24:27], v[88:95], v1
    s_branch RPGs_S123_F
RPGs_S123_T:
    v_smfmac_f32_16x16x64_bf16 v[52:55], v[28:31], v[136:143], v1
    s_branch RPGs_S23_F
RPGs_S23_T:
    v_smfmac_f32_16x16x64_bf16 v[52:55], v[32:35], v[184:191], v1
    s_branch RPGs_S3_F
RPGs_S0123_F:
    buffer_load_dwordx4 v[24:27], v2, s[8:11], s27 offen offset:0 sc1
    s_sub_u32 s26, s26, 1
    s_cbranch_scc1 K_FAIL
    s_branch RPGs_S1230
RPGs_S123_F:
    buffer_load_dwordx4 v[28:31], v2, s[8:11], s27 offen offset:1024 sc1
    s_sub_u32 s26, s26, 1
    s_cbranch_scc1 K_FAIL
    s_branch RPGs_S231
RPGs_S23_F:
    buffer_load_dwordx4 v[32:35], v2, s[8:11], s27 offen offset:2048 sc1
    s_sub_u32 s26, s26, 1
    s_cbranch_scc1 K_FAIL
    s_branch RPGs_S32
RPGs_S3_F:
    buffer_load_dwordx4 v[36:39], v2, s[8:11], s27 offen offset:3072 sc1
    s_sub_u32 s26, s26, 1
    s_cbranch_scc1 K_FAIL
    s_nop 10
    buffer_load_dwordx4 v[36:39], v2, s[8:11], s27 offen offset:3072 sc1
    s_nop 10
    buffer_load_dwordx4 v[36:39], v2, s[8:11], s27 offen offset:3072 sc1
    s_nop 10
    buffer_load_dwordx4 v[36:39], v2, s[8:11], s27 offen offset:3072 sc1
RPGs_S3_L:
    s_waitcnt vmcnt(3)
    v_max3_u32 v11, v36, v37, v38
    v_max_u32 v11, v11, v39
    v_cmp_eq_u32 vcc, -1, v11
    s_cbranch_vccz RPGs_S3_OK
    buffer_load_dwordx4 v[36:39], v2, s[8:11], s27 offen offset:3072 sc1
    s_sub_u32 s26, s26, 1
    s_cbranch_scc1 K_FAIL
    s_branch RPGs_S3_L
RPGs_S1230:
    s_waitcnt vmcnt(3)
    v_cmp_eq_u32 vcc, -1, v31
    s_cbranch_vccnz RPGs_S1230_F
RPGs_S1230_OK:
    v_smfmac_f32_16x16x64_bf16 v[40:43], v[28:31], v[112:119], v1
    s_waitcnt vmcnt(2)
    v_cmp_eq_u32 vcc, -1, v35
    v_smfmac_f32_16x16x64_bf16 v[44:47], v[28:31], v[120:127], v1
    v_max_u32 v5, v28, v29
    v_max_u32 v6, v30, v31
    v_smfmac_f32_16x16x64_bf16 v[48:51], v[28:31], v[128:135], v1
    s_cbranch_vccnz RPGs_S1230_T
    v_smfmac_f32_16x16x64_bf16 v[52:55], v[28:31], v[136:143], v1
    s_branch RPGs_S230_OK
RPGs_S1230_T:
    v_smfmac_f32_16x16x64_bf16 v[52:55], v[28:31], v[136:143], v1
    s_branch RPGs_S230_F
RPGs_S1230_F:
    buffer_load_dwordx4 v[28:31], v2, s[8:11], s27 offen offset:1024 sc1
    s_sub_u32 s26, s26, 1
    s_cbranch_scc1 K_FAIL
    s_branch RPGs_S2301
RPGs_S231:
    s_waitcnt vmcnt(2)
    v_cmp_eq_u32 vcc, -1, v35
    s_cbranch_vccnz RPGs_S231_F
RPGs_S231_OK:
    v_smfmac_f32_16x16x64_bf16 v[40:43], v[32:35], v[160:167], v1
    s_waitcnt vmcnt(1)
    v_cmp_eq_u32 vcc, -1, v39
    v_smfmac_f32_16x16x64_bf16 v[44:47], v[32:35], v[168:175], v1
    v_max3_u32 v5, v5, v32, v33
    v_max3_u32 v6, v6, v34, v35
    v_smfmac_f32_16x16x64_bf16 v[48:51], v[32:35], v[176:183], v1
    s_cbranch_vccnz RPGs_S231_T
    v_smfmac_f32_16x16x64_bf16 v[52:55], v[32:35], v[184:191], v1
    s_branch RPGs_S31_OK
RPGs_S231_T:
    v_smfmac_f32_16x16x64_bf16 v[52:55], v[32:35], v[184:191], v1
    s_branch RPGs_S31_F
RPGs_S231_F:
    buffer_load_dwordx4 v[32:35], v2, s[8:11], s27 offen offset:2048 sc1
    s_sub_u32 s26, s26, 1
    s_cbranch_scc1 K_FAIL
    s_branch RPGs_S312
RPGs_S32:
    s_waitcnt vmcnt(1)
    v_cmp_eq_u32 vcc, -1, v39
    s_cbranch_vccnz RPGs_S32_F
RPGs_S32_OK:
    v_smfmac_f32_16x16x64_bf16 v[40:43], v[36:39], v[208:215], v1
    s_waitcnt vmcnt(0)
    v_cmp_eq_u32 vcc, -1, v35
    v_smfmac_f32_16x16x64_bf16 v[44:47], v[36:39], v[216:223], v1
    v_max3_u32 v5, v5, v36, v37
    v_max3_u32 v6, v6, v38, v39
    v_smfmac_f32_16x16x64_bf16 v[48:51], v[36:39], v[224:231], v1
    s_cbranch_vccnz RPGs_S32_T
    v_smfmac_f32_16x16x64_bf16 v[52:55], v[36:39], v[232:239], v1
    s_branch RPGs_S2_OK
RPGs_S32_T:
    v_smfmac_f32_16x16x64_bf16 v[52:55], v[36:39], v[232:239], v1
    s_branch RPGs_S2_F
RPGs_S32_F:
    buffer_load_dwordx4 v[36:39], v2, s[8:11], s27 offen offset:3072 sc1
    s_sub_u32 s26, s26, 1
    s_cbranch_scc1 K_FAIL
    s_branch RPGs_S23
RPGs_S230:
    s_waitcnt vmcnt(2)
    v_cmp_eq_u32 vcc, -1, v35
    s_cbranch_vccnz RPGs_S230_F
RPGs_S230_OK:
    v_smfmac_f32_16x16x64_bf16 v[40:43], v[32:35], v[160:167], v1
    s_waitcnt vmcnt(1)
    v_cmp_eq_u32 vcc, -1, v39
    v_smfmac_f32_16x16x64_bf16 v[44:47], v[32:35], v[168:175], v1
    v_max3_u32 v5, v5, v32, v33
    v_max3_u32 v6, v6, v34, v35
    v_smfmac_f32_16x16x64_bf16 v[48:51], v[32:35], v[176:183], v1
    s_cbranch_vccnz RPGs_S230_T
    v_smfmac_f32_16x16x64_bf16 v[52:55], v[32:35], v[184:191], v1
    s_branch RPGs_S30_OK
RPGs_S230_T:
    v_smfmac_f32_16x16x64_bf16 v[52:55], v[32:35], v[184:191], v1
    s_branch RPGs_S30_F
RPGs_S230_F:
    buffer_load_dwordx4 v[32:35], v2, s[8:11], s27 offen offset:2048 sc1
    s_sub_u32 s26, s26, 1
    s_cbranch_scc1 K_FAIL
    s_branch RPGs_S302
RPGs_S2301:
    s_waitcnt vmcnt(3)
    v_cmp_eq_u32 vcc, -1, v35
    s_cbranch_vccnz RPGs_S2301_F
RPGs_S2301_OK:
    v_smfmac_f32_16x16x64_bf16 v[40:43], v[32:35], v[160:167], v1
    s_waitcnt vmcnt(2)
    v_cmp_eq_u32 vcc, -1, v39
    v_smfmac_f32_16x16x64_bf16 v[44:47], v[32:35], v[168:175], v1
    v_max_u32 v5, v32, v33
    v_max_u32 v6, v34, v35
    v_smfmac_f32_16x16x64_bf16 v[48:51], v[32:35], v[176:183], v1
    s_cbranch_vccnz RPGs_S2301_T
    v_smfmac_f32_16x16x64_bf16 v[52:55], v[32:35], v[184:191], v1
    s_branch RPGs_S301_OK
RPGs_S2301_T:
    v_smfmac_f32_16x16x64_bf16 v[52:55], v[32:35], v[184:191], v1
    s_branch RPGs_S301_F
RPGs_S2301_F:
    buffer_load_dwordx4 v[32:35], v2, s[8:11], s27 offen offset:2048 sc1
    s_sub_u32 s26, s26, 1
    s_cbranch_scc1 K_FAIL
    s_branch RPGs_S3012
RPGs_S31:
    s_waitcnt vmcnt(1)
    v_cmp_eq_u32 vcc, -1, v39
    s_cbranch_vccnz RPGs_S31_F
RPGs_S31_OK:
    v_smfmac_f32_16x16x64_bf16 v[40:43], v[36:39], v[208:215], v1
    s_waitcnt vmcnt(0)
    v_cmp_eq_u32 vcc, -1, v31
    v_smfmac_f32_16x16x64_bf16 v[44:47], v[36:39], v[216:223], v1
    v_max3_u32 v5, v5, v36, v37
    v_max3_u32 v6, v6, v38, v39
    v_smfmac_f32_16x16x64_bf16 v[48:51], v[36:39], v[224:231], v1
    s_cbranch_vccnz RPGs_S31_T
    v_smfmac_f32_16x16x64_bf16 v[52:55], v[36:39], v[232:239], v1
    s_branch RPGs_S1_OK
RPGs_S31_T:
    v_smfmac_f32_16x16x64_bf16 v[52:55], v[36:39], v[232:239], v1
    s_branch RPGs_S1_F
RPGs_S31_F:
    buffer_load_dwordx4 v[36:39], v2, s[8:11], s27 offen offset:3072 sc1
    s_sub_u32 s26, s26, 1
    s_cbranch_scc1 K_FAIL
    s_branch RPGs_S13
RPGs_S312:
    s_waitcnt vmcnt(2)
    v_cmp_eq_u32 vcc, -1, v39
    s_cbranch_vccnz RPGs_S312_F
RPGs_S312_OK:
    v_smfmac_f32_16x16x64_bf16 v[40:43], v[36:39], v[208:215], v1
    s_waitcnt vmcnt(1)
    v_cmp_eq_u32 vcc, -1, v31
    v_smfmac_f32_16x16x64_bf16 v[44:47], v[36:39], v[216:223], v1
    v_max3_u32 v5, v5, v36, v37
    v_max3_u32 v6, v6, v38, v39
    v_smfmac_f32_16x16x64_bf16 v[48:51], v[36:39], v[224:231], v1
    s_cbranch_vccnz RPGs_S312_T
    v_smfmac_f32_16x16x64_bf16 v[52:55], v[36:39], v[232:239], v1
    s_branch RPGs_S12_OK
RPGs_S312_T:
    v_smfmac_f32_16x16x64_bf16 v[52:55], v[36:39], v[232:239], v1
    s_branch RPGs_S12_F
RPGs_S312_F:
    buffer_load_dwordx4 v[36:39], v2, s[8:11], s27 offen offset:3072 sc1
    s_sub_u32 s26, s26, 1
    s_cbranch_scc1 K_FAIL
    s_branch RPGs_S123
RPGs_S2_OK:
    v_smfmac_f32_16x16x64_bf16 v[40:43], v[32:35], v[160:167], v1
    v_max3_u32 v5, v5, v32, v33
    v_max3_u32 v6, v6, v34, v35
    v_smfmac_f32_16x16x64_bf16 v[44:47], v[32:35], v[168:175], v1
    v_smfmac_f32_16x16x64_bf16 v[48:51], v[32:35], v[176:183], v1
    v_smfmac_f32_16x16x64_bf16 v[52:55], v[32:35], v[184:191], v1
    s_branch RPGs_DONE
RPGs_S2_F:
    buffer_load_dwordx4 v[32:35], v2, s[8:11], s27 offen offset:2048 sc1
    s_sub_u32 s26, s26, 1
    s_cbranch_scc1 K_FAIL
    s_nop 10
    buffer_load_dwordx4 v[32:35], v2, s[8:11], s27 offen offset:2048 sc1
    s_nop 10
    buffer_load_dwordx4 v[32:35], v2, s[8:11], s27 offen offset:2048 sc1
    s_nop 10
    buffer_load_dwordx4 v[32:35], v2, s[8:11], s27 offen offset:2048 sc1
RPGs_S2_L:
    s_waitcnt vmcnt(3)
    v_max3_u32 v11, v32, v33, v34
    v_max_u32 v11, v11, v35
    v_cmp_eq_u32 vcc, -1, v11
    s_cbranch_vccz RPGs_S2_OK
    buffer_load_dwordx4 v[32:35], v2, s[8:11], s27 offen offset:2048 sc1
    s_sub_u32 s26, s26, 1
    s_cbranch_scc1 K_FAIL
    s_branch RPGs_S2_L
RPGs_S30:
    s_waitcnt vmcnt(1)
    v_cmp_eq_u32 vcc, -1, v39
    s_cbranch_vccnz RPGs_S30_F
RPGs_S30_OK:
    v_smfmac_f32_16x16x64_bf16 v[40:43], v[36:39], v[208:215], v1
    s_waitcnt vmcnt(0)
    v_cmp_eq_u32 vcc, -1, v27
    v_smfmac_f32_16x16x64_bf16 v[44:47], v[36:39], v[216:223], v1
    v_max3_u32 v5, v5, v36, v37
    v_max3_u32 v6, v6, v38, v39
    v_smfmac_f32_16x16x64_bf16 v[48:51], v[36:39], v[224:231], v1
    s_cbranch_vccnz RPGs_S30_T
    v_smfmac_f32_16x16x64_bf16 v[52:55], v[36:39], v[232:239], v1
    s_branch RPGs_S0_OK
RPGs_S30_T:
    v_smfmac_f32_16x16x64_bf16 v[52:55], v[36:39], v[232:239], v1
    s_branch RPGs_S0_F
RPGs_S30_F:
    buffer_load_dwordx4 v[36:39], v2, s[8:11], s27 offen offset:3072 sc1
    s_sub_u32 s26, s26, 1
    s_cbranch_scc1 K_FAIL
    s_branch RPGs_S03
RPGs_S302:
    s_waitcnt vmcnt(2)
    v_cmp_eq_u32 vcc, -1, v39
    s_cbranch_vccnz RPGs_S302_F
RPGs_S302_OK:
    v_smfmac_f32_16x16x64_bf16 v[40:43], v[36:39], v[208:215], v1
    s_waitcnt vmcnt(1)
    v_cmp_eq_u32 vcc, -1, v27
    v_smfmac_f32_16x16x64_bf16 v[44:47], v[36:39], v[216:223], v1
    v_max3_u32 v5, v5, v36, v37
    v_max3_u32 v6, v6, v38, v39
    v_smfmac_f32_16x16x64_bf16 v[48:51], v[36:39], v[224:231], v1
    s_cbranch_vccnz RPGs_S302_T
    v_smfmac_f32_16x16x64_bf16 v[52:55], v[36:39], v[232:239], v1
    s_branch RPGs_S02_OK
RPGs_S302_T:
    v_smfmac_f32_16x16x64_bf16 v[52:55], v[36:39], v[232:239], v1
    s_branch RPGs_S02_F
RPGs_S302_F:
    buffer_load_dwordx4 v[36:39], v2, s[8:11], s27 offen offset:3072 sc1
    s_sub_u32 s26, s26, 1
    s_cbranch_scc1 K_FAIL
    s_branch RPGs_S023
RPGs_S301:
    s_waitcnt vmcnt(2)
    v_cmp_eq_u32 vcc, -1, v39
    s_cbranch_vccnz RPGs_S301_F
RPGs_S301_OK:
    v_smfmac_f32_16x16x64_bf16 v[40:43], v[36:39], v[208:215], v1
    s_waitcnt vmcnt(1)
    v_cmp_eq_u32 vcc, -1, v27
    v_smfmac_f32_16x16x64_bf16 v[44:47], v[36:39], v[216:223], v1
    v_max3_u32 v5, v5, v36, v37
    v_max3_u32 v6, v6, v38, v39
    v_smfmac_f32_16x16x64_bf16 v[48:51], v[36:39], v[224:231], v1
    s_cbranch_vccnz RPGs_S301_T
    v_smfmac_f32_16x16x64_bf16 v[52:55], v[36:39], v[232:239], v1
    s_branch RPGs_S01_OK
RPGs_S301_T:
    v_smfmac_f32_16x16x64_bf16 v[52:55], v[36:39], v[232:239], v1
    s_branch RPGs_S01_F
RPGs_S301_F:
    buffer_load_dwordx4 v[36:39], v2, s[8:11], s27 offen offset:3072 sc1
    s_sub_u32 s26, s26, 1
    s_cbranch_scc1 K_FAIL
    s_branch RPGs_S013
RPGs_S3012:
    s_waitcnt vmcnt(3)
    v_cmp_eq_u32 vcc, -1, v39
    s_cbranch_vccnz RPGs_S3012_F
RPGs_S3012_OK:
    v_smfmac_f32_16x16x64_bf16 v[40:43], v[36:39], v[208:215], v1
    s_waitcnt vmcnt(2)
    v_cmp_eq_u32 vcc, -1, v27
    v_smfmac_f32_16x16x64_bf16 v[44:47], v[36:39], v[216:223], v1
    v_max_u32 v5, v36, v37
    v_max_u32 v6, v38, v39
    v_smfmac_f32_16x16x64_bf16 v[48:51], v[36:39], v[224:231], v1
    s_cbranch_vccnz RPGs_S3012_T
    v_smfmac_f32_16x16x64_bf16 v[52:55], v[36:39], v[232:239], v1
    s_branch RPGs_S012_OK
RPGs_S3012_T:
    v_smfmac_f32_16x16x64_bf16 v[52:55], v[36:39], v[232:239], v1
    s_branch RPGs_S012_F
RPGs_S3012_F:
    buffer_load_dwordx4 v[36:39], v2, s[8:11], s27 offen offset:3072 sc1
    s_sub_u32 s26, s26, 1
    s_cbranch_scc1 K_FAIL
    s_branch RPGs_S0123
RPGs_S1_OK:
    v_smfmac_f32_16x16x64_bf16 v[40:43], v[28:31], v[112:119], v1
    v_max3_u32 v5, v5, v28, v29
    v_max3_u32 v6, v6, v30, v31
    v_smfmac_f32_16x16x64_bf16 v[44:47], v[28:31], v[120:127], v1
    v_smfmac_f32_16x16x64_bf16 v[48:51], v[28:31], v[128:135], v1
    v_smfmac_f32_16x16x64_bf16 v[52:55], v[28:31], v[136:143], v1
    s_branch RPGs_DONE
RPGs_S1_F:
    buffer_load_dwordx4 v[28:31], v2, s[8:11], s27 offen offset:1024 sc1
    s_sub_u32 s26, s26, 1
    s_cbranch_scc1 K_FAIL
    s_nop 10
    buffer_load_dwordx4 v[28:31], v2, s[8:11], s27 offen offset:1024 sc1
    s_nop 10
    buffer_load_dwordx4 v[28:31], v2, s[8:11], s27 offen offset:1024 sc1
    s_nop 10
    buffer_load_dwordx4 v[28:31], v2, s[8:11], s27 offen offset:1024 sc1
RPGs_S1_L:
    s_waitcnt vmcnt(3)
    v_max3_u32 v11, v28, v29, v30
    v_max_u32 v11, v11, v31
    v_cmp_eq_u32 vcc, -1, v11
    s_cbranch_vccz RPGs_S1_OK
    buffer_load_dwordx4 v[28:31], v2, s[8:11], s27 offen offset:1024 sc1
    s_sub_u32 s26, s26, 1
    s_cbranch_scc1 K_FAIL
    s_branch RPGs_S1_L
RPGs_S13:
    s_waitcnt vmcnt(1)
    v_cmp_eq_u32 vcc, -1, v31
    s_cbranch_vccnz RPGs_S13_F
RPGs_S13_OK:
    v_smfmac_f32_16x16x64_bf16 v[40:43], v[28:31], v[112:119], v1
    s_waitcnt vmcnt(0)
    v_cmp_eq_u32 vcc, -1, v39
    v_smfmac_f32_16x16x64_bf16 v[44:47], v[28:31], v[120:127], v1
    v_max3_u32 v5, v5, v28, v29
    v_max3_u32 v6, v6, v30, v31
    v_smfmac_f32_16x16x64_bf16 v[48:51], v[28:31], v[128:135], v1
    s_cbranch_vccnz RPGs_S13_T
    v_smfmac_f32_16x16x64_bf16 v[52:55], v[28:31], v[136:143], v1
    s_branch RPGs_S3_OK
RPGs_S13_T:
    v_smfmac_f32_16x16x64_bf16 v[52:55], v[28:31], v[136:143], v1
    s_branch RPGs_S3_F
RPGs_S13_F:
    buffer_load_dwordx4 v[28:31], v2, s[8:11], s27 offen offset:1024 sc1
    s_sub_u32 s26, s26, 1
    s_cbranch_scc1 K_FAIL
    s_branch RPGs_S31
RPGs_S12:
    s_waitcnt vmcnt(1)
    v_cmp_eq_u32 vcc, -1, v31
    s_cbranch_vccnz RPGs_S12_F
RPGs_S12_OK:
    v_smfmac_f32_16x16x64_bf16 v[40:43], v[28:31], v[112:119], v1
    s_waitcnt vmcnt(0)
    v_cmp_eq_u32 vcc, -1, v35
    v_smfmac_f32_16x16x64_bf16 v[44:47], v[28:31], v[120:127], v1
    v_max3_u32 v5, v5, v28, v29
    v_max3_u32 v6, v6, v30, v31
    v_smfmac_f32_16x16x64_bf16 v[48:51], v[28:31], v[128:135], v1
    s_cbranch_vccnz RPGs_S12_T
    v_smfmac_f32_16x16x64_bf16 v[52:55], v[28:31], v[136:143], v1
    s_branch RPGs_S2_OK
RPGs_S12_T:
    v_smfmac_f32_16x16x64_bf16 v[52:55], v[28:31], v[136:143], v1
    s_branch RPGs_S2_F
RPGs_S12_F:
    buffer_load_dwordx4 v[28:31], v2, s[8:11], s27 offen offset:1024 sc1
    s_sub_u32 s26, s26, 1
    s_cbranch_scc1 K_FAIL
    s_branch RPGs_S21
RPGs_S0_OK:
    v_smfmac_f32_16x16x64_bf16 v[40:43], v[24:27], v[64:71], v1
    v_max3_u32 v5, v5, v24, v25
    v_max3_u32 v6, v6, v26, v27
    v_smfmac_f32_16x16x64_bf16 v[44:47], v[24:27], v[72:79], v1
    v_smfmac_f32_16x16x64_bf16 v[48:51], v[24:27], v[80:87], v1
    v_smfmac_f32_16x16x64_bf16 v[52:55], v[24:27], v[88:95], v1
    s_branch RPGs_DONE
RPGs_S0_F:
    buffer_load_dwordx4 v[24:27], v2, s[8:11], s27 offen offset:0 sc1
    s_sub_u32 s26, s26, 1
    s_cbranch_scc1 K_FAIL
    s_nop 10
    buffer_load_dwordx4 v[24:27], v2, s[8:11], s27 offen offset:0 sc1
    s_nop 10
    buffer_load_dwordx4 v[24:27], v2, s[8:11], s27 offen offset:0 sc1
    s_nop 10
    buffer_load_dwordx4 v[24:27], v2, s[8:11], s27 offen offset:0 sc1
RPGs_S0_L:
    s_waitcnt vmcnt(3)
    v_max3_u32 v11, v24, v25, v26
    v_max_u32 v11, v11, v27
    v_cmp_eq_u32 vcc, -1, v11
    s_cbranch_vccz RPGs_S0_OK
    buffer_load_dwordx4 v[24:27], v2, s[8:11], s27 offen offset:0 sc1
    s_sub_u32 s26, s26, 1
    s_cbranch_scc1 K_FAIL
    s_branch RPGs_S0_L
RPGs_S03:
    s_waitcnt vmcnt(1)
    v_cmp_eq_u32 vcc, -1, v27
    s_cbranch_vccnz RPGs_S03_F
RPGs_S03_OK:
    v_smfmac_f32_16x16x64_bf16 v[40:43], v[24:27], v[64:71], v1
    s_waitcnt vmcnt(0)
    v_cmp_eq_u32 vcc, -1, v39
    v_smfmac_f32_16x16x64_bf16 v[44:47], v[24:27], v[72:79], v1
    v_max3_u32 v5, v5, v24, v25
    v_max3_u32 v6, v6, v26, v27
    v_smfmac_f32_16x16x64_bf16 v[48:51], v[24:27], v[80:87], v1
    s_cbranch_vccnz RPGs_S03_T
    v_smfmac_f32_16x16x64_bf16 v[52:55], v[24:27], v[88:95], v1
    s_branch RPGs_S3_OK
RPGs_S03_T:
    v_smfmac_f32_16x16x64_bf16 v[52:55], v[24:27], v[88:95], v1
    s_branch RPGs_S3_F
RPGs_S03_F:
    buffer_load_dwordx4 v[24:27], v2, s[8:11], s27 offen offset:0 sc1
    s_sub_u32 s26, s26, 1
    s_cbranch_scc1 K_FAIL
    s_branch RPGs_S30
RPGs_S02:
    s_waitcnt vmcnt(1)
    v_cmp_eq_u32 vcc, -1, v27
    s_cbranch_vccnz RPGs_S02_F
RPGs_S02_OK:
    v_smfmac_f32_16x16x64_bf16 v[40:43], v[24:27], v[64:71], v1
    s_waitcnt vmcnt(0)
    v_cmp_eq_u32 vcc, -1, v35
    v_smfmac_f32_16x16x64_bf16 v[44:47], v[24:27], v[72:79], v1
    v_max3_u32 v5, v5, v24, v25
    v_max3_u32 v6, v6, v26, v27
    v_smfmac_f32_16x16x64_bf16 v[48:51], v[24:27], v[80:87], v1
    s_cbranch_vccnz RPGs_S02_T
    v_smfmac_f32_16x16x64_bf16 v[52:55], v[24:27], v[88:95], v1
    s_branch RPGs_S2_OK
RPGs_S02_T:
    v_smfmac_f32_16x16x64_bf16 v[52:55], v[24:27], v[88:95], v1
    s_branch RPGs_S2_F
RPGs_S02_F:
    buffer_load_dwordx4 v[24:27], v2, s[8:11], s27 offen offset:0 sc1
    s_sub_u32 s26, s26, 1
    s_cbranch_scc1 K_FAIL
    s_branch RPGs_S20
RPGs_S023:
    s_waitcnt vmcnt(2)
    v_cmp_eq_u32 vcc, -1, v27
    s_cbranch_vccnz RPGs_S023_F
RPGs_S023_OK:
    v_smfmac_f32_16x16x64_bf16 v[40:43], v[24:27], v[64:71], v1
    s_waitcnt vmcnt(1)
    v_cmp_eq_u32 vcc, -1, v35
    v_smfmac_f32_16x16x64_bf16 v[44:47], v[24:27], v[72:79], v1
    v_max3_u32 v5, v5, v24, v25
    v_max3_u32 v6, v6, v26, v27
    v_smfmac_f32_16x16x64_bf16 v[48:51], v[24:27], v[80:87], v1
    s_cbranch_vccnz RPGs_S023_T
    v_smfmac_f32_16x16x64_bf16 v[52:55], v[24:27], v[88:95], v1
    s_branch RPGs_S23_OK
RPGs_S023_T:
    v_smfmac_f32_16x16x64_bf16 v[52:55], v[24:27], v[88:95], v1
    s_branch RPGs_S23_F
RPGs_S023_F:
    buffer_load_dwordx4 v[24:27], v2, s[8:11], s27 offen offset:0 sc1
    s_sub_u32 s26, s26, 1
    s_cbranch_scc1 K_FAIL
    s_branch RPGs_S230
RPGs_S01:
    s_waitcnt vmcnt(1)
    v_cmp_eq_u32 vcc, -1, v27
    s_cbranch_vccnz RPGs_S01_F
RPGs_S01_OK:
    v_smfmac_f32_16x16x64_bf16 v[40:43], v[24:27], v[64:71], v1
    s_waitcnt vmcnt(0)
    v_cmp_eq_u32 vcc, -1, v31
    v_smfmac_f32_16x16x64_bf16 v[44:47], v[24:27], v[72:79], v1
    v_max3_u32 v5, v5, v24, v25
    v_max3_u32 v6, v6, v26, v27
    v_smfmac_f32_16x16x64_bf16 v[48:51], v[24:27], v[80:87], v1
    s_cbranch_vccnz RPGs_S01_T
    v_smfmac_f32_16x16x64_bf16 v[52:55], v[24:27], v[88:95], v1
    s_branch RPGs_S1_OK
RPGs_S01_T:
    v_smfmac_f32_16x16x64_bf16 v[52:55], v[24:27], v[88:95], v1
    s_branch RPGs_S1_F
RPGs_S01_F:
    buffer_load_dwordx4 v[24:27], v2, s[8:11], s27 offen offset:0 sc1
    s_sub_u32 s26, s26, 1
    s_cbranch_scc1 K_FAIL
    s_branch RPGs_S10
RPGs_S013:
    s_waitcnt vmcnt(2)
    v_cmp_eq_u32 vcc, -1, v27
    s_cbranch_vccnz RPGs_S013_F
RPGs_S013_OK:
    v_smfmac_f32_16x16x64_bf16 v[40:43], v[24:27], v[64:71], v1
    s_waitcnt vmcnt(1)
    v_cmp_eq_u32 vcc, -1, v31
    v_smfmac_f32_16x16x64_bf16 v[44:47], v[24:27], v[72:79], v1
    v_max3_u32 v5, v5, v24, v25
    v_max3_u32 v6, v6, v26, v27
    v_smfmac_f32_16x16x64_bf16 v[48:51], v[24:27], v[80:87], v1
    s_cbranch_vccnz RPGs_S013_T
    v_smfmac_f32_16x16x64_bf16 v[52:55], v[24:27], v[88:95], v1
    s_branch RPGs_S13_OK
RPGs_S013_T:
    v_smfmac_f32_16x16x64_bf16 v[52:55], v[24:27], v[88:95], v1
    s_branch RPGs_S13_F
RPGs_S013_F:
    buffer_load_dwordx4 v[24:27], v2, s[8:11], s27 offen offset:0 sc1
    s_sub_u32 s26, s26, 1
    s_cbranch_scc1 K_FAIL
    s_branch RPGs_S130
RPGs_S012:
    s_waitcnt vmcnt(2)
    v_cmp_eq_u32 vcc, -1, v27
    s_cbranch_vccnz RPGs_S012_F
RPGs_S012_OK:
    v_smfmac_f32_16x16x64_bf16 v[40:43], v[24:27], v[64:71], v1
    s_waitcnt vmcnt(1)
    v_cmp_eq_u32 vcc, -1, v31
    v_smfmac_f32_16x16x64_bf16 v[44:47], v[24:27], v[72:79], v1
    v_max3_u32 v5, v5, v24, v25
    v_max3_u32 v6, v6, v26, v27
    v_smfmac_f32_16x16x64_bf16 v[48:51], v[24:27], v[80:87], v1
    s_cbranch_vccnz RPGs_S012_T
    v_smfmac_f32_16x16x64_bf16 v[52:55], v[24:27], v[88:95], v1
    s_branch RPGs_S12_OK
RPGs_S012_T:
    v_smfmac_f32_16x16x64_bf16 v[52:55], v[24:27], v[88:95], v1
    s_branch RPGs_S12_F
RPGs_S012_F:
    buffer_load_dwordx4 v[24:27], v2, s[8:11], s27 offen offset:0 sc1
    s_sub_u32 s26, s26, 1
    s_cbranch_scc1 K_FAIL
    s_branch RPGs_S120
RPGs_S21:
    s_waitcnt vmcnt(1)
    v_cmp_eq_u32 vcc, -1, v35
    s_cbranch_vccnz RPGs_S21_F
RPGs_S21_OK:
    v_smfmac_f32_16x16x64_bf16 v[40:43], v[32:35], v[160:167], v1
    s_waitcnt vmcnt(0)
    v_cmp_eq_u32 vcc, -1, v31
    v_smfmac_f32_16x16x64_bf16 v[44:47], v[32:35], v[168:175], v1
    v_max3_u32 v5, v5, v32, v33
    v_max3_u32 v6, v6, v34, v35
    v_smfmac_f32_16x16x64_bf16 v[48:51], v[32:35], v[176:183], v1
    s_cbranch_vccnz RPGs_S21_T
    v_smfmac_f32_16x16x64_bf16 v[52:55], v[32:35], v[184:191], v1
    s_branch RPGs_S1_OK
RPGs_S21_T:
    v_smfmac_f32_16x16x64_bf16 v[52:55], v[32:35], v[184:191], v1
    s_branch RPGs_S1_F
RPGs_S21_F:
    buffer_load_dwordx4 v[32:35], v2, s[8:11], s27 offen offset:2048 sc1
    s_sub_u32 s26, s26, 1
    s_cbranch_scc1 K_FAIL
    s_branch RPGs_S12
RPGs_S20:
    s_waitcnt vmcnt(1)
    v_cmp_eq_u32 vcc, -1, v35
    s_cbranch_vccnz RPGs_S20_F
RPGs_S20_OK:
    v_smfmac_f32_16x16x64_bf16 v[40:43], v[32:35], v[160:167], v1
    s_waitcnt vmcnt(0)
    v_cmp_eq_u32 vcc, -1, v27
    v_smfmac_f32_16x16x64_bf16 v[44:47], v[32:35], v[168:175], v1
    v_max3_u32 v5, v5, v32, v33
    v_max3_u32 v6, v6, v34, v35
    v_smfmac_f32_16x16x64_bf16 v[48:51], v[32:35], v[176:183], v1
    s_cbranch_vccnz RPGs_S20_T
    v_smfmac_f32_16x16x64_bf16 v[52:55], v[32:35], v[184:191], v1
    s_branch RPGs_S0_OK
RPGs_S20_T:
    v_smfmac_f32_16x16x64_bf16 v[52:55], v[32:35], v[184:191], v1
    s_branch RPGs_S0_F
RPGs_S20_F:
    buffer_load_dwordx4 v[32:35], v2, s[8:11], s27 offen offset:2048 sc1
    s_sub_u32 s26, s26, 1
    s_cbranch_scc1 K_FAIL
    s_branch RPGs_S02
RPGs_S10:
    s_waitcnt vmcnt(1)
    v_cmp_eq_u32 vcc, -1, v31
    s_cbranch_vccnz RPGs_S10_F
RPGs_S10_OK:
    v_smfmac_f32_16x16x64_bf16 v[40:43], v[28:31], v[112:119], v1
    s_waitcnt vmcnt(0)
    v_cmp_eq_u32 vcc, -1, v27
    v_smfmac_f32_16x16x64_bf16 v[44:47], v[28:31], v[120:127], v1
    v_max3_u32 v5, v5, v28, v29
    v_max3_u32 v6, v6, v30, v31
    v_smfmac_f32_16x16x64_bf16 v[48:51], v[28:31], v[128:135], v1
    s_cbranch_vccnz RPGs_S10_T
    v_smfmac_f32_16x16x64_bf16 v[52:55], v[28:31], v[136:143], v1
    s_branch RPGs_S0_OK
RPGs_S10_T:
    v_smfmac_f32_16x16x64_bf16 v[52:55], v[28:31], v[136:143], v1
    s_branch RPGs_S0_F
RPGs_S10_F:
    buffer_load_dwordx4 v[28:31], v2, s[8:11], s27 offen offset:1024 sc1
    s_sub_u32 s26, s26, 1
    s_cbranch_scc1 K_FAIL
    s_branch RPGs_S01
RPGs_S130:
    s_waitcnt vmcnt(2)
    v_cmp_eq_u32 vcc, -1, v31
    s_cbranch_vccnz RPGs_S130_F
RPGs_S130_OK:
    v_smfmac_f32_16x16x64_bf16 v[40:43], v[28:31], v[112:119], v1
    s_waitcnt vmcnt(1)
    v_cmp_eq_u32 vcc, -1, v39
    v_smfmac_f32_16x16x64_bf16 v[44:47], v[28:31], v[120:127], v1
    v_max3_u32 v5, v5, v28, v29
    v_max3_u32 v6, v6, v30, v31
    v_smfmac_f32_16x16x64_bf16 v[48:51], v[28:31], v[128:135], v1
    s_cbranch_vccnz RPGs_S130_T
    v_smfmac_f32_16x16x64_bf16 v[52:55], v[28:31], v[136:143], v1
    s_branch RPGs_S30_OK
RPGs_S130_T:
    v_smfmac_f32_16x16x64_bf16 v[52:55], v[28:31], v[136:143], v1
    s_branch RPGs_S30_F
RPGs_S130_F:
    buffer_load_dwordx4 v[28:31], v2, s[8:11], s27 offen offset:1024 sc1
    s_sub_u32 s26, s26, 1
    s_cbranch_scc1 K_FAIL
    s_branch RPGs_S301
RPGs_S120:
    s_waitcnt vmcnt(2)
    v_cmp_eq_u32 vcc, -1, v31
    s_cbranch_vccnz RPGs_S120_F
RPGs_S120_OK:
    v_smfmac_f32_16x16x64_bf16 v[40:43], v[28:31], v[112:119], v1
    s_waitcnt vmcnt(1)
    v_cmp_eq_u32 vcc, -1, v35
    v_smfmac_f32_16x16x64_bf16 v[44:47], v[28:31], v[120:127], v1
    v_max3_u32 v5, v5, v28, v29
    v_max3_u32 v6, v6, v30, v31
    v_smfmac_f32_16x16x64_bf16 v[48:51], v[28:31], v[128:135], v1
    s_cbranch_vccnz RPGs_S120_T
    v_smfmac_f32_16x16x64_bf16 v[52:55], v[28:31], v[136:143], v1
    s_branch RPGs_S20_OK
RPGs_S120_T:
    v_smfmac_f32_16x16x64_bf16 v[52:55], v[28:31], v[136:143], v1
    s_branch RPGs_S20_F
RPGs_S120_F:
    buffer_load_dwordx4 v[28:31], v2, s[8:11], s27 offen offset:1024 sc1
    s_sub_u32 s26, s26, 1
    s_cbranch_scc1 K_FAIL
    s_branch RPGs_S201
RPGs_S201:
    s_waitcnt vmcnt(2)
    v_cmp_eq_u32 vcc, -1, v35
    s_cbranch_vccnz RPGs_S201_F
RPGs_S201_OK:
    v_smfmac_f32_16x16x64_bf16 v[40:43], v[32:35], v[160:167], v1
    s_waitcnt vmcnt(1)
    v_cmp_eq_u32 vcc, -1, v27
    v_smfmac_f32_16x16x64_bf16 v[44:47], v[32:35], v[168:175], v1
    v_max3_u32 v5, v5, v32, v33
    v_max3_u32 v6, v6, v34, v35
    v_smfmac_f32_16x16x64_bf16 v[48:51], v[32:35], v[176:183], v1
    s_cbranch_vccnz RPGs_S201_T
    v_smfmac_f32_16x16x64_bf16 v[52:55], v[32:35], v[184:191], v1
    s_branch RPGs_S01_OK
RPGs_S201_T:
    v_smfmac_f32_16x16x64_bf16 v[52:55], v[32:35], v[184:191], v1
    s_branch RPGs_S01_F
RPGs_S201_F:
    buffer_load_dwordx4 v[32:35], v2, s[8:11], s27 offen offset:2048 sc1
    s_sub_u32 s26, s26, 1
    s_cbranch_scc1 K_FAIL
    s_branch RPGs_S012
RP_END:
    s_barrier
    s_load_dwordx2 s[4:5], s[0:1], 88
    s_lshl_b32 s33, s22, 14
    s_lshl_b32 s38, s21, 11
    s_add_u32 s33, s33, s38
    v_lshl_add_u32 v64, v0, 4, s33
    v_lshrrev_b32 v5, 4, v0
    s_lshl_b32 s38, s21, 2
    v_add_u32 v5, s38, v5
    v_lshlrev_b32 v65, 4, v5
    v_lshlrev_b32 v66, 11, v5
    v_bfe_u32 v6, v0, 1, 1
    v_lshl_add_u32 v65, v6, 2, v65
    v_bfe_u32 v6, v0, 3, 1
    v_lshl_add_u32 v65, v6, 3, v65
    v_lshl_add_u32 v66, v6, 5, v66
    v_bfe_u32 v6, v0, 2, 1
    v_lshl_add_u32 v65, v6, 8, v65
    v_and_b32 v6, 1, v0
    v_lshl_add_u32 v65, v6, 9, v65
    v_lshl_add_u32 v66, v6, 4, v66
    v_bfe_u32 v6, v0, 1, 2
    v_lshl_add_u32 v66, v6, 2, v66
    s_mov_b32 s38, 471
    s_waitcnt lgkmcnt(0)
    s_mov_b32 s12, s4
    s_and_b32 s13, s5, 0xffff
    s_mov_b32 s14, 4194304
    s_mov_b32 s15, 0x20000
    s_lshl_b32 s38, s38, 7
    s_add_u32 s38, s38, 124780544
RP_ZW:
    buffer_load_dword v6, off, s[8:11], s38 sc1
    s_sub_u32 s26, s26, 1
    s_cbranch_scc1 K_FAIL
    s_waitcnt vmcnt(0)
    v_cmp_gt_u32 vcc, 4, v6
    s_cbranch_vccz RP_ZW_OK
    s_sleep 2
    s_branch RP_ZW
RP_ZW_OK:
    s_lshr_b32 s29, s22, 2
    s_mul_i32 s29, s29, 9
    s_add_u32 s29, s29, 344
    s_lshl_b32 s29, s29, 16
    s_and_b32 s33, s22, 2
    s_lshl_b32 s33, s33, 12
    s_add_u32 s29, s29, s33
    s_and_b32 s33, s22, 1
    s_lshl_b32 s33, s33, 10
    s_add_u32 s29, s29, s33
    s_lshl_b32 s33, s49, 11
    s_add_u32 s29, s29, s33
    s_add_u32 s29, s29, 125861888
    buffer_load_dword v68, v65, s[8:11], s29 offen sc1
    s_add_u32 s29, s29, 16384
    buffer_load_dword v69, v65, s[8:11], s29 offen sc1
    s_lshl_b32 s28, s49, 15
    s_lshl_b32 s33, s22, 6
    s_add_u32 s28, s28, s33
    s_add_u32 s28, s28, 3932160
    s_lshl_b32 s27, s49, 19
    s_add_u32 s27, s27, s36
    s_add_u32 s27, s27, 192937984
    s_add_u32 s30, s28, 131072
    s_add_u32 s29, s27, 2097152
    s_xor_b32 s29, s29, 0x2000
    s_waitcnt vmcnt(0)
    v_lshlrev_b32 v48, 16, v68
    v_and_b32 v49, 0xffff0000, v68
    v_lshlrev_b32 v52, 16, v69
    v_and_b32 v53, 0xffff0000, v69
    s_barrier
    s_sleep 5
RP_TL:
    buffer_load_dwordx4 v[72:75], v64, s[8:11], s27 offen offset:0 sc1
    buffer_load_dwordx4 v[76:79], v64, s[8:11], s27 offen offset:1024 sc1
    buffer_load_dwordx4 v[80:83], v64, s[8:11], s29 offen offset:0 sc1
    buffer_load_dwordx4 v[84:87], v64, s[8:11], s29 offen offset:1024 sc1
    s_sub_u32 s26, s26, 1
    s_cbranch_scc1 K_FAIL
    s_waitcnt vmcnt(0)
    v_max3_u32 v5, v72, v73, v74
    v_max3_u32 v6, v75, v76, v77
    v_mfma_f32_16x16x32_bf16 v[40:43], v[16:19], v[72:75], v[48:51]
    v_max3_u32 v5, v5, v78, v79
    v_max3_u32 v6, v6, v80, v81
    v_mfma_f32_16x16x32_bf16 v[44:47], v[16:19], v[80:83], v[52:55]
    v_max3_u32 v5, v5, v82, v83
    v_max3_u32 v6, v6, v84, v85
    v_mfma_f32_16x16x32_bf16 v[40:43], v[16:19], v[76:79], v[40:43]
    v_max3_u32 v5, v5, v86, v87
    v_mfma_f32_16x16x32_bf16 v[44:47], v[16:19], v[84:87], v[44:47]
    v_max_u32 v5, v5, v6
    v_cmp_eq_u32 vcc, -1, v5
    s_nop 4
    s_cbranch_vccnz RP_TL
    v_cvt_pk_bf16_f32 v68, v40, v41
    buffer_store_dword v68, v66, s[12:15], s28 offen
    v_cvt_pk_bf16_f32 v69, v44, v45
    buffer_store_dword v69, v66, s[12:15], s30 offen
    s_branch R_JOIN
R_Q:
    s_cmp_eq_u32 s49, 3
    s_cbranch_scc0 RQ_NH
    v_lshrrev_b32 v30, 1, v0
    s_lshl_b32 s33, s20, 5
    v_add_u32 v30, s33, v30
    v_and_b32 v5, 1, v0
    v_lshlrev_b32 v5, 10, v5
    v_lshl_add_u32 v31, v30, 11, v5
    v_and_b32 v30, 1023, v30
    v_lshl_add_u32 v30, v30, 13, v5
    s_lshl_b32 s33, s21, 11
    s_load_dwordx2 s[4:5], s[0:1], 16
    s_waitcnt lgkmcnt(0)
    s_mov_b32 s12, s4
    s_and_b32 s13, s5, 0xffff
    s_mov_b32 s14, 8388608
    s_mov_b32 s15, 0x20000
    buffer_load_dword v51, v30, s[12:15], s33 offen offset:384
    s_mov_b32 exec_lo, 0xaaaaaaaa
    s_mov_b32 exec_hi, 0xaaaaaaaa
    buffer_load_dword v51, v30, s[12:15], s33 offen offset:896
    s_mov_b64 exec, -1
    s_load_dwordx2 s[4:5], s[0:1], 40
    s_waitcnt lgkmcnt(0)
    s_mov_b32 s12, s4
    s_and_b32 s13, s5, 0xffff
    s_mov_b32 s14, 8388608
    s_mov_b32 s15, 0x20000
    buffer_load_dword v51, v31, s[12:15], 0 offen offset:384
    s_mov_b32 exec_lo, 0xaaaaaaaa
    s_mov_b32 exec_hi, 0xaaaaaaaa
    buffer_load_dword v51, v31, s[12:15], 0 offen offset:896
    s_mov_b64 exec, -1
    s_sleep 16
    s_load_dwordx2 s[4:5], s[0:1], 24
    s_waitcnt lgkmcnt(0)
    s_mov_b32 s12, s4
    s_and_b32 s13, s5, 0xffff
    s_mov_b32 s14, 8388608
    s_mov_b32 s15, 0x20000
    buffer_load_dword v51, v30, s[12:15], s33 offen offset:384
    s_mov_b32 exec_lo, 0xaaaaaaaa
    s_mov_b32 exec_hi, 0xaaaaaaaa
    buffer_load_dword v51, v30, s[12:15], s33 offen offset:896
    s_mov_b64 exec, -1
    s_sleep 16
    s_load_dwordx2 s[4:5], s[0:1], 32
    s_waitcnt lgkmcnt(0)
    s_mov_b32 s12, s4
    s_and_b32 s13, s5, 0xffff
    s_mov_b32 s14, 8388608
    s_mov_b32 s15, 0x20000
    buffer_load_dword v51, v30, s[12:15], s33 offen offset:384
    s_mov_b32 exec_lo, 0xaaaaaaaa
    s_mov_b32 exec_hi, 0xaaaaaaaa
    buffer_load_dword v51, v30, s[12:15], s33 offen offset:896
    s_mov_b64 exec, -1
RQ_NH:
    s_add_u32 s33, s49, 1
    s_bitcmp1_b32 s33, 1
    s_cbranch_scc0 RQ_NW
    s_load_dwordx2 s[4:5], s[0:1], 40
    v_and_b32 v6, 31, v6
    v_lshlrev_b32 v6, 11, v6
    v_bfe_u32 v30, v0, 1, 2
    v_lshl_add_u32 v6, v30, 2, v6
    v_and_b32 v30, 1, v0
    v_lshl_add_u32 v6, v30, 4, v6
    v_and_b32 v30, 8, v0
    v_lshl_add_u32 v6, v30, 2, v6
    s_lshl_b32 s33, s21, 21
    s_lshl_b32 s38, s22, 6
    s_add_u32 s33, s33, s38
    s_and_b32 s38, s49, 1
    s_lshl_b32 s38, s38, 20
    s_add_u32 s33, s33, s38
    v_add_u32 v6, s33, v6
    s_waitcnt lgkmcnt(0)
    s_mov_b32 s12, s4
    s_and_b32 s13, s5, 0xffff
    s_mov_b32 s14, 8388608
    s_mov_b32 s15, 0x20000
    s_mov_b32 s33, 0
    s_mov_b32 s38, 2048
    buffer_load_dword v128, v6, s[12:15], s33 offen nt
    buffer_load_dword v136, v6, s[12:15], s38 offen nt
    s_mov_b32 s33, 16384
    s_mov_b32 s38, 18432
    buffer_load_dword v129, v6, s[12:15], s33 offen nt
    buffer_load_dword v137, v6, s[12:15], s38 offen nt
    s_mov_b32 s33, 4096
    s_mov_b32 s38, 6144
    buffer_load_dword v130, v6, s[12:15], s33 offen nt
    buffer_load_dword v138, v6, s[12:15], s38 offen nt
    s_mov_b32 s33, 20480
    s_mov_b32 s38, 22528
    buffer_load_dword v131, v6, s[12:15], s33 offen nt
    buffer_load_dword v139, v6, s[12:15], s38 offen nt
    s_mov_b32 s33, 65536
    s_mov_b32 s38, 67584
    buffer_load_dword v132, v6, s[12:15], s33 offen nt
    buffer_load_dword v140, v6, s[12:15], s38 offen nt
    s_mov_b32 s33, 81920
    s_mov_b32 s38, 83968
    buffer_load_dword v133, v6, s[12:15], s33 offen nt
    buffer_load_dword v141, v6, s[12:15], s38 offen nt
    s_mov_b32 s33, 69632
    s_mov_b32 s38, 71680
    buffer_load_dword v134, v6, s[12:15], s33 offen nt
    buffer_load_dword v142, v6, s[12:15], s38 offen nt
    s_mov_b32 s33, 86016
    s_mov_b32 s38, 88064
    buffer_load_dword v135, v6, s[12:15], s33 offen nt
    buffer_load_dword v143, v6, s[12:15], s38 offen nt
    s_waitcnt vmcnt(44)
    s_mov_b32 s33, 131072
    s_mov_b32 s38, 133120
    buffer_load_dword v144, v6, s[12:15], s33 offen nt
    buffer_load_dword v152, v6, s[12:15], s38 offen nt
    s_mov_b32 s33, 147456
    s_mov_b32 s38, 149504
    buffer_load_dword v145, v6, s[12:15], s33 offen nt
    buffer_load_dword v153, v6, s[12:15], s38 offen nt
    s_mov_b32 s33, 135168
    s_mov_b32 s38, 137216
    buffer_load_dword v146, v6, s[12:15], s33 offen nt
    buffer_load_dword v154, v6, s[12:15], s38 offen nt
    s_mov_b32 s33, 151552
    s_mov_b32 s38, 153600
    buffer_load_dword v147, v6, s[12:15], s33 offen nt
    buffer_load_dword v155, v6, s[12:15], s38 offen nt
    s_mov_b32 s33, 196608
    s_mov_b32 s38, 198656
    buffer_load_dword v148, v6, s[12:15], s33 offen nt
    buffer_load_dword v156, v6, s[12:15], s38 offen nt
    s_mov_b32 s33, 212992
    s_mov_b32 s38, 215040
    buffer_load_dword v149, v6, s[12:15], s33 offen nt
    buffer_load_dword v157, v6, s[12:15], s38 offen nt
    s_mov_b32 s33, 200704
    s_mov_b32 s38, 202752
    buffer_load_dword v150, v6, s[12:15], s33 offen nt
    buffer_load_dword v158, v6, s[12:15], s38 offen nt
    s_mov_b32 s33, 217088
    s_mov_b32 s38, 219136
    buffer_load_dword v151, v6, s[12:15], s33 offen nt
    buffer_load_dword v159, v6, s[12:15], s38 offen nt
    s_waitcnt vmcnt(44)
    s_mov_b32 s33, 262144
    s_mov_b32 s38, 264192
    buffer_load_dword v160, v6, s[12:15], s33 offen nt
    buffer_load_dword v168, v6, s[12:15], s38 offen nt
    s_mov_b32 s33, 278528
    s_mov_b32 s38, 280576
    buffer_load_dword v161, v6, s[12:15], s33 offen nt
    buffer_load_dword v169, v6, s[12:15], s38 offen nt
    s_mov_b32 s33, 266240
    s_mov_b32 s38, 268288
    buffer_load_dword v162, v6, s[12:15], s33 offen nt
    buffer_load_dword v170, v6, s[12:15], s38 offen nt
    s_mov_b32 s33, 282624
    s_mov_b32 s38, 284672
    buffer_load_dword v163, v6, s[12:15], s33 offen nt
    buffer_load_dword v171, v6, s[12:15], s38 offen nt
    s_mov_b32 s33, 327680
    s_mov_b32 s38, 329728
    buffer_load_dword v164, v6, s[12:15], s33 offen nt
    buffer_load_dword v172, v6, s[12:15], s38 offen nt
    s_mov_b32 s33, 344064
    s_mov_b32 s38, 346112
    buffer_load_dword v165, v6, s[12:15], s33 offen nt
    buffer_load_dword v173, v6, s[12:15], s38 offen nt
    s_mov_b32 s33, 331776
    s_mov_b32 s38, 333824
    buffer_load_dword v166, v6, s[12:15], s33 offen nt
    buffer_load_dword v174, v6, s[12:15], s38 offen nt
    s_mov_b32 s33, 348160
    s_mov_b32 s38, 350208
    buffer_load_dword v167, v6, s[12:15], s33 offen nt
    buffer_load_dword v175, v6, s[12:15], s38 offen nt
    s_waitcnt vmcnt(44)
    s_mov_b32 s33, 393216
    s_mov_b32 s38, 395264
    buffer_load_dword v176, v6, s[12:15], s33 offen nt
    buffer_load_dword v184, v6, s[12:15], s38 offen nt
    s_mov_b32 s33, 409600
    s_mov_b32 s38, 411648
    buffer_load_dword v177, v6, s[12:15], s33 offen nt
    buffer_load_dword v185, v6, s[12:15], s38 offen nt
    s_mov_b32 s33, 397312
    s_mov_b32 s38, 399360
    buffer_load_dword v178, v6, s[12:15], s33 offen nt
    buffer_load_dword v186, v6, s[12:15], s38 offen nt
    s_mov_b32 s33, 413696
    s_mov_b32 s38, 415744
    buffer_load_dword v179, v6, s[12:15], s33 offen nt
    buffer_load_dword v187, v6, s[12:15], s38 offen nt
    s_mov_b32 s33, 458752
    s_mov_b32 s38, 460800
    buffer_load_dword v180, v6, s[12:15], s33 offen nt
    buffer_load_dword v188, v6, s[12:15], s38 offen nt
    s_mov_b32 s33, 475136
    s_mov_b32 s38, 477184
    buffer_load_dword v181, v6, s[12:15], s33 offen nt
    buffer_load_dword v189, v6, s[12:15], s38 offen nt
    s_mov_b32 s33, 462848
    s_mov_b32 s38, 464896
    buffer_load_dword v182, v6, s[12:15], s33 offen nt
    buffer_load_dword v190, v6, s[12:15], s38 offen nt
    s_mov_b32 s33, 479232
    s_mov_b32 s38, 481280
    buffer_load_dword v183, v6, s[12:15], s33 offen nt
    buffer_load_dword v191, v6, s[12:15], s38 offen nt
    s_waitcnt vmcnt(44)
    s_mov_b32 s33, 524288
    s_mov_b32 s38, 526336
    buffer_load_dword v192, v6, s[12:15], s33 offen nt
    buffer_load_dword v200, v6, s[12:15], s38 offen nt
    s_mov_b32 s33, 540672
    s_mov_b32 s38, 542720
    buffer_load_dword v193, v6, s[12:15], s33 offen nt
    buffer_load_dword v201, v6, s[12:15], s38 offen nt
    s_mov_b32 s33, 528384
    s_mov_b32 s38, 530432
    buffer_load_dword v194, v6, s[12:15], s33 offen nt
    buffer_load_dword v202, v6, s[12:15], s38 offen nt
    s_mov_b32 s33, 544768
    s_mov_b32 s38, 546816
    buffer_load_dword v195, v6, s[12:15], s33 offen nt
    buffer_load_dword v203, v6, s[12:15], s38 offen nt
    s_mov_b32 s33, 589824
    s_mov_b32 s38, 591872
    buffer_load_dword v196, v6, s[12:15], s33 offen nt
    buffer_load_dword v204, v6, s[12:15], s38 offen nt
    s_mov_b32 s33, 606208
    s_mov_b32 s38, 608256
    buffer_load_dword v197, v6, s[12:15], s33 offen nt
    buffer_load_dword v205, v6, s[12:15], s38 offen nt
    s_mov_b32 s33, 593920
    s_mov_b32 s38, 595968
    buffer_load_dword v198, v6, s[12:15], s33 offen nt
    buffer_load_dword v206, v6, s[12:15], s38 offen nt
    s_mov_b32 s33, 610304
    s_mov_b32 s38, 612352
    buffer_load_dword v199, v6, s[12:15], s33 offen nt
    buffer_load_dword v207, v6, s[12:15], s38 offen nt
    s_waitcnt vmcnt(44)
    s_mov_b32 s33, 655360
    s_mov_b32 s38, 657408
    buffer_load_dword v208, v6, s[12:15], s33 offen nt
    buffer_load_dword v216, v6, s[12:15], s38 offen nt
    s_mov_b32 s33, 671744
    s_mov_b32 s38, 673792
    buffer_load_dword v209, v6, s[12:15], s33 offen nt
    buffer_load_dword v217, v6, s[12:15], s38 offen nt
    s_mov_b32 s33, 659456
    s_mov_b32 s38, 661504
    buffer_load_dword v210, v6, s[12:15], s33 offen nt
    buffer_load_dword v218, v6, s[12:15], s38 offen nt
    s_mov_b32 s33, 675840
    s_mov_b32 s38, 677888
    buffer_load_dword v211, v6, s[12:15], s33 offen nt
    buffer_load_dword v219, v6, s[12:15], s38 offen nt
    s_mov_b32 s33, 720896
    s_mov_b32 s38, 722944
    buffer_load_dword v212, v6, s[12:15], s33 offen nt
    buffer_load_dword v220, v6, s[12:15], s38 offen nt
    s_mov_b32 s33, 737280
    s_mov_b32 s38, 739328
    buffer_load_dword v213, v6, s[12:15], s33 offen nt
    buffer_load_dword v221, v6, s[12:15], s38 offen nt
    s_mov_b32 s33, 724992
    s_mov_b32 s38, 727040
    buffer_load_dword v214, v6, s[12:15], s33 offen nt
    buffer_load_dword v222, v6, s[12:15], s38 offen nt
    s_mov_b32 s33, 741376
    s_mov_b32 s38, 743424
    buffer_load_dword v215, v6, s[12:15], s33 offen nt
    buffer_load_dword v223, v6, s[12:15], s38 offen nt
    s_waitcnt vmcnt(44)
    s_mov_b32 s33, 786432
    s_mov_b32 s38, 788480
    buffer_load_dword v224, v6, s[12:15], s33 offen nt
    buffer_load_dword v232, v6, s[12:15], s38 offen nt
    s_mov_b32 s33, 802816
    s_mov_b32 s38, 804864
    buffer_load_dword v225, v6, s[12:15], s33 offen nt
    buffer_load_dword v233, v6, s[12:15], s38 offen nt
    s_mov_b32 s33, 790528
    s_mov_b32 s38, 792576
    buffer_load_dword v226, v6, s[12:15], s33 offen nt
    buffer_load_dword v234, v6, s[12:15], s38 offen nt
    s_mov_b32 s33, 806912
    s_mov_b32 s38, 808960
    buffer_load_dword v227, v6, s[12:15], s33 offen nt
    buffer_load_dword v235, v6, s[12:15], s38 offen nt
    s_mov_b32 s33, 851968
    s_mov_b32 s38, 854016
    buffer_load_dword v228, v6, s[12:15], s33 offen nt
    buffer_load_dword v236, v6, s[12:15], s38 offen nt
    s_mov_b32 s33, 868352
    s_mov_b32 s38, 870400
    buffer_load_dword v229, v6, s[12:15], s33 offen nt
    buffer_load_dword v237, v6, s[12:15], s38 offen nt
    s_mov_b32 s33, 856064
    s_mov_b32 s38, 858112
    buffer_load_dword v230, v6, s[12:15], s33 offen nt
    buffer_load_dword v238, v6, s[12:15], s38 offen nt
    s_mov_b32 s33, 872448
    s_mov_b32 s38, 874496
    buffer_load_dword v231, v6, s[12:15], s33 offen nt
    buffer_load_dword v239, v6, s[12:15], s38 offen nt
    s_waitcnt vmcnt(44)
    s_mov_b32 s33, 917504
    s_mov_b32 s38, 919552
    buffer_load_dword v240, v6, s[12:15], s33 offen nt
    buffer_load_dword v248, v6, s[12:15], s38 offen nt
    s_mov_b32 s33, 933888
    s_mov_b32 s38, 935936
    buffer_load_dword v241, v6, s[12:15], s33 offen nt
    buffer_load_dword v249, v6, s[12:15], s38 offen nt
    s_mov_b32 s33, 921600
    s_mov_b32 s38, 923648
    buffer_load_dword v242, v6, s[12:15], s33 offen nt
    buffer_load_dword v250, v6, s[12:15], s38 offen nt
    s_mov_b32 s33, 937984
    s_mov_b32 s38, 940032
    buffer_load_dword v243, v6, s[12:15], s33 offen nt
    buffer_load_dword v251, v6, s[12:15], s38 offen nt
    s_mov_b32 s33, 983040
    s_mov_b32 s38, 985088
    buffer_load_dword v244, v6, s[12:15], s33 offen nt
    buffer_load_dword v252, v6, s[12:15], s38 offen nt
    s_mov_b32 s33, 999424
    s_mov_b32 s38, 1001472
    buffer_load_dword v245, v6, s[12:15], s33 offen nt
    buffer_load_dword v253, v6, s[12:15], s38 offen nt
    s_mov_b32 s33, 987136
    s_mov_b32 s38, 989184
    buffer_load_dword v246, v6, s[12:15], s33 offen nt
    buffer_load_dword v254, v6, s[12:15], s38 offen nt
    s_mov_b32 s33, 1003520
    s_mov_b32 s38, 1005568
    buffer_load_dword v247, v6, s[12:15], s33 offen nt
    buffer_load_dword v255, v6, s[12:15], s38 offen nt
    s_waitcnt vmcnt(44)
RQ_NW:
    s_lshl_b32 s33, s21, 1
    s_lshr_b32 s38, s49, 1
    s_add_u32 s33, s33, s38
    s_lshl_b32 s33, s33, 14
    s_and_b32 s38, s49, 1
    s_lshl_b32 s38, s38, 12
    s_add_u32 s33, s33, s38
    s_add_u32 s33, s33, 1572864
    v_lshl_add_u32 v2, v0, 4, s33
    v_bfe_u32 v31, v0, 1, 2
    v_lshlrev_b32 v31, 2, v31
    v_bfe_u32 v30, v0, 3, 1
    v_lshl_add_u32 v31, v30, 1, v31
    v_and_b32 v30, 1, v0
    v_add_u32 v31, v31, v30
    v_and_b32 v30, 1, v29
    v_lshlrev_b32 v3, 11, v30
    v_lshrrev_b32 v30, 1, v29
    v_lshl_add_u32 v3, v30, 8, v3
    v_lshl_add_u32 v3, v31, 4, v3
    s_lshl_b32 s33, s49, 9
    v_add_u32 v3, s33, v3
    v_lshrrev_b32 v30, 2, v28
    v_lshlrev_b32 v30, 1, v30
    v_and_b32 v5, 1, v28
    v_add_u32 v30, v30, v5
    v_and_b32 v5, 2, v28
    v_lshl_add_u32 v30, v5, 2, v30
    v_and_b32 v5, 1, v30
    v_lshlrev_b32 v5, 4, v5
    v_mov_b32 v20, 0x3f80
    v_lshlrev_b32 v5, v5, v20
    v_lshrrev_b32 v20, 1, v30
    v_cmp_eq_u32 vcc, 0, v20
    s_nop 1
    v_cndmask_b32 v16, 0, v5, vcc
    v_cmp_eq_u32 vcc, 1, v20
    s_nop 1
    v_cndmask_b32 v17, 0, v5, vcc
    v_cmp_eq_u32 vcc, 2, v20
    s_nop 1
    v_cndmask_b32 v18, 0, v5, vcc
    v_cmp_eq_u32 vcc, 3, v20
    s_nop 1
    v_cndmask_b32 v19, 0, v5, vcc
    s_lshr_b32 s27, s20, 4
    s_lshl_b32 s27, s27, 14
    s_and_b32 s38, s20, 15
    s_lshl_b32 s38, s38, 9
    s_add_u32 s27, s27, s38
    s_xor_b32 s30, s27, 0
    s_lshr_b32 s28, s20, 3
    s_lshl_b32 s28, s28, 14
    s_and_b32 s38, s20, 4
    s_lshl_b32 s38, s38, 10
    s_add_u32 s28, s28, s38
    s_and_b32 s39, s49, 1
    s_lshl_b32 s33, s21, 1
    s_add_u32 s33, s33, s39
    s_lshl_b32 s33, s33, 14
    s_add_u32 s33, s33, 1572864
    v_lshl_add_u32 v2, v0, 4, s33
    s_lshl_b32 s33, s39, 11
    v_lshl_add_u32 v4, v0, 4, s33
    v_lshl_add_u32 v7, v0, 4, s28
    v_and_b32 v30, 7, v0
    v_lshl_add_u32 v8, v30, 4, s27
    v_lshl_add_u32 v8, v29, 7, v8
    v_add_u32 v8, 1572864, v8
    s_lshr_b32 s33, s20, 2
    s_lshl_b32 s33, s33, 14
    v_lshl_add_u32 v9, v0, 4, s33
    s_lshr_b32 s33, s22, 1
    s_lshl_b32 s33, s33, 14
    s_and_b32 s38, s22, 1
    s_lshl_b32 s38, s38, 12
    s_add_u32 s33, s33, s38
    v_add_u32 v11, s33, v4
    v_mov_b32 v30, 268435456
    v_cmp_eq_u32 vcc, s21, v29
    s_lshl_b32 s38, s21, 8
    s_add_u32 s33, s33, s38
    v_cndmask_b32 v11, v11, v30, vcc
    v_and_b32 v30, 1, v29
    v_lshlrev_b32 v3, 11, v30
    v_lshl_add_u32 v3, v28, 3, v3
    v_lshrrev_b32 v30, 1, v29
    v_lshl_add_u32 v3, v30, 7, v3
    s_lshl_b32 s38, s39, 10
    s_add_u32 s33, s33, s38
    v_add_u32 v10, s33, v3
    s_lshl_b32 s38, s39, 8
    v_add_u32 v3, s38, v3
    v_mov_b32 v20, 0
    v_mov_b32 v21, 0
    v_mov_b32 v22, 0
    v_mov_b32 v23, 0
    ds_write_b128 v4, v[20:23] offset:12288
    s_waitcnt lgkmcnt(0)
    s_lshl_b32 s33, s39, 6
    s_add_u32 s33, s33, s30
    s_add_u32 s33, s33, 1048576
    v_and_b32 v30, 3, v0
    v_lshl_add_u32 v12, v30, 2, s33
    v_and_b32 v30, 4, v0
    v_lshl_add_u32 v12, v30, 6, v12
    v_and_b32 v30, 8, v0
    v_lshl_add_u32 v12, v30, 2, v12
    v_and_b32 v30, 16, v0
    v_add_u32 v12, v30, v12
    v_and_b32 v30, 32, v0
    v_lshl_add_u32 v12, v30, 2, v12
    v_mov_b32 v96, -1
    v_mov_b32 v97, -1
    v_mov_b32 v98, -1
    v_mov_b32 v99, -1
    v_mov_b32 v108, v8
    s_add_u32 s33, s49, 1
    s_bitcmp1_b32 s33, 1
    s_cbranch_scc1 RQ_N0
    s_cmp_eq_u32 s49, 3
    s_cbranch_scc0 RQ_N3
    v_lshlrev_b32 v7, 8, v29
    v_lshl_add_u32 v7, v31, 4, v7
    v_lshlrev_b32 v12, 7, v0
    v_subrev_u32 v30, 8, v28
    v_lshlrev_b32 v30, 1, v30
    v_add_u32 v30, 0, v30
    v_and_b32 v5, 1, v30
    v_lshlrev_b32 v5, 4, v5
    v_mov_b32 v20, 0x3f80
    v_lshlrev_b32 v5, v5, v20
    v_lshrrev_b32 v20, 1, v30
    v_cmp_eq_u32 vcc, 0, v20
    s_nop 1
    v_cndmask_b32 v128, 0, v5, vcc
    v_cmp_eq_u32 vcc, 1, v20
    s_nop 1
    v_cndmask_b32 v129, 0, v5, vcc
    v_cmp_eq_u32 vcc, 2, v20
    s_nop 1
    v_cndmask_b32 v130, 0, v5, vcc
    v_cmp_eq_u32 vcc, 3, v20
    s_nop 1
    v_cndmask_b32 v131, 0, v5, vcc
    v_subrev_u32 v30, 8, v28
    v_lshlrev_b32 v30, 1, v30
    v_add_u32 v30, 1, v30
    v_and_b32 v5, 1, v30
    v_lshlrev_b32 v5, 4, v5
    v_mov_b32 v20, 0x3f80
    v_lshlrev_b32 v5, v5, v20
    v_lshrrev_b32 v20, 1, v30
    v_cmp_eq_u32 vcc, 0, v20
    s_nop 1
    v_cndmask_b32 v132, 0, v5, vcc
    v_cmp_eq_u32 vcc, 1, v20
    s_nop 1
    v_cndmask_b32 v133, 0, v5, vcc
    v_cmp_eq_u32 vcc, 2, v20
    s_nop 1
    v_cndmask_b32 v134, 0, v5, vcc
    v_cmp_eq_u32 vcc, 3, v20
    s_nop 1
    v_cndmask_b32 v135, 0, v5, vcc
    v_subrev_u32 v30, 12, v28
    v_lshlrev_b32 v30, 1, v30
    v_add_u32 v30, 0, v30
    v_and_b32 v5, 1, v30
    v_lshlrev_b32 v5, 4, v5
    v_mov_b32 v20, 0x3f80
    v_lshlrev_b32 v5, v5, v20
    v_lshrrev_b32 v20, 1, v30
    v_cmp_eq_u32 vcc, 0, v20
    s_nop 1
    v_cndmask_b32 v136, 0, v5, vcc
    v_cmp_eq_u32 vcc, 1, v20
    s_nop 1
    v_cndmask_b32 v137, 0, v5, vcc
    v_cmp_eq_u32 vcc, 2, v20
    s_nop 1
    v_cndmask_b32 v138, 0, v5, vcc
    v_cmp_eq_u32 vcc, 3, v20
    s_nop 1
    v_cndmask_b32 v139, 0, v5, vcc
    v_subrev_u32 v30, 12, v28
    v_lshlrev_b32 v30, 1, v30
    v_add_u32 v30, 1, v30
    v_and_b32 v5, 1, v30
    v_lshlrev_b32 v5, 4, v5
    v_mov_b32 v20, 0x3f80
    v_lshlrev_b32 v5, v5, v20
    v_lshrrev_b32 v20, 1, v30
    v_cmp_eq_u32 vcc, 0, v20
    s_nop 1
    v_cndmask_b32 v140, 0, v5, vcc
    v_cmp_eq_u32 vcc, 1, v20
    s_nop 1
    v_cndmask_b32 v141, 0, v5, vcc
    v_cmp_eq_u32 vcc, 2, v20
    s_nop 1
    v_cndmask_b32 v142, 0, v5, vcc
    v_cmp_eq_u32 vcc, 3, v20
    s_nop 1
    v_cndmask_b32 v143, 0, v5, vcc
    s_branch RQ_PADP0
RQ_PADRET:
    s_branch RQ_N0
RQ_N3:
    s_load_dwordx2 s[4:5], s[0:1], 8
    v_and_b32 v30, 7, v0
    v_lshlrev_b32 v30, 11, v30
    v_bfe_u32 v5, v0, 3, 2
    v_lshl_add_u32 v30, v5, 4, v30
    s_lshl_b32 s33, s22, 6
    s_waitcnt lgkmcnt(0)
    s_mov_b32 s12, s4
    s_and_b32 s13, s5, 0xffff
    s_mov_b32 s14, 16384
    s_mov_b32 s15, 0x20000
    buffer_load_dwordx4 v[24:27], v30, s[12:15], s33 offen
    v_and_b32 v30, 31, v0
    s_add_u32 s33, s30, 1048576
    s_add_u32 s38, s27, 1572864
    v_lshl_add_u32 v5, v30, 4, s33
    v_lshl_add_u32 v30, v30, 4, s38
    v_cmp_gt_u32 vcc, 32, v0
    s_nop 1
    v_cndmask_b32 v5, v30, v5, vcc
    v_mov_b32 v108, v5
    s_branch RQ_PADQ0
RQ_PADRET0:
    s_waitcnt vmcnt(0)
    v_min_u32 v24, -2, v24
    v_cndmask_b32 v104, -1, v24, vcc
    v_min_u32 v25, -2, v25
    v_cndmask_b32 v105, -1, v25, vcc
    v_min_u32 v26, -2, v26
    v_cndmask_b32 v106, -1, v26, vcc
    v_min_u32 v27, -2, v27
    v_cndmask_b32 v107, -1, v27, vcc
RQ_PG0:
    buffer_load_dwordx2 v[24:25], off, s[16:19], 0 offset:72 sc1
    s_sub_u32 s26, s26, 1
    s_cbranch_scc1 K_FAIL
    s_waitcnt vmcnt(0)
    v_lshrrev_b32 v25, 4, v25
    v_min_u32 v25, v24, v25
    v_cmp_eq_u32 vcc, 0, v25
    s_cbranch_vccz RQ_PG0_OK
    s_sleep 8
    s_branch RQ_PG0
RQ_PG0_OK:
    v_readfirstlane_b32 s43, v24
    s_nop 3
    s_and_b32 s43, s43, 2097152
    s_add_u32 s8, s44, s43
    s_addc_u32 s9, s45, 0
    s_and_b32 s9, s9, 0xffff
    v_mov_b32 v30, 0xff800000
    v_cmp_gt_u32 vcc, 32, v0
    s_nop 1
    v_cndmask_b32 v180, 0, v30, vcc
    v_cndmask_b32 v181, 0, v30, vcc
    v_cndmask_b32 v182, 0, v30, vcc
    v_cndmask_b32 v183, 0, v30, vcc
    v_mov_b32 v176, 0x3f803f80
    v_mov_b32 v177, 0x3f803f80
    v_mov_b32 v178, 0x3f803f80
    v_mov_b32 v179, 0x3f803f80
RQ_N0:
    s_waitcnt vmcnt(0)
    s_barrier
    s_cmp_lg_u32 s49, 0
    s_cbranch_scc1 RQ_ARR
    s_and_b32 s38, s20, 3
    s_lshl_b32 s38, s38, 10
    s_add_u32 s38, s38, s37
    s_add_u32 s33, s38, 0
    buffer_load_dword v51, v7, s[8:11], s33 offen sc1
    s_add_u32 s33, s36, 0
    buffer_load_dword v51, v108, s[8:11], s33 offen sc1
    s_add_u32 s33, s38, 262144
    buffer_load_dword v51, v7, s[8:11], s33 offen sc1
    s_add_u32 s33, s36, 131072
    buffer_load_dword v51, v108, s[8:11], s33 offen sc1
    s_add_u32 s33, s38, 524288
    buffer_load_dword v51, v7, s[8:11], s33 offen sc1
    s_add_u32 s33, s36, 262144
    buffer_load_dword v51, v108, s[8:11], s33 offen sc1
    s_add_u32 s33, s38, 786432
    buffer_load_dword v51, v7, s[8:11], s33 offen sc1
    s_add_u32 s33, s36, 393216
    buffer_load_dword v51, v108, s[8:11], s33 offen sc1
    s_and_b32 s38, s20, 3
    s_lshl_b32 s38, s38, 10
    s_add_u32 s38, s38, s37
    s_add_u32 s33, s38, 0
    buffer_store_dwordx4 v[96:99], v7, s[8:11], s33 offen
    s_add_u32 s33, s36, 0
    buffer_store_dwordx4 v[104:107], v108, s[8:11], s33 offen
    s_add_u32 s33, s38, 262144
    buffer_store_dwordx4 v[96:99], v7, s[8:11], s33 offen
    s_add_u32 s33, s36, 131072
    buffer_store_dwordx4 v[96:99], v108, s[8:11], s33 offen
    s_add_u32 s33, s38, 524288
    buffer_store_dwordx4 v[96:99], v7, s[8:11], s33 offen
    s_add_u32 s33, s36, 262144
    buffer_store_dwordx4 v[96:99], v108, s[8:11], s33 offen
    s_and_b32 s33, s20, 14
    s_cmp_lg_u32 s33, 6
    s_cbranch_scc1 RQ_AR1
    s_lshr_b32 s33, s20, 4
    s_lshl_b32 s33, s33, 1
    s_and_b32 s38, s20, 1
    s_add_u32 s33, s33, s38
    s_lshl_b32 s33, s33, 15
    s_add_u32 s33, s33, s36
    buffer_store_dwordx4 v[96:99], v4, s[8:11], s33 offen offset:0 sc1
    buffer_store_dwordx4 v[96:99], v4, s[8:11], s33 offen offset:1024 sc1
    buffer_store_dwordx4 v[96:99], v4, s[8:11], s33 offen offset:2048 sc1
    buffer_store_dwordx4 v[96:99], v4, s[8:11], s33 offen offset:3072 sc1
    s_add_u32 s33, s33, 4096
    buffer_store_dwordx4 v[96:99], v4, s[8:11], s33 offen offset:0 sc1
    buffer_store_dwordx4 v[96:99], v4, s[8:11], s33 offen offset:1024 sc1
    buffer_store_dwordx4 v[96:99], v4, s[8:11], s33 offen offset:2048 sc1
    buffer_store_dwordx4 v[96:99], v4, s[8:11], s33 offen offset:3072 sc1
    s_add_u32 s33, s33, 12288
    buffer_store_dwordx4 v[96:99], v4, s[8:11], s33 offen offset:0 sc1
    buffer_store_dwordx4 v[96:99], v4, s[8:11], s33 offen offset:1024 sc1
    buffer_store_dwordx4 v[96:99], v4, s[8:11], s33 offen offset:2048 sc1
    buffer_store_dwordx4 v[96:99], v4, s[8:11], s33 offen offset:3072 sc1
    s_add_u32 s33, s33, 4096
    buffer_store_dwordx4 v[96:99], v4, s[8:11], s33 offen offset:0 sc1
    buffer_store_dwordx4 v[96:99], v4, s[8:11], s33 offen offset:1024 sc1
    buffer_store_dwordx4 v[96:99], v4, s[8:11], s33 offen offset:2048 sc1
    buffer_store_dwordx4 v[96:99], v4, s[8:11], s33 offen offset:3072 sc1
    s_add_u32 s33, s33, 4096
    s_mov_b32 s38, 124794368
    v_mov_b32 v5, 1
    s_waitcnt vmcnt(0)
    s_mov_b64 exec, 1
    buffer_atomic_add v5, off, s[8:11], s38 sc1
    s_mov_b64 exec, -1
RQ_AR1:
    s_waitcnt vmcnt(0)
    s_add_u32 s33, s51, 1
    s_add_u32 s38, s21, 96
    s_lshl_b32 s38, s38, 7
    s_add_u32 s38, s38, 124780544
    v_mov_b32 v24, s33
    s_mov_b64 exec, 1
    buffer_atomic_add v24, off, s[8:11], s38 sc1
    s_mov_b64 exec, -1
RQ_ARR:
    s_add_u32 s33, s49, 1
    s_bitcmp1_b32 s33, 1
    s_cbranch_scc0 RQ_NW3
    v_perm_b32 v6, v136, v128, s31
    v_perm_b32 v136, v136, v128, s42
    v_mov_b32 v128, v6
    v_perm_b32 v6, v137, v129, s31
    v_perm_b32 v137, v137, v129, s42
    v_mov_b32 v129, v6
    v_perm_b32 v6, v138, v130, s31
    v_perm_b32 v138, v138, v130, s42
    v_mov_b32 v130, v6
    v_perm_b32 v6, v139, v131, s31
    v_perm_b32 v139, v139, v131, s42
    v_mov_b32 v131, v6
    v_perm_b32 v6, v140, v132, s31
    v_perm_b32 v140, v140, v132, s42
    v_mov_b32 v132, v6
    v_perm_b32 v6, v141, v133, s31
    v_perm_b32 v141, v141, v133, s42
    v_mov_b32 v133, v6
    v_perm_b32 v6, v142, v134, s31
    v_perm_b32 v142, v142, v134, s42
    v_mov_b32 v134, v6
    v_perm_b32 v6, v143, v135, s31
    v_perm_b32 v143, v143, v135, s42
    v_mov_b32 v135, v6
    v_perm_b32 v6, v152, v144, s31
    v_perm_b32 v152, v152, v144, s42
    v_mov_b32 v144, v6
    v_perm_b32 v6, v153, v145, s31
    v_perm_b32 v153, v153, v145, s42
    v_mov_b32 v145, v6
    v_perm_b32 v6, v154, v146, s31
    v_perm_b32 v154, v154, v146, s42
    v_mov_b32 v146, v6
    v_perm_b32 v6, v155, v147, s31
    v_perm_b32 v155, v155, v147, s42
    v_mov_b32 v147, v6
    v_perm_b32 v6, v156, v148, s31
    v_perm_b32 v156, v156, v148, s42
    v_mov_b32 v148, v6
    v_perm_b32 v6, v157, v149, s31
    v_perm_b32 v157, v157, v149, s42
    v_mov_b32 v149, v6
    v_perm_b32 v6, v158, v150, s31
    v_perm_b32 v158, v158, v150, s42
    v_mov_b32 v150, v6
    v_perm_b32 v6, v159, v151, s31
    v_perm_b32 v159, v159, v151, s42
    v_mov_b32 v151, v6
    v_perm_b32 v6, v168, v160, s31
    v_perm_b32 v168, v168, v160, s42
    v_mov_b32 v160, v6
    v_perm_b32 v6, v169, v161, s31
    v_perm_b32 v169, v169, v161, s42
    v_mov_b32 v161, v6
    v_perm_b32 v6, v170, v162, s31
    v_perm_b32 v170, v170, v162, s42
    v_mov_b32 v162, v6
    v_perm_b32 v6, v171, v163, s31
    v_perm_b32 v171, v171, v163, s42
    v_mov_b32 v163, v6
    v_perm_b32 v6, v172, v164, s31
    v_perm_b32 v172, v172, v164, s42
    v_mov_b32 v164, v6
    v_perm_b32 v6, v173, v165, s31
    v_perm_b32 v173, v173, v165, s42
    v_mov_b32 v165, v6
    v_perm_b32 v6, v174, v166, s31
    v_perm_b32 v174, v174, v166, s42
    v_mov_b32 v166, v6
    v_perm_b32 v6, v175, v167, s31
    v_perm_b32 v175, v175, v167, s42
    v_mov_b32 v167, v6
    v_perm_b32 v6, v184, v176, s31
    v_perm_b32 v184, v184, v176, s42
    v_mov_b32 v176, v6
    v_perm_b32 v6, v185, v177, s31
    v_perm_b32 v185, v185, v177, s42
    v_mov_b32 v177, v6
    v_perm_b32 v6, v186, v178, s31
    v_perm_b32 v186, v186, v178, s42
    v_mov_b32 v178, v6
    v_perm_b32 v6, v187, v179, s31
    v_perm_b32 v187, v187, v179, s42
    v_mov_b32 v179, v6
    v_perm_b32 v6, v188, v180, s31
    v_perm_b32 v188, v188, v180, s42
    v_mov_b32 v180, v6
    v_perm_b32 v6, v189, v181, s31
    v_perm_b32 v189, v189, v181, s42
    v_mov_b32 v181, v6
    v_perm_b32 v6, v190, v182, s31
    v_perm_b32 v190, v190, v182, s42
    v_mov_b32 v182, v6
    v_perm_b32 v6, v191, v183, s31
    v_perm_b32 v191, v191, v183, s42
    v_mov_b32 v183, v6
    v_perm_b32 v6, v200, v192, s31
    v_perm_b32 v200, v200, v192, s42
    v_mov_b32 v192, v6
    v_perm_b32 v6, v201, v193, s31
    v_perm_b32 v201, v201, v193, s42
    v_mov_b32 v193, v6
    v_perm_b32 v6, v202, v194, s31
    v_perm_b32 v202, v202, v194, s42
    v_mov_b32 v194, v6
    v_perm_b32 v6, v203, v195, s31
    v_perm_b32 v203, v203, v195, s42
    v_mov_b32 v195, v6
    v_perm_b32 v6, v204, v196, s31
    v_perm_b32 v204, v204, v196, s42
    v_mov_b32 v196, v6
    v_perm_b32 v6, v205, v197, s31
    v_perm_b32 v205, v205, v197, s42
    v_mov_b32 v197, v6
    v_perm_b32 v6, v206, v198, s31
    v_perm_b32 v206, v206, v198, s42
    v_mov_b32 v198, v6
    v_perm_b32 v6, v207, v199, s31
    v_perm_b32 v207, v207, v199, s42
    v_mov_b32 v199, v6
    v_perm_b32 v6, v216, v208, s31
    v_perm_b32 v216, v216, v208, s42
    v_mov_b32 v208, v6
    v_perm_b32 v6, v217, v209, s31
    v_perm_b32 v217, v217, v209, s42
    v_mov_b32 v209, v6
    v_perm_b32 v6, v218, v210, s31
    v_perm_b32 v218, v218, v210, s42
    v_mov_b32 v210, v6
    v_perm_b32 v6, v219, v211, s31
    v_perm_b32 v219, v219, v211, s42
    v_mov_b32 v211, v6
    v_perm_b32 v6, v220, v212, s31
    v_perm_b32 v220, v220, v212, s42
    v_mov_b32 v212, v6
    v_perm_b32 v6, v221, v213, s31
    v_perm_b32 v221, v221, v213, s42
    v_mov_b32 v213, v6
    v_perm_b32 v6, v222, v214, s31
    v_perm_b32 v222, v222, v214, s42
    v_mov_b32 v214, v6
    v_perm_b32 v6, v223, v215, s31
    v_perm_b32 v223, v223, v215, s42
    v_mov_b32 v215, v6
    v_perm_b32 v6, v232, v224, s31
    v_perm_b32 v232, v232, v224, s42
    v_mov_b32 v224, v6
    v_perm_b32 v6, v233, v225, s31
    v_perm_b32 v233, v233, v225, s42
    v_mov_b32 v225, v6
    v_perm_b32 v6, v234, v226, s31
    v_perm_b32 v234, v234, v226, s42
    v_mov_b32 v226, v6
    v_perm_b32 v6, v235, v227, s31
    v_perm_b32 v235, v235, v227, s42
    v_mov_b32 v227, v6
    v_perm_b32 v6, v236, v228, s31
    v_perm_b32 v236, v236, v228, s42
    v_mov_b32 v228, v6
    v_perm_b32 v6, v237, v229, s31
    v_perm_b32 v237, v237, v229, s42
    v_mov_b32 v229, v6
    v_perm_b32 v6, v238, v230, s31
    v_perm_b32 v238, v238, v230, s42
    v_mov_b32 v230, v6
    v_perm_b32 v6, v239, v231, s31
    v_perm_b32 v239, v239, v231, s42
    v_mov_b32 v231, v6
    v_perm_b32 v6, v248, v240, s31
    v_perm_b32 v248, v248, v240, s42
    v_mov_b32 v240, v6
    v_perm_b32 v6, v249, v241, s31
    v_perm_b32 v249, v249, v241, s42
    v_mov_b32 v241, v6
    v_perm_b32 v6, v250, v242, s31
    v_perm_b32 v250, v250, v242, s42
    v_mov_b32 v242, v6
    v_perm_b32 v6, v251, v243, s31
    v_perm_b32 v251, v251, v243, s42
    v_mov_b32 v243, v6
    v_perm_b32 v6, v252, v244, s31
    v_perm_b32 v252, v252, v244, s42
    v_mov_b32 v244, v6
    v_perm_b32 v6, v253, v245, s31
    v_perm_b32 v253, v253, v245, s42
    v_mov_b32 v245, v6
    v_perm_b32 v6, v254, v246, s31
    v_perm_b32 v254, v254, v246, s42
    v_mov_b32 v246, v6
    v_perm_b32 v6, v255, v247, s31
    v_perm_b32 v255, v255, v247, s42
    v_mov_b32 v247, v6
RQ_NW3:
    s_mov_b32 s52, 0
    s_mov_b32 s53, 0
    s_mov_b32 s54, 0
    s_mov_b32 s34, 0
    s_mov_b32 s47, 0
    s_and_b32 s55, s20, 3
    s_mov_b32 s52, 4194304
    s_mov_b32 s53, 4198400
    s_lshl_b32 s54, s55, 11
    s_add_u32 s54, s54, 4202496
    s_mov_b32 s35, 54525952
    s_lshl_b32 s34, s55, 9
    s_add_u32 s34, s34, 54529536
    s_lshl_b32 s46, s20, 12
    s_add_u32 s46, s46, 5242880
    s_cmp_lg_u32 s49, 0
    s_cbranch_scc1 RQ_I1
    s_add_u32 s38, s21, 96
    s_lshl_b32 s38, s38, 7
    s_add_u32 s38, s38, 124780544
RQ_M0:
    s_sleep 2
    buffer_load_dword v24, off, s[8:11], s38 sc1
    s_sub_u32 s26, s26, 1
    s_cbranch_scc1 K_FAIL
    s_waitcnt vmcnt(0)
    v_and_b32 v25, 0xffff, v24
    v_cmp_gt_u32 vcc, 32, v25
    s_cbranch_vccnz RQ_M0
    v_lshrrev_b32 v26, 16, v24
    v_mov_b32 v27, s43
    v_mov_b32 v5, 16384
    ds_write_b64 v5, v[26:27]
    v_cmp_eq_u32 vcc, 0, v26
    s_cbranch_vccnz RQ_M2
    s_and_b32 s38, s20, 3
    s_lshl_b32 s38, s38, 10
    s_add_u32 s38, s38, s37
    s_add_u32 s33, s38, 0
    buffer_store_dwordx4 v[96:99], v7, s[8:11], s33 offen sc1
    s_add_u32 s33, s36, 0
    buffer_store_dwordx4 v[104:107], v108, s[8:11], s33 offen sc1
    s_add_u32 s33, s38, 262144
    buffer_store_dwordx4 v[96:99], v7, s[8:11], s33 offen sc1
    s_add_u32 s33, s36, 131072
    buffer_store_dwordx4 v[96:99], v108, s[8:11], s33 offen sc1
    s_add_u32 s33, s38, 524288
    buffer_store_dwordx4 v[96:99], v7, s[8:11], s33 offen sc1
    s_add_u32 s33, s36, 262144
    buffer_store_dwordx4 v[96:99], v108, s[8:11], s33 offen sc1
    s_waitcnt vmcnt(0)
    s_add_u32 s38, s21, 100
    s_lshl_b32 s38, s38, 7
    s_add_u32 s38, s38, 124780544
    v_mov_b32 v24, 1
    s_mov_b64 exec, 1
    buffer_atomic_add v24, off, s[8:11], s38 sc1
    s_mov_b64 exec, -1
RQ_M1:
    s_sleep 2
    buffer_load_dword v24, off, s[8:11], s38 sc1
    s_sub_u32 s26, s26, 1
    s_cbranch_scc1 K_FAIL
    s_waitcnt vmcnt(0)
    v_and_b32 v25, 0xffff, v24
    v_cmp_gt_u32 vcc, 32, v25
    s_cbranch_vccnz RQ_M1
RQ_M2:
    s_mov_b32 s38, 108
    s_lshl_b32 s38, s38, 7
    s_add_u32 s38, s38, 124780544
RQ_BW:
    buffer_load_dword v6, off, s[8:11], s38 sc1
    s_sub_u32 s26, s26, 1
    s_cbranch_scc1 K_FAIL
    s_waitcnt vmcnt(0)
    v_cmp_gt_u32 vcc, 16, v6
    s_cbranch_vccz RQ_BW_OK
    s_sleep 2
    s_branch RQ_BW
RQ_BW_OK:
    s_waitcnt lgkmcnt(0)
    s_mov_b32 s38, 0
    s_mul_i32 s39, s21, 8
    s_add_u32 s38, s38, s39
    s_lshl_b32 s38, s38, 7
    s_add_u32 s38, s38, 124780544
RQ_KV0:
    buffer_load_dword v6, off, s[8:11], s38 sc1
    s_sub_u32 s26, s26, 1
    s_cbranch_scc1 K_FAIL
    s_waitcnt vmcnt(0)
    v_cmp_gt_u32 vcc, 32, v6
    s_cbranch_vccz RQ_KV0_OK
    s_sleep 3
    s_branch RQ_KV0
RQ_KV0_OK:
    buffer_load_dwordx4 v[128:131], v9, s[8:11], s52 offen offset:0 sc1
    buffer_load_dwordx4 v[132:135], v9, s[8:11], s52 offen offset:1024 sc1
    buffer_load_dwordx4 v[136:139], v9, s[8:11], s52 offen offset:2048 sc1
    buffer_load_dwordx4 v[140:143], v9, s[8:11], s52 offen offset:3072 sc1
    buffer_load_dwordx4 v[144:147], v9, s[8:11], s53 offen offset:0 sc1
    buffer_load_dwordx4 v[148:151], v9, s[8:11], s53 offen offset:1024 sc1
    buffer_load_dwordx4 v[152:155], v9, s[8:11], s53 offen offset:2048 sc1
    buffer_load_dwordx4 v[156:159], v9, s[8:11], s53 offen offset:3072 sc1
    buffer_load_dwordx4 v[160:163], v9, s[8:11], s54 offen offset:0 sc1
    buffer_load_dwordx4 v[164:167], v9, s[8:11], s54 offen offset:1024 sc1
    s_add_u32 s52, s52, 524288
    s_add_u32 s53, s53, 524288
    s_add_u32 s54, s54, 524288
RQ_I1:
    s_barrier
    v_mov_b32 v24, 16384
    ds_read_b64 v[24:25], v24
    s_waitcnt lgkmcnt(0)
    v_readfirstlane_b32 s51, v24
    v_readfirstlane_b32 s43, v25
    s_nop 3
    s_and_b32 s43, s43, 2097152
    s_add_u32 s8, s44, s43
    s_addc_u32 s9, s45, 0
    s_and_b32 s9, s9, 0xffff
    s_cmp_lg_u32 s51, 0
    s_cbranch_scc1 RQs_LOOP
RQf_LOOP:
    s_and_b32 s27, s25, 3
    s_lshl_b32 s27, s27, 18
    s_add_u32 s27, s27, s37
    s_and_b32 s28, s25, 3
    s_lshl_b32 s28, s28, 17
    s_add_u32 s28, s28, s36
    s_add_u32 s30, s25, 2
    s_and_b32 s30, s30, 3
    s_lshl_b32 s30, s30, 18
    s_add_u32 s30, s30, s36
    s_add_u32 s32, s25, 1
    s_and_b32 s32, s32, 3
    s_lshl_b32 s32, s32, 17
    s_add_u32 s32, s32, s36
    s_and_b32 s29, s25, 3
    s_lshl_b32 s29, s29, 18
    s_add_u32 s29, s29, s36
    s_add_u32 s23, s28, 4096
    s_cmp_eq_u32 s49, 3
    s_cbranch_scc1 RQf_VR
    s_cmp_ge_u32 s25, 63
    s_cbranch_scc1 RQ_LAST
    s_cmp_eq_u32 s49, 0
    s_cbranch_scc1 RQf_AT
    s_barrier
    s_barrier
    s_barrier
    s_branch RQf_OG
RQf_VR:
    s_waitcnt vmcnt(0)
    s_barrier
    s_barrier
    ds_read_b128 v[144:147], v7 offset:8192
    ds_read_b128 v[148:151], v7 offset:9216
    ds_read_b128 v[152:155], v7 offset:10240
    ds_read_b128 v[156:159], v7 offset:11264
    s_waitcnt lgkmcnt(3)
    v_mfma_f32_16x16x32_bf16 v[160:163], v[128:131], v[144:147], 0
    v_mfma_f32_16x16x32_bf16 v[164:167], v[132:135], v[144:147], 0
    s_waitcnt lgkmcnt(2)
    v_mfma_f32_16x16x32_bf16 v[160:163], v[128:131], v[148:151], v[160:163]
    v_mfma_f32_16x16x32_bf16 v[164:167], v[132:135], v[148:151], v[164:167]
    s_waitcnt lgkmcnt(1)
    v_mfma_f32_16x16x32_bf16 v[160:163], v[136:139], v[152:155], v[160:163]
    v_mfma_f32_16x16x32_bf16 v[164:167], v[140:143], v[152:155], v[164:167]
    s_waitcnt lgkmcnt(0)
    v_mfma_f32_16x16x32_bf16 v[160:163], v[136:139], v[156:159], v[160:163]
    v_mfma_f32_16x16x32_bf16 v[164:167], v[140:143], v[156:159], v[164:167]
    s_nop 7
    v_cvt_pk_bf16_f32 v100, v160, v161
    v_cvt_pk_bf16_f32 v101, v162, v163
    v_cvt_pk_bf16_f32 v102, v164, v165
    v_cvt_pk_bf16_f32 v103, v166, v167
    s_cmp_ge_u32 s25, 63
    s_cbranch_scc1 RQf_FINAL
    ds_write_b128 v4, v[100:103] offset:18432
    s_waitcnt lgkmcnt(0)
    s_barrier
    s_lshr_b32 s33, s34, 8
    s_xor_b32 s33, s33, s36
    s_and_b32 s33, s33, 0x2000
    s_add_u32 s33, s33, s34
    s_mov_b32 exec_lo, 0
    buffer_store_dwordx4 v[100:103], v9, s[8:11], s33 offen sc1
    s_mov_b32 exec_lo, -1
    s_add_u32 s34, s34, 524288
RQf_NC1:
    s_barrier
    s_barrier
    s_waitcnt vmcnt(0)
    s_mov_b64 exec, 1
    s_cmp_eq_u32 s25, 0
    s_cbranch_scc1 RQf_SG
    s_and_b32 s33, s25, 31
    s_cmp_lg_u32 s33, s22
    s_cbranch_scc1 RQf_SG_B
    s_lshl_b32 s33, s21, 6
    s_add_u32 s33, s33, s25
    s_lshl_b32 s33, s33, 7
    s_add_u32 s33, s33, 124794752
    v_mov_b32 v14, 64
    buffer_store_dword v14, off, s[8:11], s33 sc1
RQf_SG_B:
    s_cmp_lt_u32 s25, 48
    s_cbranch_scc1 RQf_SG
    s_lshr_b32 s33, s20, 2
    s_lshl_b32 s33, s33, 5
    s_add_u32 s33, s33, s25
    s_lshl_b32 s33, s33, 2
    s_add_u32 s33, s33, 124835648
    v_mov_b32 v13, 16
    buffer_atomic_add v13, off, s[8:11], s33 sc1
RQf_SG:
    s_mov_b64 exec, -1
    s_barrier
    s_cmp_lg_u32 s25, 40
    s_cbranch_scc1 RQf_PW_OK
    s_mov_b32 s38, 104
    s_lshl_b32 s38, s38, 7
    s_add_u32 s38, s38, 124780544
RQf_PW:
    buffer_load_dword v6, off, s[8:11], s38 sc1
    s_sub_u32 s26, s26, 1
    s_cbranch_scc1 K_FAIL
    s_waitcnt vmcnt(0)
    v_cmp_gt_u32 vcc, 128, v6
    s_cbranch_vccz RQf_PW_OK
    s_sleep 2
    s_branch RQf_PW
RQf_PW_OK:
    s_branch RQf_E
RQf_AT:
    s_barrier
    s_nop 15
    s_nop 15
    s_nop 15
    s_nop 15
    s_nop 1
    buffer_load_dwordx4 v[48:51], v7, s[8:11], s27 offen offset:0 sc1
    buffer_load_dwordx4 v[52:55], v7, s[8:11], s27 offen offset:1024 sc1
    buffer_load_dwordx4 v[56:59], v7, s[8:11], s27 offen offset:2048 sc1
    buffer_load_dwordx4 v[60:63], v7, s[8:11], s27 offen offset:3072 sc1
    s_barrier
    buffer_load_dwordx4 v[48:51], v7, s[8:11], s27 offen offset:0 sc1
    buffer_load_dwordx4 v[52:55], v7, s[8:11], s27 offen offset:1024 sc1
    buffer_load_dwordx4 v[56:59], v7, s[8:11], s27 offen offset:2048 sc1
    buffer_load_dwordx4 v[60:63], v7, s[8:11], s27 offen offset:3072 sc1
    s_nop 11
    buffer_load_dwordx4 v[48:51], v7, s[8:11], s27 offen offset:0 sc1
    buffer_load_dwordx4 v[52:55], v7, s[8:11], s27 offen offset:1024 sc1
    buffer_load_dwordx4 v[56:59], v7, s[8:11], s27 offen offset:2048 sc1
    buffer_load_dwordx4 v[60:63], v7, s[8:11], s27 offen offset:3072 sc1
    s_nop 11
RQf_TF:
    buffer_load_dwordx4 v[48:51], v7, s[8:11], s27 offen offset:0 sc1
    buffer_load_dwordx4 v[52:55], v7, s[8:11], s27 offen offset:1024 sc1
    buffer_load_dwordx4 v[56:59], v7, s[8:11], s27 offen offset:2048 sc1
    buffer_load_dwordx4 v[60:63], v7, s[8:11], s27 offen offset:3072 sc1
    s_sub_u32 s26, s26, 1
    s_cbranch_scc1 K_FAIL
    s_waitcnt vmcnt(12)
    v_max3_u32 v13, v51, v55, v59
    v_max3_u32 v5, v48, v49, v50
    v_max_u32 v13, v13, v63
    v_mfma_f32_16x16x32_bf16 v[64:67], v[48:51], v[48:51], v[180:183]
    v_cmp_eq_u32 vcc, -1, v13
    v_max3_u32 v6, v52, v53, v54
    v_mfma_f32_16x16x32_bf16 v[68:71], v[128:131], v[48:51], 0
    v_max3_u32 v5, v5, v56, v57
    v_max3_u32 v6, v6, v58, v60
    v_mfma_f32_16x16x32_bf16 v[72:75], v[144:147], v[48:51], 0
    s_cbranch_vccnz RQf_TF
    v_mfma_f32_16x16x32_bf16 v[64:67], v[52:55], v[52:55], v[64:67]
    v_max3_u32 v5, v5, v61, v62
    v_max_u32 v5, v5, v6
    v_mfma_f32_16x16x32_bf16 v[68:71], v[132:135], v[52:55], v[68:71]
    v_cmp_eq_u32 vcc, -1, v5
    v_mfma_f32_16x16x32_bf16 v[72:75], v[148:151], v[52:55], v[72:75]
    v_mfma_f32_16x16x32_bf16 v[64:67], v[56:59], v[56:59], v[64:67]
    s_cbranch_vccnz RQf_TF
    v_mfma_f32_16x16x32_bf16 v[68:71], v[136:139], v[56:59], v[68:71]
    s_barrier
    v_mfma_f32_16x16x32_bf16 v[72:75], v[152:155], v[56:59], v[72:75]
    ds_read_b128 v[100:103], v4 offset:20480
    v_mfma_f32_16x16x32_bf16 v[64:67], v[60:63], v[60:63], v[64:67]
    v_mfma_f32_16x16x32_bf16 v[68:71], v[140:143], v[60:63], v[68:71]
    v_mfma_f32_16x16x32_bf16 v[72:75], v[156:159], v[60:63], v[72:75]
    s_nop 1
    v_max3_f32 v13, v64, v65, v66
    s_nop 1
    v_max3_f32 v14, v67, v68, v69
    v_max3_f32 v13, v13, v70, v71
    s_nop 0
    v_max3_f32 v14, v14, v72, v73
    v_max3_f32 v13, v13, v74, v75
    v_max_f32 v6, v13, v14
    v_max_f32 v13, v13, v14
    v_pk_mul_f32 v[64:65], v[64:65], s[40:41] op_sel_hi:[1,0]
    v_pk_mul_f32 v[66:67], v[66:67], s[40:41] op_sel_hi:[1,0]
    v_permlane32_swap_b32 v13, v6
    v_max_f32 v14, v13, v6
    v_max_f32 v13, v13, v6
    v_pk_mul_f32 v[68:69], v[68:69], s[40:41] op_sel_hi:[1,0]
    v_pk_mul_f32 v[70:71], v[70:71], s[40:41] op_sel_hi:[1,0]
    v_permlane16_swap_b32 v13, v14
    v_pk_mul_f32 v[72:73], v[72:73], s[40:41] op_sel_hi:[1,0]
    v_max_f32 v13, v13, v14
    v_pk_mul_f32 v[74:75], v[74:75], s[40:41] op_sel_hi:[1,0]
    v_mul_f32 v14, s41, v13
    v_pk_add_f32 v[64:65], v[64:65], v[14:15] op_sel_hi:[1,0]
    v_pk_add_f32 v[66:67], v[66:67], v[14:15] op_sel_hi:[1,0]
    v_pk_add_f32 v[68:69], v[68:69], v[14:15] op_sel_hi:[1,0]
    v_pk_add_f32 v[70:71], v[70:71], v[14:15] op_sel_hi:[1,0]
    v_pk_add_f32 v[72:73], v[72:73], v[14:15] op_sel_hi:[1,0]
    v_pk_add_f32 v[74:75], v[74:75], v[14:15] op_sel_hi:[1,0]
    v_exp_f32 v64, v64
    v_exp_f32 v65, v65
    v_exp_f32 v66, v66
    v_exp_f32 v67, v67
    v_exp_f32 v68, v68
    v_exp_f32 v69, v69
    v_cvt_pk_bf16_f32 v172, v64, v65
    v_cvt_pk_bf16_f32 v173, v66, v67
    v_exp_f32 v70, v70
    v_exp_f32 v71, v71
    s_waitcnt lgkmcnt(0)
    v_mfma_f32_16x16x16_bf16 v[192:195], v[176:177], v[172:173], 0
    v_exp_f32 v72, v72
    v_mfma_f32_16x16x16_bf16 v[184:187], v[100:101], v[172:173], 0
    v_exp_f32 v73, v73
    v_mfma_f32_16x16x16_bf16 v[188:191], v[102:103], v[172:173], 0
    v_exp_f32 v74, v74
    v_exp_f32 v75, v75
    v_cvt_pk_bf16_f32 v168, v68, v69
    v_cvt_pk_bf16_f32 v169, v70, v71
    v_cvt_pk_bf16_f32 v170, v72, v73
    v_cvt_pk_bf16_f32 v171, v74, v75
    s_nop 1
    v_mfma_f32_16x16x32_bf16 v[192:195], v[176:179], v[168:171], v[192:195]
    v_mfma_f32_16x16x32_bf16 v[184:187], v[160:163], v[168:171], v[184:187]
    v_mfma_f32_16x16x32_bf16 v[188:191], v[164:167], v[168:171], v[188:191]
    s_mov_b32 exec_lo, 0x00ff00ff
    s_mov_b32 exec_hi, 0x00ff00ff
    v_rcp_f32 v192, v192
    s_nop 1
    v_pk_mul_f32 v[184:185], v[184:185], v[192:193] op_sel_hi:[1,0]
    v_pk_mul_f32 v[186:187], v[186:187], v[192:193] op_sel_hi:[1,0]
    s_nop 0
    v_pk_mul_f32 v[188:189], v[188:189], v[192:193] op_sel_hi:[1,0]
    v_pk_mul_f32 v[190:191], v[190:191], v[192:193] op_sel_hi:[1,0]
    v_cvt_pk_bf16_f32 v196, v184, v188
    v_cvt_pk_bf16_f32 v197, v185, v189
    v_cvt_pk_bf16_f32 v198, v186, v190
    v_cvt_pk_bf16_f32 v199, v187, v191
    v_min_u32 v196, -2, v196
    v_min_u32 v197, -2, v197
    v_min_u32 v198, -2, v198
    v_min_u32 v199, -2, v199
    buffer_store_dwordx4 v[196:199], v8, s[8:11], s28 offen
    s_mov_b64 exec, -1
    s_barrier
    s_barrier
    s_barrier
    buffer_load_dwordx4 v[128:131], v9, s[8:11], s52 offen offset:0 sc1
    buffer_load_dwordx4 v[132:135], v9, s[8:11], s52 offen offset:1024 sc1
    buffer_load_dwordx4 v[136:139], v9, s[8:11], s52 offen offset:2048 sc1
    buffer_load_dwordx4 v[140:143], v9, s[8:11], s52 offen offset:3072 sc1
    buffer_load_dwordx4 v[144:147], v9, s[8:11], s53 offen offset:0 sc1
    buffer_load_dwordx4 v[148:151], v9, s[8:11], s53 offen offset:1024 sc1
    buffer_load_dwordx4 v[152:155], v9, s[8:11], s53 offen offset:2048 sc1
    buffer_load_dwordx4 v[156:159], v9, s[8:11], s53 offen offset:3072 sc1
    buffer_load_dwordx4 v[160:163], v9, s[8:11], s54 offen offset:0 sc1
    buffer_load_dwordx4 v[164:167], v9, s[8:11], s54 offen offset:1024 sc1
    s_add_u32 s52, s52, 524288
    s_add_u32 s53, s53, 524288
    s_add_u32 s54, s54, 524288
    s_branch RQf_E
RQf_OG:
    s_barrier
    s_nop 15
    s_nop 11
RQf_RETRY:
    buffer_load_dwordx4 v[48:51], v2, s[8:11], s28 offen offset:0 sc1
    buffer_load_dwordx4 v[52:55], v2, s[8:11], s28 offen offset:1024 sc1
    v_mov_b32 v40, 0
    v_mov_b32 v41, 0
    v_mov_b32 v42, 0
    v_mov_b32 v43, 0
    v_mov_b32 v44, 0
    v_mov_b32 v45, 0
    v_mov_b32 v46, 0
    v_mov_b32 v47, 0
    s_nop 3
    buffer_load_dwordx4 v[56:59], v2, s[8:11], s28 offen offset:2048 sc1
    buffer_load_dwordx4 v[60:63], v2, s[8:11], s28 offen offset:3072 sc1
    s_nop 11
    buffer_load_dwordx4 v[64:67], v2, s[8:11], s23 offen offset:0 sc1
    buffer_load_dwordx4 v[68:71], v2, s[8:11], s23 offen offset:1024 sc1
    s_nop 11
    buffer_load_dwordx4 v[72:75], v2, s[8:11], s23 offen offset:2048 sc1
    buffer_load_dwordx4 v[76:79], v2, s[8:11], s23 offen offset:3072 sc1
ROGf_S0123:
    s_waitcnt vmcnt(6)
    v_max_u32 v13, v51, v55
    v_cmp_eq_u32 vcc, -1, v13
    s_cbranch_vccnz ROGf_S0123_F
ROGf_S0123_OK:
    v_smfmac_f32_16x16x64_bf16 v[40:43], v[48:51], v[128:135], v1
    s_waitcnt vmcnt(4)
    v_max_u32 v13, v59, v63
    v_cmp_eq_u32 vcc, -1, v13
    v_smfmac_f32_16x16x64_bf16 v[40:43], v[52:55], v[144:151], v1
    v_max_u32 v5, v48, v49
    v_max_u32 v6, v50, v51
    v_smfmac_f32_16x16x64_bf16 v[44:47], v[48:51], v[136:143], v1
    s_cbranch_vccnz ROGf_S0123_T
    v_smfmac_f32_16x16x64_bf16 v[44:47], v[52:55], v[152:159], v1
    v_max3_u32 v5, v5, v52, v53
    v_max3_u32 v6, v6, v54, v55
ROGf_S123_OK:
    v_smfmac_f32_16x16x64_bf16 v[40:43], v[56:59], v[160:167], v1
    s_waitcnt vmcnt(2)
    v_max_u32 v13, v67, v71
    v_cmp_eq_u32 vcc, -1, v13
    v_smfmac_f32_16x16x64_bf16 v[40:43], v[60:63], v[176:183], v1
    v_max3_u32 v5, v5, v56, v57
    v_max3_u32 v6, v6, v58, v59
    v_smfmac_f32_16x16x64_bf16 v[44:47], v[56:59], v[168:175], v1
    s_cbranch_vccnz ROGf_S123_T
    v_smfmac_f32_16x16x64_bf16 v[44:47], v[60:63], v[184:191], v1
    v_max3_u32 v5, v5, v60, v61
    v_max3_u32 v6, v6, v62, v63
ROGf_S23_OK:
    v_smfmac_f32_16x16x64_bf16 v[40:43], v[64:67], v[192:199], v1
    s_waitcnt vmcnt(0)
    v_max_u32 v13, v75, v79
    v_cmp_eq_u32 vcc, -1, v13
    v_smfmac_f32_16x16x64_bf16 v[40:43], v[68:71], v[208:215], v1
    v_max3_u32 v5, v5, v64, v65
    v_max3_u32 v6, v6, v66, v67
    v_smfmac_f32_16x16x64_bf16 v[44:47], v[64:67], v[200:207], v1
    s_cbranch_vccnz ROGf_S23_T
    v_smfmac_f32_16x16x64_bf16 v[44:47], v[68:71], v[216:223], v1
    v_max3_u32 v5, v5, v68, v69
    v_max3_u32 v6, v6, v70, v71
ROGf_S3_OK:
    v_smfmac_f32_16x16x64_bf16 v[40:43], v[72:75], v[224:231], v1
    v_max3_u32 v5, v5, v72, v73
    v_max3_u32 v6, v6, v74, v75
    v_smfmac_f32_16x16x64_bf16 v[40:43], v[76:79], v[240:247], v1
    v_max3_u32 v5, v5, v76, v77
    v_max3_u32 v6, v6, v78, v79
    v_smfmac_f32_16x16x64_bf16 v[44:47], v[72:75], v[232:239], v1
    v_smfmac_f32_16x16x64_bf16 v[44:47], v[76:79], v[248:255], v1
ROGf_DONE:
    v_max_u32 v5, v5, v6
    v_cmp_eq_u32 vcc, -1, v5
    v_permlane32_swap_b32 v40, v42
    v_permlane32_swap_b32 v41, v43
    v_pk_add_f32 v[40:41], v[40:41], v[42:43]
    s_cbranch_vccnz RQf_RO
    s_nop 1
    v_permlane32_swap_b32 v44, v46
    v_permlane32_swap_b32 v45, v47
    v_pk_add_f32 v[44:45], v[44:45], v[46:47]
    v_cvt_pk_bf16_f32 v42, v40, v44
    v_cvt_pk_bf16_f32 v43, v41, v45
    v_min_u32 v42, -2, v42
    v_min_u32 v43, -2, v43
    buffer_store_dwordx2 v[42:43], v10, s[8:11], s29 offen sc1
    ds_write_b64 v3, v[42:43] offset:12288
    buffer_store_dwordx2 v[96:97], v10, s[8:11], s30 offen sc1
    s_waitcnt lgkmcnt(0)
    s_barrier
    ds_read_b128 v[80:83], v4 offset:12288
    s_waitcnt lgkmcnt(0)
    v_mfma_f32_16x16x32_bf16 v[20:23], v[16:19], v[80:83], 0
    s_sleep 4
    s_nop 7
    buffer_load_dwordx4 v[80:83], v11, s[8:11], s29 offen offset:0 sc1
    buffer_load_dwordx4 v[84:87], v11, s[8:11], s29 offen offset:1024 sc1
    s_barrier
RQf_B1W:
    s_waitcnt vmcnt(0)
    v_max3_u32 v5, v80, v81, v82
    v_max3_u32 v5, v5, v83, v84
    v_mfma_f32_16x16x32_bf16 v[88:91], v[16:19], v[80:83], v[20:23]
    v_max3_u32 v6, v85, v86, v87
    v_mfma_f32_16x16x32_bf16 v[88:91], v[16:19], v[84:87], v[88:91]
    v_max_u32 v5, v5, v6
    v_cmp_eq_u32 vcc, -1, v5
    s_nop 4
    s_cbranch_vccnz RQf_B1F
    v_cvt_pk_bf16_f32 v6, v88, v89
    v_min_u32 v6, -2, v6
    buffer_store_dword v6, v12, s[8:11], s32 offen
RQf_E:
    s_add_u32 s25, s25, 1
    s_barrier
    s_branch RQf_LOOP
RQf_RO:
    s_sub_u32 s26, s26, 1
    s_cbranch_scc1 K_FAIL
    s_waitcnt vmcnt(0)
    s_nop 4
    s_branch RQf_RETRY
RQf_B1F:
    buffer_load_dwordx4 v[80:83], v11, s[8:11], s29 offen offset:0 sc1
    buffer_load_dwordx4 v[84:87], v11, s[8:11], s29 offen offset:1024 sc1
    s_sub_u32 s26, s26, 1
    s_cbranch_scc1 K_FAIL
    s_branch RQf_B1W
RQ_PADQ0:
    s_branch RQ_PADQ1
ROGf_S123:
    s_waitcnt vmcnt(4)
    v_max_u32 v13, v59, v63
    v_cmp_eq_u32 vcc, -1, v13
    s_cbranch_vccnz ROGf_S123_F
    s_branch ROGf_S123_OK
RQ_PADQ1:
    s_branch RQ_PADQ2
ROGf_S23:
    s_waitcnt vmcnt(2)
    v_max_u32 v13, v67, v71
    v_cmp_eq_u32 vcc, -1, v13
    s_cbranch_vccnz ROGf_S23_F
    s_branch ROGf_S23_OK
RQ_PADQ2:
    s_branch RQ_PADQ3
ROGf_S0123_T:
    v_smfmac_f32_16x16x64_bf16 v[44:47], v[52:55], v[152:159], v1
    v_max3_u32 v5, v5, v52, v53
    v_max3_u32 v6, v6, v54, v55
    s_branch ROGf_S123_F
RQ_PADQ3:
    s_branch RQ_PADQ4
ROGf_S123_T:
    v_smfmac_f32_16x16x64_bf16 v[44:47], v[60:63], v[184:191], v1
    v_max3_u32 v5, v5, v60, v61
    v_max3_u32 v6, v6, v62, v63
    s_branch ROGf_S23_F
RQ_PADQ4:
    s_branch RQ_PADQ5
ROGf_S23_T:
    v_smfmac_f32_16x16x64_bf16 v[44:47], v[68:71], v[216:223], v1
    v_max3_u32 v5, v5, v68, v69
    v_max3_u32 v6, v6, v70, v71
    s_branch ROGf_S3_F
RQ_PADQ5:
    s_branch RQ_PADQ6
ROGf_S0123_F:
    buffer_load_dwordx4 v[48:51], v2, s[8:11], s28 offen offset:0 sc1
    buffer_load_dwordx4 v[52:55], v2, s[8:11], s28 offen offset:1024 sc1
    s_sub_u32 s26, s26, 1
    s_cbranch_scc1 K_FAIL
    s_branch ROGf_S1230
RQ_PADQ6:
    s_branch RQ_PADQ7
ROGf_S123_F:
    buffer_load_dwordx4 v[56:59], v2, s[8:11], s28 offen offset:2048 sc1
    buffer_load_dwordx4 v[60:63], v2, s[8:11], s28 offen offset:3072 sc1
    s_sub_u32 s26, s26, 1
    s_cbranch_scc1 K_FAIL
    s_branch ROGf_S231
RQ_PADQ7:
    s_branch RQ_PADQ8
ROGf_S23_F:
    buffer_load_dwordx4 v[64:67], v2, s[8:11], s23 offen offset:0 sc1
    buffer_load_dwordx4 v[68:71], v2, s[8:11], s23 offen offset:1024 sc1
    s_sub_u32 s26, s26, 1
    s_cbranch_scc1 K_FAIL
    s_branch ROGf_S32
RQ_PADQ8:
    s_branch RQ_PADQ9
ROGf_S3_F:
    buffer_load_dwordx4 v[72:75], v2, s[8:11], s23 offen offset:2048 sc1
    buffer_load_dwordx4 v[76:79], v2, s[8:11], s23 offen offset:3072 sc1
    s_sub_u32 s26, s26, 1
    s_cbranch_scc1 K_FAIL
    s_nop 10
    buffer_load_dwordx4 v[72:75], v2, s[8:11], s23 offen offset:2048 sc1
    buffer_load_dwordx4 v[76:79], v2, s[8:11], s23 offen offset:3072 sc1
    s_nop 10
    buffer_load_dwordx4 v[72:75], v2, s[8:11], s23 offen offset:2048 sc1
    buffer_load_dwordx4 v[76:79], v2, s[8:11], s23 offen offset:3072 sc1
    s_nop 10
    buffer_load_dwordx4 v[72:75], v2, s[8:11], s23 offen offset:2048 sc1
    buffer_load_dwordx4 v[76:79], v2, s[8:11], s23 offen offset:3072 sc1
ROGf_S3_L:
    s_waitcnt vmcnt(6)
    v_max3_u32 v13, v72, v73, v74
    v_max3_u32 v13, v13, v75, v76
    v_max3_u32 v13, v13, v77, v78
    v_max_u32 v13, v13, v79
    v_cmp_eq_u32 vcc, -1, v13
    s_cbranch_vccz ROGf_S3_OK
    buffer_load_dwordx4 v[72:75], v2, s[8:11], s23 offen offset:2048 sc1
    buffer_load_dwordx4 v[76:79], v2, s[8:11], s23 offen offset:3072 sc1
    s_sub_u32 s26, s26, 1
    s_cbranch_scc1 K_FAIL
    s_branch ROGf_S3_L
RQ_PADQ9:
    s_branch RQ_PADQ10
ROGf_S1230:
    s_waitcnt vmcnt(6)
    v_max_u32 v13, v59, v63
    v_cmp_eq_u32 vcc, -1, v13
    s_cbranch_vccnz ROGf_S1230_F
ROGf_S1230_OK:
    v_smfmac_f32_16x16x64_bf16 v[40:43], v[56:59], v[160:167], v1
    s_waitcnt vmcnt(4)
    v_max_u32 v13, v67, v71
    v_cmp_eq_u32 vcc, -1, v13
    v_smfmac_f32_16x16x64_bf16 v[40:43], v[60:63], v[176:183], v1
    v_max_u32 v5, v56, v57
    v_max_u32 v6, v58, v59
    v_smfmac_f32_16x16x64_bf16 v[44:47], v[56:59], v[168:175], v1
    s_cbranch_vccnz ROGf_S1230_T
    v_smfmac_f32_16x16x64_bf16 v[44:47], v[60:63], v[184:191], v1
    v_max3_u32 v5, v5, v60, v61
    v_max3_u32 v6, v6, v62, v63
    s_branch ROGf_S230_OK
RQ_PADQ10:
    s_branch RQ_PADQ11
ROGf_S1230_T:
    v_smfmac_f32_16x16x64_bf16 v[44:47], v[60:63], v[184:191], v1
    v_max3_u32 v5, v5, v60, v61
    v_max3_u32 v6, v6, v62, v63
    s_branch ROGf_S230_F
RQ_PADQ11:
    s_branch RQ_PADQ12
ROGf_S1230_F:
    buffer_load_dwordx4 v[56:59], v2, s[8:11], s28 offen offset:2048 sc1
    buffer_load_dwordx4 v[60:63], v2, s[8:11], s28 offen offset:3072 sc1
    s_sub_u32 s26, s26, 1
    s_cbranch_scc1 K_FAIL
    s_branch ROGf_S2301
RQ_PADQ12:
    s_branch RQ_PADQ13
ROGf_S231:
    s_waitcnt vmcnt(4)
    v_max_u32 v13, v67, v71
    v_cmp_eq_u32 vcc, -1, v13
    s_cbranch_vccnz ROGf_S231_F
ROGf_S231_OK:
    v_smfmac_f32_16x16x64_bf16 v[40:43], v[64:67], v[192:199], v1
    s_waitcnt vmcnt(2)
    v_max_u32 v13, v75, v79
    v_cmp_eq_u32 vcc, -1, v13
    v_smfmac_f32_16x16x64_bf16 v[40:43], v[68:71], v[208:215], v1
    v_max3_u32 v5, v5, v64, v65
    v_max3_u32 v6, v6, v66, v67
    v_smfmac_f32_16x16x64_bf16 v[44:47], v[64:67], v[200:207], v1
    s_cbranch_vccnz ROGf_S231_T
    v_smfmac_f32_16x16x64_bf16 v[44:47], v[68:71], v[216:223], v1
    v_max3_u32 v5, v5, v68, v69
    v_max3_u32 v6, v6, v70, v71
    s_branch ROGf_S31_OK
RQ_PADQ13:
    s_branch RQ_PADQ14
ROGf_S231_T:
    v_smfmac_f32_16x16x64_bf16 v[44:47], v[68:71], v[216:223], v1
    v_max3_u32 v5, v5, v68, v69
    v_max3_u32 v6, v6, v70, v71
    s_branch ROGf_S31_F
RQ_PADQ14:
    s_branch RQ_PADQ15
ROGf_S231_F:
    buffer_load_dwordx4 v[64:67], v2, s[8:11], s23 offen offset:0 sc1
    buffer_load_dwordx4 v[68:71], v2, s[8:11], s23 offen offset:1024 sc1
    s_sub_u32 s26, s26, 1
    s_cbranch_scc1 K_FAIL
    s_branch ROGf_S312
RQ_PADQ15:
    s_branch RQ_PADQ16
ROGf_S32:
    s_waitcnt vmcnt(2)
    v_max_u32 v13, v75, v79
    v_cmp_eq_u32 vcc, -1, v13
    s_cbranch_vccnz ROGf_S32_F
ROGf_S32_OK:
    v_smfmac_f32_16x16x64_bf16 v[40:43], v[72:75], v[224:231], v1
    s_waitcnt vmcnt(0)
    v_max_u32 v13, v67, v71
    v_cmp_eq_u32 vcc, -1, v13
    v_smfmac_f32_16x16x64_bf16 v[40:43], v[76:79], v[240:247], v1
    v_max3_u32 v5, v5, v72, v73
    v_max3_u32 v6, v6, v74, v75
    v_smfmac_f32_16x16x64_bf16 v[44:47], v[72:75], v[232:239], v1
    s_cbranch_vccnz ROGf_S32_T
    v_smfmac_f32_16x16x64_bf16 v[44:47], v[76:79], v[248:255], v1
    v_max3_u32 v5, v5, v76, v77
    v_max3_u32 v6, v6, v78, v79
    s_branch ROGf_S2_OK
RQ_PADQ16:
    s_branch RQ_PADQ17
ROGf_S32_T:
    v_smfmac_f32_16x16x64_bf16 v[44:47], v[76:79], v[248:255], v1
    v_max3_u32 v5, v5, v76, v77
    v_max3_u32 v6, v6, v78, v79
    s_branch ROGf_S2_F
RQ_PADQ17:
    s_branch RQ_PADQ18
ROGf_S32_F:
    buffer_load_dwordx4 v[72:75], v2, s[8:11], s23 offen offset:2048 sc1
    buffer_load_dwordx4 v[76:79], v2, s[8:11], s23 offen offset:3072 sc1
    s_sub_u32 s26, s26, 1
    s_cbranch_scc1 K_FAIL
    s_branch ROGf_S23
RQ_PADQ18:
    s_branch RQ_PADQ19
ROGf_S230:
    s_waitcnt vmcnt(4)
    v_max_u32 v13, v67, v71
    v_cmp_eq_u32 vcc, -1, v13
    s_cbranch_vccnz ROGf_S230_F
ROGf_S230_OK:
    v_smfmac_f32_16x16x64_bf16 v[40:43], v[64:67], v[192:199], v1
    s_waitcnt vmcnt(2)
    v_max_u32 v13, v75, v79
    v_cmp_eq_u32 vcc, -1, v13
    v_smfmac_f32_16x16x64_bf16 v[40:43], v[68:71], v[208:215], v1
    v_max3_u32 v5, v5, v64, v65
    v_max3_u32 v6, v6, v66, v67
    v_smfmac_f32_16x16x64_bf16 v[44:47], v[64:67], v[200:207], v1
    s_cbranch_vccnz ROGf_S230_T
    v_smfmac_f32_16x16x64_bf16 v[44:47], v[68:71], v[216:223], v1
    v_max3_u32 v5, v5, v68, v69
    v_max3_u32 v6, v6, v70, v71
    s_branch ROGf_S30_OK
RQ_PADQ19:
    s_branch RQ_PADQ20
ROGf_S230_T:
    v_smfmac_f32_16x16x64_bf16 v[44:47], v[68:71], v[216:223], v1
    v_max3_u32 v5, v5, v68, v69
    v_max3_u32 v6, v6, v70, v71
    s_branch ROGf_S30_F
RQ_PADQ20:
    s_branch RQ_PADQ21
ROGf_S230_F:
    buffer_load_dwordx4 v[64:67], v2, s[8:11], s23 offen offset:0 sc1
    buffer_load_dwordx4 v[68:71], v2, s[8:11], s23 offen offset:1024 sc1
    s_sub_u32 s26, s26, 1
    s_cbranch_scc1 K_FAIL
    s_branch ROGf_S302
RQ_PADQ21:
    s_branch RQ_PADQ22
ROGf_S2301:
    s_waitcnt vmcnt(6)
    v_max_u32 v13, v67, v71
    v_cmp_eq_u32 vcc, -1, v13
    s_cbranch_vccnz ROGf_S2301_F
ROGf_S2301_OK:
    v_smfmac_f32_16x16x64_bf16 v[40:43], v[64:67], v[192:199], v1
    s_waitcnt vmcnt(4)
    v_max_u32 v13, v75, v79
    v_cmp_eq_u32 vcc, -1, v13
    v_smfmac_f32_16x16x64_bf16 v[40:43], v[68:71], v[208:215], v1
    v_max_u32 v5, v64, v65
    v_max_u32 v6, v66, v67
    v_smfmac_f32_16x16x64_bf16 v[44:47], v[64:67], v[200:207], v1
    s_cbranch_vccnz ROGf_S2301_T
    v_smfmac_f32_16x16x64_bf16 v[44:47], v[68:71], v[216:223], v1
    v_max3_u32 v5, v5, v68, v69
    v_max3_u32 v6, v6, v70, v71
    s_branch ROGf_S301_OK
RQ_PADQ22:
    s_branch RQ_PADQ23
ROGf_S2301_T:
    v_smfmac_f32_16x16x64_bf16 v[44:47], v[68:71], v[216:223], v1
    v_max3_u32 v5, v5, v68, v69
    v_max3_u32 v6, v6, v70, v71
    s_branch ROGf_S301_F
RQ_PADQ23:
    s_branch RQ_PADQ24
ROGf_S2301_F:
    buffer_load_dwordx4 v[64:67], v2, s[8:11], s23 offen offset:0 sc1
    buffer_load_dwordx4 v[68:71], v2, s[8:11], s23 offen offset:1024 sc1
    s_sub_u32 s26, s26, 1
    s_cbranch_scc1 K_FAIL
    s_branch ROGf_S3012
RQ_PADQ24:
    s_branch RQ_PADQ25
ROGf_S31:
    s_waitcnt vmcnt(2)
    v_max_u32 v13, v75, v79
    v_cmp_eq_u32 vcc, -1, v13
    s_cbranch_vccnz ROGf_S31_F
ROGf_S31_OK:
    v_smfmac_f32_16x16x64_bf16 v[40:43], v[72:75], v[224:231], v1
    s_waitcnt vmcnt(0)
    v_max_u32 v13, v59, v63
    v_cmp_eq_u32 vcc, -1, v13
    v_smfmac_f32_16x16x64_bf16 v[40:43], v[76:79], v[240:247], v1
    v_max3_u32 v5, v5, v72, v73
    v_max3_u32 v6, v6, v74, v75
    v_smfmac_f32_16x16x64_bf16 v[44:47], v[72:75], v[232:239], v1
    s_cbranch_vccnz ROGf_S31_T
    v_smfmac_f32_16x16x64_bf16 v[44:47], v[76:79], v[248:255], v1
    v_max3_u32 v5, v5, v76, v77
    v_max3_u32 v6, v6, v78, v79
    s_branch ROGf_S1_OK
RQ_PADQ25:
    s_branch RQ_PADQ26
ROGf_S31_T:
    v_smfmac_f32_16x16x64_bf16 v[44:47], v[76:79], v[248:255], v1
    v_max3_u32 v5, v5, v76, v77
    v_max3_u32 v6, v6, v78, v79
    s_branch ROGf_S1_F
RQ_PADQ26:
    s_branch RQ_PADQ27
ROGf_S31_F:
    buffer_load_dwordx4 v[72:75], v2, s[8:11], s23 offen offset:2048 sc1
    buffer_load_dwordx4 v[76:79], v2, s[8:11], s23 offen offset:3072 sc1
    s_sub_u32 s26, s26, 1
    s_cbranch_scc1 K_FAIL
    s_branch ROGf_S13
RQ_PADQ27:
    s_branch RQ_PADQ28
ROGf_S312:
    s_waitcnt vmcnt(4)
    v_max_u32 v13, v75, v79
    v_cmp_eq_u32 vcc, -1, v13
    s_cbranch_vccnz ROGf_S312_F
ROGf_S312_OK:
    v_smfmac_f32_16x16x64_bf16 v[40:43], v[72:75], v[224:231], v1
    s_waitcnt vmcnt(2)
    v_max_u32 v13, v59, v63
    v_cmp_eq_u32 vcc, -1, v13
    v_smfmac_f32_16x16x64_bf16 v[40:43], v[76:79], v[240:247], v1
    v_max3_u32 v5, v5, v72, v73
    v_max3_u32 v6, v6, v74, v75
    v_smfmac_f32_16x16x64_bf16 v[44:47], v[72:75], v[232:239], v1
    s_cbranch_vccnz ROGf_S312_T
    v_smfmac_f32_16x16x64_bf16 v[44:47], v[76:79], v[248:255], v1
    v_max3_u32 v5, v5, v76, v77
    v_max3_u32 v6, v6, v78, v79
    s_branch ROGf_S12_OK
RQ_PADQ28:
    s_branch RQ_PADQ29
ROGf_S312_T:
    v_smfmac_f32_16x16x64_bf16 v[44:47], v[76:79], v[248:255], v1
    v_max3_u32 v5, v5, v76, v77
    v_max3_u32 v6, v6, v78, v79
    s_branch ROGf_S12_F
RQ_PADQ29:
    s_branch RQ_PADQ30
ROGf_S312_F:
    buffer_load_dwordx4 v[72:75], v2, s[8:11], s23 offen offset:2048 sc1
    buffer_load_dwordx4 v[76:79], v2, s[8:11], s23 offen offset:3072 sc1
    s_sub_u32 s26, s26, 1
    s_cbranch_scc1 K_FAIL
    s_branch ROGf_S123
RQ_PADQ30:
    s_branch RQ_PADQ31
ROGf_S2_OK:
    v_smfmac_f32_16x16x64_bf16 v[40:43], v[64:67], v[192:199], v1
    v_max3_u32 v5, v5, v64, v65
    v_max3_u32 v6, v6, v66, v67
    v_smfmac_f32_16x16x64_bf16 v[40:43], v[68:71], v[208:215], v1
    v_max3_u32 v5, v5, v68, v69
    v_max3_u32 v6, v6, v70, v71
    v_smfmac_f32_16x16x64_bf16 v[44:47], v[64:67], v[200:207], v1
    v_smfmac_f32_16x16x64_bf16 v[44:47], v[68:71], v[216:223], v1
    s_branch ROGf_DONE
RQ_PADQ31:
    s_branch RQ_PADQ32
ROGf_S2_F:
    buffer_load_dwordx4 v[64:67], v2, s[8:11], s23 offen offset:0 sc1
    buffer_load_dwordx4 v[68:71], v2, s[8:11], s23 offen offset:1024 sc1
    s_sub_u32 s26, s26, 1
    s_cbranch_scc1 K_FAIL
    s_nop 10
    buffer_load_dwordx4 v[64:67], v2, s[8:11], s23 offen offset:0 sc1
    buffer_load_dwordx4 v[68:71], v2, s[8:11], s23 offen offset:1024 sc1
    s_nop 10
    buffer_load_dwordx4 v[64:67], v2, s[8:11], s23 offen offset:0 sc1
    buffer_load_dwordx4 v[68:71], v2, s[8:11], s23 offen offset:1024 sc1
    s_nop 10
    buffer_load_dwordx4 v[64:67], v2, s[8:11], s23 offen offset:0 sc1
    buffer_load_dwordx4 v[68:71], v2, s[8:11], s23 offen offset:1024 sc1
ROGf_S2_L:
    s_waitcnt vmcnt(6)
    v_max3_u32 v13, v64, v65, v66
    v_max3_u32 v13, v13, v67, v68
    v_max3_u32 v13, v13, v69, v70
    v_max_u32 v13, v13, v71
    v_cmp_eq_u32 vcc, -1, v13
    s_cbranch_vccz ROGf_S2_OK
    buffer_load_dwordx4 v[64:67], v2, s[8:11], s23 offen offset:0 sc1
    buffer_load_dwordx4 v[68:71], v2, s[8:11], s23 offen offset:1024 sc1
    s_sub_u32 s26, s26, 1
    s_cbranch_scc1 K_FAIL
    s_branch ROGf_S2_L
RQ_PADQ32:
    s_branch RQ_PADQ33
ROGf_S30:
    s_waitcnt vmcnt(2)
    v_max_u32 v13, v75, v79
    v_cmp_eq_u32 vcc, -1, v13
    s_cbranch_vccnz ROGf_S30_F
ROGf_S30_OK:
    v_smfmac_f32_16x16x64_bf16 v[40:43], v[72:75], v[224:231], v1
    s_waitcnt vmcnt(0)
    v_max_u32 v13, v51, v55
    v_cmp_eq_u32 vcc, -1, v13
    v_smfmac_f32_16x16x64_bf16 v[40:43], v[76:79], v[240:247], v1
    v_max3_u32 v5, v5, v72, v73
    v_max3_u32 v6, v6, v74, v75
    v_smfmac_f32_16x16x64_bf16 v[44:47], v[72:75], v[232:239], v1
    s_cbranch_vccnz ROGf_S30_T
    v_smfmac_f32_16x16x64_bf16 v[44:47], v[76:79], v[248:255], v1
    v_max3_u32 v5, v5, v76, v77
    v_max3_u32 v6, v6, v78, v79
    s_branch ROGf_S0_OK
RQ_PADQ33:
    s_branch RQ_PADQ34
ROGf_S30_T:
    v_smfmac_f32_16x16x64_bf16 v[44:47], v[76:79], v[248:255], v1
    v_max3_u32 v5, v5, v76, v77
    v_max3_u32 v6, v6, v78, v79
    s_branch ROGf_S0_F
RQ_PADQ34:
    s_branch RQ_PADQ35
ROGf_S30_F:
    buffer_load_dwordx4 v[72:75], v2, s[8:11], s23 offen offset:2048 sc1
    buffer_load_dwordx4 v[76:79], v2, s[8:11], s23 offen offset:3072 sc1
    s_sub_u32 s26, s26, 1
    s_cbranch_scc1 K_FAIL
    s_branch ROGf_S03
RQ_PADQ35:
    s_branch RQ_PADQ36
ROGf_S302:
    s_waitcnt vmcnt(4)
    v_max_u32 v13, v75, v79
    v_cmp_eq_u32 vcc, -1, v13
    s_cbranch_vccnz ROGf_S302_F
ROGf_S302_OK:
    v_smfmac_f32_16x16x64_bf16 v[40:43], v[72:75], v[224:231], v1
    s_waitcnt vmcnt(2)
    v_max_u32 v13, v51, v55
    v_cmp_eq_u32 vcc, -1, v13
    v_smfmac_f32_16x16x64_bf16 v[40:43], v[76:79], v[240:247], v1
    v_max3_u32 v5, v5, v72, v73
    v_max3_u32 v6, v6, v74, v75
    v_smfmac_f32_16x16x64_bf16 v[44:47], v[72:75], v[232:239], v1
    s_cbranch_vccnz ROGf_S302_T
    v_smfmac_f32_16x16x64_bf16 v[44:47], v[76:79], v[248:255], v1
    v_max3_u32 v5, v5, v76, v77
    v_max3_u32 v6, v6, v78, v79
    s_branch ROGf_S02_OK
RQ_PADQ36:
    s_branch RQ_PADQ37
ROGf_S302_T:
    v_smfmac_f32_16x16x64_bf16 v[44:47], v[76:79], v[248:255], v1
    v_max3_u32 v5, v5, v76, v77
    v_max3_u32 v6, v6, v78, v79
    s_branch ROGf_S02_F
RQ_PADQ37:
    s_branch RQ_PADQ38
ROGf_S302_F:
    buffer_load_dwordx4 v[72:75], v2, s[8:11], s23 offen offset:2048 sc1
    buffer_load_dwordx4 v[76:79], v2, s[8:11], s23 offen offset:3072 sc1
    s_sub_u32 s26, s26, 1
    s_cbranch_scc1 K_FAIL
    s_branch ROGf_S023
RQ_PADQ38:
    s_branch RQ_PADQ39
ROGf_S301:
    s_waitcnt vmcnt(4)
    v_max_u32 v13, v75, v79
    v_cmp_eq_u32 vcc, -1, v13
    s_cbranch_vccnz ROGf_S301_F
ROGf_S301_OK:
    v_smfmac_f32_16x16x64_bf16 v[40:43], v[72:75], v[224:231], v1
    s_waitcnt vmcnt(2)
    v_max_u32 v13, v51, v55
    v_cmp_eq_u32 vcc, -1, v13
    v_smfmac_f32_16x16x64_bf16 v[40:43], v[76:79], v[240:247], v1
    v_max3_u32 v5, v5, v72, v73
    v_max3_u32 v6, v6, v74, v75
    v_smfmac_f32_16x16x64_bf16 v[44:47], v[72:75], v[232:239], v1
    s_cbranch_vccnz ROGf_S301_T
    v_smfmac_f32_16x16x64_bf16 v[44:47], v[76:79], v[248:255], v1
    v_max3_u32 v5, v5, v76, v77
    v_max3_u32 v6, v6, v78, v79
    s_branch ROGf_S01_OK
RQ_PADQ39:
    s_branch RQ_PADQ40
ROGf_S301_T:
    v_smfmac_f32_16x16x64_bf16 v[44:47], v[76:79], v[248:255], v1
    v_max3_u32 v5, v5, v76, v77
    v_max3_u32 v6, v6, v78, v79
    s_branch ROGf_S01_F
RQ_PADQ40:
    s_branch RQ_PADQ41
ROGf_S301_F:
    buffer_load_dwordx4 v[72:75], v2, s[8:11], s23 offen offset:2048 sc1
    buffer_load_dwordx4 v[76:79], v2, s[8:11], s23 offen offset:3072 sc1
    s_sub_u32 s26, s26, 1
    s_cbranch_scc1 K_FAIL
    s_branch ROGf_S013
RQ_PADQ41:
    s_branch RQ_PADQ42
ROGf_S3012:
    s_waitcnt vmcnt(6)
    v_max_u32 v13, v75, v79
    v_cmp_eq_u32 vcc, -1, v13
    s_cbranch_vccnz ROGf_S3012_F
ROGf_S3012_OK:
    v_smfmac_f32_16x16x64_bf16 v[40:43], v[72:75], v[224:231], v1
    s_waitcnt vmcnt(4)
    v_max_u32 v13, v51, v55
    v_cmp_eq_u32 vcc, -1, v13
    v_smfmac_f32_16x16x64_bf16 v[40:43], v[76:79], v[240:247], v1
    v_max_u32 v5, v72, v73
    v_max_u32 v6, v74, v75
    v_smfmac_f32_16x16x64_bf16 v[44:47], v[72:75], v[232:239], v1
    s_cbranch_vccnz ROGf_S3012_T
    v_smfmac_f32_16x16x64_bf16 v[44:47], v[76:79], v[248:255], v1
    v_max3_u32 v5, v5, v76, v77
    v_max3_u32 v6, v6, v78, v79
    s_branch ROGf_S012_OK
RQ_PADQ42:
    s_branch RQ_PADQ43
ROGf_S3012_T:
    v_smfmac_f32_16x16x64_bf16 v[44:47], v[76:79], v[248:255], v1
    v_max3_u32 v5, v5, v76, v77
    v_max3_u32 v6, v6, v78, v79
    s_branch ROGf_S012_F
RQ_PADQ43:
    s_branch RQ_PADQ44
ROGf_S3012_F:
    buffer_load_dwordx4 v[72:75], v2, s[8:11], s23 offen offset:2048 sc1
    buffer_load_dwordx4 v[76:79], v2, s[8:11], s23 offen offset:3072 sc1
    s_sub_u32 s26, s26, 1
    s_cbranch_scc1 K_FAIL
    s_branch ROGf_S0123
RQ_PADQ44:
    s_branch RQ_PADQ45
ROGf_S1_OK:
    v_smfmac_f32_16x16x64_bf16 v[40:43], v[56:59], v[160:167], v1
    v_max3_u32 v5, v5, v56, v57
    v_max3_u32 v6, v6, v58, v59
    v_smfmac_f32_16x16x64_bf16 v[40:43], v[60:63], v[176:183], v1
    v_max3_u32 v5, v5, v60, v61
    v_max3_u32 v6, v6, v62, v63
    v_smfmac_f32_16x16x64_bf16 v[44:47], v[56:59], v[168:175], v1
    v_smfmac_f32_16x16x64_bf16 v[44:47], v[60:63], v[184:191], v1
    s_branch ROGf_DONE
RQ_PADQ45:
    s_branch RQ_PADQ46
ROGf_S1_F:
    buffer_load_dwordx4 v[56:59], v2, s[8:11], s28 offen offset:2048 sc1
    buffer_load_dwordx4 v[60:63], v2, s[8:11], s28 offen offset:3072 sc1
    s_sub_u32 s26, s26, 1
    s_cbranch_scc1 K_FAIL
    s_nop 10
    buffer_load_dwordx4 v[56:59], v2, s[8:11], s28 offen offset:2048 sc1
    buffer_load_dwordx4 v[60:63], v2, s[8:11], s28 offen offset:3072 sc1
    s_nop 10
    buffer_load_dwordx4 v[56:59], v2, s[8:11], s28 offen offset:2048 sc1
    buffer_load_dwordx4 v[60:63], v2, s[8:11], s28 offen offset:3072 sc1
    s_nop 10
    buffer_load_dwordx4 v[56:59], v2, s[8:11], s28 offen offset:2048 sc1
    buffer_load_dwordx4 v[60:63], v2, s[8:11], s28 offen offset:3072 sc1
ROGf_S1_L:
    s_waitcnt vmcnt(6)
    v_max3_u32 v13, v56, v57, v58
    v_max3_u32 v13, v13, v59, v60
    v_max3_u32 v13, v13, v61, v62
    v_max_u32 v13, v13, v63
    v_cmp_eq_u32 vcc, -1, v13
    s_cbranch_vccz ROGf_S1_OK
    buffer_load_dwordx4 v[56:59], v2, s[8:11], s28 offen offset:2048 sc1
    buffer_load_dwordx4 v[60:63], v2, s[8:11], s28 offen offset:3072 sc1
    s_sub_u32 s26, s26, 1
    s_cbranch_scc1 K_FAIL
    s_branch ROGf_S1_L
RQ_PADQ46:
    s_branch RQ_PADQ47
ROGf_S13:
    s_waitcnt vmcnt(2)
    v_max_u32 v13, v59, v63
    v_cmp_eq_u32 vcc, -1, v13
    s_cbranch_vccnz ROGf_S13_F
ROGf_S13_OK:
    v_smfmac_f32_16x16x64_bf16 v[40:43], v[56:59], v[160:167], v1
    s_waitcnt vmcnt(0)
    v_max_u32 v13, v75, v79
    v_cmp_eq_u32 vcc, -1, v13
    v_smfmac_f32_16x16x64_bf16 v[40:43], v[60:63], v[176:183], v1
    v_max3_u32 v5, v5, v56, v57
    v_max3_u32 v6, v6, v58, v59
    v_smfmac_f32_16x16x64_bf16 v[44:47], v[56:59], v[168:175], v1
    s_cbranch_vccnz ROGf_S13_T
    v_smfmac_f32_16x16x64_bf16 v[44:47], v[60:63], v[184:191], v1
    v_max3_u32 v5, v5, v60, v61
    v_max3_u32 v6, v6, v62, v63
    s_branch ROGf_S3_OK
RQ_PADQ47:
    s_branch RQ_PADQ48
ROGf_S13_T:
    v_smfmac_f32_16x16x64_bf16 v[44:47], v[60:63], v[184:191], v1
    v_max3_u32 v5, v5, v60, v61
    v_max3_u32 v6, v6, v62, v63
    s_branch ROGf_S3_F
RQ_PADQ48:
    s_branch RQ_PADQ49
ROGf_S13_F:
    buffer_load_dwordx4 v[56:59], v2, s[8:11], s28 offen offset:2048 sc1
    buffer_load_dwordx4 v[60:63], v2, s[8:11], s28 offen offset:3072 sc1
    s_sub_u32 s26, s26, 1
    s_cbranch_scc1 K_FAIL
    s_branch ROGf_S31
RQ_PADQ49:
    s_branch RQ_PADQ50
ROGf_S12:
    s_waitcnt vmcnt(2)
    v_max_u32 v13, v59, v63
    v_cmp_eq_u32 vcc, -1, v13
    s_cbranch_vccnz ROGf_S12_F
ROGf_S12_OK:
    v_smfmac_f32_16x16x64_bf16 v[40:43], v[56:59], v[160:167], v1
    s_waitcnt vmcnt(0)
    v_max_u32 v13, v67, v71
    v_cmp_eq_u32 vcc, -1, v13
    v_smfmac_f32_16x16x64_bf16 v[40:43], v[60:63], v[176:183], v1
    v_max3_u32 v5, v5, v56, v57
    v_max3_u32 v6, v6, v58, v59
    v_smfmac_f32_16x16x64_bf16 v[44:47], v[56:59], v[168:175], v1
    s_cbranch_vccnz ROGf_S12_T
    v_smfmac_f32_16x16x64_bf16 v[44:47], v[60:63], v[184:191], v1
    v_max3_u32 v5, v5, v60, v61
    v_max3_u32 v6, v6, v62, v63
    s_branch ROGf_S2_OK
RQ_PADQ50:
    s_branch RQ_PADQ51
ROGf_S12_T:
    v_smfmac_f32_16x16x64_bf16 v[44:47], v[60:63], v[184:191], v1
    v_max3_u32 v5, v5, v60, v61
    v_max3_u32 v6, v6, v62, v63
    s_branch ROGf_S2_F
RQ_PADQ51:
    s_branch RQ_PADQ52
ROGf_S12_F:
    buffer_load_dwordx4 v[56:59], v2, s[8:11], s28 offen offset:2048 sc1
    buffer_load_dwordx4 v[60:63], v2, s[8:11], s28 offen offset:3072 sc1
    s_sub_u32 s26, s26, 1
    s_cbranch_scc1 K_FAIL
    s_branch ROGf_S21
RQ_PADQ52:
    s_branch RQ_PADQ53
ROGf_S0_OK:
    v_smfmac_f32_16x16x64_bf16 v[40:43], v[48:51], v[128:135], v1
    v_max3_u32 v5, v5, v48, v49
    v_max3_u32 v6, v6, v50, v51
    v_smfmac_f32_16x16x64_bf16 v[40:43], v[52:55], v[144:151], v1
    v_max3_u32 v5, v5, v52, v53
    v_max3_u32 v6, v6, v54, v55
    v_smfmac_f32_16x16x64_bf16 v[44:47], v[48:51], v[136:143], v1
    v_smfmac_f32_16x16x64_bf16 v[44:47], v[52:55], v[152:159], v1
    s_branch ROGf_DONE
RQ_PADQ53:
    s_branch RQ_PADQ54
ROGf_S0_F:
    buffer_load_dwordx4 v[48:51], v2, s[8:11], s28 offen offset:0 sc1
    buffer_load_dwordx4 v[52:55], v2, s[8:11], s28 offen offset:1024 sc1
    s_sub_u32 s26, s26, 1
    s_cbranch_scc1 K_FAIL
    s_nop 10
    buffer_load_dwordx4 v[48:51], v2, s[8:11], s28 offen offset:0 sc1
    buffer_load_dwordx4 v[52:55], v2, s[8:11], s28 offen offset:1024 sc1
    s_nop 10
    buffer_load_dwordx4 v[48:51], v2, s[8:11], s28 offen offset:0 sc1
    buffer_load_dwordx4 v[52:55], v2, s[8:11], s28 offen offset:1024 sc1
    s_nop 10
    buffer_load_dwordx4 v[48:51], v2, s[8:11], s28 offen offset:0 sc1
    buffer_load_dwordx4 v[52:55], v2, s[8:11], s28 offen offset:1024 sc1
ROGf_S0_L:
    s_waitcnt vmcnt(6)
    v_max3_u32 v13, v48, v49, v50
    v_max3_u32 v13, v13, v51, v52
    v_max3_u32 v13, v13, v53, v54
    v_max_u32 v13, v13, v55
    v_cmp_eq_u32 vcc, -1, v13
    s_cbranch_vccz ROGf_S0_OK
    buffer_load_dwordx4 v[48:51], v2, s[8:11], s28 offen offset:0 sc1
    buffer_load_dwordx4 v[52:55], v2, s[8:11], s28 offen offset:1024 sc1
    s_sub_u32 s26, s26, 1
    s_cbranch_scc1 K_FAIL
    s_branch ROGf_S0_L
RQ_PADQ54:
    s_branch RQ_PADQ55
ROGf_S03:
    s_waitcnt vmcnt(2)
    v_max_u32 v13, v51, v55
    v_cmp_eq_u32 vcc, -1, v13
    s_cbranch_vccnz ROGf_S03_F
ROGf_S03_OK:
    v_smfmac_f32_16x16x64_bf16 v[40:43], v[48:51], v[128:135], v1
    s_waitcnt vmcnt(0)
    v_max_u32 v13, v75, v79
    v_cmp_eq_u32 vcc, -1, v13
    v_smfmac_f32_16x16x64_bf16 v[40:43], v[52:55], v[144:151], v1
    v_max3_u32 v5, v5, v48, v49
    v_max3_u32 v6, v6, v50, v51
    v_smfmac_f32_16x16x64_bf16 v[44:47], v[48:51], v[136:143], v1
    s_cbranch_vccnz ROGf_S03_T
    v_smfmac_f32_16x16x64_bf16 v[44:47], v[52:55], v[152:159], v1
    v_max3_u32 v5, v5, v52, v53
    v_max3_u32 v6, v6, v54, v55
    s_branch ROGf_S3_OK
RQ_PADQ55:
    s_branch RQ_PADQ56
ROGf_S03_T:
    v_smfmac_f32_16x16x64_bf16 v[44:47], v[52:55], v[152:159], v1
    v_max3_u32 v5, v5, v52, v53
    v_max3_u32 v6, v6, v54, v55
    s_branch ROGf_S3_F
RQ_PADQ56:
    s_branch RQ_PADQ57
ROGf_S03_F:
    buffer_load_dwordx4 v[48:51], v2, s[8:11], s28 offen offset:0 sc1
    buffer_load_dwordx4 v[52:55], v2, s[8:11], s28 offen offset:1024 sc1
    s_sub_u32 s26, s26, 1
    s_cbranch_scc1 K_FAIL
    s_branch ROGf_S30
RQ_PADQ57:
    s_branch RQ_PADQ58
ROGf_S02:
    s_waitcnt vmcnt(2)
    v_max_u32 v13, v51, v55
    v_cmp_eq_u32 vcc, -1, v13
    s_cbranch_vccnz ROGf_S02_F
ROGf_S02_OK:
    v_smfmac_f32_16x16x64_bf16 v[40:43], v[48:51], v[128:135], v1
    s_waitcnt vmcnt(0)
    v_max_u32 v13, v67, v71
    v_cmp_eq_u32 vcc, -1, v13
    v_smfmac_f32_16x16x64_bf16 v[40:43], v[52:55], v[144:151], v1
    v_max3_u32 v5, v5, v48, v49
    v_max3_u32 v6, v6, v50, v51
    v_smfmac_f32_16x16x64_bf16 v[44:47], v[48:51], v[136:143], v1
    s_cbranch_vccnz ROGf_S02_T
    v_smfmac_f32_16x16x64_bf16 v[44:47], v[52:55], v[152:159], v1
    v_max3_u32 v5, v5, v52, v53
    v_max3_u32 v6, v6, v54, v55
    s_branch ROGf_S2_OK
RQ_PADQ58:
    s_branch RQ_PADQ59
ROGf_S02_T:
    v_smfmac_f32_16x16x64_bf16 v[44:47], v[52:55], v[152:159], v1
    v_max3_u32 v5, v5, v52, v53
    v_max3_u32 v6, v6, v54, v55
    s_branch ROGf_S2_F
RQ_PADQ59:
    s_branch RQ_PADQ60
ROGf_S02_F:
    buffer_load_dwordx4 v[48:51], v2, s[8:11], s28 offen offset:0 sc1
    buffer_load_dwordx4 v[52:55], v2, s[8:11], s28 offen offset:1024 sc1
    s_sub_u32 s26, s26, 1
    s_cbranch_scc1 K_FAIL
    s_branch ROGf_S20
RQ_PADQ60:
    s_branch RQ_PADQ61
ROGf_S023:
    s_waitcnt vmcnt(4)
    v_max_u32 v13, v51, v55
    v_cmp_eq_u32 vcc, -1, v13
    s_cbranch_vccnz ROGf_S023_F
ROGf_S023_OK:
    v_smfmac_f32_16x16x64_bf16 v[40:43], v[48:51], v[128:135], v1
    s_waitcnt vmcnt(2)
    v_max_u32 v13, v67, v71
    v_cmp_eq_u32 vcc, -1, v13
    v_smfmac_f32_16x16x64_bf16 v[40:43], v[52:55], v[144:151], v1
    v_max3_u32 v5, v5, v48, v49
    v_max3_u32 v6, v6, v50, v51
    v_smfmac_f32_16x16x64_bf16 v[44:47], v[48:51], v[136:143], v1
    s_cbranch_vccnz ROGf_S023_T
    v_smfmac_f32_16x16x64_bf16 v[44:47], v[52:55], v[152:159], v1
    v_max3_u32 v5, v5, v52, v53
    v_max3_u32 v6, v6, v54, v55
    s_branch ROGf_S23_OK
RQ_PADQ61:
    s_branch RQ_PADQ62
ROGf_S023_T:
    v_smfmac_f32_16x16x64_bf16 v[44:47], v[52:55], v[152:159], v1
    v_max3_u32 v5, v5, v52, v53
    v_max3_u32 v6, v6, v54, v55
    s_branch ROGf_S23_F
RQ_PADQ62:
    s_branch RQ_PADQ63
ROGf_S023_F:
    buffer_load_dwordx4 v[48:51], v2, s[8:11], s28 offen offset:0 sc1
    buffer_load_dwordx4 v[52:55], v2, s[8:11], s28 offen offset:1024 sc1
    s_sub_u32 s26, s26, 1
    s_cbranch_scc1 K_FAIL
    s_branch ROGf_S230
RQ_PADQ63:
    s_branch RQ_PADQ64
ROGf_S01:
    s_waitcnt vmcnt(2)
    v_max_u32 v13, v51, v55
    v_cmp_eq_u32 vcc, -1, v13
    s_cbranch_vccnz ROGf_S01_F
ROGf_S01_OK:
    v_smfmac_f32_16x16x64_bf16 v[40:43], v[48:51], v[128:135], v1
    s_waitcnt vmcnt(0)
    v_max_u32 v13, v59, v63
    v_cmp_eq_u32 vcc, -1, v13
    v_smfmac_f32_16x16x64_bf16 v[40:43], v[52:55], v[144:151], v1
    v_max3_u32 v5, v5, v48, v49
    v_max3_u32 v6, v6, v50, v51
    v_smfmac_f32_16x16x64_bf16 v[44:47], v[48:51], v[136:143], v1
    s_cbranch_vccnz ROGf_S01_T
    v_smfmac_f32_16x16x64_bf16 v[44:47], v[52:55], v[152:159], v1
    v_max3_u32 v5, v5, v52, v53
    v_max3_u32 v6, v6, v54, v55
    s_branch ROGf_S1_OK
RQ_PADQ64:
    s_branch RQ_PADQ65
ROGf_S01_T:
    v_smfmac_f32_16x16x64_bf16 v[44:47], v[52:55], v[152:159], v1
    v_max3_u32 v5, v5, v52, v53
    v_max3_u32 v6, v6, v54, v55
    s_branch ROGf_S1_F
RQ_PADQ65:
    s_branch RQ_PADQ66
ROGf_S01_F:
    buffer_load_dwordx4 v[48:51], v2, s[8:11], s28 offen offset:0 sc1
    buffer_load_dwordx4 v[52:55], v2, s[8:11], s28 offen offset:1024 sc1
    s_sub_u32 s26, s26, 1
    s_cbranch_scc1 K_FAIL
    s_branch ROGf_S10
RQ_PADQ66:
    s_branch RQ_PADQ67
ROGf_S013:
    s_waitcnt vmcnt(4)
    v_max_u32 v13, v51, v55
    v_cmp_eq_u32 vcc, -1, v13
    s_cbranch_vccnz ROGf_S013_F
ROGf_S013_OK:
    v_smfmac_f32_16x16x64_bf16 v[40:43], v[48:51], v[128:135], v1
    s_waitcnt vmcnt(2)
    v_max_u32 v13, v59, v63
    v_cmp_eq_u32 vcc, -1, v13
    v_smfmac_f32_16x16x64_bf16 v[40:43], v[52:55], v[144:151], v1
    v_max3_u32 v5, v5, v48, v49
    v_max3_u32 v6, v6, v50, v51
    v_smfmac_f32_16x16x64_bf16 v[44:47], v[48:51], v[136:143], v1
    s_cbranch_vccnz ROGf_S013_T
    v_smfmac_f32_16x16x64_bf16 v[44:47], v[52:55], v[152:159], v1
    v_max3_u32 v5, v5, v52, v53
    v_max3_u32 v6, v6, v54, v55
    s_branch ROGf_S13_OK
RQ_PADQ67:
    s_branch RQ_PADQ68
ROGf_S013_T:
    v_smfmac_f32_16x16x64_bf16 v[44:47], v[52:55], v[152:159], v1
    v_max3_u32 v5, v5, v52, v53
    v_max3_u32 v6, v6, v54, v55
    s_branch ROGf_S13_F
RQ_PADQ68:
    s_branch RQ_PADQ69
ROGf_S013_F:
    buffer_load_dwordx4 v[48:51], v2, s[8:11], s28 offen offset:0 sc1
    buffer_load_dwordx4 v[52:55], v2, s[8:11], s28 offen offset:1024 sc1
    s_sub_u32 s26, s26, 1
    s_cbranch_scc1 K_FAIL
    s_branch ROGf_S130
RQ_PADQ69:
    s_branch RQ_PADQ70
ROGf_S012:
    s_waitcnt vmcnt(4)
    v_max_u32 v13, v51, v55
    v_cmp_eq_u32 vcc, -1, v13
    s_cbranch_vccnz ROGf_S012_F
ROGf_S012_OK:
    v_smfmac_f32_16x16x64_bf16 v[40:43], v[48:51], v[128:135], v1
    s_waitcnt vmcnt(2)
    v_max_u32 v13, v59, v63
    v_cmp_eq_u32 vcc, -1, v13
    v_smfmac_f32_16x16x64_bf16 v[40:43], v[52:55], v[144:151], v1
    v_max3_u32 v5, v5, v48, v49
    v_max3_u32 v6, v6, v50, v51
    v_smfmac_f32_16x16x64_bf16 v[44:47], v[48:51], v[136:143], v1
    s_cbranch_vccnz ROGf_S012_T
    v_smfmac_f32_16x16x64_bf16 v[44:47], v[52:55], v[152:159], v1
    v_max3_u32 v5, v5, v52, v53
    v_max3_u32 v6, v6, v54, v55
    s_branch ROGf_S12_OK
RQ_PADQ70:
    s_branch RQ_PADQ71
ROGf_S012_T:
    v_smfmac_f32_16x16x64_bf16 v[44:47], v[52:55], v[152:159], v1
    v_max3_u32 v5, v5, v52, v53
    v_max3_u32 v6, v6, v54, v55
    s_branch ROGf_S12_F
RQ_PADQ71:
    s_branch RQ_PADQ72
ROGf_S012_F:
    buffer_load_dwordx4 v[48:51], v2, s[8:11], s28 offen offset:0 sc1
    buffer_load_dwordx4 v[52:55], v2, s[8:11], s28 offen offset:1024 sc1
    s_sub_u32 s26, s26, 1
    s_cbranch_scc1 K_FAIL
    s_branch ROGf_S120
RQ_PADQ72:
    s_branch RQ_PADQ73
ROGf_S21:
    s_waitcnt vmcnt(2)
    v_max_u32 v13, v67, v71
    v_cmp_eq_u32 vcc, -1, v13
    s_cbranch_vccnz ROGf_S21_F
ROGf_S21_OK:
    v_smfmac_f32_16x16x64_bf16 v[40:43], v[64:67], v[192:199], v1
    s_waitcnt vmcnt(0)
    v_max_u32 v13, v59, v63
    v_cmp_eq_u32 vcc, -1, v13
    v_smfmac_f32_16x16x64_bf16 v[40:43], v[68:71], v[208:215], v1
    v_max3_u32 v5, v5, v64, v65
    v_max3_u32 v6, v6, v66, v67
    v_smfmac_f32_16x16x64_bf16 v[44:47], v[64:67], v[200:207], v1
    s_cbranch_vccnz ROGf_S21_T
    v_smfmac_f32_16x16x64_bf16 v[44:47], v[68:71], v[216:223], v1
    v_max3_u32 v5, v5, v68, v69
    v_max3_u32 v6, v6, v70, v71
    s_branch ROGf_S1_OK
RQ_PADQ73:
    s_branch RQ_PADQ74
ROGf_S21_T:
    v_smfmac_f32_16x16x64_bf16 v[44:47], v[68:71], v[216:223], v1
    v_max3_u32 v5, v5, v68, v69
    v_max3_u32 v6, v6, v70, v71
    s_branch ROGf_S1_F
RQ_PADQ74:
    s_branch RQ_PADQ75
ROGf_S21_F:
    buffer_load_dwordx4 v[64:67], v2, s[8:11], s23 offen offset:0 sc1
    buffer_load_dwordx4 v[68:71], v2, s[8:11], s23 offen offset:1024 sc1
    s_sub_u32 s26, s26, 1
    s_cbranch_scc1 K_FAIL
    s_branch ROGf_S12
RQ_PADQ75:
    s_branch RQ_PADQ76
ROGf_S20:
    s_waitcnt vmcnt(2)
    v_max_u32 v13, v67, v71
    v_cmp_eq_u32 vcc, -1, v13
    s_cbranch_vccnz ROGf_S20_F
ROGf_S20_OK:
    v_smfmac_f32_16x16x64_bf16 v[40:43], v[64:67], v[192:199], v1
    s_waitcnt vmcnt(0)
    v_max_u32 v13, v51, v55
    v_cmp_eq_u32 vcc, -1, v13
    v_smfmac_f32_16x16x64_bf16 v[40:43], v[68:71], v[208:215], v1
    v_max3_u32 v5, v5, v64, v65
    v_max3_u32 v6, v6, v66, v67
    v_smfmac_f32_16x16x64_bf16 v[44:47], v[64:67], v[200:207], v1
    s_cbranch_vccnz ROGf_S20_T
    v_smfmac_f32_16x16x64_bf16 v[44:47], v[68:71], v[216:223], v1
    v_max3_u32 v5, v5, v68, v69
    v_max3_u32 v6, v6, v70, v71
    s_branch ROGf_S0_OK
RQ_PADQ76:
    s_branch RQ_PADQ77
ROGf_S20_T:
    v_smfmac_f32_16x16x64_bf16 v[44:47], v[68:71], v[216:223], v1
    v_max3_u32 v5, v5, v68, v69
    v_max3_u32 v6, v6, v70, v71
    s_branch ROGf_S0_F
RQ_PADQ77:
    s_branch RQ_PADQ78
ROGf_S20_F:
    buffer_load_dwordx4 v[64:67], v2, s[8:11], s23 offen offset:0 sc1
    buffer_load_dwordx4 v[68:71], v2, s[8:11], s23 offen offset:1024 sc1
    s_sub_u32 s26, s26, 1
    s_cbranch_scc1 K_FAIL
    s_branch ROGf_S02
RQ_PADQ78:
    s_branch RQ_PADQ79
ROGf_S10:
    s_waitcnt vmcnt(2)
    v_max_u32 v13, v59, v63
    v_cmp_eq_u32 vcc, -1, v13
    s_cbranch_vccnz ROGf_S10_F
ROGf_S10_OK:
    v_smfmac_f32_16x16x64_bf16 v[40:43], v[56:59], v[160:167], v1
    s_waitcnt vmcnt(0)
    v_max_u32 v13, v51, v55
    v_cmp_eq_u32 vcc, -1, v13
    v_smfmac_f32_16x16x64_bf16 v[40:43], v[60:63], v[176:183], v1
    v_max3_u32 v5, v5, v56, v57
    v_max3_u32 v6, v6, v58, v59
    v_smfmac_f32_16x16x64_bf16 v[44:47], v[56:59], v[168:175], v1
    s_cbranch_vccnz ROGf_S10_T
    v_smfmac_f32_16x16x64_bf16 v[44:47], v[60:63], v[184:191], v1
    v_max3_u32 v5, v5, v60, v61
    v_max3_u32 v6, v6, v62, v63
    s_branch ROGf_S0_OK
RQ_PADQ79:
    s_branch RQ_PADQ80
ROGf_S10_T:
    v_smfmac_f32_16x16x64_bf16 v[44:47], v[60:63], v[184:191], v1
    v_max3_u32 v5, v5, v60, v61
    v_max3_u32 v6, v6, v62, v63
    s_branch ROGf_S0_F
RQ_PADQ80:
    s_branch RQ_PADQ81
ROGf_S10_F:
    buffer_load_dwordx4 v[56:59], v2, s[8:11], s28 offen offset:2048 sc1
    buffer_load_dwordx4 v[60:63], v2, s[8:11], s28 offen offset:3072 sc1
    s_sub_u32 s26, s26, 1
    s_cbranch_scc1 K_FAIL
    s_branch ROGf_S01
RQ_PADQ81:
    s_branch RQ_PADQ82
ROGf_S130:
    s_waitcnt vmcnt(4)
    v_max_u32 v13, v59, v63
    v_cmp_eq_u32 vcc, -1, v13
    s_cbranch_vccnz ROGf_S130_F
ROGf_S130_OK:
    v_smfmac_f32_16x16x64_bf16 v[40:43], v[56:59], v[160:167], v1
    s_waitcnt vmcnt(2)
    v_max_u32 v13, v75, v79
    v_cmp_eq_u32 vcc, -1, v13
    v_smfmac_f32_16x16x64_bf16 v[40:43], v[60:63], v[176:183], v1
    v_max3_u32 v5, v5, v56, v57
    v_max3_u32 v6, v6, v58, v59
    v_smfmac_f32_16x16x64_bf16 v[44:47], v[56:59], v[168:175], v1
    s_cbranch_vccnz ROGf_S130_T
    v_smfmac_f32_16x16x64_bf16 v[44:47], v[60:63], v[184:191], v1
    v_max3_u32 v5, v5, v60, v61
    v_max3_u32 v6, v6, v62, v63
    s_branch ROGf_S30_OK
RQ_PADQ82:
    s_branch RQ_PADQ83
ROGf_S130_T:
    v_smfmac_f32_16x16x64_bf16 v[44:47], v[60:63], v[184:191], v1
    v_max3_u32 v5, v5, v60, v61
    v_max3_u32 v6, v6, v62, v63
    s_branch ROGf_S30_F
RQ_PADQ83:
    s_branch RQ_PADQ84
ROGf_S130_F:
    buffer_load_dwordx4 v[56:59], v2, s[8:11], s28 offen offset:2048 sc1
    buffer_load_dwordx4 v[60:63], v2, s[8:11], s28 offen offset:3072 sc1
    s_sub_u32 s26, s26, 1
    s_cbranch_scc1 K_FAIL
    s_branch ROGf_S301
RQ_PADQ84:
    s_branch RQ_PADQ85
ROGf_S120:
    s_waitcnt vmcnt(4)
    v_max_u32 v13, v59, v63
    v_cmp_eq_u32 vcc, -1, v13
    s_cbranch_vccnz ROGf_S120_F
ROGf_S120_OK:
    v_smfmac_f32_16x16x64_bf16 v[40:43], v[56:59], v[160:167], v1
    s_waitcnt vmcnt(2)
    v_max_u32 v13, v67, v71
    v_cmp_eq_u32 vcc, -1, v13
    v_smfmac_f32_16x16x64_bf16 v[40:43], v[60:63], v[176:183], v1
    v_max3_u32 v5, v5, v56, v57
    v_max3_u32 v6, v6, v58, v59
    v_smfmac_f32_16x16x64_bf16 v[44:47], v[56:59], v[168:175], v1
    s_cbranch_vccnz ROGf_S120_T
    v_smfmac_f32_16x16x64_bf16 v[44:47], v[60:63], v[184:191], v1
    v_max3_u32 v5, v5, v60, v61
    v_max3_u32 v6, v6, v62, v63
    s_branch ROGf_S20_OK
RQ_PADQ85:
    s_branch RQ_PADQ86
ROGf_S120_T:
    v_smfmac_f32_16x16x64_bf16 v[44:47], v[60:63], v[184:191], v1
    v_max3_u32 v5, v5, v60, v61
    v_max3_u32 v6, v6, v62, v63
    s_branch ROGf_S20_F
RQ_PADQ86:
    s_branch RQ_PADQ87
ROGf_S120_F:
    buffer_load_dwordx4 v[56:59], v2, s[8:11], s28 offen offset:2048 sc1
    buffer_load_dwordx4 v[60:63], v2, s[8:11], s28 offen offset:3072 sc1
    s_sub_u32 s26, s26, 1
    s_cbranch_scc1 K_FAIL
    s_branch ROGf_S201
RQ_PADQ87:
    s_branch RQ_PADQ88
ROGf_S201:
    s_waitcnt vmcnt(4)
    v_max_u32 v13, v67, v71
    v_cmp_eq_u32 vcc, -1, v13
    s_cbranch_vccnz ROGf_S201_F
ROGf_S201_OK:
    v_smfmac_f32_16x16x64_bf16 v[40:43], v[64:67], v[192:199], v1
    s_waitcnt vmcnt(2)
    v_max_u32 v13, v51, v55
    v_cmp_eq_u32 vcc, -1, v13
    v_smfmac_f32_16x16x64_bf16 v[40:43], v[68:71], v[208:215], v1
    v_max3_u32 v5, v5, v64, v65
    v_max3_u32 v6, v6, v66, v67
    v_smfmac_f32_16x16x64_bf16 v[44:47], v[64:67], v[200:207], v1
    s_cbranch_vccnz ROGf_S201_T
    v_smfmac_f32_16x16x64_bf16 v[44:47], v[68:71], v[216:223], v1
    v_max3_u32 v5, v5, v68, v69
    v_max3_u32 v6, v6, v70, v71
    s_branch ROGf_S01_OK
RQ_PADQ88:
    s_branch RQ_PADQ89
ROGf_S201_T:
    v_smfmac_f32_16x16x64_bf16 v[44:47], v[68:71], v[216:223], v1
    v_max3_u32 v5, v5, v68, v69
    v_max3_u32 v6, v6, v70, v71
    s_branch ROGf_S01_F
RQ_PADQ89:
    s_branch RQ_PADQ90
ROGf_S201_F:
    buffer_load_dwordx4 v[64:67], v2, s[8:11], s23 offen offset:0 sc1
    buffer_load_dwordx4 v[68:71], v2, s[8:11], s23 offen offset:1024 sc1
    s_sub_u32 s26, s26, 1
    s_cbranch_scc1 K_FAIL
    s_branch ROGf_S012
RQ_PADQ90:
    s_branch RQ_PADQ91
RQ_PADQ91:
    s_branch RQ_PADRET0
RQf_FINAL:
    s_lshr_b32 s33, s34, 8
    s_xor_b32 s33, s33, s36
    s_and_b32 s33, s33, 0x2000
    s_add_u32 s33, s33, s34
    s_mov_b32 exec_lo, 0
    buffer_store_dwordx4 v[100:103], v9, s[8:11], s33 offen sc1
    s_mov_b32 exec_lo, -1
    s_add_u32 s34, s34, 524288
    s_waitcnt vmcnt(0)
    s_barrier
    s_mov_b64 exec, 1
    s_lshr_b32 s33, s20, 2
    s_lshl_b32 s33, s33, 5
    s_add_u32 s33, s33, s25
    s_lshl_b32 s33, s33, 2
    s_add_u32 s33, s33, 124835648
    v_mov_b32 v13, 16
    buffer_atomic_add v13, off, s[8:11], s33 sc1
RQf_SGF:
    s_mov_b64 exec, -1
    s_waitcnt vmcnt(0)
    s_branch RQ_END
RQs_LOOP:
    s_and_b32 s27, s25, 3
    s_lshl_b32 s27, s27, 18
    s_add_u32 s27, s27, s37
    s_and_b32 s28, s25, 3
    s_lshl_b32 s28, s28, 17
    s_add_u32 s28, s28, s36
    s_add_u32 s30, s25, 2
    s_and_b32 s30, s30, 3
    s_lshl_b32 s30, s30, 18
    s_add_u32 s30, s30, s36
    s_add_u32 s32, s25, 1
    s_and_b32 s32, s32, 3
    s_lshl_b32 s32, s32, 17
    s_add_u32 s32, s32, s36
    s_and_b32 s29, s25, 3
    s_lshl_b32 s29, s29, 18
    s_add_u32 s29, s29, s36
    s_add_u32 s23, s28, 4096
    s_cmp_eq_u32 s49, 3
    s_cbranch_scc1 RQs_VR
    s_cmp_ge_u32 s25, 63
    s_cbranch_scc1 RQ_LAST
    s_cmp_eq_u32 s49, 0
    s_cbranch_scc1 RQs_AT
    s_barrier
    s_barrier
    s_barrier
    s_branch RQs_OG
RQs_VR:
    s_waitcnt vmcnt(0)
    s_barrier
    s_barrier
    ds_read_b128 v[144:147], v7 offset:8192
    ds_read_b128 v[148:151], v7 offset:9216
    ds_read_b128 v[152:155], v7 offset:10240
    ds_read_b128 v[156:159], v7 offset:11264
    s_waitcnt lgkmcnt(3)
    v_mfma_f32_16x16x32_bf16 v[160:163], v[128:131], v[144:147], 0
    v_mfma_f32_16x16x32_bf16 v[164:167], v[132:135], v[144:147], 0
    s_waitcnt lgkmcnt(2)
    v_mfma_f32_16x16x32_bf16 v[160:163], v[128:131], v[148:151], v[160:163]
    v_mfma_f32_16x16x32_bf16 v[164:167], v[132:135], v[148:151], v[164:167]
    s_waitcnt lgkmcnt(1)
    v_mfma_f32_16x16x32_bf16 v[160:163], v[136:139], v[152:155], v[160:163]
    v_mfma_f32_16x16x32_bf16 v[164:167], v[140:143], v[152:155], v[164:167]
    s_waitcnt lgkmcnt(0)
    v_mfma_f32_16x16x32_bf16 v[160:163], v[136:139], v[156:159], v[160:163]
    v_mfma_f32_16x16x32_bf16 v[164:167], v[140:143], v[156:159], v[164:167]
    s_nop 7
    v_cvt_pk_bf16_f32 v100, v160, v161
    v_cvt_pk_bf16_f32 v101, v162, v163
    v_cvt_pk_bf16_f32 v102, v164, v165
    v_cvt_pk_bf16_f32 v103, v166, v167
    s_cmp_ge_u32 s25, 63
    s_cbranch_scc1 RQs_FINAL
    ds_write_b128 v4, v[100:103] offset:18432
    s_waitcnt lgkmcnt(0)
    s_barrier
    s_lshr_b32 s33, s34, 8
    s_xor_b32 s33, s33, s36
    s_and_b32 s33, s33, 0x2000
    s_add_u32 s33, s33, s34
    s_mov_b32 exec_lo, 0
    buffer_store_dwordx4 v[100:103], v9, s[8:11], s33 offen sc1
    s_mov_b32 exec_lo, -1
    s_add_u32 s34, s34, 524288
RQs_NC1:
    s_barrier
    s_barrier
    s_waitcnt vmcnt(0)
    s_mov_b64 exec, 1
    s_cmp_eq_u32 s25, 0
    s_cbranch_scc1 RQs_SG
    s_and_b32 s33, s25, 31
    s_cmp_lg_u32 s33, s22
    s_cbranch_scc1 RQs_SG_B
    s_lshl_b32 s33, s21, 6
    s_add_u32 s33, s33, s25
    s_lshl_b32 s33, s33, 7
    s_add_u32 s33, s33, 124794752
    v_mov_b32 v14, 64
    buffer_store_dword v14, off, s[8:11], s33 sc1
RQs_SG_B:
    s_cmp_lt_u32 s25, 48
    s_cbranch_scc1 RQs_SG
    s_lshr_b32 s33, s20, 2
    s_lshl_b32 s33, s33, 5
    s_add_u32 s33, s33, s25
    s_lshl_b32 s33, s33, 2
    s_add_u32 s33, s33, 124835648
    v_mov_b32 v13, 16
    buffer_atomic_add v13, off, s[8:11], s33 sc1
RQs_SG:
    s_mov_b64 exec, -1
    s_barrier
    s_cmp_lg_u32 s25, 40
    s_cbranch_scc1 RQs_PW_OK
    s_mov_b32 s38, 104
    s_lshl_b32 s38, s38, 7
    s_add_u32 s38, s38, 124780544
RQs_PW:
    buffer_load_dword v6, off, s[8:11], s38 sc1
    s_sub_u32 s26, s26, 1
    s_cbranch_scc1 K_FAIL
    s_waitcnt vmcnt(0)
    v_cmp_gt_u32 vcc, 128, v6
    s_cbranch_vccz RQs_PW_OK
    s_sleep 2
    s_branch RQs_PW
RQs_PW_OK:
    s_branch RQs_E
RQs_AT:
    s_barrier
    s_nop 15
    s_nop 15
    s_nop 15
    s_nop 15
    s_nop 1
    buffer_load_dwordx4 v[48:51], v7, s[8:11], s27 offen offset:0 sc1
    buffer_load_dwordx4 v[52:55], v7, s[8:11], s27 offen offset:1024 sc1
    buffer_load_dwordx4 v[56:59], v7, s[8:11], s27 offen offset:2048 sc1
    buffer_load_dwordx4 v[60:63], v7, s[8:11], s27 offen offset:3072 sc1
    s_barrier
    buffer_load_dwordx4 v[48:51], v7, s[8:11], s27 offen offset:0 sc1
    buffer_load_dwordx4 v[52:55], v7, s[8:11], s27 offen offset:1024 sc1
    buffer_load_dwordx4 v[56:59], v7, s[8:11], s27 offen offset:2048 sc1
    buffer_load_dwordx4 v[60:63], v7, s[8:11], s27 offen offset:3072 sc1
    s_nop 11
    buffer_load_dwordx4 v[48:51], v7, s[8:11], s27 offen offset:0 sc1
    buffer_load_dwordx4 v[52:55], v7, s[8:11], s27 offen offset:1024 sc1
    buffer_load_dwordx4 v[56:59], v7, s[8:11], s27 offen offset:2048 sc1
    buffer_load_dwordx4 v[60:63], v7, s[8:11], s27 offen offset:3072 sc1
    s_nop 11
RQs_TF:
    buffer_load_dwordx4 v[48:51], v7, s[8:11], s27 offen offset:0 sc1
    buffer_load_dwordx4 v[52:55], v7, s[8:11], s27 offen offset:1024 sc1
    buffer_load_dwordx4 v[56:59], v7, s[8:11], s27 offen offset:2048 sc1
    buffer_load_dwordx4 v[60:63], v7, s[8:11], s27 offen offset:3072 sc1
    s_sub_u32 s26, s26, 1
    s_cbranch_scc1 K_FAIL
    s_waitcnt vmcnt(12)
    v_max3_u32 v13, v51, v55, v59
    v_max3_u32 v5, v48, v49, v50
    v_max_u32 v13, v13, v63
    v_mfma_f32_16x16x32_bf16 v[64:67], v[48:51], v[48:51], v[180:183]
    v_cmp_eq_u32 vcc, -1, v13
    v_max3_u32 v6, v52, v53, v54
    v_mfma_f32_16x16x32_bf16 v[68:71], v[128:131], v[48:51], 0
    v_max3_u32 v5, v5, v56, v57
    v_max3_u32 v6, v6, v58, v60
    v_mfma_f32_16x16x32_bf16 v[72:75], v[144:147], v[48:51], 0
    s_cbranch_vccnz RQs_TF
    v_mfma_f32_16x16x32_bf16 v[64:67], v[52:55], v[52:55], v[64:67]
    v_max3_u32 v5, v5, v61, v62
    v_max_u32 v5, v5, v6
    v_mfma_f32_16x16x32_bf16 v[68:71], v[132:135], v[52:55], v[68:71]
    v_cmp_eq_u32 vcc, -1, v5
    v_mfma_f32_16x16x32_bf16 v[72:75], v[148:151], v[52:55], v[72:75]
    v_mfma_f32_16x16x32_bf16 v[64:67], v[56:59], v[56:59], v[64:67]
    s_cbranch_vccnz RQs_TF
    v_mfma_f32_16x16x32_bf16 v[68:71], v[136:139], v[56:59], v[68:71]
    s_barrier
    v_mfma_f32_16x16x32_bf16 v[72:75], v[152:155], v[56:59], v[72:75]
    ds_read_b128 v[100:103], v4 offset:20480
    v_mfma_f32_16x16x32_bf16 v[64:67], v[60:63], v[60:63], v[64:67]
    v_mfma_f32_16x16x32_bf16 v[68:71], v[140:143], v[60:63], v[68:71]
    v_mfma_f32_16x16x32_bf16 v[72:75], v[156:159], v[60:63], v[72:75]
    s_nop 1
    v_max3_f32 v13, v64, v65, v66
    s_nop 1
    v_max3_f32 v14, v67, v68, v69
    v_max3_f32 v13, v13, v70, v71
    s_nop 0
    v_max3_f32 v14, v14, v72, v73
    v_max3_f32 v13, v13, v74, v75
    v_max_f32 v6, v13, v14
    v_max_f32 v13, v13, v14
    v_pk_mul_f32 v[64:65], v[64:65], s[40:41] op_sel_hi:[1,0]
    v_pk_mul_f32 v[66:67], v[66:67], s[40:41] op_sel_hi:[1,0]
    v_permlane32_swap_b32 v13, v6
    v_max_f32 v14, v13, v6
    v_max_f32 v13, v13, v6
    v_pk_mul_f32 v[68:69], v[68:69], s[40:41] op_sel_hi:[1,0]
    v_pk_mul_f32 v[70:71], v[70:71], s[40:41] op_sel_hi:[1,0]
    v_permlane16_swap_b32 v13, v14
    v_pk_mul_f32 v[72:73], v[72:73], s[40:41] op_sel_hi:[1,0]
    v_max_f32 v13, v13, v14
    v_pk_mul_f32 v[74:75], v[74:75], s[40:41] op_sel_hi:[1,0]
    v_mul_f32 v14, s41, v13
    v_pk_add_f32 v[64:65], v[64:65], v[14:15] op_sel_hi:[1,0]
    v_pk_add_f32 v[66:67], v[66:67], v[14:15] op_sel_hi:[1,0]
    v_pk_add_f32 v[68:69], v[68:69], v[14:15] op_sel_hi:[1,0]
    v_pk_add_f32 v[70:71], v[70:71], v[14:15] op_sel_hi:[1,0]
    v_pk_add_f32 v[72:73], v[72:73], v[14:15] op_sel_hi:[1,0]
    v_pk_add_f32 v[74:75], v[74:75], v[14:15] op_sel_hi:[1,0]
    v_exp_f32 v64, v64
    v_exp_f32 v65, v65
    v_exp_f32 v66, v66
    v_exp_f32 v67, v67
    v_exp_f32 v68, v68
    v_exp_f32 v69, v69
    v_cvt_pk_bf16_f32 v172, v64, v65
    v_cvt_pk_bf16_f32 v173, v66, v67
    v_exp_f32 v70, v70
    v_exp_f32 v71, v71
    s_waitcnt lgkmcnt(0)
    v_mfma_f32_16x16x16_bf16 v[192:195], v[176:177], v[172:173], 0
    v_exp_f32 v72, v72
    v_mfma_f32_16x16x16_bf16 v[184:187], v[100:101], v[172:173], 0
    v_exp_f32 v73, v73
    v_mfma_f32_16x16x16_bf16 v[188:191], v[102:103], v[172:173], 0
    v_exp_f32 v74, v74
    v_exp_f32 v75, v75
    v_cvt_pk_bf16_f32 v168, v68, v69
    v_cvt_pk_bf16_f32 v169, v70, v71
    v_cvt_pk_bf16_f32 v170, v72, v73
    v_cvt_pk_bf16_f32 v171, v74, v75
    s_nop 1
    v_mfma_f32_16x16x32_bf16 v[192:195], v[176:179], v[168:171], v[192:195]
    v_mfma_f32_16x16x32_bf16 v[184:187], v[160:163], v[168:171], v[184:187]
    v_mfma_f32_16x16x32_bf16 v[188:191], v[164:167], v[168:171], v[188:191]
    s_mov_b32 exec_lo, 0x00ff00ff
    s_mov_b32 exec_hi, 0x00ff00ff
    v_rcp_f32 v192, v192
    s_nop 1
    v_pk_mul_f32 v[184:185], v[184:185], v[192:193] op_sel_hi:[1,0]
    v_pk_mul_f32 v[186:187], v[186:187], v[192:193] op_sel_hi:[1,0]
    s_nop 0
    v_pk_mul_f32 v[188:189], v[188:189], v[192:193] op_sel_hi:[1,0]
    v_pk_mul_f32 v[190:191], v[190:191], v[192:193] op_sel_hi:[1,0]
    v_cvt_pk_bf16_f32 v196, v184, v188
    v_cvt_pk_bf16_f32 v197, v185, v189
    v_cvt_pk_bf16_f32 v198, v186, v190
    v_cvt_pk_bf16_f32 v199, v187, v191
    v_min_u32 v196, -2, v196
    v_min_u32 v197, -2, v197
    v_min_u32 v198, -2, v198
    v_min_u32 v199, -2, v199
    buffer_store_dwordx4 v[196:199], v8, s[8:11], s28 offen sc1
    s_mov_b64 exec, -1
    s_barrier
    s_barrier
    s_barrier
    buffer_load_dwordx4 v[128:131], v9, s[8:11], s52 offen offset:0 sc1
    buffer_load_dwordx4 v[132:135], v9, s[8:11], s52 offen offset:1024 sc1
    buffer_load_dwordx4 v[136:139], v9, s[8:11], s52 offen offset:2048 sc1
    buffer_load_dwordx4 v[140:143], v9, s[8:11], s52 offen offset:3072 sc1
    buffer_load_dwordx4 v[144:147], v9, s[8:11], s53 offen offset:0 sc1
    buffer_load_dwordx4 v[148:151], v9, s[8:11], s53 offen offset:1024 sc1
    buffer_load_dwordx4 v[152:155], v9, s[8:11], s53 offen offset:2048 sc1
    buffer_load_dwordx4 v[156:159], v9, s[8:11], s53 offen offset:3072 sc1
    buffer_load_dwordx4 v[160:163], v9, s[8:11], s54 offen offset:0 sc1
    buffer_load_dwordx4 v[164:167], v9, s[8:11], s54 offen offset:1024 sc1
    s_add_u32 s52, s52, 524288
    s_add_u32 s53, s53, 524288
    s_add_u32 s54, s54, 524288
    s_branch RQs_E
RQs_OG:
    s_barrier
    s_nop 15
    s_nop 11
RQs_RETRY:
    buffer_load_dwordx4 v[48:51], v2, s[8:11], s28 offen offset:0 sc1
    buffer_load_dwordx4 v[52:55], v2, s[8:11], s28 offen offset:1024 sc1
    v_mov_b32 v40, 0
    v_mov_b32 v41, 0
    v_mov_b32 v42, 0
    v_mov_b32 v43, 0
    v_mov_b32 v44, 0
    v_mov_b32 v45, 0
    v_mov_b32 v46, 0
    v_mov_b32 v47, 0
    s_nop 3
    buffer_load_dwordx4 v[56:59], v2, s[8:11], s28 offen offset:2048 sc1
    buffer_load_dwordx4 v[60:63], v2, s[8:11], s28 offen offset:3072 sc1
    s_nop 11
    buffer_load_dwordx4 v[64:67], v2, s[8:11], s23 offen offset:0 sc1
    buffer_load_dwordx4 v[68:71], v2, s[8:11], s23 offen offset:1024 sc1
    s_nop 11
    buffer_load_dwordx4 v[72:75], v2, s[8:11], s23 offen offset:2048 sc1
    buffer_load_dwordx4 v[76:79], v2, s[8:11], s23 offen offset:3072 sc1
ROGs_S0123:
    s_waitcnt vmcnt(6)
    v_max_u32 v13, v51, v55
    v_cmp_eq_u32 vcc, -1, v13
    s_cbranch_vccnz ROGs_S0123_F
ROGs_S0123_OK:
    v_smfmac_f32_16x16x64_bf16 v[40:43], v[48:51], v[128:135], v1
    s_waitcnt vmcnt(4)
    v_max_u32 v13, v59, v63
    v_cmp_eq_u32 vcc, -1, v13
    v_smfmac_f32_16x16x64_bf16 v[40:43], v[52:55], v[144:151], v1
    v_max_u32 v5, v48, v49
    v_max_u32 v6, v50, v51
    v_smfmac_f32_16x16x64_bf16 v[44:47], v[48:51], v[136:143], v1
    s_cbranch_vccnz ROGs_S0123_T
    v_smfmac_f32_16x16x64_bf16 v[44:47], v[52:55], v[152:159], v1
    v_max3_u32 v5, v5, v52, v53
    v_max3_u32 v6, v6, v54, v55
ROGs_S123_OK:
    v_smfmac_f32_16x16x64_bf16 v[40:43], v[56:59], v[160:167], v1
    s_waitcnt vmcnt(2)
    v_max_u32 v13, v67, v71
    v_cmp_eq_u32 vcc, -1, v13
    v_smfmac_f32_16x16x64_bf16 v[40:43], v[60:63], v[176:183], v1
    v_max3_u32 v5, v5, v56, v57
    v_max3_u32 v6, v6, v58, v59
    v_smfmac_f32_16x16x64_bf16 v[44:47], v[56:59], v[168:175], v1
    s_cbranch_vccnz ROGs_S123_T
    v_smfmac_f32_16x16x64_bf16 v[44:47], v[60:63], v[184:191], v1
    v_max3_u32 v5, v5, v60, v61
    v_max3_u32 v6, v6, v62, v63
ROGs_S23_OK:
    v_smfmac_f32_16x16x64_bf16 v[40:43], v[64:67], v[192:199], v1
    s_waitcnt vmcnt(0)
    v_max_u32 v13, v75, v79
    v_cmp_eq_u32 vcc, -1, v13
    v_smfmac_f32_16x16x64_bf16 v[40:43], v[68:71], v[208:215], v1
    v_max3_u32 v5, v5, v64, v65
    v_max3_u32 v6, v6, v66, v67
    v_smfmac_f32_16x16x64_bf16 v[44:47], v[64:67], v[200:207], v1
    s_cbranch_vccnz ROGs_S23_T
    v_smfmac_f32_16x16x64_bf16 v[44:47], v[68:71], v[216:223], v1
    v_max3_u32 v5, v5, v68, v69
    v_max3_u32 v6, v6, v70, v71
ROGs_S3_OK:
    v_smfmac_f32_16x16x64_bf16 v[40:43], v[72:75], v[224:231], v1
    v_max3_u32 v5, v5, v72, v73
    v_max3_u32 v6, v6, v74, v75
    v_smfmac_f32_16x16x64_bf16 v[40:43], v[76:79], v[240:247], v1
    v_max3_u32 v5, v5, v76, v77
    v_max3_u32 v6, v6, v78, v79
    v_smfmac_f32_16x16x64_bf16 v[44:47], v[72:75], v[232:239], v1
    v_smfmac_f32_16x16x64_bf16 v[44:47], v[76:79], v[248:255], v1
ROGs_DONE:
    v_max_u32 v5, v5, v6
    v_cmp_eq_u32 vcc, -1, v5
    v_permlane32_swap_b32 v40, v42
    v_permlane32_swap_b32 v41, v43
    v_pk_add_f32 v[40:41], v[40:41], v[42:43]
    s_cbranch_vccnz RQs_RO
    s_nop 1
    v_permlane32_swap_b32 v44, v46
    v_permlane32_swap_b32 v45, v47
    v_pk_add_f32 v[44:45], v[44:45], v[46:47]
    v_cvt_pk_bf16_f32 v42, v40, v44
    v_cvt_pk_bf16_f32 v43, v41, v45
    v_min_u32 v42, -2, v42
    v_min_u32 v43, -2, v43
    buffer_store_dwordx2 v[42:43], v10, s[8:11], s29 offen sc1
    ds_write_b64 v3, v[42:43] offset:12288
    buffer_store_dwordx2 v[96:97], v10, s[8:11], s30 offen sc1
    s_waitcnt lgkmcnt(0)
    s_barrier
    ds_read_b128 v[80:83], v4 offset:12288
    s_waitcnt lgkmcnt(0)
    v_mfma_f32_16x16x32_bf16 v[20:23], v[16:19], v[80:83], 0
    s_sleep 4
    s_nop 7
    buffer_load_dwordx4 v[80:83], v11, s[8:11], s29 offen offset:0 sc1
    buffer_load_dwordx4 v[84:87], v11, s[8:11], s29 offen offset:1024 sc1
    s_barrier
RQs_B1W:
    s_waitcnt vmcnt(0)
    v_max3_u32 v5, v80, v81, v82
    v_max3_u32 v5, v5, v83, v84
    v_mfma_f32_16x16x32_bf16 v[88:91], v[16:19], v[80:83], v[20:23]
    v_max3_u32 v6, v85, v86, v87
    v_mfma_f32_16x16x32_bf16 v[88:91], v[16:19], v[84:87], v[88:91]
    v_max_u32 v5, v5, v6
    v_cmp_eq_u32 vcc, -1, v5
    s_nop 4
    s_cbranch_vccnz RQs_B1F
    v_cvt_pk_bf16_f32 v6, v88, v89
    v_min_u32 v6, -2, v6
    buffer_store_dword v6, v12, s[8:11], s32 offen sc1
RQs_E:
    s_add_u32 s25, s25, 1
    s_barrier
    s_branch RQs_LOOP
RQs_RO:
    s_sub_u32 s26, s26, 1
    s_cbranch_scc1 K_FAIL
    s_waitcnt vmcnt(0)
    s_nop 4
    s_branch RQs_RETRY
RQs_B1F:
    buffer_load_dwordx4 v[80:83], v11, s[8:11], s29 offen offset:0 sc1
    buffer_load_dwordx4 v[84:87], v11, s[8:11], s29 offen offset:1024 sc1
    s_sub_u32 s26, s26, 1
    s_cbranch_scc1 K_FAIL
    s_branch RQs_B1W
ROGs_S123:
    s_waitcnt vmcnt(4)
    v_max_u32 v13, v59, v63
    v_cmp_eq_u32 vcc, -1, v13
    s_cbranch_vccnz ROGs_S123_F
    s_branch ROGs_S123_OK
ROGs_S23:
    s_waitcnt vmcnt(2)
    v_max_u32 v13, v67, v71
    v_cmp_eq_u32 vcc, -1, v13
    s_cbranch_vccnz ROGs_S23_F
    s_branch ROGs_S23_OK
ROGs_S0123_T:
    v_smfmac_f32_16x16x64_bf16 v[44:47], v[52:55], v[152:159], v1
    v_max3_u32 v5, v5, v52, v53
    v_max3_u32 v6, v6, v54, v55
    s_branch ROGs_S123_F
ROGs_S123_T:
    v_smfmac_f32_16x16x64_bf16 v[44:47], v[60:63], v[184:191], v1
    v_max3_u32 v5, v5, v60, v61
    v_max3_u32 v6, v6, v62, v63
    s_branch ROGs_S23_F
ROGs_S23_T:
    v_smfmac_f32_16x16x64_bf16 v[44:47], v[68:71], v[216:223], v1
    v_max3_u32 v5, v5, v68, v69
    v_max3_u32 v6, v6, v70, v71
    s_branch ROGs_S3_F
ROGs_S0123_F:
    buffer_load_dwordx4 v[48:51], v2, s[8:11], s28 offen offset:0 sc1
    buffer_load_dwordx4 v[52:55], v2, s[8:11], s28 offen offset:1024 sc1
    s_sub_u32 s26, s26, 1
    s_cbranch_scc1 K_FAIL
    s_branch ROGs_S1230
ROGs_S123_F:
    buffer_load_dwordx4 v[56:59], v2, s[8:11], s28 offen offset:2048 sc1
    buffer_load_dwordx4 v[60:63], v2, s[8:11], s28 offen offset:3072 sc1
    s_sub_u32 s26, s26, 1
    s_cbranch_scc1 K_FAIL
    s_branch ROGs_S231
ROGs_S23_F:
    buffer_load_dwordx4 v[64:67], v2, s[8:11], s23 offen offset:0 sc1
    buffer_load_dwordx4 v[68:71], v2, s[8:11], s23 offen offset:1024 sc1
    s_sub_u32 s26, s26, 1
    s_cbranch_scc1 K_FAIL
    s_branch ROGs_S32
ROGs_S3_F:
    buffer_load_dwordx4 v[72:75], v2, s[8:11], s23 offen offset:2048 sc1
    buffer_load_dwordx4 v[76:79], v2, s[8:11], s23 offen offset:3072 sc1
    s_sub_u32 s26, s26, 1
    s_cbranch_scc1 K_FAIL
    s_nop 10
    buffer_load_dwordx4 v[72:75], v2, s[8:11], s23 offen offset:2048 sc1
    buffer_load_dwordx4 v[76:79], v2, s[8:11], s23 offen offset:3072 sc1
    s_nop 10
    buffer_load_dwordx4 v[72:75], v2, s[8:11], s23 offen offset:2048 sc1
    buffer_load_dwordx4 v[76:79], v2, s[8:11], s23 offen offset:3072 sc1
    s_nop 10
    buffer_load_dwordx4 v[72:75], v2, s[8:11], s23 offen offset:2048 sc1
    buffer_load_dwordx4 v[76:79], v2, s[8:11], s23 offen offset:3072 sc1
ROGs_S3_L:
    s_waitcnt vmcnt(6)
    v_max3_u32 v13, v72, v73, v74
    v_max3_u32 v13, v13, v75, v76
    v_max3_u32 v13, v13, v77, v78
    v_max_u32 v13, v13, v79
    v_cmp_eq_u32 vcc, -1, v13
    s_cbranch_vccz ROGs_S3_OK
    buffer_load_dwordx4 v[72:75], v2, s[8:11], s23 offen offset:2048 sc1
    buffer_load_dwordx4 v[76:79], v2, s[8:11], s23 offen offset:3072 sc1
    s_sub_u32 s26, s26, 1
    s_cbranch_scc1 K_FAIL
    s_branch ROGs_S3_L
ROGs_S1230:
    s_waitcnt vmcnt(6)
    v_max_u32 v13, v59, v63
    v_cmp_eq_u32 vcc, -1, v13
    s_cbranch_vccnz ROGs_S1230_F
ROGs_S1230_OK:
    v_smfmac_f32_16x16x64_bf16 v[40:43], v[56:59], v[160:167], v1
    s_waitcnt vmcnt(4)
    v_max_u32 v13, v67, v71
    v_cmp_eq_u32 vcc, -1, v13
    v_smfmac_f32_16x16x64_bf16 v[40:43], v[60:63], v[176:183], v1
    v_max_u32 v5, v56, v57
    v_max_u32 v6, v58, v59
    v_smfmac_f32_16x16x64_bf16 v[44:47], v[56:59], v[168:175], v1
    s_cbranch_vccnz ROGs_S1230_T
    v_smfmac_f32_16x16x64_bf16 v[44:47], v[60:63], v[184:191], v1
    v_max3_u32 v5, v5, v60, v61
    v_max3_u32 v6, v6, v62, v63
    s_branch ROGs_S230_OK
ROGs_S1230_T:
    v_smfmac_f32_16x16x64_bf16 v[44:47], v[60:63], v[184:191], v1
    v_max3_u32 v5, v5, v60, v61
    v_max3_u32 v6, v6, v62, v63
    s_branch ROGs_S230_F
ROGs_S1230_F:
    buffer_load_dwordx4 v[56:59], v2, s[8:11], s28 offen offset:2048 sc1
    buffer_load_dwordx4 v[60:63], v2, s[8:11], s28 offen offset:3072 sc1
    s_sub_u32 s26, s26, 1
    s_cbranch_scc1 K_FAIL
    s_branch ROGs_S2301
ROGs_S231:
    s_waitcnt vmcnt(4)
    v_max_u32 v13, v67, v71
    v_cmp_eq_u32 vcc, -1, v13
    s_cbranch_vccnz ROGs_S231_F
ROGs_S231_OK:
    v_smfmac_f32_16x16x64_bf16 v[40:43], v[64:67], v[192:199], v1
    s_waitcnt vmcnt(2)
    v_max_u32 v13, v75, v79
    v_cmp_eq_u32 vcc, -1, v13
    v_smfmac_f32_16x16x64_bf16 v[40:43], v[68:71], v[208:215], v1
    v_max3_u32 v5, v5, v64, v65
    v_max3_u32 v6, v6, v66, v67
    v_smfmac_f32_16x16x64_bf16 v[44:47], v[64:67], v[200:207], v1
    s_cbranch_vccnz ROGs_S231_T
    v_smfmac_f32_16x16x64_bf16 v[44:47], v[68:71], v[216:223], v1
    v_max3_u32 v5, v5, v68, v69
    v_max3_u32 v6, v6, v70, v71
    s_branch ROGs_S31_OK
ROGs_S231_T:
    v_smfmac_f32_16x16x64_bf16 v[44:47], v[68:71], v[216:223], v1
    v_max3_u32 v5, v5, v68, v69
    v_max3_u32 v6, v6, v70, v71
    s_branch ROGs_S31_F
ROGs_S231_F:
    buffer_load_dwordx4 v[64:67], v2, s[8:11], s23 offen offset:0 sc1
    buffer_load_dwordx4 v[68:71], v2, s[8:11], s23 offen offset:1024 sc1
    s_sub_u32 s26, s26, 1
    s_cbranch_scc1 K_FAIL
    s_branch ROGs_S312
ROGs_S32:
    s_waitcnt vmcnt(2)
    v_max_u32 v13, v75, v79
    v_cmp_eq_u32 vcc, -1, v13
    s_cbranch_vccnz ROGs_S32_F
ROGs_S32_OK:
    v_smfmac_f32_16x16x64_bf16 v[40:43], v[72:75], v[224:231], v1
    s_waitcnt vmcnt(0)
    v_max_u32 v13, v67, v71
    v_cmp_eq_u32 vcc, -1, v13
    v_smfmac_f32_16x16x64_bf16 v[40:43], v[76:79], v[240:247], v1
    v_max3_u32 v5, v5, v72, v73
    v_max3_u32 v6, v6, v74, v75
    v_smfmac_f32_16x16x64_bf16 v[44:47], v[72:75], v[232:239], v1
    s_cbranch_vccnz ROGs_S32_T
    v_smfmac_f32_16x16x64_bf16 v[44:47], v[76:79], v[248:255], v1
    v_max3_u32 v5, v5, v76, v77
    v_max3_u32 v6, v6, v78, v79
    s_branch ROGs_S2_OK
ROGs_S32_T:
    v_smfmac_f32_16x16x64_bf16 v[44:47], v[76:79], v[248:255], v1
    v_max3_u32 v5, v5, v76, v77
    v_max3_u32 v6, v6, v78, v79
    s_branch ROGs_S2_F
ROGs_S32_F:
    buffer_load_dwordx4 v[72:75], v2, s[8:11], s23 offen offset:2048 sc1
    buffer_load_dwordx4 v[76:79], v2, s[8:11], s23 offen offset:3072 sc1
    s_sub_u32 s26, s26, 1
    s_cbranch_scc1 K_FAIL
    s_branch ROGs_S23
ROGs_S230:
    s_waitcnt vmcnt(4)
    v_max_u32 v13, v67, v71
    v_cmp_eq_u32 vcc, -1, v13
    s_cbranch_vccnz ROGs_S230_F
ROGs_S230_OK:
    v_smfmac_f32_16x16x64_bf16 v[40:43], v[64:67], v[192:199], v1
    s_waitcnt vmcnt(2)
    v_max_u32 v13, v75, v79
    v_cmp_eq_u32 vcc, -1, v13
    v_smfmac_f32_16x16x64_bf16 v[40:43], v[68:71], v[208:215], v1
    v_max3_u32 v5, v5, v64, v65
    v_max3_u32 v6, v6, v66, v67
    v_smfmac_f32_16x16x64_bf16 v[44:47], v[64:67], v[200:207], v1
    s_cbranch_vccnz ROGs_S230_T
    v_smfmac_f32_16x16x64_bf16 v[44:47], v[68:71], v[216:223], v1
    v_max3_u32 v5, v5, v68, v69
    v_max3_u32 v6, v6, v70, v71
    s_branch ROGs_S30_OK
ROGs_S230_T:
    v_smfmac_f32_16x16x64_bf16 v[44:47], v[68:71], v[216:223], v1
    v_max3_u32 v5, v5, v68, v69
    v_max3_u32 v6, v6, v70, v71
    s_branch ROGs_S30_F
ROGs_S230_F:
    buffer_load_dwordx4 v[64:67], v2, s[8:11], s23 offen offset:0 sc1
    buffer_load_dwordx4 v[68:71], v2, s[8:11], s23 offen offset:1024 sc1
    s_sub_u32 s26, s26, 1
    s_cbranch_scc1 K_FAIL
    s_branch ROGs_S302
ROGs_S2301:
    s_waitcnt vmcnt(6)
    v_max_u32 v13, v67, v71
    v_cmp_eq_u32 vcc, -1, v13
    s_cbranch_vccnz ROGs_S2301_F
ROGs_S2301_OK:
    v_smfmac_f32_16x16x64_bf16 v[40:43], v[64:67], v[192:199], v1
    s_waitcnt vmcnt(4)
    v_max_u32 v13, v75, v79
    v_cmp_eq_u32 vcc, -1, v13
    v_smfmac_f32_16x16x64_bf16 v[40:43], v[68:71], v[208:215], v1
    v_max_u32 v5, v64, v65
    v_max_u32 v6, v66, v67
    v_smfmac_f32_16x16x64_bf16 v[44:47], v[64:67], v[200:207], v1
    s_cbranch_vccnz ROGs_S2301_T
    v_smfmac_f32_16x16x64_bf16 v[44:47], v[68:71], v[216:223], v1
    v_max3_u32 v5, v5, v68, v69
    v_max3_u32 v6, v6, v70, v71
    s_branch ROGs_S301_OK
ROGs_S2301_T:
    v_smfmac_f32_16x16x64_bf16 v[44:47], v[68:71], v[216:223], v1
    v_max3_u32 v5, v5, v68, v69
    v_max3_u32 v6, v6, v70, v71
    s_branch ROGs_S301_F
ROGs_S2301_F:
    buffer_load_dwordx4 v[64:67], v2, s[8:11], s23 offen offset:0 sc1
    buffer_load_dwordx4 v[68:71], v2, s[8:11], s23 offen offset:1024 sc1
    s_sub_u32 s26, s26, 1
    s_cbranch_scc1 K_FAIL
    s_branch ROGs_S3012
ROGs_S31:
    s_waitcnt vmcnt(2)
    v_max_u32 v13, v75, v79
    v_cmp_eq_u32 vcc, -1, v13
    s_cbranch_vccnz ROGs_S31_F
ROGs_S31_OK:
    v_smfmac_f32_16x16x64_bf16 v[40:43], v[72:75], v[224:231], v1
    s_waitcnt vmcnt(0)
    v_max_u32 v13, v59, v63
    v_cmp_eq_u32 vcc, -1, v13
    v_smfmac_f32_16x16x64_bf16 v[40:43], v[76:79], v[240:247], v1
    v_max3_u32 v5, v5, v72, v73
    v_max3_u32 v6, v6, v74, v75
    v_smfmac_f32_16x16x64_bf16 v[44:47], v[72:75], v[232:239], v1
    s_cbranch_vccnz ROGs_S31_T
    v_smfmac_f32_16x16x64_bf16 v[44:47], v[76:79], v[248:255], v1
    v_max3_u32 v5, v5, v76, v77
    v_max3_u32 v6, v6, v78, v79
    s_branch ROGs_S1_OK
ROGs_S31_T:
    v_smfmac_f32_16x16x64_bf16 v[44:47], v[76:79], v[248:255], v1
    v_max3_u32 v5, v5, v76, v77
    v_max3_u32 v6, v6, v78, v79
    s_branch ROGs_S1_F
ROGs_S31_F:
    buffer_load_dwordx4 v[72:75], v2, s[8:11], s23 offen offset:2048 sc1
    buffer_load_dwordx4 v[76:79], v2, s[8:11], s23 offen offset:3072 sc1
    s_sub_u32 s26, s26, 1
    s_cbranch_scc1 K_FAIL
    s_branch ROGs_S13
ROGs_S312:
    s_waitcnt vmcnt(4)
    v_max_u32 v13, v75, v79
    v_cmp_eq_u32 vcc, -1, v13
    s_cbranch_vccnz ROGs_S312_F
ROGs_S312_OK:
    v_smfmac_f32_16x16x64_bf16 v[40:43], v[72:75], v[224:231], v1
    s_waitcnt vmcnt(2)
    v_max_u32 v13, v59, v63
    v_cmp_eq_u32 vcc, -1, v13
    v_smfmac_f32_16x16x64_bf16 v[40:43], v[76:79], v[240:247], v1
    v_max3_u32 v5, v5, v72, v73
    v_max3_u32 v6, v6, v74, v75
    v_smfmac_f32_16x16x64_bf16 v[44:47], v[72:75], v[232:239], v1
    s_cbranch_vccnz ROGs_S312_T
    v_smfmac_f32_16x16x64_bf16 v[44:47], v[76:79], v[248:255], v1
    v_max3_u32 v5, v5, v76, v77
    v_max3_u32 v6, v6, v78, v79
    s_branch ROGs_S12_OK
ROGs_S312_T:
    v_smfmac_f32_16x16x64_bf16 v[44:47], v[76:79], v[248:255], v1
    v_max3_u32 v5, v5, v76, v77
    v_max3_u32 v6, v6, v78, v79
    s_branch ROGs_S12_F
ROGs_S312_F:
    buffer_load_dwordx4 v[72:75], v2, s[8:11], s23 offen offset:2048 sc1
    buffer_load_dwordx4 v[76:79], v2, s[8:11], s23 offen offset:3072 sc1
    s_sub_u32 s26, s26, 1
    s_cbranch_scc1 K_FAIL
    s_branch ROGs_S123
ROGs_S2_OK:
    v_smfmac_f32_16x16x64_bf16 v[40:43], v[64:67], v[192:199], v1
    v_max3_u32 v5, v5, v64, v65
    v_max3_u32 v6, v6, v66, v67
    v_smfmac_f32_16x16x64_bf16 v[40:43], v[68:71], v[208:215], v1
    v_max3_u32 v5, v5, v68, v69
    v_max3_u32 v6, v6, v70, v71
    v_smfmac_f32_16x16x64_bf16 v[44:47], v[64:67], v[200:207], v1
    v_smfmac_f32_16x16x64_bf16 v[44:47], v[68:71], v[216:223], v1
    s_branch ROGs_DONE
ROGs_S2_F:
    buffer_load_dwordx4 v[64:67], v2, s[8:11], s23 offen offset:0 sc1
    buffer_load_dwordx4 v[68:71], v2, s[8:11], s23 offen offset:1024 sc1
    s_sub_u32 s26, s26, 1
    s_cbranch_scc1 K_FAIL
    s_nop 10
    buffer_load_dwordx4 v[64:67], v2, s[8:11], s23 offen offset:0 sc1
    buffer_load_dwordx4 v[68:71], v2, s[8:11], s23 offen offset:1024 sc1
    s_nop 10
    buffer_load_dwordx4 v[64:67], v2, s[8:11], s23 offen offset:0 sc1
    buffer_load_dwordx4 v[68:71], v2, s[8:11], s23 offen offset:1024 sc1
    s_nop 10
    buffer_load_dwordx4 v[64:67], v2, s[8:11], s23 offen offset:0 sc1
    buffer_load_dwordx4 v[68:71], v2, s[8:11], s23 offen offset:1024 sc1
ROGs_S2_L:
    s_waitcnt vmcnt(6)
    v_max3_u32 v13, v64, v65, v66
    v_max3_u32 v13, v13, v67, v68
    v_max3_u32 v13, v13, v69, v70
    v_max_u32 v13, v13, v71
    v_cmp_eq_u32 vcc, -1, v13
    s_cbranch_vccz ROGs_S2_OK
    buffer_load_dwordx4 v[64:67], v2, s[8:11], s23 offen offset:0 sc1
    buffer_load_dwordx4 v[68:71], v2, s[8:11], s23 offen offset:1024 sc1
    s_sub_u32 s26, s26, 1
    s_cbranch_scc1 K_FAIL
    s_branch ROGs_S2_L
ROGs_S30:
    s_waitcnt vmcnt(2)
    v_max_u32 v13, v75, v79
    v_cmp_eq_u32 vcc, -1, v13
    s_cbranch_vccnz ROGs_S30_F
ROGs_S30_OK:
    v_smfmac_f32_16x16x64_bf16 v[40:43], v[72:75], v[224:231], v1
    s_waitcnt vmcnt(0)
    v_max_u32 v13, v51, v55
    v_cmp_eq_u32 vcc, -1, v13
    v_smfmac_f32_16x16x64_bf16 v[40:43], v[76:79], v[240:247], v1
    v_max3_u32 v5, v5, v72, v73
    v_max3_u32 v6, v6, v74, v75
    v_smfmac_f32_16x16x64_bf16 v[44:47], v[72:75], v[232:239], v1
    s_cbranch_vccnz ROGs_S30_T
    v_smfmac_f32_16x16x64_bf16 v[44:47], v[76:79], v[248:255], v1
    v_max3_u32 v5, v5, v76, v77
    v_max3_u32 v6, v6, v78, v79
    s_branch ROGs_S0_OK
ROGs_S30_T:
    v_smfmac_f32_16x16x64_bf16 v[44:47], v[76:79], v[248:255], v1
    v_max3_u32 v5, v5, v76, v77
    v_max3_u32 v6, v6, v78, v79
    s_branch ROGs_S0_F
ROGs_S30_F:
    buffer_load_dwordx4 v[72:75], v2, s[8:11], s23 offen offset:2048 sc1
    buffer_load_dwordx4 v[76:79], v2, s[8:11], s23 offen offset:3072 sc1
    s_sub_u32 s26, s26, 1
    s_cbranch_scc1 K_FAIL
    s_branch ROGs_S03
ROGs_S302:
    s_waitcnt vmcnt(4)
    v_max_u32 v13, v75, v79
    v_cmp_eq_u32 vcc, -1, v13
    s_cbranch_vccnz ROGs_S302_F
ROGs_S302_OK:
    v_smfmac_f32_16x16x64_bf16 v[40:43], v[72:75], v[224:231], v1
    s_waitcnt vmcnt(2)
    v_max_u32 v13, v51, v55
    v_cmp_eq_u32 vcc, -1, v13
    v_smfmac_f32_16x16x64_bf16 v[40:43], v[76:79], v[240:247], v1
    v_max3_u32 v5, v5, v72, v73
    v_max3_u32 v6, v6, v74, v75
    v_smfmac_f32_16x16x64_bf16 v[44:47], v[72:75], v[232:239], v1
    s_cbranch_vccnz ROGs_S302_T
    v_smfmac_f32_16x16x64_bf16 v[44:47], v[76:79], v[248:255], v1
    v_max3_u32 v5, v5, v76, v77
    v_max3_u32 v6, v6, v78, v79
    s_branch ROGs_S02_OK
ROGs_S302_T:
    v_smfmac_f32_16x16x64_bf16 v[44:47], v[76:79], v[248:255], v1
    v_max3_u32 v5, v5, v76, v77
    v_max3_u32 v6, v6, v78, v79
    s_branch ROGs_S02_F
ROGs_S302_F:
    buffer_load_dwordx4 v[72:75], v2, s[8:11], s23 offen offset:2048 sc1
    buffer_load_dwordx4 v[76:79], v2, s[8:11], s23 offen offset:3072 sc1
    s_sub_u32 s26, s26, 1
    s_cbranch_scc1 K_FAIL
    s_branch ROGs_S023
ROGs_S301:
    s_waitcnt vmcnt(4)
    v_max_u32 v13, v75, v79
    v_cmp_eq_u32 vcc, -1, v13
    s_cbranch_vccnz ROGs_S301_F
ROGs_S301_OK:
    v_smfmac_f32_16x16x64_bf16 v[40:43], v[72:75], v[224:231], v1
    s_waitcnt vmcnt(2)
    v_max_u32 v13, v51, v55
    v_cmp_eq_u32 vcc, -1, v13
    v_smfmac_f32_16x16x64_bf16 v[40:43], v[76:79], v[240:247], v1
    v_max3_u32 v5, v5, v72, v73
    v_max3_u32 v6, v6, v74, v75
    v_smfmac_f32_16x16x64_bf16 v[44:47], v[72:75], v[232:239], v1
    s_cbranch_vccnz ROGs_S301_T
    v_smfmac_f32_16x16x64_bf16 v[44:47], v[76:79], v[248:255], v1
    v_max3_u32 v5, v5, v76, v77
    v_max3_u32 v6, v6, v78, v79
    s_branch ROGs_S01_OK
ROGs_S301_T:
    v_smfmac_f32_16x16x64_bf16 v[44:47], v[76:79], v[248:255], v1
    v_max3_u32 v5, v5, v76, v77
    v_max3_u32 v6, v6, v78, v79
    s_branch ROGs_S01_F
ROGs_S301_F:
    buffer_load_dwordx4 v[72:75], v2, s[8:11], s23 offen offset:2048 sc1
    buffer_load_dwordx4 v[76:79], v2, s[8:11], s23 offen offset:3072 sc1
    s_sub_u32 s26, s26, 1
    s_cbranch_scc1 K_FAIL
    s_branch ROGs_S013
ROGs_S3012:
    s_waitcnt vmcnt(6)
    v_max_u32 v13, v75, v79
    v_cmp_eq_u32 vcc, -1, v13
    s_cbranch_vccnz ROGs_S3012_F
ROGs_S3012_OK:
    v_smfmac_f32_16x16x64_bf16 v[40:43], v[72:75], v[224:231], v1
    s_waitcnt vmcnt(4)
    v_max_u32 v13, v51, v55
    v_cmp_eq_u32 vcc, -1, v13
    v_smfmac_f32_16x16x64_bf16 v[40:43], v[76:79], v[240:247], v1
    v_max_u32 v5, v72, v73
    v_max_u32 v6, v74, v75
    v_smfmac_f32_16x16x64_bf16 v[44:47], v[72:75], v[232:239], v1
    s_cbranch_vccnz ROGs_S3012_T
    v_smfmac_f32_16x16x64_bf16 v[44:47], v[76:79], v[248:255], v1
    v_max3_u32 v5, v5, v76, v77
    v_max3_u32 v6, v6, v78, v79
    s_branch ROGs_S012_OK
ROGs_S3012_T:
    v_smfmac_f32_16x16x64_bf16 v[44:47], v[76:79], v[248:255], v1
    v_max3_u32 v5, v5, v76, v77
    v_max3_u32 v6, v6, v78, v79
    s_branch ROGs_S012_F
ROGs_S3012_F:
    buffer_load_dwordx4 v[72:75], v2, s[8:11], s23 offen offset:2048 sc1
    buffer_load_dwordx4 v[76:79], v2, s[8:11], s23 offen offset:3072 sc1
    s_sub_u32 s26, s26, 1
    s_cbranch_scc1 K_FAIL
    s_branch ROGs_S0123
ROGs_S1_OK:
    v_smfmac_f32_16x16x64_bf16 v[40:43], v[56:59], v[160:167], v1
    v_max3_u32 v5, v5, v56, v57
    v_max3_u32 v6, v6, v58, v59
    v_smfmac_f32_16x16x64_bf16 v[40:43], v[60:63], v[176:183], v1
    v_max3_u32 v5, v5, v60, v61
    v_max3_u32 v6, v6, v62, v63
    v_smfmac_f32_16x16x64_bf16 v[44:47], v[56:59], v[168:175], v1
    v_smfmac_f32_16x16x64_bf16 v[44:47], v[60:63], v[184:191], v1
    s_branch ROGs_DONE
ROGs_S1_F:
    buffer_load_dwordx4 v[56:59], v2, s[8:11], s28 offen offset:2048 sc1
    buffer_load_dwordx4 v[60:63], v2, s[8:11], s28 offen offset:3072 sc1
    s_sub_u32 s26, s26, 1
    s_cbranch_scc1 K_FAIL
    s_nop 10
    buffer_load_dwordx4 v[56:59], v2, s[8:11], s28 offen offset:2048 sc1
    buffer_load_dwordx4 v[60:63], v2, s[8:11], s28 offen offset:3072 sc1
    s_nop 10
    buffer_load_dwordx4 v[56:59], v2, s[8:11], s28 offen offset:2048 sc1
    buffer_load_dwordx4 v[60:63], v2, s[8:11], s28 offen offset:3072 sc1
    s_nop 10
    buffer_load_dwordx4 v[56:59], v2, s[8:11], s28 offen offset:2048 sc1
    buffer_load_dwordx4 v[60:63], v2, s[8:11], s28 offen offset:3072 sc1
ROGs_S1_L:
    s_waitcnt vmcnt(6)
    v_max3_u32 v13, v56, v57, v58
    v_max3_u32 v13, v13, v59, v60
    v_max3_u32 v13, v13, v61, v62
    v_max_u32 v13, v13, v63
    v_cmp_eq_u32 vcc, -1, v13
    s_cbranch_vccz ROGs_S1_OK
    buffer_load_dwordx4 v[56:59], v2, s[8:11], s28 offen offset:2048 sc1
    buffer_load_dwordx4 v[60:63], v2, s[8:11], s28 offen offset:3072 sc1
    s_sub_u32 s26, s26, 1
    s_cbranch_scc1 K_FAIL
    s_branch ROGs_S1_L
ROGs_S13:
    s_waitcnt vmcnt(2)
    v_max_u32 v13, v59, v63
    v_cmp_eq_u32 vcc, -1, v13
    s_cbranch_vccnz ROGs_S13_F
ROGs_S13_OK:
    v_smfmac_f32_16x16x64_bf16 v[40:43], v[56:59], v[160:167], v1
    s_waitcnt vmcnt(0)
    v_max_u32 v13, v75, v79
    v_cmp_eq_u32 vcc, -1, v13
    v_smfmac_f32_16x16x64_bf16 v[40:43], v[60:63], v[176:183], v1
    v_max3_u32 v5, v5, v56, v57
    v_max3_u32 v6, v6, v58, v59
    v_smfmac_f32_16x16x64_bf16 v[44:47], v[56:59], v[168:175], v1
    s_cbranch_vccnz ROGs_S13_T
    v_smfmac_f32_16x16x64_bf16 v[44:47], v[60:63], v[184:191], v1
    v_max3_u32 v5, v5, v60, v61
    v_max3_u32 v6, v6, v62, v63
    s_branch ROGs_S3_OK
ROGs_S13_T:
    v_smfmac_f32_16x16x64_bf16 v[44:47], v[60:63], v[184:191], v1
    v_max3_u32 v5, v5, v60, v61
    v_max3_u32 v6, v6, v62, v63
    s_branch ROGs_S3_F
ROGs_S13_F:
    buffer_load_dwordx4 v[56:59], v2, s[8:11], s28 offen offset:2048 sc1
    buffer_load_dwordx4 v[60:63], v2, s[8:11], s28 offen offset:3072 sc1
    s_sub_u32 s26, s26, 1
    s_cbranch_scc1 K_FAIL
    s_branch ROGs_S31
ROGs_S12:
    s_waitcnt vmcnt(2)
    v_max_u32 v13, v59, v63
    v_cmp_eq_u32 vcc, -1, v13
    s_cbranch_vccnz ROGs_S12_F
ROGs_S12_OK:
    v_smfmac_f32_16x16x64_bf16 v[40:43], v[56:59], v[160:167], v1
    s_waitcnt vmcnt(0)
    v_max_u32 v13, v67, v71
    v_cmp_eq_u32 vcc, -1, v13
    v_smfmac_f32_16x16x64_bf16 v[40:43], v[60:63], v[176:183], v1
    v_max3_u32 v5, v5, v56, v57
    v_max3_u32 v6, v6, v58, v59
    v_smfmac_f32_16x16x64_bf16 v[44:47], v[56:59], v[168:175], v1
    s_cbranch_vccnz ROGs_S12_T
    v_smfmac_f32_16x16x64_bf16 v[44:47], v[60:63], v[184:191], v1
    v_max3_u32 v5, v5, v60, v61
    v_max3_u32 v6, v6, v62, v63
    s_branch ROGs_S2_OK
ROGs_S12_T:
    v_smfmac_f32_16x16x64_bf16 v[44:47], v[60:63], v[184:191], v1
    v_max3_u32 v5, v5, v60, v61
    v_max3_u32 v6, v6, v62, v63
    s_branch ROGs_S2_F
ROGs_S12_F:
    buffer_load_dwordx4 v[56:59], v2, s[8:11], s28 offen offset:2048 sc1
    buffer_load_dwordx4 v[60:63], v2, s[8:11], s28 offen offset:3072 sc1
    s_sub_u32 s26, s26, 1
    s_cbranch_scc1 K_FAIL
    s_branch ROGs_S21
ROGs_S0_OK:
    v_smfmac_f32_16x16x64_bf16 v[40:43], v[48:51], v[128:135], v1
    v_max3_u32 v5, v5, v48, v49
    v_max3_u32 v6, v6, v50, v51
    v_smfmac_f32_16x16x64_bf16 v[40:43], v[52:55], v[144:151], v1
    v_max3_u32 v5, v5, v52, v53
    v_max3_u32 v6, v6, v54, v55
    v_smfmac_f32_16x16x64_bf16 v[44:47], v[48:51], v[136:143], v1
    v_smfmac_f32_16x16x64_bf16 v[44:47], v[52:55], v[152:159], v1
    s_branch ROGs_DONE
ROGs_S0_F:
    buffer_load_dwordx4 v[48:51], v2, s[8:11], s28 offen offset:0 sc1
    buffer_load_dwordx4 v[52:55], v2, s[8:11], s28 offen offset:1024 sc1
    s_sub_u32 s26, s26, 1
    s_cbranch_scc1 K_FAIL
    s_nop 10
    buffer_load_dwordx4 v[48:51], v2, s[8:11], s28 offen offset:0 sc1
    buffer_load_dwordx4 v[52:55], v2, s[8:11], s28 offen offset:1024 sc1
    s_nop 10
    buffer_load_dwordx4 v[48:51], v2, s[8:11], s28 offen offset:0 sc1
    buffer_load_dwordx4 v[52:55], v2, s[8:11], s28 offen offset:1024 sc1
    s_nop 10
    buffer_load_dwordx4 v[48:51], v2, s[8:11], s28 offen offset:0 sc1
    buffer_load_dwordx4 v[52:55], v2, s[8:11], s28 offen offset:1024 sc1
ROGs_S0_L:
    s_waitcnt vmcnt(6)
    v_max3_u32 v13, v48, v49, v50
    v_max3_u32 v13, v13, v51, v52
    v_max3_u32 v13, v13, v53, v54
    v_max_u32 v13, v13, v55
    v_cmp_eq_u32 vcc, -1, v13
    s_cbranch_vccz ROGs_S0_OK
    buffer_load_dwordx4 v[48:51], v2, s[8:11], s28 offen offset:0 sc1
    buffer_load_dwordx4 v[52:55], v2, s[8:11], s28 offen offset:1024 sc1
    s_sub_u32 s26, s26, 1
    s_cbranch_scc1 K_FAIL
    s_branch ROGs_S0_L
ROGs_S03:
    s_waitcnt vmcnt(2)
    v_max_u32 v13, v51, v55
    v_cmp_eq_u32 vcc, -1, v13
    s_cbranch_vccnz ROGs_S03_F
ROGs_S03_OK:
    v_smfmac_f32_16x16x64_bf16 v[40:43], v[48:51], v[128:135], v1
    s_waitcnt vmcnt(0)
    v_max_u32 v13, v75, v79
    v_cmp_eq_u32 vcc, -1, v13
    v_smfmac_f32_16x16x64_bf16 v[40:43], v[52:55], v[144:151], v1
    v_max3_u32 v5, v5, v48, v49
    v_max3_u32 v6, v6, v50, v51
    v_smfmac_f32_16x16x64_bf16 v[44:47], v[48:51], v[136:143], v1
    s_cbranch_vccnz ROGs_S03_T
    v_smfmac_f32_16x16x64_bf16 v[44:47], v[52:55], v[152:159], v1
    v_max3_u32 v5, v5, v52, v53
    v_max3_u32 v6, v6, v54, v55
    s_branch ROGs_S3_OK
ROGs_S03_T:
    v_smfmac_f32_16x16x64_bf16 v[44:47], v[52:55], v[152:159], v1
    v_max3_u32 v5, v5, v52, v53
    v_max3_u32 v6, v6, v54, v55
    s_branch ROGs_S3_F
ROGs_S03_F:
    buffer_load_dwordx4 v[48:51], v2, s[8:11], s28 offen offset:0 sc1
    buffer_load_dwordx4 v[52:55], v2, s[8:11], s28 offen offset:1024 sc1
    s_sub_u32 s26, s26, 1
    s_cbranch_scc1 K_FAIL
    s_branch ROGs_S30
ROGs_S02:
    s_waitcnt vmcnt(2)
    v_max_u32 v13, v51, v55
    v_cmp_eq_u32 vcc, -1, v13
    s_cbranch_vccnz ROGs_S02_F
ROGs_S02_OK:
    v_smfmac_f32_16x16x64_bf16 v[40:43], v[48:51], v[128:135], v1
    s_waitcnt vmcnt(0)
    v_max_u32 v13, v67, v71
    v_cmp_eq_u32 vcc, -1, v13
    v_smfmac_f32_16x16x64_bf16 v[40:43], v[52:55], v[144:151], v1
    v_max3_u32 v5, v5, v48, v49
    v_max3_u32 v6, v6, v50, v51
    v_smfmac_f32_16x16x64_bf16 v[44:47], v[48:51], v[136:143], v1
    s_cbranch_vccnz ROGs_S02_T
    v_smfmac_f32_16x16x64_bf16 v[44:47], v[52:55], v[152:159], v1
    v_max3_u32 v5, v5, v52, v53
    v_max3_u32 v6, v6, v54, v55
    s_branch ROGs_S2_OK
ROGs_S02_T:
    v_smfmac_f32_16x16x64_bf16 v[44:47], v[52:55], v[152:159], v1
    v_max3_u32 v5, v5, v52, v53
    v_max3_u32 v6, v6, v54, v55
    s_branch ROGs_S2_F
ROGs_S02_F:
    buffer_load_dwordx4 v[48:51], v2, s[8:11], s28 offen offset:0 sc1
    buffer_load_dwordx4 v[52:55], v2, s[8:11], s28 offen offset:1024 sc1
    s_sub_u32 s26, s26, 1
    s_cbranch_scc1 K_FAIL
    s_branch ROGs_S20
ROGs_S023:
    s_waitcnt vmcnt(4)
    v_max_u32 v13, v51, v55
    v_cmp_eq_u32 vcc, -1, v13
    s_cbranch_vccnz ROGs_S023_F
ROGs_S023_OK:
    v_smfmac_f32_16x16x64_bf16 v[40:43], v[48:51], v[128:135], v1
    s_waitcnt vmcnt(2)
    v_max_u32 v13, v67, v71
    v_cmp_eq_u32 vcc, -1, v13
    v_smfmac_f32_16x16x64_bf16 v[40:43], v[52:55], v[144:151], v1
    v_max3_u32 v5, v5, v48, v49
    v_max3_u32 v6, v6, v50, v51
    v_smfmac_f32_16x16x64_bf16 v[44:47], v[48:51], v[136:143], v1
    s_cbranch_vccnz ROGs_S023_T
    v_smfmac_f32_16x16x64_bf16 v[44:47], v[52:55], v[152:159], v1
    v_max3_u32 v5, v5, v52, v53
    v_max3_u32 v6, v6, v54, v55
    s_branch ROGs_S23_OK
ROGs_S023_T:
    v_smfmac_f32_16x16x64_bf16 v[44:47], v[52:55], v[152:159], v1
    v_max3_u32 v5, v5, v52, v53
    v_max3_u32 v6, v6, v54, v55
    s_branch ROGs_S23_F
ROGs_S023_F:
    buffer_load_dwordx4 v[48:51], v2, s[8:11], s28 offen offset:0 sc1
    buffer_load_dwordx4 v[52:55], v2, s[8:11], s28 offen offset:1024 sc1
    s_sub_u32 s26, s26, 1
    s_cbranch_scc1 K_FAIL
    s_branch ROGs_S230
ROGs_S01:
    s_waitcnt vmcnt(2)
    v_max_u32 v13, v51, v55
    v_cmp_eq_u32 vcc, -1, v13
    s_cbranch_vccnz ROGs_S01_F
ROGs_S01_OK:
    v_smfmac_f32_16x16x64_bf16 v[40:43], v[48:51], v[128:135], v1
    s_waitcnt vmcnt(0)
    v_max_u32 v13, v59, v63
    v_cmp_eq_u32 vcc, -1, v13
    v_smfmac_f32_16x16x64_bf16 v[40:43], v[52:55], v[144:151], v1
    v_max3_u32 v5, v5, v48, v49
    v_max3_u32 v6, v6, v50, v51
    v_smfmac_f32_16x16x64_bf16 v[44:47], v[48:51], v[136:143], v1
    s_cbranch_vccnz ROGs_S01_T
    v_smfmac_f32_16x16x64_bf16 v[44:47], v[52:55], v[152:159], v1
    v_max3_u32 v5, v5, v52, v53
    v_max3_u32 v6, v6, v54, v55
    s_branch ROGs_S1_OK
ROGs_S01_T:
    v_smfmac_f32_16x16x64_bf16 v[44:47], v[52:55], v[152:159], v1
    v_max3_u32 v5, v5, v52, v53
    v_max3_u32 v6, v6, v54, v55
    s_branch ROGs_S1_F
ROGs_S01_F:
    buffer_load_dwordx4 v[48:51], v2, s[8:11], s28 offen offset:0 sc1
    buffer_load_dwordx4 v[52:55], v2, s[8:11], s28 offen offset:1024 sc1
    s_sub_u32 s26, s26, 1
    s_cbranch_scc1 K_FAIL
    s_branch ROGs_S10
ROGs_S013:
    s_waitcnt vmcnt(4)
    v_max_u32 v13, v51, v55
    v_cmp_eq_u32 vcc, -1, v13
    s_cbranch_vccnz ROGs_S013_F
ROGs_S013_OK:
    v_smfmac_f32_16x16x64_bf16 v[40:43], v[48:51], v[128:135], v1
    s_waitcnt vmcnt(2)
    v_max_u32 v13, v59, v63
    v_cmp_eq_u32 vcc, -1, v13
    v_smfmac_f32_16x16x64_bf16 v[40:43], v[52:55], v[144:151], v1
    v_max3_u32 v5, v5, v48, v49
    v_max3_u32 v6, v6, v50, v51
    v_smfmac_f32_16x16x64_bf16 v[44:47], v[48:51], v[136:143], v1
    s_cbranch_vccnz ROGs_S013_T
    v_smfmac_f32_16x16x64_bf16 v[44:47], v[52:55], v[152:159], v1
    v_max3_u32 v5, v5, v52, v53
    v_max3_u32 v6, v6, v54, v55
    s_branch ROGs_S13_OK
ROGs_S013_T:
    v_smfmac_f32_16x16x64_bf16 v[44:47], v[52:55], v[152:159], v1
    v_max3_u32 v5, v5, v52, v53
    v_max3_u32 v6, v6, v54, v55
    s_branch ROGs_S13_F
ROGs_S013_F:
    buffer_load_dwordx4 v[48:51], v2, s[8:11], s28 offen offset:0 sc1
    buffer_load_dwordx4 v[52:55], v2, s[8:11], s28 offen offset:1024 sc1
    s_sub_u32 s26, s26, 1
    s_cbranch_scc1 K_FAIL
    s_branch ROGs_S130
ROGs_S012:
    s_waitcnt vmcnt(4)
    v_max_u32 v13, v51, v55
    v_cmp_eq_u32 vcc, -1, v13
    s_cbranch_vccnz ROGs_S012_F
ROGs_S012_OK:
    v_smfmac_f32_16x16x64_bf16 v[40:43], v[48:51], v[128:135], v1
    s_waitcnt vmcnt(2)
    v_max_u32 v13, v59, v63
    v_cmp_eq_u32 vcc, -1, v13
    v_smfmac_f32_16x16x64_bf16 v[40:43], v[52:55], v[144:151], v1
    v_max3_u32 v5, v5, v48, v49
    v_max3_u32 v6, v6, v50, v51
    v_smfmac_f32_16x16x64_bf16 v[44:47], v[48:51], v[136:143], v1
    s_cbranch_vccnz ROGs_S012_T
    v_smfmac_f32_16x16x64_bf16 v[44:47], v[52:55], v[152:159], v1
    v_max3_u32 v5, v5, v52, v53
    v_max3_u32 v6, v6, v54, v55
    s_branch ROGs_S12_OK
ROGs_S012_T:
    v_smfmac_f32_16x16x64_bf16 v[44:47], v[52:55], v[152:159], v1
    v_max3_u32 v5, v5, v52, v53
    v_max3_u32 v6, v6, v54, v55
    s_branch ROGs_S12_F
ROGs_S012_F:
    buffer_load_dwordx4 v[48:51], v2, s[8:11], s28 offen offset:0 sc1
    buffer_load_dwordx4 v[52:55], v2, s[8:11], s28 offen offset:1024 sc1
    s_sub_u32 s26, s26, 1
    s_cbranch_scc1 K_FAIL
    s_branch ROGs_S120
ROGs_S21:
    s_waitcnt vmcnt(2)
    v_max_u32 v13, v67, v71
    v_cmp_eq_u32 vcc, -1, v13
    s_cbranch_vccnz ROGs_S21_F
ROGs_S21_OK:
    v_smfmac_f32_16x16x64_bf16 v[40:43], v[64:67], v[192:199], v1
    s_waitcnt vmcnt(0)
    v_max_u32 v13, v59, v63
    v_cmp_eq_u32 vcc, -1, v13
    v_smfmac_f32_16x16x64_bf16 v[40:43], v[68:71], v[208:215], v1
    v_max3_u32 v5, v5, v64, v65
    v_max3_u32 v6, v6, v66, v67
    v_smfmac_f32_16x16x64_bf16 v[44:47], v[64:67], v[200:207], v1
    s_cbranch_vccnz ROGs_S21_T
    v_smfmac_f32_16x16x64_bf16 v[44:47], v[68:71], v[216:223], v1
    v_max3_u32 v5, v5, v68, v69
    v_max3_u32 v6, v6, v70, v71
    s_branch ROGs_S1_OK
ROGs_S21_T:
    v_smfmac_f32_16x16x64_bf16 v[44:47], v[68:71], v[216:223], v1
    v_max3_u32 v5, v5, v68, v69
    v_max3_u32 v6, v6, v70, v71
    s_branch ROGs_S1_F
ROGs_S21_F:
    buffer_load_dwordx4 v[64:67], v2, s[8:11], s23 offen offset:0 sc1
    buffer_load_dwordx4 v[68:71], v2, s[8:11], s23 offen offset:1024 sc1
    s_sub_u32 s26, s26, 1
    s_cbranch_scc1 K_FAIL
    s_branch ROGs_S12
ROGs_S20:
    s_waitcnt vmcnt(2)
    v_max_u32 v13, v67, v71
    v_cmp_eq_u32 vcc, -1, v13
    s_cbranch_vccnz ROGs_S20_F
ROGs_S20_OK:
    v_smfmac_f32_16x16x64_bf16 v[40:43], v[64:67], v[192:199], v1
    s_waitcnt vmcnt(0)
    v_max_u32 v13, v51, v55
    v_cmp_eq_u32 vcc, -1, v13
    v_smfmac_f32_16x16x64_bf16 v[40:43], v[68:71], v[208:215], v1
    v_max3_u32 v5, v5, v64, v65
    v_max3_u32 v6, v6, v66, v67
    v_smfmac_f32_16x16x64_bf16 v[44:47], v[64:67], v[200:207], v1
    s_cbranch_vccnz ROGs_S20_T
    v_smfmac_f32_16x16x64_bf16 v[44:47], v[68:71], v[216:223], v1
    v_max3_u32 v5, v5, v68, v69
    v_max3_u32 v6, v6, v70, v71
    s_branch ROGs_S0_OK
ROGs_S20_T:
    v_smfmac_f32_16x16x64_bf16 v[44:47], v[68:71], v[216:223], v1
    v_max3_u32 v5, v5, v68, v69
    v_max3_u32 v6, v6, v70, v71
    s_branch ROGs_S0_F
ROGs_S20_F:
    buffer_load_dwordx4 v[64:67], v2, s[8:11], s23 offen offset:0 sc1
    buffer_load_dwordx4 v[68:71], v2, s[8:11], s23 offen offset:1024 sc1
    s_sub_u32 s26, s26, 1
    s_cbranch_scc1 K_FAIL
    s_branch ROGs_S02
ROGs_S10:
    s_waitcnt vmcnt(2)
    v_max_u32 v13, v59, v63
    v_cmp_eq_u32 vcc, -1, v13
    s_cbranch_vccnz ROGs_S10_F
ROGs_S10_OK:
    v_smfmac_f32_16x16x64_bf16 v[40:43], v[56:59], v[160:167], v1
    s_waitcnt vmcnt(0)
    v_max_u32 v13, v51, v55
    v_cmp_eq_u32 vcc, -1, v13
    v_smfmac_f32_16x16x64_bf16 v[40:43], v[60:63], v[176:183], v1
    v_max3_u32 v5, v5, v56, v57
    v_max3_u32 v6, v6, v58, v59
    v_smfmac_f32_16x16x64_bf16 v[44:47], v[56:59], v[168:175], v1
    s_cbranch_vccnz ROGs_S10_T
    v_smfmac_f32_16x16x64_bf16 v[44:47], v[60:63], v[184:191], v1
    v_max3_u32 v5, v5, v60, v61
    v_max3_u32 v6, v6, v62, v63
    s_branch ROGs_S0_OK
ROGs_S10_T:
    v_smfmac_f32_16x16x64_bf16 v[44:47], v[60:63], v[184:191], v1
    v_max3_u32 v5, v5, v60, v61
    v_max3_u32 v6, v6, v62, v63
    s_branch ROGs_S0_F
ROGs_S10_F:
    buffer_load_dwordx4 v[56:59], v2, s[8:11], s28 offen offset:2048 sc1
    buffer_load_dwordx4 v[60:63], v2, s[8:11], s28 offen offset:3072 sc1
    s_sub_u32 s26, s26, 1
    s_cbranch_scc1 K_FAIL
    s_branch ROGs_S01
ROGs_S130:
    s_waitcnt vmcnt(4)
    v_max_u32 v13, v59, v63
    v_cmp_eq_u32 vcc, -1, v13
    s_cbranch_vccnz ROGs_S130_F
ROGs_S130_OK:
    v_smfmac_f32_16x16x64_bf16 v[40:43], v[56:59], v[160:167], v1
    s_waitcnt vmcnt(2)
    v_max_u32 v13, v75, v79
    v_cmp_eq_u32 vcc, -1, v13
    v_smfmac_f32_16x16x64_bf16 v[40:43], v[60:63], v[176:183], v1
    v_max3_u32 v5, v5, v56, v57
    v_max3_u32 v6, v6, v58, v59
    v_smfmac_f32_16x16x64_bf16 v[44:47], v[56:59], v[168:175], v1
    s_cbranch_vccnz ROGs_S130_T
    v_smfmac_f32_16x16x64_bf16 v[44:47], v[60:63], v[184:191], v1
    v_max3_u32 v5, v5, v60, v61
    v_max3_u32 v6, v6, v62, v63
    s_branch ROGs_S30_OK
ROGs_S130_T:
    v_smfmac_f32_16x16x64_bf16 v[44:47], v[60:63], v[184:191], v1
    v_max3_u32 v5, v5, v60, v61
    v_max3_u32 v6, v6, v62, v63
    s_branch ROGs_S30_F
ROGs_S130_F:
    buffer_load_dwordx4 v[56:59], v2, s[8:11], s28 offen offset:2048 sc1
    buffer_load_dwordx4 v[60:63], v2, s[8:11], s28 offen offset:3072 sc1
    s_sub_u32 s26, s26, 1
    s_cbranch_scc1 K_FAIL
    s_branch ROGs_S301
ROGs_S120:
    s_waitcnt vmcnt(4)
    v_max_u32 v13, v59, v63
    v_cmp_eq_u32 vcc, -1, v13
    s_cbranch_vccnz ROGs_S120_F
ROGs_S120_OK:
    v_smfmac_f32_16x16x64_bf16 v[40:43], v[56:59], v[160:167], v1
    s_waitcnt vmcnt(2)
    v_max_u32 v13, v67, v71
    v_cmp_eq_u32 vcc, -1, v13
    v_smfmac_f32_16x16x64_bf16 v[40:43], v[60:63], v[176:183], v1
    v_max3_u32 v5, v5, v56, v57
    v_max3_u32 v6, v6, v58, v59
    v_smfmac_f32_16x16x64_bf16 v[44:47], v[56:59], v[168:175], v1
    s_cbranch_vccnz ROGs_S120_T
    v_smfmac_f32_16x16x64_bf16 v[44:47], v[60:63], v[184:191], v1
    v_max3_u32 v5, v5, v60, v61
    v_max3_u32 v6, v6, v62, v63
    s_branch ROGs_S20_OK
ROGs_S120_T:
    v_smfmac_f32_16x16x64_bf16 v[44:47], v[60:63], v[184:191], v1
    v_max3_u32 v5, v5, v60, v61
    v_max3_u32 v6, v6, v62, v63
    s_branch ROGs_S20_F
ROGs_S120_F:
    buffer_load_dwordx4 v[56:59], v2, s[8:11], s28 offen offset:2048 sc1
    buffer_load_dwordx4 v[60:63], v2, s[8:11], s28 offen offset:3072 sc1
    s_sub_u32 s26, s26, 1
    s_cbranch_scc1 K_FAIL
    s_branch ROGs_S201
ROGs_S201:
    s_waitcnt vmcnt(4)
    v_max_u32 v13, v67, v71
    v_cmp_eq_u32 vcc, -1, v13
    s_cbranch_vccnz ROGs_S201_F
ROGs_S201_OK:
    v_smfmac_f32_16x16x64_bf16 v[40:43], v[64:67], v[192:199], v1
    s_waitcnt vmcnt(2)
    v_max_u32 v13, v51, v55
    v_cmp_eq_u32 vcc, -1, v13
    v_smfmac_f32_16x16x64_bf16 v[40:43], v[68:71], v[208:215], v1
    v_max3_u32 v5, v5, v64, v65
    v_max3_u32 v6, v6, v66, v67
    v_smfmac_f32_16x16x64_bf16 v[44:47], v[64:67], v[200:207], v1
    s_cbranch_vccnz ROGs_S201_T
    v_smfmac_f32_16x16x64_bf16 v[44:47], v[68:71], v[216:223], v1
    v_max3_u32 v5, v5, v68, v69
    v_max3_u32 v6, v6, v70, v71
    s_branch ROGs_S01_OK
ROGs_S201_T:
    v_smfmac_f32_16x16x64_bf16 v[44:47], v[68:71], v[216:223], v1
    v_max3_u32 v5, v5, v68, v69
    v_max3_u32 v6, v6, v70, v71
    s_branch ROGs_S01_F
ROGs_S201_F:
    buffer_load_dwordx4 v[64:67], v2, s[8:11], s23 offen offset:0 sc1
    buffer_load_dwordx4 v[68:71], v2, s[8:11], s23 offen offset:1024 sc1
    s_sub_u32 s26, s26, 1
    s_cbranch_scc1 K_FAIL
    s_branch ROGs_S012
RQs_FINAL:
    s_lshr_b32 s33, s34, 8
    s_xor_b32 s33, s33, s36
    s_and_b32 s33, s33, 0x2000
    s_add_u32 s33, s33, s34
    s_mov_b32 exec_lo, 0
    buffer_store_dwordx4 v[100:103], v9, s[8:11], s33 offen sc1
    s_mov_b32 exec_lo, -1
    s_add_u32 s34, s34, 524288
    s_waitcnt vmcnt(0)
    s_barrier
    s_mov_b64 exec, 1
    s_lshr_b32 s33, s20, 2
    s_lshl_b32 s33, s33, 5
    s_add_u32 s33, s33, s25
    s_lshl_b32 s33, s33, 2
    s_add_u32 s33, s33, 124835648
    v_mov_b32 v13, 16
    buffer_atomic_add v13, off, s[8:11], s33 sc1
RQs_SGF:
    s_mov_b64 exec, -1
    s_waitcnt vmcnt(0)
    s_branch RQ_END
RQ_LAST:
    s_barrier
    s_barrier
    s_cmp_lg_u32 s49, 0
    s_cbranch_scc1 RQ_TW
    v_lshrrev_b32 v6, 3, v0
    v_lshlrev_b32 v2, 17, v6
    v_and_b32 v6, 7, v0
    v_lshl_add_u32 v2, v6, 7, v2
    s_lshl_b32 s33, s20, 10
    s_add_u32 s33, s33, 103809024
    buffer_load_dword v6, v2, s[8:11], s33 offen sc1
    s_barrier
RQ_TP:
    s_sleep 2
    buffer_load_dword v6, v2, s[8:11], s33 offen sc1
    s_sub_u32 s26, s26, 1
    s_cbranch_scc1 K_FAIL
    s_waitcnt vmcnt(0)
    v_cmp_eq_u32 vcc, -1, v6
    s_and_b64 exec, exec, vcc
    s_cbranch_scc1 RQ_TP
    s_mov_b64 exec, -1
    s_lshl_b32 s33, s21, 2
    buffer_load_dword v6, off, s[16:19], s33 offset:160 sc1
    v_mov_b32 v5, 16384
    s_waitcnt vmcnt(0)
    ds_write_b32 v5, v6
    s_waitcnt lgkmcnt(0)
    s_branch RQ_END
RQ_TW:
    v_lshrrev_b32 v6, 4, v0
    v_and_b32 v5, 15, v0
    v_lshlrev_b32 v5, 4, v5
    v_lshl_add_u32 v2, v6, 9, v5
    v_lshl_add_u32 v10, v6, 11, v5
    s_lshl_b32 s33, s21, 1
    s_and_b32 s38, s49, 1
    s_add_u32 s33, s33, s38
    s_lshl_b32 s33, s33, 14
    v_add_u32 v2, s33, v2
    s_lshl_b32 s38, s38, 10
    s_lshl_b32 s33, s21, 8
    s_add_u32 s33, s33, s38
    s_lshl_b32 s38, s22, 14
    s_add_u32 s33, s33, s38
    v_add_u32 v10, s33, v10
    v_mov_b32 v1, 0xeeee4444
    s_mov_b32 s27, 103809024
    s_mov_b32 s30, 0
    s_lshl_b32 s33, s49, 13
    s_add_u32 s33, s33, 32768
    v_lshl_add_u32 v3, v0, 4, s33
    v_mov_b32 v4, v3
    s_add_u32 s33, s27, 0
    buffer_load_dwordx4 v[48:51], v2, s[8:11], s33 offen offset:0 sc1
    buffer_load_dwordx4 v[52:55], v2, s[8:11], s33 offen offset:256 sc1
    buffer_load_dwordx4 v[56:59], v2, s[8:11], s33 offen offset:2048 sc1
    buffer_load_dwordx4 v[60:63], v2, s[8:11], s33 offen offset:2304 sc1
    s_add_u32 s33, s27, 4096
    buffer_load_dwordx4 v[64:67], v2, s[8:11], s33 offen offset:0 sc1
    buffer_load_dwordx4 v[68:71], v2, s[8:11], s33 offen offset:256 sc1
    buffer_load_dwordx4 v[72:75], v2, s[8:11], s33 offen offset:2048 sc1
    buffer_load_dwordx4 v[76:79], v2, s[8:11], s33 offen offset:2304 sc1
    s_add_u32 s33, s27, 8192
    buffer_load_dwordx4 v[80:83], v2, s[8:11], s33 offen offset:0 sc1
    buffer_load_dwordx4 v[84:87], v2, s[8:11], s33 offen offset:256 sc1
    buffer_load_dwordx4 v[88:91], v2, s[8:11], s33 offen offset:2048 sc1
    buffer_load_dwordx4 v[92:95], v2, s[8:11], s33 offen offset:2304 sc1
    s_add_u32 s33, s27, 12288
    buffer_load_dwordx4 v[96:99], v2, s[8:11], s33 offen offset:0 sc1
    buffer_load_dwordx4 v[100:103], v2, s[8:11], s33 offen offset:256 sc1
    buffer_load_dwordx4 v[104:107], v2, s[8:11], s33 offen offset:2048 sc1
    buffer_load_dwordx4 v[108:111], v2, s[8:11], s33 offen offset:2304 sc1
    s_mov_b32 s29, 192937984
    s_mov_b32 s33, 268435456
    buffer_load_dword v13, off, s[8:11], s33
    s_barrier
RQ_TLOOP:
    s_add_u32 s30, s30, 1
    s_add_u32 s28, s27, 131072
    s_cmp_eq_u32 s30, 8
    s_cselect_b32 s28, 268435456, s28
RQ_TC:
    v_mov_b32 v40, 0
    v_mov_b32 v41, 0
    v_mov_b32 v42, 0
    v_mov_b32 v43, 0
    v_mov_b32 v44, 0
    v_mov_b32 v45, 0
    v_mov_b32 v46, 0
    v_mov_b32 v47, 0
    s_waitcnt vmcnt(9)
    v_smfmac_f32_16x16x64_bf16 v[40:43], v[48:51], v[128:135], v1
    v_max3_u32 v5, v48, v49, v50
    v_max3_u32 v6, v51, v52, v53
    v_smfmac_f32_16x16x64_bf16 v[44:47], v[48:51], v[136:143], v1
    v_max3_u32 v5, v5, v54, v55
    v_max3_u32 v6, v6, v56, v57
    s_add_u32 s33, s28, 0
    buffer_load_dwordx4 v[48:51], v2, s[8:11], s33 offen offset:0 sc1
    v_smfmac_f32_16x16x64_bf16 v[40:43], v[52:55], v[128:135], v1 abid:1
    v_max3_u32 v5, v5, v58, v59
    v_max3_u32 v6, v6, v60, v61
    v_smfmac_f32_16x16x64_bf16 v[44:47], v[52:55], v[136:143], v1 abid:1
    v_max3_u32 v5, v5, v62, v63
    v_max3_u32 v6, v6, v64, v65
    buffer_load_dwordx4 v[52:55], v2, s[8:11], s33 offen offset:256 sc1
    v_smfmac_f32_16x16x64_bf16 v[40:43], v[56:59], v[144:151], v1
    v_max3_u32 v5, v5, v66, v67
    v_max3_u32 v6, v6, v68, v69
    v_smfmac_f32_16x16x64_bf16 v[44:47], v[56:59], v[152:159], v1
    v_max3_u32 v5, v5, v70, v71
    v_max3_u32 v6, v6, v72, v73
    buffer_load_dwordx4 v[56:59], v2, s[8:11], s33 offen offset:2048 sc1
    v_smfmac_f32_16x16x64_bf16 v[40:43], v[60:63], v[144:151], v1 abid:1
    v_max3_u32 v5, v5, v74, v75
    v_max3_u32 v6, v6, v76, v77
    v_smfmac_f32_16x16x64_bf16 v[44:47], v[60:63], v[152:159], v1 abid:1
    v_max3_u32 v5, v5, v78, v79
    v_max_u32 v5, v5, v6
    buffer_load_dwordx4 v[60:63], v2, s[8:11], s33 offen offset:2304 sc1
    v_smfmac_f32_16x16x64_bf16 v[40:43], v[64:67], v[160:167], v1
    v_cmp_eq_u32 vcc, -1, v5
    v_smfmac_f32_16x16x64_bf16 v[44:47], v[64:67], v[168:175], v1
    s_add_u32 s33, s28, 4096
    buffer_load_dwordx4 v[64:67], v2, s[8:11], s33 offen offset:0 sc1
    v_smfmac_f32_16x16x64_bf16 v[40:43], v[68:71], v[160:167], v1 abid:1
    s_cbranch_vccnz RQ_TF
    v_smfmac_f32_16x16x64_bf16 v[44:47], v[68:71], v[168:175], v1 abid:1
    buffer_load_dwordx4 v[68:71], v2, s[8:11], s33 offen offset:256 sc1
    v_smfmac_f32_16x16x64_bf16 v[40:43], v[72:75], v[176:183], v1
    v_smfmac_f32_16x16x64_bf16 v[44:47], v[72:75], v[184:191], v1
    buffer_load_dwordx4 v[72:75], v2, s[8:11], s33 offen offset:2048 sc1
    v_smfmac_f32_16x16x64_bf16 v[40:43], v[76:79], v[176:183], v1 abid:1
    v_smfmac_f32_16x16x64_bf16 v[44:47], v[76:79], v[184:191], v1 abid:1
    buffer_load_dwordx4 v[76:79], v2, s[8:11], s33 offen offset:2304 sc1
    s_waitcnt vmcnt(9)
    v_smfmac_f32_16x16x64_bf16 v[40:43], v[80:83], v[192:199], v1
    v_max3_u32 v5, v80, v81, v82
    v_max3_u32 v6, v83, v84, v85
    v_smfmac_f32_16x16x64_bf16 v[44:47], v[80:83], v[200:207], v1
    v_max3_u32 v5, v5, v86, v87
    v_max3_u32 v6, v6, v88, v89
    s_add_u32 s33, s28, 8192
    buffer_load_dwordx4 v[80:83], v2, s[8:11], s33 offen offset:0 sc1
    v_smfmac_f32_16x16x64_bf16 v[40:43], v[84:87], v[192:199], v1 abid:1
    v_max3_u32 v5, v5, v90, v91
    v_max3_u32 v6, v6, v92, v93
    v_smfmac_f32_16x16x64_bf16 v[44:47], v[84:87], v[200:207], v1 abid:1
    v_max3_u32 v5, v5, v94, v95
    v_max3_u32 v6, v6, v96, v97
    buffer_load_dwordx4 v[84:87], v2, s[8:11], s33 offen offset:256 sc1
    v_smfmac_f32_16x16x64_bf16 v[40:43], v[88:91], v[208:215], v1
    v_max3_u32 v5, v5, v98, v99
    v_max3_u32 v6, v6, v100, v101
    v_smfmac_f32_16x16x64_bf16 v[44:47], v[88:91], v[216:223], v1
    v_max3_u32 v5, v5, v102, v103
    v_max3_u32 v6, v6, v104, v105
    buffer_load_dwordx4 v[88:91], v2, s[8:11], s33 offen offset:2048 sc1
    v_smfmac_f32_16x16x64_bf16 v[40:43], v[92:95], v[208:215], v1 abid:1
    v_max3_u32 v5, v5, v106, v107
    v_max3_u32 v6, v6, v108, v109
    v_smfmac_f32_16x16x64_bf16 v[44:47], v[92:95], v[216:223], v1 abid:1
    v_max3_u32 v5, v5, v110, v111
    v_max_u32 v5, v5, v6
    buffer_load_dwordx4 v[92:95], v2, s[8:11], s33 offen offset:2304 sc1
    v_smfmac_f32_16x16x64_bf16 v[40:43], v[96:99], v[224:231], v1
    v_cmp_eq_u32 vcc, -1, v5
    v_smfmac_f32_16x16x64_bf16 v[44:47], v[96:99], v[232:239], v1
    s_add_u32 s33, s28, 12288
    buffer_load_dwordx4 v[96:99], v2, s[8:11], s33 offen offset:0 sc1
    v_smfmac_f32_16x16x64_bf16 v[40:43], v[100:103], v[224:231], v1 abid:1
    s_cbranch_vccnz RQ_TF
    v_smfmac_f32_16x16x64_bf16 v[44:47], v[100:103], v[232:239], v1 abid:1
    buffer_load_dwordx4 v[100:103], v2, s[8:11], s33 offen offset:256 sc1
    v_smfmac_f32_16x16x64_bf16 v[40:43], v[104:107], v[240:247], v1
    v_smfmac_f32_16x16x64_bf16 v[44:47], v[104:107], v[248:255], v1
    buffer_load_dwordx4 v[104:107], v2, s[8:11], s33 offen offset:2048 sc1
    v_smfmac_f32_16x16x64_bf16 v[40:43], v[108:111], v[240:247], v1 abid:1
    v_smfmac_f32_16x16x64_bf16 v[44:47], v[108:111], v[248:255], v1 abid:1
    buffer_load_dwordx4 v[108:111], v2, s[8:11], s33 offen offset:2304 sc1
    s_nop 6
    v_cvt_pk_bf16_f32 v20, v40, v44
    v_cvt_pk_bf16_f32 v21, v41, v45
    v_cvt_pk_bf16_f32 v22, v42, v46
    v_cvt_pk_bf16_f32 v23, v43, v47
    v_min_u32 v20, -2, v20
    v_min_u32 v21, -2, v21
    v_min_u32 v22, -2, v22
    v_min_u32 v23, -2, v23
    buffer_store_dwordx4 v[20:23], v10, s[8:11], s29 offen sc1
    s_cmp_eq_u32 s30, 4
    s_cselect_b32 s33, 0x2000, 0
    s_add_u32 s29, s29, s33
    s_add_u32 s29, s29, 524288
    s_mov_b32 s27, s28
    s_cmp_lg_u32 s30, 8
    s_cbranch_scc1 RQ_TLOOP
    s_branch RQ_END
RQ_TF:
    s_sub_u32 s26, s26, 1
    s_cbranch_scc1 K_FAIL
    s_add_u32 s33, s27, 0
    buffer_load_dwordx4 v[48:51], v2, s[8:11], s33 offen offset:0 sc1
    buffer_load_dwordx4 v[52:55], v2, s[8:11], s33 offen offset:256 sc1
    buffer_load_dwordx4 v[56:59], v2, s[8:11], s33 offen offset:2048 sc1
    buffer_load_dwordx4 v[60:63], v2, s[8:11], s33 offen offset:2304 sc1
    s_add_u32 s33, s27, 4096
    buffer_load_dwordx4 v[64:67], v2, s[8:11], s33 offen offset:0 sc1
    buffer_load_dwordx4 v[68:71], v2, s[8:11], s33 offen offset:256 sc1
    buffer_load_dwordx4 v[72:75], v2, s[8:11], s33 offen offset:2048 sc1
    buffer_load_dwordx4 v[76:79], v2, s[8:11], s33 offen offset:2304 sc1
    s_add_u32 s33, s27, 8192
    buffer_load_dwordx4 v[80:83], v2, s[8:11], s33 offen offset:0 sc1
    buffer_load_dwordx4 v[84:87], v2, s[8:11], s33 offen offset:256 sc1
    buffer_load_dwordx4 v[88:91], v2, s[8:11], s33 offen offset:2048 sc1
    buffer_load_dwordx4 v[92:95], v2, s[8:11], s33 offen offset:2304 sc1
    s_add_u32 s33, s27, 12288
    buffer_load_dwordx4 v[96:99], v2, s[8:11], s33 offen offset:0 sc1
    buffer_load_dwordx4 v[100:103], v2, s[8:11], s33 offen offset:256 sc1
    buffer_load_dwordx4 v[104:107], v2, s[8:11], s33 offen offset:2048 sc1
    buffer_load_dwordx4 v[108:111], v2, s[8:11], s33 offen offset:2304 sc1
    s_waitcnt vmcnt(0)
    v_max3_u32 v5, v51, v55, v59
    v_max3_u32 v6, v63, v67, v71
    v_max3_u32 v5, v5, v75, v79
    v_max3_u32 v6, v6, v83, v87
    v_max3_u32 v5, v5, v91, v95
    v_max3_u32 v6, v6, v99, v103
    v_max3_u32 v5, v5, v107, v111
    v_max_u32 v5, v5, v6
    v_cmp_eq_u32 vcc, -1, v5
    s_cbranch_vccnz RQ_TF
    s_branch RQ_TC
RQ_END:
    s_barrier
    s_branch R_JOIN
K_FAIL:
    s_mov_b64 exec, -1
    v_mov_b32 v1, 147456
    v_mov_b32 v2, 0xffff
    v_mov_b32 v3, 0xffff
    ds_write_b32 v1, v2
    ds_write_b64 v1, v[2:3] offset:8
    s_waitcnt lgkmcnt(0)
K_EXIT:
    s_endpgm
R_JOIN:
    v_mov_b32 v1, 16384
    ds_read_b32 v1, v1
    s_waitcnt lgkmcnt(0)
    v_cmp_le_u32 vcc, 272, v1
    s_cbranch_vccnz K_EXIT
    s_barrier
    s_lshl_b32 s4, s24, 6
    v_add_u32 v0, s4, v0
G_ENTRY:
    v_lshrrev_b32 v1, 6, v0
    v_and_b32 v0, 63, v0
    s_bfe_u32 s52, s20, 0x20005
    v_readfirstlane_b32 s76, v1
    s_and_b32 s53, s20, 31
    s_mov_b32 s36, 0
    s_mov_b32 s31, 0
    s_mov_b32 s30, 300000
    s_mov_b32 s55, s20
    s_getpc_b64 s[28:29]
G_PC:
    s_add_u32 s28, s28, G_TABLE-G_PC
    s_addc_u32 s29, s29, 0
    s_cmp_lt_u32 s55, 128
    s_cbranch_scc0 G_E2
    s_mov_b32 s25, 0
    s_mov_b32 s53, 1023
    s_branch G_DONE
G_E2:
G_LOOP:
    s_cmp_ge_u32 s53, 312
    s_cbranch_scc1 G_EXIT
    s_lshl_b32 s4, s53, 5
    s_load_dwordx8 s[20:27], s[28:29], s4
    s_cmp_lg_u32 s76, 0
    s_cbranch_scc1 G_GO
    s_waitcnt lgkmcnt(0)
    s_lshr_b32 s4, s21, 20
    s_cbranch_scc0 G_GO
    v_mov_b32 v1, 0
    v_writelane_b32 v1, s21, 0
    v_writelane_b32 v1, s22, 1
    v_writelane_b32 v1, s23, 2
    v_writelane_b32 v1, s24, 3
    v_bfe_u32 v2, v1, 10, 7
    v_and_b32 v3, 0x3ff, v1
    v_mad_u32_u24 v2, v2, s52, v3
    v_lshlrev_b32 v2, 7, v2
    v_lshrrev_b32 v1, 20, v1
    s_mov_b32 s4, 124780544
    s_mov_b64 exec, 15
G_POLL:
    buffer_load_dword v3, v2, s[8:11], s4 offen sc1
    s_sub_u32 s30, s30, 1
    s_cbranch_scc1 K_FAIL
    s_waitcnt vmcnt(0)
    v_cmp_lt_u32 vcc, v3, v1
    s_cbranch_vccz G_POLLED
    s_sleep 2
    s_bitcmp1_b32 s21, 18
    s_cbranch_scc1 G_POLL
    s_sleep 40
    s_branch G_POLL
G_POLLED:
    s_mov_b64 exec, -1
G_GO:
    s_waitcnt lgkmcnt(0)
    s_barrier
G_DISP:
    s_and_b32 s4, s20, 255
    s_bfe_u32 s77, s20, 0x80008
    s_bfe_u32 s78, s20, 0x80010
    s_lshr_b32 s79, s20, 24
    s_cmp_eq_u32 s4, 0
    s_cbranch_scc1 H_G1W
    s_cmp_eq_u32 s4, 1
    s_cbranch_scc1 H_G1N
    s_cmp_eq_u32 s4, 2
    s_cbranch_scc1 H_PREP
    s_cmp_eq_u32 s4, 3
    s_cbranch_scc1 H_WT
    s_cmp_eq_u32 s4, 4
    s_cbranch_scc1 H_FFT
    s_cmp_eq_u32 s4, 5
    s_cbranch_scc1 H_QA
    s_cmp_eq_u32 s4, 6
    s_cbranch_scc1 H_G2
    s_cmp_eq_u32 s4, 7
    s_cbranch_scc1 H_RED
    s_cmp_eq_u32 s4, 8
    s_cbranch_scc1 H_G1S
    s_cmp_eq_u32 s4, 9
    s_cbranch_scc1 H_G2N
    s_cmp_eq_u32 s4, 10
    s_cbranch_scc1 H_G2S
    s_cmp_eq_u32 s4, 11
    s_cbranch_scc1 H_Z
G_DONE2:
    s_cmp_lg_u32 s76, 0
    s_cbranch_scc1 G_E1
    s_waitcnt vmcnt(16)
    v_lshrrev_b32 v31, 20, v29
    s_mov_b64 exec, 15
    v_cmp_lt_u32 vcc, v30, v31
    s_mov_b64 exec, 1
    v_and_b32 v29, 0x20000, v29
    v_mov_b32 v3, v28
    v_or_b32 v29, vcc_lo, v29
    v_add_u32 v28, 32, v28
    v_mov_b32 v2, 147456
    ds_write_b64 v2, v[28:29] offset:8
    s_mov_b64 exec, -1
    s_waitcnt lgkmcnt(0)
G_E1:
    s_barrier
    v_mov_b32 v4, 147456
    ds_read_b64 v[4:5], v4 offset:8
    s_waitcnt lgkmcnt(0)
    v_readfirstlane_b32 s6, v4
    v_readfirstlane_b32 s7, v5
    s_nop 3
    s_cmp_lg_u32 s7, 0
    s_cbranch_scc1 G_D1
    s_cmp_lg_u32 s76, 0
    s_cbranch_scc1 G_E2B
    s_mov_b32 s31, s25
G_E2B:
    s_mov_b32 s53, s6
    s_lshl_b32 s4, s53, 5
    s_load_dwordx8 s[20:27], s[28:29], s4
    s_waitcnt lgkmcnt(0)
    s_branch G_DISP
G_DONE:
    s_cmp_lg_u32 s76, 0
    s_cbranch_scc1 G_D1
    v_mov_b32 v3, 1
    s_lshl_b32 s4, s52, 2
    s_mov_b64 exec, 1
    buffer_atomic_add v3, off, s[16:19], s4 offset:160 sc0 sc1
    s_mov_b64 exec, -1
G_D1:
    s_waitcnt vmcnt(0) lgkmcnt(0)
    s_barrier
    s_cmp_lg_u32 s76, 0
    s_cbranch_scc1 G_NEXT
    s_mov_b64 exec, 1
    v_mov_b32 v2, 147456
    v_add_u32 v3, 32, v3
    ds_write_b32 v2, v3
    s_cmp_eq_u32 s25, 0
    s_cbranch_scc1 G_NOSIG
    s_bfe_u32 s4, s25, 0x7000a
    s_mul_i32 s4, s4, s52
    s_and_b32 s5, s25, 0x3ff
    s_add_u32 s4, s4, s5
    s_lshl_b32 s4, s4, 7
    s_add_u32 s4, s4, 124780544
    s_lshr_b32 s5, s25, 20
    v_mov_b32 v1, s5
    buffer_atomic_add v1, off, s[8:11], s4 sc1
G_NOSIG:
    s_mov_b64 exec, -1
    s_waitcnt lgkmcnt(0)
G_NEXT:
    s_barrier
    v_mov_b32 v2, 147456
    ds_read_b32 v2, v2
    s_waitcnt lgkmcnt(0)
    v_readfirstlane_b32 s53, v2
    s_nop 3
    s_branch G_LOOP
G_EXIT:
    s_endpgm
H_G1W:
    s_cmp_eq_u32 s79, 3
    s_cselect_b32 s4, 0, 2
    s_lshl_b32 s4, s52, s4
    s_add_u32 s78, s78, s4
    s_load_dwordx2 s[4:5], s[0:1], 0
    s_cmp_eq_u32 s79, 0
    s_cselect_b32 s71, 24, 32
    s_cmp_eq_u32 s79, 2
    s_cselect_b32 s71, 16, s71
    s_load_dwordx2 s[6:7], s[0:1], s71
    s_mul_i32 s68, s77, 524288
    s_mul_i32 s69, s78, 512
    s_waitcnt lgkmcnt(0)
    s_mov_b32 s60, s4
    s_and_b32 s61, s5, 0xffff
    s_mov_b32 s62, 4194304
    s_mov_b32 s63, 0x20000
    s_mov_b32 s64, s6
    s_and_b32 s65, s7, 0xffff
    s_mov_b32 s66, 8388608
    s_mov_b32 s67, 0x20000
    s_cmp_eq_u32 s79, 3
    s_cbranch_scc1 G1W_F
    s_lshr_b32 s72, s76, 2
    s_and_b32 s73, s76, 3
    v_lshrrev_b32 v14, 3, v0
    s_lshl_b32 s71, s76, 3
    v_add_u32 v14, s71, v14
    v_lshrrev_b32 v15, 1, v14
    v_xor_b32 v15, v15, v0
    v_and_b32 v15, 7, v15
    s_mov_b32 s71, 2048
    v_mul_lo_u32 v1, v14, s71
    v_lshl_add_u32 v1, v15, 4, v1
    v_and_b32 v14, 15, v0
    v_lshrrev_b32 v15, 1, v14
    v_lshrrev_b32 v16, 4, v0
    v_xor_b32 v15, v15, v16
    v_lshlrev_b32 v15, 4, v15
    v_lshl_add_u32 v14, v14, 7, v15
    s_mul_i32 s71, s72, 16384
    v_add_u32 v4, s71, v14
    v_xor_b32 v5, 64, v4
    v_lshrrev_b32 v14, 5, v0
    s_mul_i32 s71, s76, 2
    v_add_u32 v14, s71, v14
    v_and_b32 v15, 3, v14
    v_lshlrev_b32 v15, 1, v15
    v_and_b32 v16, 8, v14
    v_or_b32 v15, v15, v16
    v_and_b32 v16, 31, v0
    v_xor_b32 v15, v15, v16
    s_mov_b32 s71, 8192
    v_mul_lo_u32 v2, v14, s71
    v_lshl_add_u32 v2, v15, 4, v2
    v_bfe_u32 v14, v0, 2, 2
    v_lshrrev_b32 v15, 4, v0
    v_lshl_add_u32 v15, v15, 3, v14
    v_mul_u32_u24 v15, 512, v15
    v_and_b32 v16, 3, v0
    v_lshl_add_u32 v15, v16, 3, v15
    v_add_u32 v15, 32768, v15
    v_bfe_u32 v14, v0, 2, 3
    s_mul_i32 s71, s73, 4
    v_xor_b32 v14, s71, v14
    v_lshl_add_u32 v6, v14, 5, v15
    v_xor_b32 v7, 32, v6
    v_xor_b32 v8, 64, v6
    v_xor_b32 v9, 96, v6
    s_lshl_b32 s74, s76, 10
    s_mov_b32 s75, 0
    s_mov_b32 s59, 0
    s_cmp_eq_u32 s79, 1
    s_cbranch_scc1 G1W_V
    s_barrier
    s_add_u32 m0, s74, 0
    s_add_u32 s71, s68, 0
    buffer_load_dwordx4 v1, s[60:63], s71 offen sc1 lds
    s_add_u32 m0, s74, 8192
    s_add_u32 s71, s68, 131072
    buffer_load_dwordx4 v1, s[60:63], s71 offen sc1 lds
    s_add_u32 m0, s74, 16384
    s_add_u32 s71, s68, 262144
    buffer_load_dwordx4 v1, s[60:63], s71 offen sc1 lds
    s_add_u32 m0, s74, 24576
    s_add_u32 s71, s68, 393216
    buffer_load_dwordx4 v1, s[60:63], s71 offen sc1 lds
    s_add_u32 m0, s74, 32768
    s_add_u32 s71, s69, 0
    buffer_load_dwordx4 v2, s[64:67], s71 offen sc1 lds
    s_add_u32 m0, s74, 40960
    s_add_u32 s71, s69, 131072
    buffer_load_dwordx4 v2, s[64:67], s71 offen sc1 lds
    s_add_u32 m0, s74, 49152
    s_add_u32 s71, s69, 262144
    buffer_load_dwordx4 v2, s[64:67], s71 offen sc1 lds
    s_add_u32 m0, s74, 57344
    s_add_u32 s71, s69, 393216
    buffer_load_dwordx4 v2, s[64:67], s71 offen sc1 lds
    s_add_u32 s68, s68, 128
    s_add_u32 s69, s69, 524288
    s_add_u32 s75, s75, 1
    s_cmp_eq_u32 s75, 2
    s_cselect_b32 s75, 0, s75
    s_cselect_b32 s71, 0xfffe0000, 0
    s_add_u32 s71, s71, 65536
    s_add_u32 s74, s74, s71
    s_add_u32 m0, s74, 0
    s_add_u32 s71, s68, 0
    buffer_load_dwordx4 v1, s[60:63], s71 offen sc1 lds
    s_add_u32 m0, s74, 8192
    s_add_u32 s71, s68, 131072
    buffer_load_dwordx4 v1, s[60:63], s71 offen sc1 lds
    s_add_u32 m0, s74, 16384
    s_add_u32 s71, s68, 262144
    buffer_load_dwordx4 v1, s[60:63], s71 offen sc1 lds
    s_add_u32 m0, s74, 24576
    s_add_u32 s71, s68, 393216
    buffer_load_dwordx4 v1, s[60:63], s71 offen sc1 lds
    s_add_u32 m0, s74, 32768
    s_add_u32 s71, s69, 0
    buffer_load_dwordx4 v2, s[64:67], s71 offen sc1 lds
    s_add_u32 m0, s74, 40960
    s_add_u32 s71, s69, 131072
    buffer_load_dwordx4 v2, s[64:67], s71 offen sc1 lds
    s_add_u32 m0, s74, 49152
    s_add_u32 s71, s69, 262144
    buffer_load_dwordx4 v2, s[64:67], s71 offen sc1 lds
    s_add_u32 m0, s74, 57344
    s_add_u32 s71, s69, 393216
    buffer_load_dwordx4 v2, s[64:67], s71 offen sc1 lds
    s_add_u32 s68, s68, 128
    s_add_u32 s69, s69, 524288
    s_add_u32 s75, s75, 1
    s_cmp_eq_u32 s75, 2
    s_cselect_b32 s75, 0, s75
    s_cselect_b32 s71, 0xfffe0000, 0
    s_add_u32 s71, s71, 65536
    s_add_u32 s74, s74, s71
    s_mov_b32 s70, 16
    v_mov_b32 v128, 0
    v_mov_b32 v129, 0
    v_mov_b32 v130, 0
    v_mov_b32 v131, 0
    v_mov_b32 v132, 0
    v_mov_b32 v133, 0
    v_mov_b32 v134, 0
    v_mov_b32 v135, 0
    v_mov_b32 v136, 0
    v_mov_b32 v137, 0
    v_mov_b32 v138, 0
    v_mov_b32 v139, 0
    v_mov_b32 v140, 0
    v_mov_b32 v141, 0
    v_mov_b32 v142, 0
    v_mov_b32 v143, 0
    v_mov_b32 v144, 0
    v_mov_b32 v145, 0
    v_mov_b32 v146, 0
    v_mov_b32 v147, 0
    v_mov_b32 v148, 0
    v_mov_b32 v149, 0
    v_mov_b32 v150, 0
    v_mov_b32 v151, 0
    v_mov_b32 v152, 0
    v_mov_b32 v153, 0
    v_mov_b32 v154, 0
    v_mov_b32 v155, 0
    v_mov_b32 v156, 0
    v_mov_b32 v157, 0
    v_mov_b32 v158, 0
    v_mov_b32 v159, 0
    v_mov_b32 v160, 0
    v_mov_b32 v161, 0
    v_mov_b32 v162, 0
    v_mov_b32 v163, 0
    v_mov_b32 v164, 0
    v_mov_b32 v165, 0
    v_mov_b32 v166, 0
    v_mov_b32 v167, 0
    v_mov_b32 v168, 0
    v_mov_b32 v169, 0
    v_mov_b32 v170, 0
    v_mov_b32 v171, 0
    v_mov_b32 v172, 0
    v_mov_b32 v173, 0
    v_mov_b32 v174, 0
    v_mov_b32 v175, 0
    v_mov_b32 v176, 0
    v_mov_b32 v177, 0
    v_mov_b32 v178, 0
    v_mov_b32 v179, 0
    v_mov_b32 v180, 0
    v_mov_b32 v181, 0
    v_mov_b32 v182, 0
    v_mov_b32 v183, 0
    v_mov_b32 v184, 0
    v_mov_b32 v185, 0
    v_mov_b32 v186, 0
    v_mov_b32 v187, 0
    v_mov_b32 v188, 0
    v_mov_b32 v189, 0
    v_mov_b32 v190, 0
    v_mov_b32 v191, 0
    v_mov_b32 v192, 0
    v_mov_b32 v193, 0
    v_mov_b32 v194, 0
    v_mov_b32 v195, 0
    v_mov_b32 v196, 0
    v_mov_b32 v197, 0
    v_mov_b32 v198, 0
    v_mov_b32 v199, 0
    v_mov_b32 v200, 0
    v_mov_b32 v201, 0
    v_mov_b32 v202, 0
    v_mov_b32 v203, 0
    v_mov_b32 v204, 0
    v_mov_b32 v205, 0
    v_mov_b32 v206, 0
    v_mov_b32 v207, 0
    v_mov_b32 v208, 0
    v_mov_b32 v209, 0
    v_mov_b32 v210, 0
    v_mov_b32 v211, 0
    v_mov_b32 v212, 0
    v_mov_b32 v213, 0
    v_mov_b32 v214, 0
    v_mov_b32 v215, 0
    v_mov_b32 v216, 0
    v_mov_b32 v217, 0
    v_mov_b32 v218, 0
    v_mov_b32 v219, 0
    v_mov_b32 v220, 0
    v_mov_b32 v221, 0
    v_mov_b32 v222, 0
    v_mov_b32 v223, 0
    v_mov_b32 v224, 0
    v_mov_b32 v225, 0
    v_mov_b32 v226, 0
    v_mov_b32 v227, 0
    v_mov_b32 v228, 0
    v_mov_b32 v229, 0
    v_mov_b32 v230, 0
    v_mov_b32 v231, 0
    v_mov_b32 v232, 0
    v_mov_b32 v233, 0
    v_mov_b32 v234, 0
    v_mov_b32 v235, 0
    v_mov_b32 v236, 0
    v_mov_b32 v237, 0
    v_mov_b32 v238, 0
    v_mov_b32 v239, 0
    v_mov_b32 v240, 0
    v_mov_b32 v241, 0
    v_mov_b32 v242, 0
    v_mov_b32 v243, 0
    v_mov_b32 v244, 0
    v_mov_b32 v245, 0
    v_mov_b32 v246, 0
    v_mov_b32 v247, 0
    v_mov_b32 v248, 0
    v_mov_b32 v249, 0
    v_mov_b32 v250, 0
    v_mov_b32 v251, 0
    v_mov_b32 v252, 0
    v_mov_b32 v253, 0
    v_mov_b32 v254, 0
    v_mov_b32 v255, 0
    s_waitcnt vmcnt(8)
    s_barrier
    s_cmp_eq_u32 s31, 0
    s_cbranch_scc1 G1W_K_HS
    s_mov_b64 exec, 1
    s_bfe_u32 s4, s31, 0x7000a
    s_mul_i32 s4, s4, s52
    s_and_b32 s5, s31, 0x3ff
    s_add_u32 s4, s4, s5
    s_lshl_b32 s4, s4, 7
    s_add_u32 s4, s4, 124780544
    s_lshr_b32 s5, s31, 20
    v_mov_b32 v28, s5
    buffer_atomic_add v28, off, s[8:11], s4 sc1
    s_mov_b64 exec, -1
    s_mov_b32 s31, 0
G1W_K_HS:
    ds_read_b128 v[32:35], v4 offset:0
    ds_read_b64_tr_b16 v[64:65], v6 offset:0
    ds_read_b64_tr_b16 v[66:67], v6 offset:2048
    ds_read_b64_tr_b16 v[68:69], v7 offset:0
    ds_read_b64_tr_b16 v[70:71], v7 offset:2048
    ds_read_b64_tr_b16 v[72:73], v8 offset:0
    ds_read_b64_tr_b16 v[74:75], v8 offset:2048
    ds_read_b64_tr_b16 v[76:77], v9 offset:0
    ds_read_b64_tr_b16 v[78:79], v9 offset:2048
    ds_read_b128 v[36:39], v4 offset:2048
    ds_read_b128 v[40:43], v4 offset:4096
    ds_read_b128 v[44:47], v4 offset:6144
    ds_read_b128 v[48:51], v4 offset:8192
    ds_read_b128 v[52:55], v4 offset:10240
    ds_read_b128 v[56:59], v4 offset:12288
    ds_read_b128 v[60:63], v4 offset:14336
G1W_K_LOOP:
    s_waitcnt lgkmcnt(0)
    v_mfma_f32_16x16x32_bf16 v[128:131], v[64:67], v[32:35], v[128:131]
    ds_read_b128 v[80:83], v5 offset:0
    v_mfma_f32_16x16x32_bf16 v[132:135], v[68:71], v[32:35], v[132:135]
    ds_read_b64_tr_b16 v[112:113], v6 offset:16384
    v_mfma_f32_16x16x32_bf16 v[136:139], v[72:75], v[32:35], v[136:139]
    ds_read_b64_tr_b16 v[114:115], v6 offset:18432
    v_mfma_f32_16x16x32_bf16 v[140:143], v[76:79], v[32:35], v[140:143]
    ds_read_b64_tr_b16 v[116:117], v7 offset:16384
    v_mfma_f32_16x16x32_bf16 v[156:159], v[76:79], v[36:39], v[156:159]
    ds_read_b64_tr_b16 v[118:119], v7 offset:18432
    v_mfma_f32_16x16x32_bf16 v[152:155], v[72:75], v[36:39], v[152:155]
    ds_read_b64_tr_b16 v[120:121], v8 offset:16384
    v_mfma_f32_16x16x32_bf16 v[148:151], v[68:71], v[36:39], v[148:151]
    ds_read_b64_tr_b16 v[122:123], v8 offset:18432
    v_mfma_f32_16x16x32_bf16 v[144:147], v[64:67], v[36:39], v[144:147]
    ds_read_b64_tr_b16 v[124:125], v9 offset:16384
    v_mfma_f32_16x16x32_bf16 v[160:163], v[64:67], v[40:43], v[160:163]
    ds_read_b64_tr_b16 v[126:127], v9 offset:18432
    v_mfma_f32_16x16x32_bf16 v[164:167], v[68:71], v[40:43], v[164:167]
    ds_read_b128 v[84:87], v5 offset:2048
    v_mfma_f32_16x16x32_bf16 v[168:171], v[72:75], v[40:43], v[168:171]
    ds_read_b128 v[88:91], v5 offset:4096
    v_mfma_f32_16x16x32_bf16 v[172:175], v[76:79], v[40:43], v[172:175]
    ds_read_b128 v[92:95], v5 offset:6144
    v_mfma_f32_16x16x32_bf16 v[188:191], v[76:79], v[44:47], v[188:191]
    ds_read_b128 v[96:99], v5 offset:8192
    v_mfma_f32_16x16x32_bf16 v[184:187], v[72:75], v[44:47], v[184:187]
    ds_read_b128 v[100:103], v5 offset:10240
    v_mfma_f32_16x16x32_bf16 v[180:183], v[68:71], v[44:47], v[180:183]
    ds_read_b128 v[104:107], v5 offset:12288
    v_mfma_f32_16x16x32_bf16 v[176:179], v[64:67], v[44:47], v[176:179]
    ds_read_b128 v[108:111], v5 offset:14336
    v_mfma_f32_16x16x32_bf16 v[192:195], v[64:67], v[48:51], v[192:195]
    s_add_u32 s59, s59, 1
    s_cmp_eq_u32 s59, 2
    s_cselect_b32 s59, 0, s59
    s_cselect_b32 s71, 0xfffe0000, 0
    s_add_u32 s71, s71, 65536
    v_mfma_f32_16x16x32_bf16 v[196:199], v[68:71], v[48:51], v[196:199]
    v_add_u32 v4, s71, v4
    v_mfma_f32_16x16x32_bf16 v[200:203], v[72:75], v[48:51], v[200:203]
    v_add_u32 v5, s71, v5
    v_mfma_f32_16x16x32_bf16 v[204:207], v[76:79], v[48:51], v[204:207]
    v_add_u32 v6, s71, v6
    v_mfma_f32_16x16x32_bf16 v[220:223], v[76:79], v[52:55], v[220:223]
    v_add_u32 v7, s71, v7
    v_mfma_f32_16x16x32_bf16 v[216:219], v[72:75], v[52:55], v[216:219]
    v_add_u32 v8, s71, v8
    v_mfma_f32_16x16x32_bf16 v[212:215], v[68:71], v[52:55], v[212:215]
    v_add_u32 v9, s71, v9
    v_mfma_f32_16x16x32_bf16 v[208:211], v[64:67], v[52:55], v[208:211]
    s_sub_u32 s70, s70, 1
    v_mfma_f32_16x16x32_bf16 v[224:227], v[64:67], v[56:59], v[224:227]
    v_mfma_f32_16x16x32_bf16 v[228:231], v[68:71], v[56:59], v[228:231]
    v_mfma_f32_16x16x32_bf16 v[232:235], v[72:75], v[56:59], v[232:235]
    v_mfma_f32_16x16x32_bf16 v[236:239], v[76:79], v[56:59], v[236:239]
    v_mfma_f32_16x16x32_bf16 v[252:255], v[76:79], v[60:63], v[252:255]
    v_mfma_f32_16x16x32_bf16 v[248:251], v[72:75], v[60:63], v[248:251]
    v_mfma_f32_16x16x32_bf16 v[244:247], v[68:71], v[60:63], v[244:247]
    v_mfma_f32_16x16x32_bf16 v[240:243], v[64:67], v[60:63], v[240:243]
    s_cmp_lt_u32 s70, 2
    s_cbranch_scc1 G1W_K_TAIL
    s_waitcnt vmcnt(0) lgkmcnt(0)
    s_barrier
    v_mfma_f32_16x16x32_bf16 v[128:131], v[112:115], v[80:83], v[128:131]
    s_add_u32 m0, s74, 0
    s_add_u32 s71, s68, 0
    buffer_load_dwordx4 v1, s[60:63], s71 offen sc1 lds
    v_mfma_f32_16x16x32_bf16 v[132:135], v[116:119], v[80:83], v[132:135]
    ds_read_b128 v[32:35], v4 offset:0
    v_mfma_f32_16x16x32_bf16 v[136:139], v[120:123], v[80:83], v[136:139]
    ds_read_b64_tr_b16 v[64:65], v6 offset:0
    v_mfma_f32_16x16x32_bf16 v[140:143], v[124:127], v[80:83], v[140:143]
    s_add_u32 m0, s74, 8192
    s_add_u32 s71, s68, 131072
    buffer_load_dwordx4 v1, s[60:63], s71 offen sc1 lds
    v_mfma_f32_16x16x32_bf16 v[156:159], v[124:127], v[84:87], v[156:159]
    ds_read_b64_tr_b16 v[66:67], v6 offset:2048
    v_mfma_f32_16x16x32_bf16 v[152:155], v[120:123], v[84:87], v[152:155]
    ds_read_b64_tr_b16 v[68:69], v7 offset:0
    v_mfma_f32_16x16x32_bf16 v[148:151], v[116:119], v[84:87], v[148:151]
    s_add_u32 m0, s74, 16384
    s_add_u32 s71, s68, 262144
    buffer_load_dwordx4 v1, s[60:63], s71 offen sc1 lds
    v_mfma_f32_16x16x32_bf16 v[144:147], v[112:115], v[84:87], v[144:147]
    ds_read_b64_tr_b16 v[70:71], v7 offset:2048
    v_mfma_f32_16x16x32_bf16 v[160:163], v[112:115], v[88:91], v[160:163]
    ds_read_b64_tr_b16 v[72:73], v8 offset:0
    v_mfma_f32_16x16x32_bf16 v[164:167], v[116:119], v[88:91], v[164:167]
    s_add_u32 m0, s74, 24576
    s_add_u32 s71, s68, 393216
    buffer_load_dwordx4 v1, s[60:63], s71 offen sc1 lds
    v_mfma_f32_16x16x32_bf16 v[168:171], v[120:123], v[88:91], v[168:171]
    ds_read_b64_tr_b16 v[74:75], v8 offset:2048
    v_mfma_f32_16x16x32_bf16 v[172:175], v[124:127], v[88:91], v[172:175]
    ds_read_b64_tr_b16 v[76:77], v9 offset:0
    v_mfma_f32_16x16x32_bf16 v[188:191], v[124:127], v[92:95], v[188:191]
    s_add_u32 m0, s74, 32768
    s_add_u32 s71, s69, 0
    buffer_load_dwordx4 v2, s[64:67], s71 offen sc1 lds
    v_mfma_f32_16x16x32_bf16 v[184:187], v[120:123], v[92:95], v[184:187]
    ds_read_b64_tr_b16 v[78:79], v9 offset:2048
    v_mfma_f32_16x16x32_bf16 v[180:183], v[116:119], v[92:95], v[180:183]
    ds_read_b128 v[36:39], v4 offset:2048
    v_mfma_f32_16x16x32_bf16 v[176:179], v[112:115], v[92:95], v[176:179]
    s_add_u32 m0, s74, 40960
    s_add_u32 s71, s69, 131072
    buffer_load_dwordx4 v2, s[64:67], s71 offen sc1 lds
    v_mfma_f32_16x16x32_bf16 v[192:195], v[112:115], v[96:99], v[192:195]
    ds_read_b128 v[40:43], v4 offset:4096
    v_mfma_f32_16x16x32_bf16 v[196:199], v[116:119], v[96:99], v[196:199]
    ds_read_b128 v[44:47], v4 offset:6144
    v_mfma_f32_16x16x32_bf16 v[200:203], v[120:123], v[96:99], v[200:203]
    s_add_u32 m0, s74, 49152
    s_add_u32 s71, s69, 262144
    buffer_load_dwordx4 v2, s[64:67], s71 offen sc1 lds
    v_mfma_f32_16x16x32_bf16 v[204:207], v[124:127], v[96:99], v[204:207]
    ds_read_b128 v[48:51], v4 offset:8192
    v_mfma_f32_16x16x32_bf16 v[220:223], v[124:127], v[100:103], v[220:223]
    ds_read_b128 v[52:55], v4 offset:10240
    v_mfma_f32_16x16x32_bf16 v[216:219], v[120:123], v[100:103], v[216:219]
    s_add_u32 m0, s74, 57344
    s_add_u32 s71, s69, 393216
    buffer_load_dwordx4 v2, s[64:67], s71 offen sc1 lds
    v_mfma_f32_16x16x32_bf16 v[212:215], v[116:119], v[100:103], v[212:215]
    ds_read_b128 v[56:59], v4 offset:12288
    v_mfma_f32_16x16x32_bf16 v[208:211], v[112:115], v[100:103], v[208:211]
    ds_read_b128 v[60:63], v4 offset:14336
    v_mfma_f32_16x16x32_bf16 v[224:227], v[112:115], v[104:107], v[224:227]
    s_add_u32 s68, s68, 128
    s_add_u32 s69, s69, 524288
    s_add_u32 s75, s75, 1
    s_cmp_eq_u32 s75, 2
    s_cselect_b32 s75, 0, s75
    s_cselect_b32 s71, 0xfffe0000, 0
    s_add_u32 s71, s71, 65536
    s_add_u32 s74, s74, s71
    v_mfma_f32_16x16x32_bf16 v[228:231], v[116:119], v[104:107], v[228:231]
    v_mfma_f32_16x16x32_bf16 v[232:235], v[120:123], v[104:107], v[232:235]
    v_mfma_f32_16x16x32_bf16 v[236:239], v[124:127], v[104:107], v[236:239]
    v_mfma_f32_16x16x32_bf16 v[252:255], v[124:127], v[108:111], v[252:255]
    v_mfma_f32_16x16x32_bf16 v[248:251], v[120:123], v[108:111], v[248:251]
    v_mfma_f32_16x16x32_bf16 v[244:247], v[116:119], v[108:111], v[244:247]
    v_mfma_f32_16x16x32_bf16 v[240:243], v[112:115], v[108:111], v[240:243]
    s_branch G1W_K_LOOP
G1W_K_TAIL:
    s_waitcnt vmcnt(0) lgkmcnt(0)
    s_barrier
    s_cmp_lg_u32 s76, 0
    s_cbranch_scc1 G1W_K_HT0
    s_cmp_eq_u32 s70, 0
    s_cbranch_scc1 G1W_K_HB
    v_mov_b32 v28, 1
    s_lshl_b32 s4, s52, 2
    s_mov_b64 exec, 1
    buffer_atomic_add v28, off, s[16:19], s4 offset:160 sc0 sc1
    s_mov_b64 exec, -1
    s_branch G1W_K_HT0
G1W_K_HB:
    v_readfirstlane_b32 s4, v28
    v_lshlrev_b32 v29, 2, v0
    s_nop 2
    s_add_u32 s4, s4, 32
    s_min_u32 s4, s4, 312
    s_lshl_b32 s4, s4, 5
    v_add_u32 v29, s4, v29
    s_mov_b64 exec, 15
    global_load_dword v29, v29, s[28:29] offset:4
    s_mov_b64 exec, -1
G1W_K_HT0:
    v_mfma_f32_16x16x32_bf16 v[128:131], v[112:115], v[80:83], v[128:131]
    ds_read_b128 v[32:35], v4 offset:0
    v_mfma_f32_16x16x32_bf16 v[132:135], v[116:119], v[80:83], v[132:135]
    ds_read_b64_tr_b16 v[64:65], v6 offset:0
    v_mfma_f32_16x16x32_bf16 v[136:139], v[120:123], v[80:83], v[136:139]
    ds_read_b64_tr_b16 v[66:67], v6 offset:2048
    v_mfma_f32_16x16x32_bf16 v[140:143], v[124:127], v[80:83], v[140:143]
    ds_read_b64_tr_b16 v[68:69], v7 offset:0
    v_mfma_f32_16x16x32_bf16 v[156:159], v[124:127], v[84:87], v[156:159]
    ds_read_b64_tr_b16 v[70:71], v7 offset:2048
    v_mfma_f32_16x16x32_bf16 v[152:155], v[120:123], v[84:87], v[152:155]
    ds_read_b64_tr_b16 v[72:73], v8 offset:0
    v_mfma_f32_16x16x32_bf16 v[148:151], v[116:119], v[84:87], v[148:151]
    ds_read_b64_tr_b16 v[74:75], v8 offset:2048
    v_mfma_f32_16x16x32_bf16 v[144:147], v[112:115], v[84:87], v[144:147]
    ds_read_b64_tr_b16 v[76:77], v9 offset:0
    v_mfma_f32_16x16x32_bf16 v[160:163], v[112:115], v[88:91], v[160:163]
    ds_read_b64_tr_b16 v[78:79], v9 offset:2048
    v_mfma_f32_16x16x32_bf16 v[164:167], v[116:119], v[88:91], v[164:167]
    ds_read_b128 v[36:39], v4 offset:2048
    v_mfma_f32_16x16x32_bf16 v[168:171], v[120:123], v[88:91], v[168:171]
    ds_read_b128 v[40:43], v4 offset:4096
    v_mfma_f32_16x16x32_bf16 v[172:175], v[124:127], v[88:91], v[172:175]
    ds_read_b128 v[44:47], v4 offset:6144
    v_mfma_f32_16x16x32_bf16 v[188:191], v[124:127], v[92:95], v[188:191]
    ds_read_b128 v[48:51], v4 offset:8192
    v_mfma_f32_16x16x32_bf16 v[184:187], v[120:123], v[92:95], v[184:187]
    ds_read_b128 v[52:55], v4 offset:10240
    v_mfma_f32_16x16x32_bf16 v[180:183], v[116:119], v[92:95], v[180:183]
    ds_read_b128 v[56:59], v4 offset:12288
    v_mfma_f32_16x16x32_bf16 v[176:179], v[112:115], v[92:95], v[176:179]
    ds_read_b128 v[60:63], v4 offset:14336
    v_mfma_f32_16x16x32_bf16 v[192:195], v[112:115], v[96:99], v[192:195]
    v_mfma_f32_16x16x32_bf16 v[196:199], v[116:119], v[96:99], v[196:199]
    v_mfma_f32_16x16x32_bf16 v[200:203], v[120:123], v[96:99], v[200:203]
    v_mfma_f32_16x16x32_bf16 v[204:207], v[124:127], v[96:99], v[204:207]
    v_mfma_f32_16x16x32_bf16 v[220:223], v[124:127], v[100:103], v[220:223]
    v_mfma_f32_16x16x32_bf16 v[216:219], v[120:123], v[100:103], v[216:219]
    v_mfma_f32_16x16x32_bf16 v[212:215], v[116:119], v[100:103], v[212:215]
    v_mfma_f32_16x16x32_bf16 v[208:211], v[112:115], v[100:103], v[208:211]
    v_mfma_f32_16x16x32_bf16 v[224:227], v[112:115], v[104:107], v[224:227]
    v_mfma_f32_16x16x32_bf16 v[228:231], v[116:119], v[104:107], v[228:231]
    v_mfma_f32_16x16x32_bf16 v[232:235], v[120:123], v[104:107], v[232:235]
    v_mfma_f32_16x16x32_bf16 v[236:239], v[124:127], v[104:107], v[236:239]
    v_mfma_f32_16x16x32_bf16 v[252:255], v[124:127], v[108:111], v[252:255]
    v_mfma_f32_16x16x32_bf16 v[248:251], v[120:123], v[108:111], v[248:251]
    v_mfma_f32_16x16x32_bf16 v[244:247], v[116:119], v[108:111], v[244:247]
    v_mfma_f32_16x16x32_bf16 v[240:243], v[112:115], v[108:111], v[240:243]
    s_cmp_lg_u32 s70, 0
    s_cbranch_scc1 G1W_K_LOOP
    s_cmp_lg_u32 s76, 0
    s_cbranch_scc1 G1W_K_HT1
    s_waitcnt vmcnt(0)
    v_bfe_u32 v30, v29, 10, 7
    v_and_b32 v31, 0x3ff, v29
    v_mad_u32_u24 v30, v30, s52, v31
    v_lshlrev_b32 v30, 7, v30
    s_mov_b32 s4, 124780544
    s_mov_b64 exec, 15
    buffer_load_dword v30, v30, s[8:11], s4 offen sc1
    s_mov_b64 exec, -1
G1W_K_HT1:
    s_waitcnt lgkmcnt(0)
    s_nop 7
    s_mul_i32 s80, s77, 8
    s_mul_i32 s71, s72, 4
    s_add_u32 s80, s80, s71
    s_lshl_b32 s80, s80, 5
    s_mul_i32 s71, s78, 2
    s_add_u32 s80, s80, s71
    s_lshr_b32 s71, s73, 1
    s_add_u32 s80, s80, s71
    s_lshl_b32 s80, s80, 14
    s_and_b32 s71, s73, 1
    s_lshl_b32 s71, s71, 11
    s_add_u32 s80, s80, s71
    s_add_u32 s80, s80, 4194304
    v_lshlrev_b32 v14, 4, v0
    v_cvt_pk_bf16_f32 v32, v128, v129
    v_cvt_pk_bf16_f32 v33, v130, v131
    v_cvt_pk_bf16_f32 v34, v132, v133
    v_cvt_pk_bf16_f32 v35, v134, v135
    buffer_store_dwordx4 v[32:35], v14, s[8:11], s80 offen offset:0 sc1
    v_cvt_pk_bf16_f32 v36, v136, v137
    v_cvt_pk_bf16_f32 v37, v138, v139
    v_cvt_pk_bf16_f32 v38, v140, v141
    v_cvt_pk_bf16_f32 v39, v142, v143
    buffer_store_dwordx4 v[36:39], v14, s[8:11], s80 offen offset:1024 sc1
    s_add_u32 s80, s80, 4096
    v_cvt_pk_bf16_f32 v40, v144, v145
    v_cvt_pk_bf16_f32 v41, v146, v147
    v_cvt_pk_bf16_f32 v42, v148, v149
    v_cvt_pk_bf16_f32 v43, v150, v151
    buffer_store_dwordx4 v[40:43], v14, s[8:11], s80 offen offset:0 sc1
    v_cvt_pk_bf16_f32 v44, v152, v153
    v_cvt_pk_bf16_f32 v45, v154, v155
    v_cvt_pk_bf16_f32 v46, v156, v157
    v_cvt_pk_bf16_f32 v47, v158, v159
    buffer_store_dwordx4 v[44:47], v14, s[8:11], s80 offen offset:1024 sc1
    s_add_u32 s80, s80, 520192
    v_cvt_pk_bf16_f32 v48, v160, v161
    v_cvt_pk_bf16_f32 v49, v162, v163
    v_cvt_pk_bf16_f32 v50, v164, v165
    v_cvt_pk_bf16_f32 v51, v166, v167
    buffer_store_dwordx4 v[48:51], v14, s[8:11], s80 offen offset:0 sc1
    v_cvt_pk_bf16_f32 v52, v168, v169
    v_cvt_pk_bf16_f32 v53, v170, v171
    v_cvt_pk_bf16_f32 v54, v172, v173
    v_cvt_pk_bf16_f32 v55, v174, v175
    buffer_store_dwordx4 v[52:55], v14, s[8:11], s80 offen offset:1024 sc1
    s_add_u32 s80, s80, 4096
    v_cvt_pk_bf16_f32 v56, v176, v177
    v_cvt_pk_bf16_f32 v57, v178, v179
    v_cvt_pk_bf16_f32 v58, v180, v181
    v_cvt_pk_bf16_f32 v59, v182, v183
    buffer_store_dwordx4 v[56:59], v14, s[8:11], s80 offen offset:0 sc1
    v_cvt_pk_bf16_f32 v60, v184, v185
    v_cvt_pk_bf16_f32 v61, v186, v187
    v_cvt_pk_bf16_f32 v62, v188, v189
    v_cvt_pk_bf16_f32 v63, v190, v191
    buffer_store_dwordx4 v[60:63], v14, s[8:11], s80 offen offset:1024 sc1
    s_add_u32 s80, s80, 520192
    v_cvt_pk_bf16_f32 v32, v192, v193
    v_cvt_pk_bf16_f32 v33, v194, v195
    v_cvt_pk_bf16_f32 v34, v196, v197
    v_cvt_pk_bf16_f32 v35, v198, v199
    buffer_store_dwordx4 v[32:35], v14, s[8:11], s80 offen offset:0 sc1
    v_cvt_pk_bf16_f32 v36, v200, v201
    v_cvt_pk_bf16_f32 v37, v202, v203
    v_cvt_pk_bf16_f32 v38, v204, v205
    v_cvt_pk_bf16_f32 v39, v206, v207
    buffer_store_dwordx4 v[36:39], v14, s[8:11], s80 offen offset:1024 sc1
    s_add_u32 s80, s80, 4096
    v_cvt_pk_bf16_f32 v40, v208, v209
    v_cvt_pk_bf16_f32 v41, v210, v211
    v_cvt_pk_bf16_f32 v42, v212, v213
    v_cvt_pk_bf16_f32 v43, v214, v215
    buffer_store_dwordx4 v[40:43], v14, s[8:11], s80 offen offset:0 sc1
    v_cvt_pk_bf16_f32 v44, v216, v217
    v_cvt_pk_bf16_f32 v45, v218, v219
    v_cvt_pk_bf16_f32 v46, v220, v221
    v_cvt_pk_bf16_f32 v47, v222, v223
    buffer_store_dwordx4 v[44:47], v14, s[8:11], s80 offen offset:1024 sc1
    s_add_u32 s80, s80, 520192
    v_cvt_pk_bf16_f32 v48, v224, v225
    v_cvt_pk_bf16_f32 v49, v226, v227
    v_cvt_pk_bf16_f32 v50, v228, v229
    v_cvt_pk_bf16_f32 v51, v230, v231
    buffer_store_dwordx4 v[48:51], v14, s[8:11], s80 offen offset:0 sc1
    v_cvt_pk_bf16_f32 v52, v232, v233
    v_cvt_pk_bf16_f32 v53, v234, v235
    v_cvt_pk_bf16_f32 v54, v236, v237
    v_cvt_pk_bf16_f32 v55, v238, v239
    buffer_store_dwordx4 v[52:55], v14, s[8:11], s80 offen offset:1024 sc1
    s_add_u32 s80, s80, 4096
    v_cvt_pk_bf16_f32 v56, v240, v241
    v_cvt_pk_bf16_f32 v57, v242, v243
    v_cvt_pk_bf16_f32 v58, v244, v245
    v_cvt_pk_bf16_f32 v59, v246, v247
    buffer_store_dwordx4 v[56:59], v14, s[8:11], s80 offen offset:0 sc1
    v_cvt_pk_bf16_f32 v60, v248, v249
    v_cvt_pk_bf16_f32 v61, v250, v251
    v_cvt_pk_bf16_f32 v62, v252, v253
    v_cvt_pk_bf16_f32 v63, v254, v255
    buffer_store_dwordx4 v[60:63], v14, s[8:11], s80 offen offset:1024 sc1
    s_add_u32 s80, s80, 520192
    s_branch G_DONE2
G1W_V:
    s_mov_b32 s80, 131072
    s_mov_b32 s81, 524288
    s_mov_b32 s58, 16
    s_branch G1W_VF
G1W_F:
    s_add_u32 s69, s69, 113246208
    s_mov_b32 s64, s8
    s_mov_b32 s65, s9
    s_mov_b32 s66, s10
    s_mov_b32 s67, s11
    s_mov_b32 s60, s8
    s_mov_b32 s61, s9
    s_mov_b32 s62, s10
    s_mov_b32 s63, s11
    s_and_b32 s58, s78, 2
    s_lshl_b32 s58, s58, 9
    s_add_u32 s68, s68, s58
    s_add_u32 s68, s68, 37748736
    s_mov_b32 s58, 8
    s_lshr_b32 s72, s76, 2
    s_and_b32 s73, s76, 3
    v_lshrrev_b32 v14, 3, v0
    s_lshl_b32 s71, s76, 3
    v_add_u32 v14, s71, v14
    v_lshrrev_b32 v15, 1, v14
    v_xor_b32 v15, v15, v0
    v_and_b32 v15, 7, v15
    s_mov_b32 s71, 2048
    v_mul_lo_u32 v1, v14, s71
    v_lshl_add_u32 v1, v15, 4, v1
    v_and_b32 v14, 15, v0
    v_lshrrev_b32 v15, 1, v14
    v_lshrrev_b32 v16, 4, v0
    v_xor_b32 v15, v15, v16
    v_lshlrev_b32 v15, 4, v15
    v_lshl_add_u32 v14, v14, 7, v15
    s_mul_i32 s71, s72, 16384
    v_add_u32 v4, s71, v14
    v_xor_b32 v5, 64, v4
    v_lshrrev_b32 v14, 5, v0
    s_mul_i32 s71, s76, 2
    v_add_u32 v14, s71, v14
    v_and_b32 v15, 3, v14
    v_lshlrev_b32 v15, 1, v15
    v_and_b32 v16, 8, v14
    v_or_b32 v15, v15, v16
    v_and_b32 v16, 31, v0
    v_xor_b32 v15, v15, v16
    s_mov_b32 s71, 2048
    v_mul_lo_u32 v2, v14, s71
    v_lshl_add_u32 v2, v15, 4, v2
    v_bfe_u32 v14, v0, 2, 2
    v_lshrrev_b32 v15, 4, v0
    v_lshl_add_u32 v15, v15, 3, v14
    v_mul_u32_u24 v15, 512, v15
    v_and_b32 v16, 3, v0
    v_lshl_add_u32 v15, v16, 3, v15
    v_add_u32 v15, 32768, v15
    v_bfe_u32 v14, v0, 2, 3
    s_mul_i32 s71, s73, 4
    v_xor_b32 v14, s71, v14
    v_lshl_add_u32 v6, v14, 5, v15
    v_xor_b32 v7, 32, v6
    v_xor_b32 v8, 64, v6
    v_xor_b32 v9, 96, v6
    s_lshl_b32 s74, s76, 10
    s_mov_b32 s75, 0
    s_mov_b32 s59, 0
    s_mov_b32 s80, 32768
    s_mov_b32 s81, 131072
G1W_VF:
    s_lshl_b32 s82, s80, 1
    s_add_u32 s83, s82, s80
    s_barrier
    s_add_u32 m0, s74, 0
    s_add_u32 s71, s68, 0
    buffer_load_dwordx4 v1, s[60:63], s71 offen sc1 lds
    s_add_u32 m0, s74, 8192
    s_add_u32 s71, s68, 131072
    buffer_load_dwordx4 v1, s[60:63], s71 offen sc1 lds
    s_add_u32 m0, s74, 16384
    s_add_u32 s71, s68, 262144
    buffer_load_dwordx4 v1, s[60:63], s71 offen sc1 lds
    s_add_u32 m0, s74, 24576
    s_add_u32 s71, s68, 393216
    buffer_load_dwordx4 v1, s[60:63], s71 offen sc1 lds
    s_add_u32 m0, s74, 32768
    s_add_u32 s71, s69, 0
    buffer_load_dwordx4 v2, s[64:67], s71 offen sc1 lds
    s_add_u32 m0, s74, 40960
    s_add_u32 s71, s69, s80
    buffer_load_dwordx4 v2, s[64:67], s71 offen sc1 lds
    s_add_u32 m0, s74, 49152
    s_add_u32 s71, s69, s82
    buffer_load_dwordx4 v2, s[64:67], s71 offen sc1 lds
    s_add_u32 m0, s74, 57344
    s_add_u32 s71, s69, s83
    buffer_load_dwordx4 v2, s[64:67], s71 offen sc1 lds
    s_add_u32 s68, s68, 128
    s_add_u32 s69, s69, s81
    s_add_u32 s75, s75, 1
    s_cmp_eq_u32 s75, 2
    s_cselect_b32 s75, 0, s75
    s_cselect_b32 s71, 0xfffe0000, 0
    s_add_u32 s71, s71, 65536
    s_add_u32 s74, s74, s71
    s_add_u32 m0, s74, 0
    s_add_u32 s71, s68, 0
    buffer_load_dwordx4 v1, s[60:63], s71 offen sc1 lds
    s_add_u32 m0, s74, 8192
    s_add_u32 s71, s68, 131072
    buffer_load_dwordx4 v1, s[60:63], s71 offen sc1 lds
    s_add_u32 m0, s74, 16384
    s_add_u32 s71, s68, 262144
    buffer_load_dwordx4 v1, s[60:63], s71 offen sc1 lds
    s_add_u32 m0, s74, 24576
    s_add_u32 s71, s68, 393216
    buffer_load_dwordx4 v1, s[60:63], s71 offen sc1 lds
    s_add_u32 m0, s74, 32768
    s_add_u32 s71, s69, 0
    buffer_load_dwordx4 v2, s[64:67], s71 offen sc1 lds
    s_add_u32 m0, s74, 40960
    s_add_u32 s71, s69, s80
    buffer_load_dwordx4 v2, s[64:67], s71 offen sc1 lds
    s_add_u32 m0, s74, 49152
    s_add_u32 s71, s69, s82
    buffer_load_dwordx4 v2, s[64:67], s71 offen sc1 lds
    s_add_u32 m0, s74, 57344
    s_add_u32 s71, s69, s83
    buffer_load_dwordx4 v2, s[64:67], s71 offen sc1 lds
    s_add_u32 s68, s68, 128
    s_add_u32 s69, s69, s81
    s_add_u32 s75, s75, 1
    s_cmp_eq_u32 s75, 2
    s_cselect_b32 s75, 0, s75
    s_cselect_b32 s71, 0xfffe0000, 0
    s_add_u32 s71, s71, 65536
    s_add_u32 s74, s74, s71
    s_mov_b32 s70, s58
    v_mov_b32 v128, 0
    v_mov_b32 v129, 0
    v_mov_b32 v130, 0
    v_mov_b32 v131, 0
    v_mov_b32 v132, 0
    v_mov_b32 v133, 0
    v_mov_b32 v134, 0
    v_mov_b32 v135, 0
    v_mov_b32 v136, 0
    v_mov_b32 v137, 0
    v_mov_b32 v138, 0
    v_mov_b32 v139, 0
    v_mov_b32 v140, 0
    v_mov_b32 v141, 0
    v_mov_b32 v142, 0
    v_mov_b32 v143, 0
    v_mov_b32 v144, 0
    v_mov_b32 v145, 0
    v_mov_b32 v146, 0
    v_mov_b32 v147, 0
    v_mov_b32 v148, 0
    v_mov_b32 v149, 0
    v_mov_b32 v150, 0
    v_mov_b32 v151, 0
    v_mov_b32 v152, 0
    v_mov_b32 v153, 0
    v_mov_b32 v154, 0
    v_mov_b32 v155, 0
    v_mov_b32 v156, 0
    v_mov_b32 v157, 0
    v_mov_b32 v158, 0
    v_mov_b32 v159, 0
    v_mov_b32 v160, 0
    v_mov_b32 v161, 0
    v_mov_b32 v162, 0
    v_mov_b32 v163, 0
    v_mov_b32 v164, 0
    v_mov_b32 v165, 0
    v_mov_b32 v166, 0
    v_mov_b32 v167, 0
    v_mov_b32 v168, 0
    v_mov_b32 v169, 0
    v_mov_b32 v170, 0
    v_mov_b32 v171, 0
    v_mov_b32 v172, 0
    v_mov_b32 v173, 0
    v_mov_b32 v174, 0
    v_mov_b32 v175, 0
    v_mov_b32 v176, 0
    v_mov_b32 v177, 0
    v_mov_b32 v178, 0
    v_mov_b32 v179, 0
    v_mov_b32 v180, 0
    v_mov_b32 v181, 0
    v_mov_b32 v182, 0
    v_mov_b32 v183, 0
    v_mov_b32 v184, 0
    v_mov_b32 v185, 0
    v_mov_b32 v186, 0
    v_mov_b32 v187, 0
    v_mov_b32 v188, 0
    v_mov_b32 v189, 0
    v_mov_b32 v190, 0
    v_mov_b32 v191, 0
    v_mov_b32 v192, 0
    v_mov_b32 v193, 0
    v_mov_b32 v194, 0
    v_mov_b32 v195, 0
    v_mov_b32 v196, 0
    v_mov_b32 v197, 0
    v_mov_b32 v198, 0
    v_mov_b32 v199, 0
    v_mov_b32 v200, 0
    v_mov_b32 v201, 0
    v_mov_b32 v202, 0
    v_mov_b32 v203, 0
    v_mov_b32 v204, 0
    v_mov_b32 v205, 0
    v_mov_b32 v206, 0
    v_mov_b32 v207, 0
    v_mov_b32 v208, 0
    v_mov_b32 v209, 0
    v_mov_b32 v210, 0
    v_mov_b32 v211, 0
    v_mov_b32 v212, 0
    v_mov_b32 v213, 0
    v_mov_b32 v214, 0
    v_mov_b32 v215, 0
    v_mov_b32 v216, 0
    v_mov_b32 v217, 0
    v_mov_b32 v218, 0
    v_mov_b32 v219, 0
    v_mov_b32 v220, 0
    v_mov_b32 v221, 0
    v_mov_b32 v222, 0
    v_mov_b32 v223, 0
    v_mov_b32 v224, 0
    v_mov_b32 v225, 0
    v_mov_b32 v226, 0
    v_mov_b32 v227, 0
    v_mov_b32 v228, 0
    v_mov_b32 v229, 0
    v_mov_b32 v230, 0
    v_mov_b32 v231, 0
    v_mov_b32 v232, 0
    v_mov_b32 v233, 0
    v_mov_b32 v234, 0
    v_mov_b32 v235, 0
    v_mov_b32 v236, 0
    v_mov_b32 v237, 0
    v_mov_b32 v238, 0
    v_mov_b32 v239, 0
    v_mov_b32 v240, 0
    v_mov_b32 v241, 0
    v_mov_b32 v242, 0
    v_mov_b32 v243, 0
    v_mov_b32 v244, 0
    v_mov_b32 v245, 0
    v_mov_b32 v246, 0
    v_mov_b32 v247, 0
    v_mov_b32 v248, 0
    v_mov_b32 v249, 0
    v_mov_b32 v250, 0
    v_mov_b32 v251, 0
    v_mov_b32 v252, 0
    v_mov_b32 v253, 0
    v_mov_b32 v254, 0
    v_mov_b32 v255, 0
    s_waitcnt vmcnt(8)
    s_barrier
    s_cmp_eq_u32 s31, 0
    s_cbranch_scc1 G1W_VF_HS
    s_mov_b64 exec, 1
    s_bfe_u32 s4, s31, 0x7000a
    s_mul_i32 s4, s4, s52
    s_and_b32 s5, s31, 0x3ff
    s_add_u32 s4, s4, s5
    s_lshl_b32 s4, s4, 7
    s_add_u32 s4, s4, 124780544
    s_lshr_b32 s5, s31, 20
    v_mov_b32 v28, s5
    buffer_atomic_add v28, off, s[8:11], s4 sc1
    s_mov_b64 exec, -1
    s_mov_b32 s31, 0
G1W_VF_HS:
    ds_read_b128 v[32:35], v4 offset:0
    ds_read_b64_tr_b16 v[64:65], v6 offset:0
    ds_read_b64_tr_b16 v[66:67], v6 offset:2048
    ds_read_b64_tr_b16 v[68:69], v7 offset:0
    ds_read_b64_tr_b16 v[70:71], v7 offset:2048
    ds_read_b64_tr_b16 v[72:73], v8 offset:0
    ds_read_b64_tr_b16 v[74:75], v8 offset:2048
    ds_read_b64_tr_b16 v[76:77], v9 offset:0
    ds_read_b64_tr_b16 v[78:79], v9 offset:2048
    ds_read_b128 v[36:39], v4 offset:2048
    ds_read_b128 v[40:43], v4 offset:4096
    ds_read_b128 v[44:47], v4 offset:6144
    ds_read_b128 v[48:51], v4 offset:8192
    ds_read_b128 v[52:55], v4 offset:10240
    ds_read_b128 v[56:59], v4 offset:12288
    ds_read_b128 v[60:63], v4 offset:14336
G1W_VF_LOOP:
    s_waitcnt lgkmcnt(0)
    v_mfma_f32_16x16x32_bf16 v[128:131], v[32:35], v[64:67], v[128:131]
    ds_read_b128 v[80:83], v5 offset:0
    v_mfma_f32_16x16x32_bf16 v[132:135], v[32:35], v[68:71], v[132:135]
    ds_read_b64_tr_b16 v[112:113], v6 offset:16384
    v_mfma_f32_16x16x32_bf16 v[136:139], v[32:35], v[72:75], v[136:139]
    ds_read_b64_tr_b16 v[114:115], v6 offset:18432
    v_mfma_f32_16x16x32_bf16 v[140:143], v[32:35], v[76:79], v[140:143]
    ds_read_b64_tr_b16 v[116:117], v7 offset:16384
    v_mfma_f32_16x16x32_bf16 v[156:159], v[36:39], v[76:79], v[156:159]
    ds_read_b64_tr_b16 v[118:119], v7 offset:18432
    v_mfma_f32_16x16x32_bf16 v[152:155], v[36:39], v[72:75], v[152:155]
    ds_read_b64_tr_b16 v[120:121], v8 offset:16384
    v_mfma_f32_16x16x32_bf16 v[148:151], v[36:39], v[68:71], v[148:151]
    ds_read_b64_tr_b16 v[122:123], v8 offset:18432
    v_mfma_f32_16x16x32_bf16 v[144:147], v[36:39], v[64:67], v[144:147]
    ds_read_b64_tr_b16 v[124:125], v9 offset:16384
    v_mfma_f32_16x16x32_bf16 v[160:163], v[40:43], v[64:67], v[160:163]
    ds_read_b64_tr_b16 v[126:127], v9 offset:18432
    v_mfma_f32_16x16x32_bf16 v[164:167], v[40:43], v[68:71], v[164:167]
    ds_read_b128 v[84:87], v5 offset:2048
    v_mfma_f32_16x16x32_bf16 v[168:171], v[40:43], v[72:75], v[168:171]
    ds_read_b128 v[88:91], v5 offset:4096
    v_mfma_f32_16x16x32_bf16 v[172:175], v[40:43], v[76:79], v[172:175]
    ds_read_b128 v[92:95], v5 offset:6144
    v_mfma_f32_16x16x32_bf16 v[188:191], v[44:47], v[76:79], v[188:191]
    ds_read_b128 v[96:99], v5 offset:8192
    v_mfma_f32_16x16x32_bf16 v[184:187], v[44:47], v[72:75], v[184:187]
    ds_read_b128 v[100:103], v5 offset:10240
    v_mfma_f32_16x16x32_bf16 v[180:183], v[44:47], v[68:71], v[180:183]
    ds_read_b128 v[104:107], v5 offset:12288
    v_mfma_f32_16x16x32_bf16 v[176:179], v[44:47], v[64:67], v[176:179]
    ds_read_b128 v[108:111], v5 offset:14336
    v_mfma_f32_16x16x32_bf16 v[192:195], v[48:51], v[64:67], v[192:195]
    s_add_u32 s59, s59, 1
    s_cmp_eq_u32 s59, 2
    s_cselect_b32 s59, 0, s59
    s_cselect_b32 s71, 0xfffe0000, 0
    s_add_u32 s71, s71, 65536
    v_mfma_f32_16x16x32_bf16 v[196:199], v[48:51], v[68:71], v[196:199]
    v_add_u32 v4, s71, v4
    v_mfma_f32_16x16x32_bf16 v[200:203], v[48:51], v[72:75], v[200:203]
    v_add_u32 v5, s71, v5
    v_mfma_f32_16x16x32_bf16 v[204:207], v[48:51], v[76:79], v[204:207]
    v_add_u32 v6, s71, v6
    v_mfma_f32_16x16x32_bf16 v[220:223], v[52:55], v[76:79], v[220:223]
    v_add_u32 v7, s71, v7
    v_mfma_f32_16x16x32_bf16 v[216:219], v[52:55], v[72:75], v[216:219]
    v_add_u32 v8, s71, v8
    v_mfma_f32_16x16x32_bf16 v[212:215], v[52:55], v[68:71], v[212:215]
    v_add_u32 v9, s71, v9
    v_mfma_f32_16x16x32_bf16 v[208:211], v[52:55], v[64:67], v[208:211]
    s_sub_u32 s70, s70, 1
    v_mfma_f32_16x16x32_bf16 v[224:227], v[56:59], v[64:67], v[224:227]
    v_mfma_f32_16x16x32_bf16 v[228:231], v[56:59], v[68:71], v[228:231]
    v_mfma_f32_16x16x32_bf16 v[232:235], v[56:59], v[72:75], v[232:235]
    v_mfma_f32_16x16x32_bf16 v[236:239], v[56:59], v[76:79], v[236:239]
    v_mfma_f32_16x16x32_bf16 v[252:255], v[60:63], v[76:79], v[252:255]
    v_mfma_f32_16x16x32_bf16 v[248:251], v[60:63], v[72:75], v[248:251]
    v_mfma_f32_16x16x32_bf16 v[244:247], v[60:63], v[68:71], v[244:247]
    v_mfma_f32_16x16x32_bf16 v[240:243], v[60:63], v[64:67], v[240:243]
    s_cmp_lt_u32 s70, 2
    s_cbranch_scc1 G1W_VF_TAIL
    s_waitcnt vmcnt(0) lgkmcnt(0)
    s_barrier
    v_mfma_f32_16x16x32_bf16 v[128:131], v[80:83], v[112:115], v[128:131]
    s_add_u32 m0, s74, 0
    s_add_u32 s71, s68, 0
    buffer_load_dwordx4 v1, s[60:63], s71 offen sc1 lds
    v_mfma_f32_16x16x32_bf16 v[132:135], v[80:83], v[116:119], v[132:135]
    ds_read_b128 v[32:35], v4 offset:0
    v_mfma_f32_16x16x32_bf16 v[136:139], v[80:83], v[120:123], v[136:139]
    ds_read_b64_tr_b16 v[64:65], v6 offset:0
    v_mfma_f32_16x16x32_bf16 v[140:143], v[80:83], v[124:127], v[140:143]
    s_add_u32 m0, s74, 8192
    s_add_u32 s71, s68, 131072
    buffer_load_dwordx4 v1, s[60:63], s71 offen sc1 lds
    v_mfma_f32_16x16x32_bf16 v[156:159], v[84:87], v[124:127], v[156:159]
    ds_read_b64_tr_b16 v[66:67], v6 offset:2048
    v_mfma_f32_16x16x32_bf16 v[152:155], v[84:87], v[120:123], v[152:155]
    ds_read_b64_tr_b16 v[68:69], v7 offset:0
    v_mfma_f32_16x16x32_bf16 v[148:151], v[84:87], v[116:119], v[148:151]
    s_add_u32 m0, s74, 16384
    s_add_u32 s71, s68, 262144
    buffer_load_dwordx4 v1, s[60:63], s71 offen sc1 lds
    v_mfma_f32_16x16x32_bf16 v[144:147], v[84:87], v[112:115], v[144:147]
    ds_read_b64_tr_b16 v[70:71], v7 offset:2048
    v_mfma_f32_16x16x32_bf16 v[160:163], v[88:91], v[112:115], v[160:163]
    ds_read_b64_tr_b16 v[72:73], v8 offset:0
    v_mfma_f32_16x16x32_bf16 v[164:167], v[88:91], v[116:119], v[164:167]
    s_add_u32 m0, s74, 24576
    s_add_u32 s71, s68, 393216
    buffer_load_dwordx4 v1, s[60:63], s71 offen sc1 lds
    v_mfma_f32_16x16x32_bf16 v[168:171], v[88:91], v[120:123], v[168:171]
    ds_read_b64_tr_b16 v[74:75], v8 offset:2048
    v_mfma_f32_16x16x32_bf16 v[172:175], v[88:91], v[124:127], v[172:175]
    ds_read_b64_tr_b16 v[76:77], v9 offset:0
    v_mfma_f32_16x16x32_bf16 v[188:191], v[92:95], v[124:127], v[188:191]
    s_add_u32 m0, s74, 32768
    s_add_u32 s71, s69, 0
    buffer_load_dwordx4 v2, s[64:67], s71 offen sc1 lds
    v_mfma_f32_16x16x32_bf16 v[184:187], v[92:95], v[120:123], v[184:187]
    ds_read_b64_tr_b16 v[78:79], v9 offset:2048
    v_mfma_f32_16x16x32_bf16 v[180:183], v[92:95], v[116:119], v[180:183]
    ds_read_b128 v[36:39], v4 offset:2048
    v_mfma_f32_16x16x32_bf16 v[176:179], v[92:95], v[112:115], v[176:179]
    s_add_u32 m0, s74, 40960
    s_add_u32 s71, s69, s80
    buffer_load_dwordx4 v2, s[64:67], s71 offen sc1 lds
    v_mfma_f32_16x16x32_bf16 v[192:195], v[96:99], v[112:115], v[192:195]
    ds_read_b128 v[40:43], v4 offset:4096
    v_mfma_f32_16x16x32_bf16 v[196:199], v[96:99], v[116:119], v[196:199]
    ds_read_b128 v[44:47], v4 offset:6144
    v_mfma_f32_16x16x32_bf16 v[200:203], v[96:99], v[120:123], v[200:203]
    s_add_u32 m0, s74, 49152
    s_add_u32 s71, s69, s82
    buffer_load_dwordx4 v2, s[64:67], s71 offen sc1 lds
    v_mfma_f32_16x16x32_bf16 v[204:207], v[96:99], v[124:127], v[204:207]
    ds_read_b128 v[48:51], v4 offset:8192
    v_mfma_f32_16x16x32_bf16 v[220:223], v[100:103], v[124:127], v[220:223]
    ds_read_b128 v[52:55], v4 offset:10240
    v_mfma_f32_16x16x32_bf16 v[216:219], v[100:103], v[120:123], v[216:219]
    s_add_u32 m0, s74, 57344
    s_add_u32 s71, s69, s83
    buffer_load_dwordx4 v2, s[64:67], s71 offen sc1 lds
    v_mfma_f32_16x16x32_bf16 v[212:215], v[100:103], v[116:119], v[212:215]
    ds_read_b128 v[56:59], v4 offset:12288
    v_mfma_f32_16x16x32_bf16 v[208:211], v[100:103], v[112:115], v[208:211]
    ds_read_b128 v[60:63], v4 offset:14336
    v_mfma_f32_16x16x32_bf16 v[224:227], v[104:107], v[112:115], v[224:227]
    s_add_u32 s68, s68, 128
    s_add_u32 s69, s69, s81
    s_add_u32 s75, s75, 1
    s_cmp_eq_u32 s75, 2
    s_cselect_b32 s75, 0, s75
    s_cselect_b32 s71, 0xfffe0000, 0
    s_add_u32 s71, s71, 65536
    s_add_u32 s74, s74, s71
    v_mfma_f32_16x16x32_bf16 v[228:231], v[104:107], v[116:119], v[228:231]
    v_mfma_f32_16x16x32_bf16 v[232:235], v[104:107], v[120:123], v[232:235]
    v_mfma_f32_16x16x32_bf16 v[236:239], v[104:107], v[124:127], v[236:239]
    v_mfma_f32_16x16x32_bf16 v[252:255], v[108:111], v[124:127], v[252:255]
    v_mfma_f32_16x16x32_bf16 v[248:251], v[108:111], v[120:123], v[248:251]
    v_mfma_f32_16x16x32_bf16 v[244:247], v[108:111], v[116:119], v[244:247]
    v_mfma_f32_16x16x32_bf16 v[240:243], v[108:111], v[112:115], v[240:243]
    s_branch G1W_VF_LOOP
G1W_VF_TAIL:
    s_waitcnt vmcnt(0) lgkmcnt(0)
    s_barrier
    s_cmp_lg_u32 s76, 0
    s_cbranch_scc1 G1W_VF_HT0
    s_cmp_eq_u32 s70, 0
    s_cbranch_scc1 G1W_VF_HB
    v_mov_b32 v28, 1
    s_lshl_b32 s4, s52, 2
    s_mov_b64 exec, 1
    buffer_atomic_add v28, off, s[16:19], s4 offset:160 sc0 sc1
    s_mov_b64 exec, -1
    s_branch G1W_VF_HT0
G1W_VF_HB:
    v_readfirstlane_b32 s4, v28
    v_lshlrev_b32 v29, 2, v0
    s_nop 2
    s_add_u32 s4, s4, 32
    s_min_u32 s4, s4, 312
    s_lshl_b32 s4, s4, 5
    v_add_u32 v29, s4, v29
    s_mov_b64 exec, 15
    global_load_dword v29, v29, s[28:29] offset:4
    s_mov_b64 exec, -1
G1W_VF_HT0:
    v_mfma_f32_16x16x32_bf16 v[128:131], v[80:83], v[112:115], v[128:131]
    ds_read_b128 v[32:35], v4 offset:0
    v_mfma_f32_16x16x32_bf16 v[132:135], v[80:83], v[116:119], v[132:135]
    ds_read_b64_tr_b16 v[64:65], v6 offset:0
    v_mfma_f32_16x16x32_bf16 v[136:139], v[80:83], v[120:123], v[136:139]
    ds_read_b64_tr_b16 v[66:67], v6 offset:2048
    v_mfma_f32_16x16x32_bf16 v[140:143], v[80:83], v[124:127], v[140:143]
    ds_read_b64_tr_b16 v[68:69], v7 offset:0
    v_mfma_f32_16x16x32_bf16 v[156:159], v[84:87], v[124:127], v[156:159]
    ds_read_b64_tr_b16 v[70:71], v7 offset:2048
    v_mfma_f32_16x16x32_bf16 v[152:155], v[84:87], v[120:123], v[152:155]
    ds_read_b64_tr_b16 v[72:73], v8 offset:0
    v_mfma_f32_16x16x32_bf16 v[148:151], v[84:87], v[116:119], v[148:151]
    ds_read_b64_tr_b16 v[74:75], v8 offset:2048
    v_mfma_f32_16x16x32_bf16 v[144:147], v[84:87], v[112:115], v[144:147]
    ds_read_b64_tr_b16 v[76:77], v9 offset:0
    v_mfma_f32_16x16x32_bf16 v[160:163], v[88:91], v[112:115], v[160:163]
    ds_read_b64_tr_b16 v[78:79], v9 offset:2048
    v_mfma_f32_16x16x32_bf16 v[164:167], v[88:91], v[116:119], v[164:167]
    ds_read_b128 v[36:39], v4 offset:2048
    v_mfma_f32_16x16x32_bf16 v[168:171], v[88:91], v[120:123], v[168:171]
    ds_read_b128 v[40:43], v4 offset:4096
    v_mfma_f32_16x16x32_bf16 v[172:175], v[88:91], v[124:127], v[172:175]
    ds_read_b128 v[44:47], v4 offset:6144
    v_mfma_f32_16x16x32_bf16 v[188:191], v[92:95], v[124:127], v[188:191]
    ds_read_b128 v[48:51], v4 offset:8192
    v_mfma_f32_16x16x32_bf16 v[184:187], v[92:95], v[120:123], v[184:187]
    ds_read_b128 v[52:55], v4 offset:10240
    v_mfma_f32_16x16x32_bf16 v[180:183], v[92:95], v[116:119], v[180:183]
    ds_read_b128 v[56:59], v4 offset:12288
    v_mfma_f32_16x16x32_bf16 v[176:179], v[92:95], v[112:115], v[176:179]
    ds_read_b128 v[60:63], v4 offset:14336
    v_mfma_f32_16x16x32_bf16 v[192:195], v[96:99], v[112:115], v[192:195]
    v_mfma_f32_16x16x32_bf16 v[196:199], v[96:99], v[116:119], v[196:199]
    v_mfma_f32_16x16x32_bf16 v[200:203], v[96:99], v[120:123], v[200:203]
    v_mfma_f32_16x16x32_bf16 v[204:207], v[96:99], v[124:127], v[204:207]
    v_mfma_f32_16x16x32_bf16 v[220:223], v[100:103], v[124:127], v[220:223]
    v_mfma_f32_16x16x32_bf16 v[216:219], v[100:103], v[120:123], v[216:219]
    v_mfma_f32_16x16x32_bf16 v[212:215], v[100:103], v[116:119], v[212:215]
    v_mfma_f32_16x16x32_bf16 v[208:211], v[100:103], v[112:115], v[208:211]
    v_mfma_f32_16x16x32_bf16 v[224:227], v[104:107], v[112:115], v[224:227]
    v_mfma_f32_16x16x32_bf16 v[228:231], v[104:107], v[116:119], v[228:231]
    v_mfma_f32_16x16x32_bf16 v[232:235], v[104:107], v[120:123], v[232:235]
    v_mfma_f32_16x16x32_bf16 v[236:239], v[104:107], v[124:127], v[236:239]
    v_mfma_f32_16x16x32_bf16 v[252:255], v[108:111], v[124:127], v[252:255]
    v_mfma_f32_16x16x32_bf16 v[248:251], v[108:111], v[120:123], v[248:251]
    v_mfma_f32_16x16x32_bf16 v[244:247], v[108:111], v[116:119], v[244:247]
    v_mfma_f32_16x16x32_bf16 v[240:243], v[108:111], v[112:115], v[240:243]
    s_cmp_lg_u32 s70, 0
    s_cbranch_scc1 G1W_VF_LOOP
    s_cmp_lg_u32 s76, 0
    s_cbranch_scc1 G1W_VF_HT1
    s_waitcnt vmcnt(0)
    v_bfe_u32 v30, v29, 10, 7
    v_and_b32 v31, 0x3ff, v29
    v_mad_u32_u24 v30, v30, s52, v31
    v_lshlrev_b32 v30, 7, v30
    s_mov_b32 s4, 124780544
    s_mov_b64 exec, 15
    buffer_load_dword v30, v30, s[8:11], s4 offen sc1
    s_mov_b64 exec, -1
G1W_VF_HT1:
    s_waitcnt lgkmcnt(0)
    s_nop 7
    s_cmp_eq_u32 s79, 3
    s_cbranch_scc1 G1W_FE
    s_mul_i32 s80, s77, 8
    s_mul_i32 s71, s72, 4
    s_add_u32 s80, s80, s71
    s_lshl_b32 s80, s80, 5
    s_mul_i32 s71, s78, 2
    s_add_u32 s80, s80, s71
    s_lshr_b32 s71, s73, 1
    s_add_u32 s80, s80, s71
    s_lshl_b32 s80, s80, 14
    s_and_b32 s71, s73, 1
    s_lshl_b32 s71, s71, 12
    s_add_u32 s80, s80, s71
    s_add_u32 s80, s80, 4202496
    v_bfe_u32 v14, v0, 1, 3
    v_lshlrev_b32 v14, 4, v14
    v_and_b32 v15, 1, v0
    v_lshl_add_u32 v14, v15, 10, v14
    v_lshrrev_b32 v15, 4, v0
    v_lshl_add_u32 v14, v15, 8, v14
    v_cvt_pk_bf16_f32 v32, v128, v129
    v_cvt_pk_bf16_f32 v33, v130, v131
    v_cvt_pk_bf16_f32 v34, v144, v145
    v_cvt_pk_bf16_f32 v35, v146, v147
    buffer_store_dwordx4 v[32:35], v14, s[8:11], s80 offen offset:0 sc1
    v_cvt_pk_bf16_f32 v36, v132, v133
    v_cvt_pk_bf16_f32 v37, v134, v135
    v_cvt_pk_bf16_f32 v38, v148, v149
    v_cvt_pk_bf16_f32 v39, v150, v151
    buffer_store_dwordx4 v[36:39], v14, s[8:11], s80 offen offset:128 sc1
    v_cvt_pk_bf16_f32 v40, v136, v137
    v_cvt_pk_bf16_f32 v41, v138, v139
    v_cvt_pk_bf16_f32 v42, v152, v153
    v_cvt_pk_bf16_f32 v43, v154, v155
    buffer_store_dwordx4 v[40:43], v14, s[8:11], s80 offen offset:2048 sc1
    v_cvt_pk_bf16_f32 v44, v140, v141
    v_cvt_pk_bf16_f32 v45, v142, v143
    v_cvt_pk_bf16_f32 v46, v156, v157
    v_cvt_pk_bf16_f32 v47, v158, v159
    buffer_store_dwordx4 v[44:47], v14, s[8:11], s80 offen offset:2176 sc1
    s_add_u32 s80, s80, 524288
    v_cvt_pk_bf16_f32 v48, v160, v161
    v_cvt_pk_bf16_f32 v49, v162, v163
    v_cvt_pk_bf16_f32 v50, v176, v177
    v_cvt_pk_bf16_f32 v51, v178, v179
    buffer_store_dwordx4 v[48:51], v14, s[8:11], s80 offen offset:0 sc1
    v_cvt_pk_bf16_f32 v52, v164, v165
    v_cvt_pk_bf16_f32 v53, v166, v167
    v_cvt_pk_bf16_f32 v54, v180, v181
    v_cvt_pk_bf16_f32 v55, v182, v183
    buffer_store_dwordx4 v[52:55], v14, s[8:11], s80 offen offset:128 sc1
    v_cvt_pk_bf16_f32 v56, v168, v169
    v_cvt_pk_bf16_f32 v57, v170, v171
    v_cvt_pk_bf16_f32 v58, v184, v185
    v_cvt_pk_bf16_f32 v59, v186, v187
    buffer_store_dwordx4 v[56:59], v14, s[8:11], s80 offen offset:2048 sc1
    v_cvt_pk_bf16_f32 v60, v172, v173
    v_cvt_pk_bf16_f32 v61, v174, v175
    v_cvt_pk_bf16_f32 v62, v188, v189
    v_cvt_pk_bf16_f32 v63, v190, v191
    buffer_store_dwordx4 v[60:63], v14, s[8:11], s80 offen offset:2176 sc1
    s_add_u32 s80, s80, 524288
    v_cvt_pk_bf16_f32 v32, v192, v193
    v_cvt_pk_bf16_f32 v33, v194, v195
    v_cvt_pk_bf16_f32 v34, v208, v209
    v_cvt_pk_bf16_f32 v35, v210, v211
    buffer_store_dwordx4 v[32:35], v14, s[8:11], s80 offen offset:0 sc1
    v_cvt_pk_bf16_f32 v36, v196, v197
    v_cvt_pk_bf16_f32 v37, v198, v199
    v_cvt_pk_bf16_f32 v38, v212, v213
    v_cvt_pk_bf16_f32 v39, v214, v215
    buffer_store_dwordx4 v[36:39], v14, s[8:11], s80 offen offset:128 sc1
    v_cvt_pk_bf16_f32 v40, v200, v201
    v_cvt_pk_bf16_f32 v41, v202, v203
    v_cvt_pk_bf16_f32 v42, v216, v217
    v_cvt_pk_bf16_f32 v43, v218, v219
    buffer_store_dwordx4 v[40:43], v14, s[8:11], s80 offen offset:2048 sc1
    v_cvt_pk_bf16_f32 v44, v204, v205
    v_cvt_pk_bf16_f32 v45, v206, v207
    v_cvt_pk_bf16_f32 v46, v220, v221
    v_cvt_pk_bf16_f32 v47, v222, v223
    buffer_store_dwordx4 v[44:47], v14, s[8:11], s80 offen offset:2176 sc1
    s_add_u32 s80, s80, 524288
    v_cvt_pk_bf16_f32 v48, v224, v225
    v_cvt_pk_bf16_f32 v49, v226, v227
    v_cvt_pk_bf16_f32 v50, v240, v241
    v_cvt_pk_bf16_f32 v51, v242, v243
    buffer_store_dwordx4 v[48:51], v14, s[8:11], s80 offen offset:0 sc1
    v_cvt_pk_bf16_f32 v52, v228, v229
    v_cvt_pk_bf16_f32 v53, v230, v231
    v_cvt_pk_bf16_f32 v54, v244, v245
    v_cvt_pk_bf16_f32 v55, v246, v247
    buffer_store_dwordx4 v[52:55], v14, s[8:11], s80 offen offset:128 sc1
    v_cvt_pk_bf16_f32 v56, v232, v233
    v_cvt_pk_bf16_f32 v57, v234, v235
    v_cvt_pk_bf16_f32 v58, v248, v249
    v_cvt_pk_bf16_f32 v59, v250, v251
    buffer_store_dwordx4 v[56:59], v14, s[8:11], s80 offen offset:2048 sc1
    v_cvt_pk_bf16_f32 v60, v236, v237
    v_cvt_pk_bf16_f32 v61, v238, v239
    v_cvt_pk_bf16_f32 v62, v252, v253
    v_cvt_pk_bf16_f32 v63, v254, v255
    buffer_store_dwordx4 v[60:63], v14, s[8:11], s80 offen offset:2176 sc1
    s_add_u32 s80, s80, 524288
    s_branch G_DONE2
G1W_FE:
    s_mul_i32 s80, s78, 256
    s_lshl_b32 s71, s73, 6
    s_add_u32 s80, s80, s71
    s_lshl_b32 s80, s80, 12
    s_mul_i32 s71, s77, 512
    s_add_u32 s80, s80, s71
    s_mul_i32 s71, s72, 256
    s_add_u32 s80, s80, s71
    s_add_u32 s80, s80, 104857600
    v_and_b32 v14, 15, v0
    v_lshlrev_b32 v14, 12, v14
    v_lshrrev_b32 v15, 4, v0
    v_lshl_add_u32 v14, v15, 4, v14
    v_cvt_pk_bf16_f32 v32, v128, v129
    v_cvt_pk_bf16_f32 v33, v130, v131
    v_cvt_pk_bf16_f32 v34, v144, v145
    v_cvt_pk_bf16_f32 v35, v146, v147
    buffer_store_dwordx4 v[32:35], v14, s[8:11], s80 offen offset:0 sc1
    v_cvt_pk_bf16_f32 v36, v160, v161
    v_cvt_pk_bf16_f32 v37, v162, v163
    v_cvt_pk_bf16_f32 v38, v176, v177
    v_cvt_pk_bf16_f32 v39, v178, v179
    buffer_store_dwordx4 v[36:39], v14, s[8:11], s80 offen offset:64 sc1
    v_cvt_pk_bf16_f32 v40, v192, v193
    v_cvt_pk_bf16_f32 v41, v194, v195
    v_cvt_pk_bf16_f32 v42, v208, v209
    v_cvt_pk_bf16_f32 v43, v210, v211
    buffer_store_dwordx4 v[40:43], v14, s[8:11], s80 offen offset:128 sc1
    v_cvt_pk_bf16_f32 v44, v224, v225
    v_cvt_pk_bf16_f32 v45, v226, v227
    v_cvt_pk_bf16_f32 v46, v240, v241
    v_cvt_pk_bf16_f32 v47, v242, v243
    buffer_store_dwordx4 v[44:47], v14, s[8:11], s80 offen offset:192 sc1
    s_add_u32 s80, s80, 65536
    v_cvt_pk_bf16_f32 v48, v132, v133
    v_cvt_pk_bf16_f32 v49, v134, v135
    v_cvt_pk_bf16_f32 v50, v148, v149
    v_cvt_pk_bf16_f32 v51, v150, v151
    buffer_store_dwordx4 v[48:51], v14, s[8:11], s80 offen offset:0 sc1
    v_cvt_pk_bf16_f32 v52, v164, v165
    v_cvt_pk_bf16_f32 v53, v166, v167
    v_cvt_pk_bf16_f32 v54, v180, v181
    v_cvt_pk_bf16_f32 v55, v182, v183
    buffer_store_dwordx4 v[52:55], v14, s[8:11], s80 offen offset:64 sc1
    v_cvt_pk_bf16_f32 v56, v196, v197
    v_cvt_pk_bf16_f32 v57, v198, v199
    v_cvt_pk_bf16_f32 v58, v212, v213
    v_cvt_pk_bf16_f32 v59, v214, v215
    buffer_store_dwordx4 v[56:59], v14, s[8:11], s80 offen offset:128 sc1
    v_cvt_pk_bf16_f32 v60, v228, v229
    v_cvt_pk_bf16_f32 v61, v230, v231
    v_cvt_pk_bf16_f32 v62, v244, v245
    v_cvt_pk_bf16_f32 v63, v246, v247
    buffer_store_dwordx4 v[60:63], v14, s[8:11], s80 offen offset:192 sc1
    s_add_u32 s80, s80, 65536
    v_cvt_pk_bf16_f32 v32, v136, v137
    v_cvt_pk_bf16_f32 v33, v138, v139
    v_cvt_pk_bf16_f32 v34, v152, v153
    v_cvt_pk_bf16_f32 v35, v154, v155
    buffer_store_dwordx4 v[32:35], v14, s[8:11], s80 offen offset:0 sc1
    v_cvt_pk_bf16_f32 v36, v168, v169
    v_cvt_pk_bf16_f32 v37, v170, v171
    v_cvt_pk_bf16_f32 v38, v184, v185
    v_cvt_pk_bf16_f32 v39, v186, v187
    buffer_store_dwordx4 v[36:39], v14, s[8:11], s80 offen offset:64 sc1
    v_cvt_pk_bf16_f32 v40, v200, v201
    v_cvt_pk_bf16_f32 v41, v202, v203
    v_cvt_pk_bf16_f32 v42, v216, v217
    v_cvt_pk_bf16_f32 v43, v218, v219
    buffer_store_dwordx4 v[40:43], v14, s[8:11], s80 offen offset:128 sc1
    v_cvt_pk_bf16_f32 v44, v232, v233
    v_cvt_pk_bf16_f32 v45, v234, v235
    v_cvt_pk_bf16_f32 v46, v248, v249
    v_cvt_pk_bf16_f32 v47, v250, v251
    buffer_store_dwordx4 v[44:47], v14, s[8:11], s80 offen offset:192 sc1
    s_add_u32 s80, s80, 65536
    v_cvt_pk_bf16_f32 v48, v140, v141
    v_cvt_pk_bf16_f32 v49, v142, v143
    v_cvt_pk_bf16_f32 v50, v156, v157
    v_cvt_pk_bf16_f32 v51, v158, v159
    buffer_store_dwordx4 v[48:51], v14, s[8:11], s80 offen offset:0 sc1
    v_cvt_pk_bf16_f32 v52, v172, v173
    v_cvt_pk_bf16_f32 v53, v174, v175
    v_cvt_pk_bf16_f32 v54, v188, v189
    v_cvt_pk_bf16_f32 v55, v190, v191
    buffer_store_dwordx4 v[52:55], v14, s[8:11], s80 offen offset:64 sc1
    v_cvt_pk_bf16_f32 v56, v204, v205
    v_cvt_pk_bf16_f32 v57, v206, v207
    v_cvt_pk_bf16_f32 v58, v220, v221
    v_cvt_pk_bf16_f32 v59, v222, v223
    buffer_store_dwordx4 v[56:59], v14, s[8:11], s80 offen offset:128 sc1
    v_cvt_pk_bf16_f32 v60, v236, v237
    v_cvt_pk_bf16_f32 v61, v238, v239
    v_cvt_pk_bf16_f32 v62, v252, v253
    v_cvt_pk_bf16_f32 v63, v254, v255
    buffer_store_dwordx4 v[60:63], v14, s[8:11], s80 offen offset:192 sc1
    s_add_u32 s80, s80, 65536
    s_branch G_DONE2
H_G1N:
    s_lshl_b32 s4, s52, 3
    s_add_u32 s78, s78, s4
    s_load_dwordx2 s[4:5], s[0:1], 0
    s_cmp_eq_u32 s79, 0
    s_cselect_b32 s71, 24, 32
    s_cmp_eq_u32 s79, 2
    s_cselect_b32 s71, 16, s71
    s_load_dwordx2 s[6:7], s[0:1], s71
    s_mul_i32 s68, s77, 524288
    s_mul_i32 s69, s78, 256
    s_waitcnt lgkmcnt(0)
    s_mov_b32 s60, s4
    s_and_b32 s61, s5, 0xffff
    s_mov_b32 s62, 4194304
    s_mov_b32 s63, 0x20000
    s_mov_b32 s64, s6
    s_and_b32 s65, s7, 0xffff
    s_mov_b32 s66, 8388608
    s_mov_b32 s67, 0x20000
    s_lshr_b32 s72, s76, 1
    s_and_b32 s73, s76, 1
    v_lshrrev_b32 v14, 3, v0
    s_lshl_b32 s71, s76, 3
    v_add_u32 v14, s71, v14
    v_lshrrev_b32 v15, 1, v14
    v_xor_b32 v15, v15, v0
    v_and_b32 v15, 7, v15
    s_mov_b32 s71, 2048
    v_mul_lo_u32 v1, v14, s71
    v_lshl_add_u32 v1, v15, 4, v1
    v_and_b32 v14, 15, v0
    v_lshrrev_b32 v15, 1, v14
    v_lshrrev_b32 v16, 4, v0
    v_xor_b32 v15, v15, v16
    v_lshlrev_b32 v15, 4, v15
    v_lshl_add_u32 v14, v14, 7, v15
    s_mul_i32 s71, s72, 8192
    v_add_u32 v4, s71, v14
    v_xor_b32 v5, 64, v4
    v_lshrrev_b32 v14, 4, v0
    s_mul_i32 s71, s76, 4
    v_add_u32 v14, s71, v14
    v_and_b32 v15, 3, v14
    v_lshlrev_b32 v15, 1, v15
    v_and_b32 v16, 8, v14
    v_or_b32 v15, v15, v16
    v_and_b32 v16, 15, v0
    v_xor_b32 v15, v15, v16
    s_mov_b32 s71, 8192
    v_mul_lo_u32 v2, v14, s71
    v_lshl_add_u32 v2, v15, 4, v2
    v_bfe_u32 v14, v0, 2, 2
    v_lshrrev_b32 v15, 4, v0
    v_lshl_add_u32 v15, v15, 3, v14
    v_mul_u32_u24 v15, 256, v15
    v_and_b32 v16, 3, v0
    v_lshl_add_u32 v15, v16, 3, v15
    v_add_u32 v15, 32768, v15
    v_bfe_u32 v14, v0, 2, 3
    s_mul_i32 s71, s73, 4
    v_xor_b32 v14, s71, v14
    v_lshl_add_u32 v6, v14, 5, v15
    v_xor_b32 v7, 32, v6
    v_xor_b32 v8, 64, v6
    v_xor_b32 v9, 96, v6
    s_lshl_b32 s74, s76, 10
    s_mov_b32 s75, 0
    s_mov_b32 s59, 0
    s_cmp_eq_u32 s79, 1
    s_cbranch_scc1 G1N_V
    s_barrier
    s_add_u32 m0, s74, 0
    s_add_u32 s71, s68, 0
    buffer_load_dwordx4 v1, s[60:63], s71 offen lds
    s_add_u32 m0, s74, 8192
    s_add_u32 s71, s68, 131072
    buffer_load_dwordx4 v1, s[60:63], s71 offen lds
    s_add_u32 m0, s74, 16384
    s_add_u32 s71, s68, 262144
    buffer_load_dwordx4 v1, s[60:63], s71 offen lds
    s_add_u32 m0, s74, 24576
    s_add_u32 s71, s68, 393216
    buffer_load_dwordx4 v1, s[60:63], s71 offen lds
    s_add_u32 m0, s74, 32768
    s_add_u32 s71, s69, 0
    buffer_load_dwordx4 v2, s[64:67], s71 offen lds
    s_add_u32 m0, s74, 40960
    s_add_u32 s71, s69, 262144
    buffer_load_dwordx4 v2, s[64:67], s71 offen lds
    s_add_u32 s68, s68, 128
    s_add_u32 s69, s69, 524288
    s_add_u32 s75, s75, 1
    s_cmp_eq_u32 s75, 3
    s_cselect_b32 s75, 0, s75
    s_cselect_b32 s71, 0xfffdc000, 0
    s_add_u32 s71, s71, 49152
    s_add_u32 s74, s74, s71
    s_add_u32 m0, s74, 0
    s_add_u32 s71, s68, 0
    buffer_load_dwordx4 v1, s[60:63], s71 offen lds
    s_add_u32 m0, s74, 8192
    s_add_u32 s71, s68, 131072
    buffer_load_dwordx4 v1, s[60:63], s71 offen lds
    s_add_u32 m0, s74, 16384
    s_add_u32 s71, s68, 262144
    buffer_load_dwordx4 v1, s[60:63], s71 offen lds
    s_add_u32 m0, s74, 24576
    s_add_u32 s71, s68, 393216
    buffer_load_dwordx4 v1, s[60:63], s71 offen lds
    s_add_u32 m0, s74, 32768
    s_add_u32 s71, s69, 0
    buffer_load_dwordx4 v2, s[64:67], s71 offen lds
    s_add_u32 m0, s74, 40960
    s_add_u32 s71, s69, 262144
    buffer_load_dwordx4 v2, s[64:67], s71 offen lds
    s_add_u32 s68, s68, 128
    s_add_u32 s69, s69, 524288
    s_add_u32 s75, s75, 1
    s_cmp_eq_u32 s75, 3
    s_cselect_b32 s75, 0, s75
    s_cselect_b32 s71, 0xfffdc000, 0
    s_add_u32 s71, s71, 49152
    s_add_u32 s74, s74, s71
    s_add_u32 m0, s74, 0
    s_add_u32 s71, s68, 0
    buffer_load_dwordx4 v1, s[60:63], s71 offen lds
    s_add_u32 m0, s74, 8192
    s_add_u32 s71, s68, 131072
    buffer_load_dwordx4 v1, s[60:63], s71 offen lds
    s_add_u32 m0, s74, 16384
    s_add_u32 s71, s68, 262144
    buffer_load_dwordx4 v1, s[60:63], s71 offen lds
    s_add_u32 m0, s74, 24576
    s_add_u32 s71, s68, 393216
    buffer_load_dwordx4 v1, s[60:63], s71 offen lds
    s_add_u32 m0, s74, 32768
    s_add_u32 s71, s69, 0
    buffer_load_dwordx4 v2, s[64:67], s71 offen lds
    s_add_u32 m0, s74, 40960
    s_add_u32 s71, s69, 262144
    buffer_load_dwordx4 v2, s[64:67], s71 offen lds
    s_add_u32 s68, s68, 128
    s_add_u32 s69, s69, 524288
    s_add_u32 s75, s75, 1
    s_cmp_eq_u32 s75, 3
    s_cselect_b32 s75, 0, s75
    s_cselect_b32 s71, 0xfffdc000, 0
    s_add_u32 s71, s71, 49152
    s_add_u32 s74, s74, s71
    s_mov_b32 s70, 16
    v_mov_b32 v128, 0
    v_mov_b32 v129, 0
    v_mov_b32 v130, 0
    v_mov_b32 v131, 0
    v_mov_b32 v132, 0
    v_mov_b32 v133, 0
    v_mov_b32 v134, 0
    v_mov_b32 v135, 0
    v_mov_b32 v136, 0
    v_mov_b32 v137, 0
    v_mov_b32 v138, 0
    v_mov_b32 v139, 0
    v_mov_b32 v140, 0
    v_mov_b32 v141, 0
    v_mov_b32 v142, 0
    v_mov_b32 v143, 0
    v_mov_b32 v144, 0
    v_mov_b32 v145, 0
    v_mov_b32 v146, 0
    v_mov_b32 v147, 0
    v_mov_b32 v148, 0
    v_mov_b32 v149, 0
    v_mov_b32 v150, 0
    v_mov_b32 v151, 0
    v_mov_b32 v152, 0
    v_mov_b32 v153, 0
    v_mov_b32 v154, 0
    v_mov_b32 v155, 0
    v_mov_b32 v156, 0
    v_mov_b32 v157, 0
    v_mov_b32 v158, 0
    v_mov_b32 v159, 0
    v_mov_b32 v160, 0
    v_mov_b32 v161, 0
    v_mov_b32 v162, 0
    v_mov_b32 v163, 0
    v_mov_b32 v164, 0
    v_mov_b32 v165, 0
    v_mov_b32 v166, 0
    v_mov_b32 v167, 0
    v_mov_b32 v168, 0
    v_mov_b32 v169, 0
    v_mov_b32 v170, 0
    v_mov_b32 v171, 0
    v_mov_b32 v172, 0
    v_mov_b32 v173, 0
    v_mov_b32 v174, 0
    v_mov_b32 v175, 0
    v_mov_b32 v176, 0
    v_mov_b32 v177, 0
    v_mov_b32 v178, 0
    v_mov_b32 v179, 0
    v_mov_b32 v180, 0
    v_mov_b32 v181, 0
    v_mov_b32 v182, 0
    v_mov_b32 v183, 0
    v_mov_b32 v184, 0
    v_mov_b32 v185, 0
    v_mov_b32 v186, 0
    v_mov_b32 v187, 0
    v_mov_b32 v188, 0
    v_mov_b32 v189, 0
    v_mov_b32 v190, 0
    v_mov_b32 v191, 0
    s_waitcnt vmcnt(12)
    s_barrier
    s_cmp_eq_u32 s31, 0
    s_cbranch_scc1 G1N_K_HS
    s_mov_b64 exec, 1
    s_bfe_u32 s4, s31, 0x7000a
    s_mul_i32 s4, s4, s52
    s_and_b32 s5, s31, 0x3ff
    s_add_u32 s4, s4, s5
    s_lshl_b32 s4, s4, 7
    s_add_u32 s4, s4, 124780544
    s_lshr_b32 s5, s31, 20
    v_mov_b32 v28, s5
    buffer_atomic_add v28, off, s[8:11], s4 sc1
    s_mov_b64 exec, -1
    s_mov_b32 s31, 0
G1N_K_HS:
    ds_read_b128 v[32:35], v4 offset:0
    ds_read_b64_tr_b16 v[48:49], v6 offset:0
    ds_read_b64_tr_b16 v[50:51], v6 offset:1024
    ds_read_b64_tr_b16 v[52:53], v7 offset:0
    ds_read_b64_tr_b16 v[54:55], v7 offset:1024
    ds_read_b64_tr_b16 v[56:57], v8 offset:0
    ds_read_b64_tr_b16 v[58:59], v8 offset:1024
    ds_read_b64_tr_b16 v[60:61], v9 offset:0
    ds_read_b64_tr_b16 v[62:63], v9 offset:1024
    ds_read_b128 v[36:39], v4 offset:2048
    ds_read_b128 v[40:43], v4 offset:4096
    ds_read_b128 v[44:47], v4 offset:6144
G1N_K_LOOP:
    s_waitcnt lgkmcnt(0)
    v_mfma_f32_16x16x32_bf16 v[128:131], v[48:51], v[32:35], v[128:131]
    ds_read_b128 v[64:67], v5 offset:0
    ds_read_b64_tr_b16 v[80:81], v6 offset:8192
    v_mfma_f32_16x16x32_bf16 v[132:135], v[52:55], v[32:35], v[132:135]
    ds_read_b64_tr_b16 v[82:83], v6 offset:9216
    ds_read_b64_tr_b16 v[84:85], v7 offset:8192
    v_mfma_f32_16x16x32_bf16 v[136:139], v[56:59], v[32:35], v[136:139]
    ds_read_b64_tr_b16 v[86:87], v7 offset:9216
    ds_read_b64_tr_b16 v[88:89], v8 offset:8192
    v_mfma_f32_16x16x32_bf16 v[140:143], v[60:63], v[32:35], v[140:143]
    ds_read_b64_tr_b16 v[90:91], v8 offset:9216
    ds_read_b64_tr_b16 v[92:93], v9 offset:8192
    v_mfma_f32_16x16x32_bf16 v[156:159], v[60:63], v[36:39], v[156:159]
    ds_read_b64_tr_b16 v[94:95], v9 offset:9216
    ds_read_b128 v[68:71], v5 offset:2048
    v_mfma_f32_16x16x32_bf16 v[152:155], v[56:59], v[36:39], v[152:155]
    ds_read_b128 v[72:75], v5 offset:4096
    ds_read_b128 v[76:79], v5 offset:6144
    v_mfma_f32_16x16x32_bf16 v[148:151], v[52:55], v[36:39], v[148:151]
    s_add_u32 s59, s59, 1
    s_cmp_eq_u32 s59, 3
    s_cselect_b32 s59, 0, s59
    s_cselect_b32 s71, 0xfffdc000, 0
    s_add_u32 s71, s71, 49152
    v_add_u32 v4, s71, v4
    v_mfma_f32_16x16x32_bf16 v[144:147], v[48:51], v[36:39], v[144:147]
    v_add_u32 v5, s71, v5
    v_add_u32 v6, s71, v6
    v_mfma_f32_16x16x32_bf16 v[160:163], v[48:51], v[40:43], v[160:163]
    v_add_u32 v7, s71, v7
    v_add_u32 v8, s71, v8
    v_mfma_f32_16x16x32_bf16 v[164:167], v[52:55], v[40:43], v[164:167]
    v_add_u32 v9, s71, v9
    s_sub_u32 s70, s70, 1
    v_mfma_f32_16x16x32_bf16 v[168:171], v[56:59], v[40:43], v[168:171]
    v_mfma_f32_16x16x32_bf16 v[172:175], v[60:63], v[40:43], v[172:175]
    v_mfma_f32_16x16x32_bf16 v[188:191], v[60:63], v[44:47], v[188:191]
    v_mfma_f32_16x16x32_bf16 v[184:187], v[56:59], v[44:47], v[184:187]
    v_mfma_f32_16x16x32_bf16 v[180:183], v[52:55], v[44:47], v[180:183]
    v_mfma_f32_16x16x32_bf16 v[176:179], v[48:51], v[44:47], v[176:179]
    s_cmp_lt_u32 s70, 3
    s_cbranch_scc1 G1N_K_TAIL
    s_waitcnt vmcnt(6) lgkmcnt(0)
    s_barrier
    v_mfma_f32_16x16x32_bf16 v[128:131], v[80:83], v[64:67], v[128:131]
    s_add_u32 m0, s74, 0
    s_add_u32 s71, s68, 0
    buffer_load_dwordx4 v1, s[60:63], s71 offen lds
    ds_read_b128 v[32:35], v4 offset:0
    v_mfma_f32_16x16x32_bf16 v[132:135], v[84:87], v[64:67], v[132:135]
    ds_read_b64_tr_b16 v[48:49], v6 offset:0
    s_add_u32 m0, s74, 8192
    s_add_u32 s71, s68, 131072
    buffer_load_dwordx4 v1, s[60:63], s71 offen lds
    v_mfma_f32_16x16x32_bf16 v[136:139], v[88:91], v[64:67], v[136:139]
    ds_read_b64_tr_b16 v[50:51], v6 offset:1024
    ds_read_b64_tr_b16 v[52:53], v7 offset:0
    v_mfma_f32_16x16x32_bf16 v[140:143], v[92:95], v[64:67], v[140:143]
    s_add_u32 m0, s74, 16384
    s_add_u32 s71, s68, 262144
    buffer_load_dwordx4 v1, s[60:63], s71 offen lds
    ds_read_b64_tr_b16 v[54:55], v7 offset:1024
    v_mfma_f32_16x16x32_bf16 v[156:159], v[92:95], v[68:71], v[156:159]
    ds_read_b64_tr_b16 v[56:57], v8 offset:0
    s_add_u32 m0, s74, 24576
    s_add_u32 s71, s68, 393216
    buffer_load_dwordx4 v1, s[60:63], s71 offen lds
    v_mfma_f32_16x16x32_bf16 v[152:155], v[88:91], v[68:71], v[152:155]
    ds_read_b64_tr_b16 v[58:59], v8 offset:1024
    ds_read_b64_tr_b16 v[60:61], v9 offset:0
    v_mfma_f32_16x16x32_bf16 v[148:151], v[84:87], v[68:71], v[148:151]
    s_add_u32 m0, s74, 32768
    s_add_u32 s71, s69, 0
    buffer_load_dwordx4 v2, s[64:67], s71 offen lds
    ds_read_b64_tr_b16 v[62:63], v9 offset:1024
    v_mfma_f32_16x16x32_bf16 v[144:147], v[80:83], v[68:71], v[144:147]
    ds_read_b128 v[36:39], v4 offset:2048
    s_add_u32 m0, s74, 40960
    s_add_u32 s71, s69, 262144
    buffer_load_dwordx4 v2, s[64:67], s71 offen lds
    v_mfma_f32_16x16x32_bf16 v[160:163], v[80:83], v[72:75], v[160:163]
    ds_read_b128 v[40:43], v4 offset:4096
    ds_read_b128 v[44:47], v4 offset:6144
    v_mfma_f32_16x16x32_bf16 v[164:167], v[84:87], v[72:75], v[164:167]
    s_add_u32 s68, s68, 128
    s_add_u32 s69, s69, 524288
    s_add_u32 s75, s75, 1
    s_cmp_eq_u32 s75, 3
    s_cselect_b32 s75, 0, s75
    s_cselect_b32 s71, 0xfffdc000, 0
    s_add_u32 s71, s71, 49152
    s_add_u32 s74, s74, s71
    v_mfma_f32_16x16x32_bf16 v[168:171], v[88:91], v[72:75], v[168:171]
    v_mfma_f32_16x16x32_bf16 v[172:175], v[92:95], v[72:75], v[172:175]
    v_mfma_f32_16x16x32_bf16 v[188:191], v[92:95], v[76:79], v[188:191]
    v_mfma_f32_16x16x32_bf16 v[184:187], v[88:91], v[76:79], v[184:187]
    v_mfma_f32_16x16x32_bf16 v[180:183], v[84:87], v[76:79], v[180:183]
    v_mfma_f32_16x16x32_bf16 v[176:179], v[80:83], v[76:79], v[176:179]
    s_branch G1N_K_LOOP
G1N_K_TAIL:
    s_waitcnt vmcnt(0) lgkmcnt(0)
    s_barrier
    v_mfma_f32_16x16x32_bf16 v[128:131], v[80:83], v[64:67], v[128:131]
    ds_read_b128 v[32:35], v4 offset:0
    v_mfma_f32_16x16x32_bf16 v[132:135], v[84:87], v[64:67], v[132:135]
    ds_read_b64_tr_b16 v[48:49], v6 offset:0
    v_mfma_f32_16x16x32_bf16 v[136:139], v[88:91], v[64:67], v[136:139]
    ds_read_b64_tr_b16 v[50:51], v6 offset:1024
    v_mfma_f32_16x16x32_bf16 v[140:143], v[92:95], v[64:67], v[140:143]
    ds_read_b64_tr_b16 v[52:53], v7 offset:0
    v_mfma_f32_16x16x32_bf16 v[156:159], v[92:95], v[68:71], v[156:159]
    ds_read_b64_tr_b16 v[54:55], v7 offset:1024
    v_mfma_f32_16x16x32_bf16 v[152:155], v[88:91], v[68:71], v[152:155]
    ds_read_b64_tr_b16 v[56:57], v8 offset:0
    v_mfma_f32_16x16x32_bf16 v[148:151], v[84:87], v[68:71], v[148:151]
    ds_read_b64_tr_b16 v[58:59], v8 offset:1024
    v_mfma_f32_16x16x32_bf16 v[144:147], v[80:83], v[68:71], v[144:147]
    ds_read_b64_tr_b16 v[60:61], v9 offset:0
    v_mfma_f32_16x16x32_bf16 v[160:163], v[80:83], v[72:75], v[160:163]
    ds_read_b64_tr_b16 v[62:63], v9 offset:1024
    v_mfma_f32_16x16x32_bf16 v[164:167], v[84:87], v[72:75], v[164:167]
    ds_read_b128 v[36:39], v4 offset:2048
    v_mfma_f32_16x16x32_bf16 v[168:171], v[88:91], v[72:75], v[168:171]
    ds_read_b128 v[40:43], v4 offset:4096
    v_mfma_f32_16x16x32_bf16 v[172:175], v[92:95], v[72:75], v[172:175]
    ds_read_b128 v[44:47], v4 offset:6144
    v_mfma_f32_16x16x32_bf16 v[188:191], v[92:95], v[76:79], v[188:191]
    v_mfma_f32_16x16x32_bf16 v[184:187], v[88:91], v[76:79], v[184:187]
    v_mfma_f32_16x16x32_bf16 v[180:183], v[84:87], v[76:79], v[180:183]
    v_mfma_f32_16x16x32_bf16 v[176:179], v[80:83], v[76:79], v[176:179]
    s_cmp_lg_u32 s70, 0
    s_cbranch_scc1 G1N_K_LOOP
    s_waitcnt lgkmcnt(0)
    s_nop 7
    s_mul_i32 s80, s77, 8
    s_mul_i32 s71, s72, 2
    s_add_u32 s80, s80, s71
    s_lshl_b32 s80, s80, 5
    s_mul_i32 s71, s78, 1
    s_add_u32 s80, s80, s71
    s_lshr_b32 s71, s73, 1
    s_add_u32 s80, s80, s71
    s_lshl_b32 s80, s80, 14
    s_and_b32 s71, s73, 1
    s_lshl_b32 s71, s71, 11
    s_add_u32 s80, s80, s71
    s_add_u32 s80, s80, 4194304
    v_lshlrev_b32 v14, 4, v0
    v_cvt_pk_bf16_f32 v32, v128, v129
    v_cvt_pk_bf16_f32 v33, v130, v131
    v_cvt_pk_bf16_f32 v34, v132, v133
    v_cvt_pk_bf16_f32 v35, v134, v135
    buffer_store_dwordx4 v[32:35], v14, s[8:11], s80 offen offset:0 sc1
    v_cvt_pk_bf16_f32 v36, v136, v137
    v_cvt_pk_bf16_f32 v37, v138, v139
    v_cvt_pk_bf16_f32 v38, v140, v141
    v_cvt_pk_bf16_f32 v39, v142, v143
    buffer_store_dwordx4 v[36:39], v14, s[8:11], s80 offen offset:1024 sc1
    s_add_u32 s80, s80, 4096
    v_cvt_pk_bf16_f32 v40, v144, v145
    v_cvt_pk_bf16_f32 v41, v146, v147
    v_cvt_pk_bf16_f32 v42, v148, v149
    v_cvt_pk_bf16_f32 v43, v150, v151
    buffer_store_dwordx4 v[40:43], v14, s[8:11], s80 offen offset:0 sc1
    v_cvt_pk_bf16_f32 v44, v152, v153
    v_cvt_pk_bf16_f32 v45, v154, v155
    v_cvt_pk_bf16_f32 v46, v156, v157
    v_cvt_pk_bf16_f32 v47, v158, v159
    buffer_store_dwordx4 v[44:47], v14, s[8:11], s80 offen offset:1024 sc1
    s_add_u32 s80, s80, 520192
    v_cvt_pk_bf16_f32 v48, v160, v161
    v_cvt_pk_bf16_f32 v49, v162, v163
    v_cvt_pk_bf16_f32 v50, v164, v165
    v_cvt_pk_bf16_f32 v51, v166, v167
    buffer_store_dwordx4 v[48:51], v14, s[8:11], s80 offen offset:0 sc1
    v_cvt_pk_bf16_f32 v52, v168, v169
    v_cvt_pk_bf16_f32 v53, v170, v171
    v_cvt_pk_bf16_f32 v54, v172, v173
    v_cvt_pk_bf16_f32 v55, v174, v175
    buffer_store_dwordx4 v[52:55], v14, s[8:11], s80 offen offset:1024 sc1
    s_add_u32 s80, s80, 4096
    v_cvt_pk_bf16_f32 v56, v176, v177
    v_cvt_pk_bf16_f32 v57, v178, v179
    v_cvt_pk_bf16_f32 v58, v180, v181
    v_cvt_pk_bf16_f32 v59, v182, v183
    buffer_store_dwordx4 v[56:59], v14, s[8:11], s80 offen offset:0 sc1
    v_cvt_pk_bf16_f32 v60, v184, v185
    v_cvt_pk_bf16_f32 v61, v186, v187
    v_cvt_pk_bf16_f32 v62, v188, v189
    v_cvt_pk_bf16_f32 v63, v190, v191
    buffer_store_dwordx4 v[60:63], v14, s[8:11], s80 offen offset:1024 sc1
    s_add_u32 s80, s80, 520192
    s_branch G_DONE
G1N_V:
    s_barrier
    s_add_u32 m0, s74, 0
    s_add_u32 s71, s68, 0
    buffer_load_dwordx4 v1, s[60:63], s71 offen lds
    s_add_u32 m0, s74, 8192
    s_add_u32 s71, s68, 131072
    buffer_load_dwordx4 v1, s[60:63], s71 offen lds
    s_add_u32 m0, s74, 16384
    s_add_u32 s71, s68, 262144
    buffer_load_dwordx4 v1, s[60:63], s71 offen lds
    s_add_u32 m0, s74, 24576
    s_add_u32 s71, s68, 393216
    buffer_load_dwordx4 v1, s[60:63], s71 offen lds
    s_add_u32 m0, s74, 32768
    s_add_u32 s71, s69, 0
    buffer_load_dwordx4 v2, s[64:67], s71 offen lds
    s_add_u32 m0, s74, 40960
    s_add_u32 s71, s69, 262144
    buffer_load_dwordx4 v2, s[64:67], s71 offen lds
    s_add_u32 s68, s68, 128
    s_add_u32 s69, s69, 524288
    s_add_u32 s75, s75, 1
    s_cmp_eq_u32 s75, 3
    s_cselect_b32 s75, 0, s75
    s_cselect_b32 s71, 0xfffdc000, 0
    s_add_u32 s71, s71, 49152
    s_add_u32 s74, s74, s71
    s_add_u32 m0, s74, 0
    s_add_u32 s71, s68, 0
    buffer_load_dwordx4 v1, s[60:63], s71 offen lds
    s_add_u32 m0, s74, 8192
    s_add_u32 s71, s68, 131072
    buffer_load_dwordx4 v1, s[60:63], s71 offen lds
    s_add_u32 m0, s74, 16384
    s_add_u32 s71, s68, 262144
    buffer_load_dwordx4 v1, s[60:63], s71 offen lds
    s_add_u32 m0, s74, 24576
    s_add_u32 s71, s68, 393216
    buffer_load_dwordx4 v1, s[60:63], s71 offen lds
    s_add_u32 m0, s74, 32768
    s_add_u32 s71, s69, 0
    buffer_load_dwordx4 v2, s[64:67], s71 offen lds
    s_add_u32 m0, s74, 40960
    s_add_u32 s71, s69, 262144
    buffer_load_dwordx4 v2, s[64:67], s71 offen lds
    s_add_u32 s68, s68, 128
    s_add_u32 s69, s69, 524288
    s_add_u32 s75, s75, 1
    s_cmp_eq_u32 s75, 3
    s_cselect_b32 s75, 0, s75
    s_cselect_b32 s71, 0xfffdc000, 0
    s_add_u32 s71, s71, 49152
    s_add_u32 s74, s74, s71
    s_add_u32 m0, s74, 0
    s_add_u32 s71, s68, 0
    buffer_load_dwordx4 v1, s[60:63], s71 offen lds
    s_add_u32 m0, s74, 8192
    s_add_u32 s71, s68, 131072
    buffer_load_dwordx4 v1, s[60:63], s71 offen lds
    s_add_u32 m0, s74, 16384
    s_add_u32 s71, s68, 262144
    buffer_load_dwordx4 v1, s[60:63], s71 offen lds
    s_add_u32 m0, s74, 24576
    s_add_u32 s71, s68, 393216
    buffer_load_dwordx4 v1, s[60:63], s71 offen lds
    s_add_u32 m0, s74, 32768
    s_add_u32 s71, s69, 0
    buffer_load_dwordx4 v2, s[64:67], s71 offen lds
    s_add_u32 m0, s74, 40960
    s_add_u32 s71, s69, 262144
    buffer_load_dwordx4 v2, s[64:67], s71 offen lds
    s_add_u32 s68, s68, 128
    s_add_u32 s69, s69, 524288
    s_add_u32 s75, s75, 1
    s_cmp_eq_u32 s75, 3
    s_cselect_b32 s75, 0, s75
    s_cselect_b32 s71, 0xfffdc000, 0
    s_add_u32 s71, s71, 49152
    s_add_u32 s74, s74, s71
    s_mov_b32 s70, 16
    v_mov_b32 v128, 0
    v_mov_b32 v129, 0
    v_mov_b32 v130, 0
    v_mov_b32 v131, 0
    v_mov_b32 v132, 0
    v_mov_b32 v133, 0
    v_mov_b32 v134, 0
    v_mov_b32 v135, 0
    v_mov_b32 v136, 0
    v_mov_b32 v137, 0
    v_mov_b32 v138, 0
    v_mov_b32 v139, 0
    v_mov_b32 v140, 0
    v_mov_b32 v141, 0
    v_mov_b32 v142, 0
    v_mov_b32 v143, 0
    v_mov_b32 v144, 0
    v_mov_b32 v145, 0
    v_mov_b32 v146, 0
    v_mov_b32 v147, 0
    v_mov_b32 v148, 0
    v_mov_b32 v149, 0
    v_mov_b32 v150, 0
    v_mov_b32 v151, 0
    v_mov_b32 v152, 0
    v_mov_b32 v153, 0
    v_mov_b32 v154, 0
    v_mov_b32 v155, 0
    v_mov_b32 v156, 0
    v_mov_b32 v157, 0
    v_mov_b32 v158, 0
    v_mov_b32 v159, 0
    v_mov_b32 v160, 0
    v_mov_b32 v161, 0
    v_mov_b32 v162, 0
    v_mov_b32 v163, 0
    v_mov_b32 v164, 0
    v_mov_b32 v165, 0
    v_mov_b32 v166, 0
    v_mov_b32 v167, 0
    v_mov_b32 v168, 0
    v_mov_b32 v169, 0
    v_mov_b32 v170, 0
    v_mov_b32 v171, 0
    v_mov_b32 v172, 0
    v_mov_b32 v173, 0
    v_mov_b32 v174, 0
    v_mov_b32 v175, 0
    v_mov_b32 v176, 0
    v_mov_b32 v177, 0
    v_mov_b32 v178, 0
    v_mov_b32 v179, 0
    v_mov_b32 v180, 0
    v_mov_b32 v181, 0
    v_mov_b32 v182, 0
    v_mov_b32 v183, 0
    v_mov_b32 v184, 0
    v_mov_b32 v185, 0
    v_mov_b32 v186, 0
    v_mov_b32 v187, 0
    v_mov_b32 v188, 0
    v_mov_b32 v189, 0
    v_mov_b32 v190, 0
    v_mov_b32 v191, 0
    s_waitcnt vmcnt(12)
    s_barrier
    s_cmp_eq_u32 s31, 0
    s_cbranch_scc1 G1N_VF_HS
    s_mov_b64 exec, 1
    s_bfe_u32 s4, s31, 0x7000a
    s_mul_i32 s4, s4, s52
    s_and_b32 s5, s31, 0x3ff
    s_add_u32 s4, s4, s5
    s_lshl_b32 s4, s4, 7
    s_add_u32 s4, s4, 124780544
    s_lshr_b32 s5, s31, 20
    v_mov_b32 v28, s5
    buffer_atomic_add v28, off, s[8:11], s4 sc1
    s_mov_b64 exec, -1
    s_mov_b32 s31, 0
G1N_VF_HS:
    ds_read_b128 v[32:35], v4 offset:0
    ds_read_b64_tr_b16 v[48:49], v6 offset:0
    ds_read_b64_tr_b16 v[50:51], v6 offset:1024
    ds_read_b64_tr_b16 v[52:53], v7 offset:0
    ds_read_b64_tr_b16 v[54:55], v7 offset:1024
    ds_read_b64_tr_b16 v[56:57], v8 offset:0
    ds_read_b64_tr_b16 v[58:59], v8 offset:1024
    ds_read_b64_tr_b16 v[60:61], v9 offset:0
    ds_read_b64_tr_b16 v[62:63], v9 offset:1024
    ds_read_b128 v[36:39], v4 offset:2048
    ds_read_b128 v[40:43], v4 offset:4096
    ds_read_b128 v[44:47], v4 offset:6144
G1N_VF_LOOP:
    s_waitcnt lgkmcnt(0)
    v_mfma_f32_16x16x32_bf16 v[128:131], v[32:35], v[48:51], v[128:131]
    ds_read_b128 v[64:67], v5 offset:0
    ds_read_b64_tr_b16 v[80:81], v6 offset:8192
    v_mfma_f32_16x16x32_bf16 v[132:135], v[32:35], v[52:55], v[132:135]
    ds_read_b64_tr_b16 v[82:83], v6 offset:9216
    ds_read_b64_tr_b16 v[84:85], v7 offset:8192
    v_mfma_f32_16x16x32_bf16 v[136:139], v[32:35], v[56:59], v[136:139]
    ds_read_b64_tr_b16 v[86:87], v7 offset:9216
    ds_read_b64_tr_b16 v[88:89], v8 offset:8192
    v_mfma_f32_16x16x32_bf16 v[140:143], v[32:35], v[60:63], v[140:143]
    ds_read_b64_tr_b16 v[90:91], v8 offset:9216
    ds_read_b64_tr_b16 v[92:93], v9 offset:8192
    v_mfma_f32_16x16x32_bf16 v[156:159], v[36:39], v[60:63], v[156:159]
    ds_read_b64_tr_b16 v[94:95], v9 offset:9216
    ds_read_b128 v[68:71], v5 offset:2048
    v_mfma_f32_16x16x32_bf16 v[152:155], v[36:39], v[56:59], v[152:155]
    ds_read_b128 v[72:75], v5 offset:4096
    ds_read_b128 v[76:79], v5 offset:6144
    v_mfma_f32_16x16x32_bf16 v[148:151], v[36:39], v[52:55], v[148:151]
    s_add_u32 s59, s59, 1
    s_cmp_eq_u32 s59, 3
    s_cselect_b32 s59, 0, s59
    s_cselect_b32 s71, 0xfffdc000, 0
    s_add_u32 s71, s71, 49152
    v_add_u32 v4, s71, v4
    v_mfma_f32_16x16x32_bf16 v[144:147], v[36:39], v[48:51], v[144:147]
    v_add_u32 v5, s71, v5
    v_add_u32 v6, s71, v6
    v_mfma_f32_16x16x32_bf16 v[160:163], v[40:43], v[48:51], v[160:163]
    v_add_u32 v7, s71, v7
    v_add_u32 v8, s71, v8
    v_mfma_f32_16x16x32_bf16 v[164:167], v[40:43], v[52:55], v[164:167]
    v_add_u32 v9, s71, v9
    s_sub_u32 s70, s70, 1
    v_mfma_f32_16x16x32_bf16 v[168:171], v[40:43], v[56:59], v[168:171]
    v_mfma_f32_16x16x32_bf16 v[172:175], v[40:43], v[60:63], v[172:175]
    v_mfma_f32_16x16x32_bf16 v[188:191], v[44:47], v[60:63], v[188:191]
    v_mfma_f32_16x16x32_bf16 v[184:187], v[44:47], v[56:59], v[184:187]
    v_mfma_f32_16x16x32_bf16 v[180:183], v[44:47], v[52:55], v[180:183]
    v_mfma_f32_16x16x32_bf16 v[176:179], v[44:47], v[48:51], v[176:179]
    s_cmp_lt_u32 s70, 3
    s_cbranch_scc1 G1N_VF_TAIL
    s_waitcnt vmcnt(6) lgkmcnt(0)
    s_barrier
    v_mfma_f32_16x16x32_bf16 v[128:131], v[64:67], v[80:83], v[128:131]
    s_add_u32 m0, s74, 0
    s_add_u32 s71, s68, 0
    buffer_load_dwordx4 v1, s[60:63], s71 offen lds
    ds_read_b128 v[32:35], v4 offset:0
    v_mfma_f32_16x16x32_bf16 v[132:135], v[64:67], v[84:87], v[132:135]
    ds_read_b64_tr_b16 v[48:49], v6 offset:0
    s_add_u32 m0, s74, 8192
    s_add_u32 s71, s68, 131072
    buffer_load_dwordx4 v1, s[60:63], s71 offen lds
    v_mfma_f32_16x16x32_bf16 v[136:139], v[64:67], v[88:91], v[136:139]
    ds_read_b64_tr_b16 v[50:51], v6 offset:1024
    ds_read_b64_tr_b16 v[52:53], v7 offset:0
    v_mfma_f32_16x16x32_bf16 v[140:143], v[64:67], v[92:95], v[140:143]
    s_add_u32 m0, s74, 16384
    s_add_u32 s71, s68, 262144
    buffer_load_dwordx4 v1, s[60:63], s71 offen lds
    ds_read_b64_tr_b16 v[54:55], v7 offset:1024
    v_mfma_f32_16x16x32_bf16 v[156:159], v[68:71], v[92:95], v[156:159]
    ds_read_b64_tr_b16 v[56:57], v8 offset:0
    s_add_u32 m0, s74, 24576
    s_add_u32 s71, s68, 393216
    buffer_load_dwordx4 v1, s[60:63], s71 offen lds
    v_mfma_f32_16x16x32_bf16 v[152:155], v[68:71], v[88:91], v[152:155]
    ds_read_b64_tr_b16 v[58:59], v8 offset:1024
    ds_read_b64_tr_b16 v[60:61], v9 offset:0
    v_mfma_f32_16x16x32_bf16 v[148:151], v[68:71], v[84:87], v[148:151]
    s_add_u32 m0, s74, 32768
    s_add_u32 s71, s69, 0
    buffer_load_dwordx4 v2, s[64:67], s71 offen lds
    ds_read_b64_tr_b16 v[62:63], v9 offset:1024
    v_mfma_f32_16x16x32_bf16 v[144:147], v[68:71], v[80:83], v[144:147]
    ds_read_b128 v[36:39], v4 offset:2048
    s_add_u32 m0, s74, 40960
    s_add_u32 s71, s69, 262144
    buffer_load_dwordx4 v2, s[64:67], s71 offen lds
    v_mfma_f32_16x16x32_bf16 v[160:163], v[72:75], v[80:83], v[160:163]
    ds_read_b128 v[40:43], v4 offset:4096
    ds_read_b128 v[44:47], v4 offset:6144
    v_mfma_f32_16x16x32_bf16 v[164:167], v[72:75], v[84:87], v[164:167]
    s_add_u32 s68, s68, 128
    s_add_u32 s69, s69, 524288
    s_add_u32 s75, s75, 1
    s_cmp_eq_u32 s75, 3
    s_cselect_b32 s75, 0, s75
    s_cselect_b32 s71, 0xfffdc000, 0
    s_add_u32 s71, s71, 49152
    s_add_u32 s74, s74, s71
    v_mfma_f32_16x16x32_bf16 v[168:171], v[72:75], v[88:91], v[168:171]
    v_mfma_f32_16x16x32_bf16 v[172:175], v[72:75], v[92:95], v[172:175]
    v_mfma_f32_16x16x32_bf16 v[188:191], v[76:79], v[92:95], v[188:191]
    v_mfma_f32_16x16x32_bf16 v[184:187], v[76:79], v[88:91], v[184:187]
    v_mfma_f32_16x16x32_bf16 v[180:183], v[76:79], v[84:87], v[180:183]
    v_mfma_f32_16x16x32_bf16 v[176:179], v[76:79], v[80:83], v[176:179]
    s_branch G1N_VF_LOOP
G1N_VF_TAIL:
    s_waitcnt vmcnt(0) lgkmcnt(0)
    s_barrier
    v_mfma_f32_16x16x32_bf16 v[128:131], v[64:67], v[80:83], v[128:131]
    ds_read_b128 v[32:35], v4 offset:0
    v_mfma_f32_16x16x32_bf16 v[132:135], v[64:67], v[84:87], v[132:135]
    ds_read_b64_tr_b16 v[48:49], v6 offset:0
    v_mfma_f32_16x16x32_bf16 v[136:139], v[64:67], v[88:91], v[136:139]
    ds_read_b64_tr_b16 v[50:51], v6 offset:1024
    v_mfma_f32_16x16x32_bf16 v[140:143], v[64:67], v[92:95], v[140:143]
    ds_read_b64_tr_b16 v[52:53], v7 offset:0
    v_mfma_f32_16x16x32_bf16 v[156:159], v[68:71], v[92:95], v[156:159]
    ds_read_b64_tr_b16 v[54:55], v7 offset:1024
    v_mfma_f32_16x16x32_bf16 v[152:155], v[68:71], v[88:91], v[152:155]
    ds_read_b64_tr_b16 v[56:57], v8 offset:0
    v_mfma_f32_16x16x32_bf16 v[148:151], v[68:71], v[84:87], v[148:151]
    ds_read_b64_tr_b16 v[58:59], v8 offset:1024
    v_mfma_f32_16x16x32_bf16 v[144:147], v[68:71], v[80:83], v[144:147]
    ds_read_b64_tr_b16 v[60:61], v9 offset:0
    v_mfma_f32_16x16x32_bf16 v[160:163], v[72:75], v[80:83], v[160:163]
    ds_read_b64_tr_b16 v[62:63], v9 offset:1024
    v_mfma_f32_16x16x32_bf16 v[164:167], v[72:75], v[84:87], v[164:167]
    ds_read_b128 v[36:39], v4 offset:2048
    v_mfma_f32_16x16x32_bf16 v[168:171], v[72:75], v[88:91], v[168:171]
    ds_read_b128 v[40:43], v4 offset:4096
    v_mfma_f32_16x16x32_bf16 v[172:175], v[72:75], v[92:95], v[172:175]
    ds_read_b128 v[44:47], v4 offset:6144
    v_mfma_f32_16x16x32_bf16 v[188:191], v[76:79], v[92:95], v[188:191]
    v_mfma_f32_16x16x32_bf16 v[184:187], v[76:79], v[88:91], v[184:187]
    v_mfma_f32_16x16x32_bf16 v[180:183], v[76:79], v[84:87], v[180:183]
    v_mfma_f32_16x16x32_bf16 v[176:179], v[76:79], v[80:83], v[176:179]
    s_cmp_lg_u32 s70, 0
    s_cbranch_scc1 G1N_VF_LOOP
    s_waitcnt lgkmcnt(0)
    s_nop 7
    s_mul_i32 s80, s77, 8
    s_mul_i32 s71, s72, 2
    s_add_u32 s80, s80, s71
    s_lshl_b32 s80, s80, 5
    s_mul_i32 s71, s78, 1
    s_add_u32 s80, s80, s71
    s_lshr_b32 s71, s73, 1
    s_add_u32 s80, s80, s71
    s_lshl_b32 s80, s80, 14
    s_and_b32 s71, s73, 1
    s_lshl_b32 s71, s71, 12
    s_add_u32 s80, s80, s71
    s_add_u32 s80, s80, 4202496
    v_bfe_u32 v14, v0, 1, 3
    v_lshlrev_b32 v14, 4, v14
    v_and_b32 v15, 1, v0
    v_lshl_add_u32 v14, v15, 10, v14
    v_lshrrev_b32 v15, 4, v0
    v_lshl_add_u32 v14, v15, 8, v14
    v_cvt_pk_bf16_f32 v32, v128, v129
    v_cvt_pk_bf16_f32 v33, v130, v131
    v_cvt_pk_bf16_f32 v34, v144, v145
    v_cvt_pk_bf16_f32 v35, v146, v147
    buffer_store_dwordx4 v[32:35], v14, s[8:11], s80 offen offset:0 sc1
    v_cvt_pk_bf16_f32 v36, v132, v133
    v_cvt_pk_bf16_f32 v37, v134, v135
    v_cvt_pk_bf16_f32 v38, v148, v149
    v_cvt_pk_bf16_f32 v39, v150, v151
    buffer_store_dwordx4 v[36:39], v14, s[8:11], s80 offen offset:128 sc1
    v_cvt_pk_bf16_f32 v40, v136, v137
    v_cvt_pk_bf16_f32 v41, v138, v139
    v_cvt_pk_bf16_f32 v42, v152, v153
    v_cvt_pk_bf16_f32 v43, v154, v155
    buffer_store_dwordx4 v[40:43], v14, s[8:11], s80 offen offset:2048 sc1
    v_cvt_pk_bf16_f32 v44, v140, v141
    v_cvt_pk_bf16_f32 v45, v142, v143
    v_cvt_pk_bf16_f32 v46, v156, v157
    v_cvt_pk_bf16_f32 v47, v158, v159
    buffer_store_dwordx4 v[44:47], v14, s[8:11], s80 offen offset:2176 sc1
    s_add_u32 s80, s80, 524288
    v_cvt_pk_bf16_f32 v48, v160, v161
    v_cvt_pk_bf16_f32 v49, v162, v163
    v_cvt_pk_bf16_f32 v50, v176, v177
    v_cvt_pk_bf16_f32 v51, v178, v179
    buffer_store_dwordx4 v[48:51], v14, s[8:11], s80 offen offset:0 sc1
    v_cvt_pk_bf16_f32 v52, v164, v165
    v_cvt_pk_bf16_f32 v53, v166, v167
    v_cvt_pk_bf16_f32 v54, v180, v181
    v_cvt_pk_bf16_f32 v55, v182, v183
    buffer_store_dwordx4 v[52:55], v14, s[8:11], s80 offen offset:128 sc1
    v_cvt_pk_bf16_f32 v56, v168, v169
    v_cvt_pk_bf16_f32 v57, v170, v171
    v_cvt_pk_bf16_f32 v58, v184, v185
    v_cvt_pk_bf16_f32 v59, v186, v187
    buffer_store_dwordx4 v[56:59], v14, s[8:11], s80 offen offset:2048 sc1
    v_cvt_pk_bf16_f32 v60, v172, v173
    v_cvt_pk_bf16_f32 v61, v174, v175
    v_cvt_pk_bf16_f32 v62, v188, v189
    v_cvt_pk_bf16_f32 v63, v190, v191
    buffer_store_dwordx4 v[60:63], v14, s[8:11], s80 offen offset:2176 sc1
    s_add_u32 s80, s80, 524288
    s_branch G_DONE
H_G1S:
    s_lshl_b32 s4, s52, 3
    s_add_u32 s78, s78, s4
    s_load_dwordx2 s[4:5], s[0:1], 0
    s_cmp_eq_u32 s79, 0
    s_cselect_b32 s71, 24, 32
    s_cmp_eq_u32 s79, 2
    s_cselect_b32 s71, 16, s71
    s_load_dwordx2 s[6:7], s[0:1], s71
    s_mul_i32 s68, s77, 262144
    s_mul_i32 s69, s78, 256
    s_waitcnt lgkmcnt(0)
    s_mov_b32 s60, s4
    s_and_b32 s61, s5, 0xffff
    s_mov_b32 s62, 4194304
    s_mov_b32 s63, 0x20000
    s_mov_b32 s64, s6
    s_and_b32 s65, s7, 0xffff
    s_mov_b32 s66, 8388608
    s_mov_b32 s67, 0x20000
    s_lshr_b32 s72, s76, 1
    s_and_b32 s73, s76, 1
    v_lshrrev_b32 v14, 3, v0
    s_lshl_b32 s71, s76, 3
    v_add_u32 v14, s71, v14
    v_lshrrev_b32 v15, 1, v14
    v_xor_b32 v15, v15, v0
    v_and_b32 v15, 7, v15
    s_mov_b32 s71, 2048
    v_mul_lo_u32 v1, v14, s71
    v_lshl_add_u32 v1, v15, 4, v1
    v_and_b32 v14, 15, v0
    v_lshrrev_b32 v15, 1, v14
    v_lshrrev_b32 v16, 4, v0
    v_xor_b32 v15, v15, v16
    v_lshlrev_b32 v15, 4, v15
    v_lshl_add_u32 v14, v14, 7, v15
    s_mul_i32 s71, s72, 4096
    v_add_u32 v4, s71, v14
    v_xor_b32 v5, 64, v4
    v_lshrrev_b32 v14, 4, v0
    s_mul_i32 s71, s76, 4
    v_add_u32 v14, s71, v14
    v_and_b32 v15, 3, v14
    v_lshlrev_b32 v15, 1, v15
    v_and_b32 v16, 8, v14
    v_or_b32 v15, v15, v16
    v_and_b32 v16, 15, v0
    v_xor_b32 v15, v15, v16
    s_mov_b32 s71, 8192
    v_mul_lo_u32 v2, v14, s71
    v_lshl_add_u32 v2, v15, 4, v2
    v_bfe_u32 v14, v0, 2, 2
    v_lshrrev_b32 v15, 4, v0
    v_lshl_add_u32 v15, v15, 3, v14
    v_mul_u32_u24 v15, 256, v15
    v_and_b32 v16, 3, v0
    v_lshl_add_u32 v15, v16, 3, v15
    v_add_u32 v15, 16384, v15
    v_bfe_u32 v14, v0, 2, 3
    s_mul_i32 s71, s73, 4
    v_xor_b32 v14, s71, v14
    v_lshl_add_u32 v6, v14, 5, v15
    v_xor_b32 v7, 32, v6
    v_xor_b32 v8, 64, v6
    v_xor_b32 v9, 96, v6
    s_lshl_b32 s74, s76, 10
    s_mov_b32 s75, 0
    s_mov_b32 s59, 0
    s_cmp_eq_u32 s79, 1
    s_cbranch_scc1 G1S_V
    s_barrier
    s_add_u32 m0, s74, 0
    s_add_u32 s71, s68, 0
    buffer_load_dwordx4 v1, s[60:63], s71 offen lds
    s_add_u32 m0, s74, 8192
    s_add_u32 s71, s68, 131072
    buffer_load_dwordx4 v1, s[60:63], s71 offen lds
    s_add_u32 m0, s74, 16384
    s_add_u32 s71, s69, 0
    buffer_load_dwordx4 v2, s[64:67], s71 offen lds
    s_add_u32 m0, s74, 24576
    s_add_u32 s71, s69, 262144
    buffer_load_dwordx4 v2, s[64:67], s71 offen lds
    s_add_u32 s68, s68, 128
    s_add_u32 s69, s69, 524288
    s_add_u32 s75, s75, 1
    s_cmp_eq_u32 s75, 4
    s_cselect_b32 s75, 0, s75
    s_cselect_b32 s71, 0xfffe0000, 0
    s_add_u32 s71, s71, 32768
    s_add_u32 s74, s74, s71
    s_add_u32 m0, s74, 0
    s_add_u32 s71, s68, 0
    buffer_load_dwordx4 v1, s[60:63], s71 offen lds
    s_add_u32 m0, s74, 8192
    s_add_u32 s71, s68, 131072
    buffer_load_dwordx4 v1, s[60:63], s71 offen lds
    s_add_u32 m0, s74, 16384
    s_add_u32 s71, s69, 0
    buffer_load_dwordx4 v2, s[64:67], s71 offen lds
    s_add_u32 m0, s74, 24576
    s_add_u32 s71, s69, 262144
    buffer_load_dwordx4 v2, s[64:67], s71 offen lds
    s_add_u32 s68, s68, 128
    s_add_u32 s69, s69, 524288
    s_add_u32 s75, s75, 1
    s_cmp_eq_u32 s75, 4
    s_cselect_b32 s75, 0, s75
    s_cselect_b32 s71, 0xfffe0000, 0
    s_add_u32 s71, s71, 32768
    s_add_u32 s74, s74, s71
    s_add_u32 m0, s74, 0
    s_add_u32 s71, s68, 0
    buffer_load_dwordx4 v1, s[60:63], s71 offen lds
    s_add_u32 m0, s74, 8192
    s_add_u32 s71, s68, 131072
    buffer_load_dwordx4 v1, s[60:63], s71 offen lds
    s_add_u32 m0, s74, 16384
    s_add_u32 s71, s69, 0
    buffer_load_dwordx4 v2, s[64:67], s71 offen lds
    s_add_u32 m0, s74, 24576
    s_add_u32 s71, s69, 262144
    buffer_load_dwordx4 v2, s[64:67], s71 offen lds
    s_add_u32 s68, s68, 128
    s_add_u32 s69, s69, 524288
    s_add_u32 s75, s75, 1
    s_cmp_eq_u32 s75, 4
    s_cselect_b32 s75, 0, s75
    s_cselect_b32 s71, 0xfffe0000, 0
    s_add_u32 s71, s71, 32768
    s_add_u32 s74, s74, s71
    s_add_u32 m0, s74, 0
    s_add_u32 s71, s68, 0
    buffer_load_dwordx4 v1, s[60:63], s71 offen lds
    s_add_u32 m0, s74, 8192
    s_add_u32 s71, s68, 131072
    buffer_load_dwordx4 v1, s[60:63], s71 offen lds
    s_add_u32 m0, s74, 16384
    s_add_u32 s71, s69, 0
    buffer_load_dwordx4 v2, s[64:67], s71 offen lds
    s_add_u32 m0, s74, 24576
    s_add_u32 s71, s69, 262144
    buffer_load_dwordx4 v2, s[64:67], s71 offen lds
    s_add_u32 s68, s68, 128
    s_add_u32 s69, s69, 524288
    s_add_u32 s75, s75, 1
    s_cmp_eq_u32 s75, 4
    s_cselect_b32 s75, 0, s75
    s_cselect_b32 s71, 0xfffe0000, 0
    s_add_u32 s71, s71, 32768
    s_add_u32 s74, s74, s71
    s_mov_b32 s70, 16
    v_mov_b32 v128, 0
    v_mov_b32 v129, 0
    v_mov_b32 v130, 0
    v_mov_b32 v131, 0
    v_mov_b32 v132, 0
    v_mov_b32 v133, 0
    v_mov_b32 v134, 0
    v_mov_b32 v135, 0
    v_mov_b32 v136, 0
    v_mov_b32 v137, 0
    v_mov_b32 v138, 0
    v_mov_b32 v139, 0
    v_mov_b32 v140, 0
    v_mov_b32 v141, 0
    v_mov_b32 v142, 0
    v_mov_b32 v143, 0
    v_mov_b32 v144, 0
    v_mov_b32 v145, 0
    v_mov_b32 v146, 0
    v_mov_b32 v147, 0
    v_mov_b32 v148, 0
    v_mov_b32 v149, 0
    v_mov_b32 v150, 0
    v_mov_b32 v151, 0
    v_mov_b32 v152, 0
    v_mov_b32 v153, 0
    v_mov_b32 v154, 0
    v_mov_b32 v155, 0
    v_mov_b32 v156, 0
    v_mov_b32 v157, 0
    v_mov_b32 v158, 0
    v_mov_b32 v159, 0
    s_waitcnt vmcnt(12)
    s_barrier
    s_cmp_lg_u32 s76, 0
    s_cbranch_scc1 G1S_K_H0
    buffer_load_dwordx2 v[20:21], off, s[16:19], 0 offset:72 sc1
G1S_K_H0:
    s_cmp_eq_u32 s31, 0
    s_cbranch_scc1 G1S_K_HS
    s_mov_b64 exec, 1
    s_bfe_u32 s4, s31, 0x7000a
    s_mul_i32 s4, s4, s52
    s_and_b32 s5, s31, 0x3ff
    s_add_u32 s4, s4, s5
    s_lshl_b32 s4, s4, 7
    s_add_u32 s4, s4, 124780544
    s_lshr_b32 s5, s31, 20
    v_mov_b32 v28, s5
    buffer_atomic_add v28, off, s[8:11], s4 sc1
    s_mov_b64 exec, -1
    s_mov_b32 s31, 0
G1S_K_HS:
    ds_read_b128 v[32:35], v4 offset:0
    ds_read_b64_tr_b16 v[40:41], v6 offset:0
    ds_read_b64_tr_b16 v[42:43], v6 offset:1024
    ds_read_b64_tr_b16 v[44:45], v7 offset:0
    ds_read_b64_tr_b16 v[46:47], v7 offset:1024
    ds_read_b64_tr_b16 v[48:49], v8 offset:0
    ds_read_b64_tr_b16 v[50:51], v8 offset:1024
    ds_read_b64_tr_b16 v[52:53], v9 offset:0
    ds_read_b64_tr_b16 v[54:55], v9 offset:1024
    ds_read_b128 v[36:39], v4 offset:2048
G1S_K_LOOP:
    s_waitcnt lgkmcnt(0)
    v_mfma_f32_16x16x32_bf16 v[128:131], v[40:43], v[32:35], v[128:131]
    ds_read_b128 v[56:59], v5 offset:0
    ds_read_b64_tr_b16 v[64:65], v6 offset:8192
    ds_read_b64_tr_b16 v[66:67], v6 offset:9216
    v_mfma_f32_16x16x32_bf16 v[132:135], v[44:47], v[32:35], v[132:135]
    ds_read_b64_tr_b16 v[68:69], v7 offset:8192
    ds_read_b64_tr_b16 v[70:71], v7 offset:9216
    ds_read_b64_tr_b16 v[72:73], v8 offset:8192
    v_mfma_f32_16x16x32_bf16 v[136:139], v[48:51], v[32:35], v[136:139]
    ds_read_b64_tr_b16 v[74:75], v8 offset:9216
    ds_read_b64_tr_b16 v[76:77], v9 offset:8192
    ds_read_b64_tr_b16 v[78:79], v9 offset:9216
    v_mfma_f32_16x16x32_bf16 v[140:143], v[52:55], v[32:35], v[140:143]
    ds_read_b128 v[60:63], v5 offset:2048
    s_add_u32 s59, s59, 1
    s_cmp_eq_u32 s59, 4
    s_cselect_b32 s59, 0, s59
    s_cselect_b32 s71, 0xfffe0000, 0
    s_add_u32 s71, s71, 32768
    v_add_u32 v4, s71, v4
    v_mfma_f32_16x16x32_bf16 v[156:159], v[52:55], v[36:39], v[156:159]
    v_add_u32 v5, s71, v5
    v_add_u32 v6, s71, v6
    v_add_u32 v7, s71, v7
    v_mfma_f32_16x16x32_bf16 v[152:155], v[48:51], v[36:39], v[152:155]
    v_add_u32 v8, s71, v8
    v_add_u32 v9, s71, v9
    s_sub_u32 s70, s70, 1
    v_mfma_f32_16x16x32_bf16 v[148:151], v[44:47], v[36:39], v[148:151]
    v_mfma_f32_16x16x32_bf16 v[144:147], v[40:43], v[36:39], v[144:147]
    s_cmp_lt_u32 s70, 4
    s_cbranch_scc1 G1S_K_TAIL
    s_waitcnt vmcnt(8) lgkmcnt(0)
    s_barrier
    v_mfma_f32_16x16x32_bf16 v[128:131], v[64:67], v[56:59], v[128:131]
    s_add_u32 m0, s74, 0
    s_add_u32 s71, s68, 0
    buffer_load_dwordx4 v1, s[60:63], s71 offen lds
    ds_read_b128 v[32:35], v4 offset:0
    v_mfma_f32_16x16x32_bf16 v[132:135], v[68:71], v[56:59], v[132:135]
    ds_read_b64_tr_b16 v[40:41], v6 offset:0
    s_add_u32 m0, s74, 8192
    s_add_u32 s71, s68, 131072
    buffer_load_dwordx4 v1, s[60:63], s71 offen lds
    v_mfma_f32_16x16x32_bf16 v[136:139], v[72:75], v[56:59], v[136:139]
    ds_read_b64_tr_b16 v[42:43], v6 offset:1024
    ds_read_b64_tr_b16 v[44:45], v7 offset:0
    v_mfma_f32_16x16x32_bf16 v[140:143], v[76:79], v[56:59], v[140:143]
    s_add_u32 m0, s74, 16384
    s_add_u32 s71, s69, 0
    buffer_load_dwordx4 v2, s[64:67], s71 offen lds
    ds_read_b64_tr_b16 v[46:47], v7 offset:1024
    v_mfma_f32_16x16x32_bf16 v[156:159], v[76:79], v[60:63], v[156:159]
    ds_read_b64_tr_b16 v[48:49], v8 offset:0
    s_add_u32 m0, s74, 24576
    s_add_u32 s71, s69, 262144
    buffer_load_dwordx4 v2, s[64:67], s71 offen lds
    v_mfma_f32_16x16x32_bf16 v[152:155], v[72:75], v[60:63], v[152:155]
    ds_read_b64_tr_b16 v[50:51], v8 offset:1024
    ds_read_b64_tr_b16 v[52:53], v9 offset:0
    v_mfma_f32_16x16x32_bf16 v[148:151], v[68:71], v[60:63], v[148:151]
    ds_read_b64_tr_b16 v[54:55], v9 offset:1024
    ds_read_b128 v[36:39], v4 offset:2048
    v_mfma_f32_16x16x32_bf16 v[144:147], v[64:67], v[60:63], v[144:147]
    s_add_u32 s68, s68, 128
    s_add_u32 s69, s69, 524288
    s_add_u32 s75, s75, 1
    s_cmp_eq_u32 s75, 4
    s_cselect_b32 s75, 0, s75
    s_cselect_b32 s71, 0xfffe0000, 0
    s_add_u32 s71, s71, 32768
    s_add_u32 s74, s74, s71
    s_branch G1S_K_LOOP
G1S_K_TAIL:
    s_waitcnt vmcnt(0) lgkmcnt(0)
    s_barrier
    v_mfma_f32_16x16x32_bf16 v[128:131], v[64:67], v[56:59], v[128:131]
    ds_read_b128 v[32:35], v4 offset:0
    ds_read_b64_tr_b16 v[40:41], v6 offset:0
    v_mfma_f32_16x16x32_bf16 v[132:135], v[68:71], v[56:59], v[132:135]
    ds_read_b64_tr_b16 v[42:43], v6 offset:1024
    ds_read_b64_tr_b16 v[44:45], v7 offset:0
    v_mfma_f32_16x16x32_bf16 v[136:139], v[72:75], v[56:59], v[136:139]
    ds_read_b64_tr_b16 v[46:47], v7 offset:1024
    ds_read_b64_tr_b16 v[48:49], v8 offset:0
    v_mfma_f32_16x16x32_bf16 v[140:143], v[76:79], v[56:59], v[140:143]
    ds_read_b64_tr_b16 v[50:51], v8 offset:1024
    ds_read_b64_tr_b16 v[52:53], v9 offset:0
    v_mfma_f32_16x16x32_bf16 v[156:159], v[76:79], v[60:63], v[156:159]
    ds_read_b64_tr_b16 v[54:55], v9 offset:1024
    ds_read_b128 v[36:39], v4 offset:2048
    v_mfma_f32_16x16x32_bf16 v[152:155], v[72:75], v[60:63], v[152:155]
    v_mfma_f32_16x16x32_bf16 v[148:151], v[68:71], v[60:63], v[148:151]
    v_mfma_f32_16x16x32_bf16 v[144:147], v[64:67], v[60:63], v[144:147]
    s_cmp_lg_u32 s70, 0
    s_cbranch_scc1 G1S_K_LOOP
    s_waitcnt lgkmcnt(0)
    s_nop 7
    s_cmp_lg_u32 s76, 0
    s_cbranch_scc1 G_LS1_B
    s_branch G_LS1_C
G_LS1:
    buffer_load_dwordx2 v[20:21], off, s[16:19], 0 offset:72 sc1
    s_sub_u32 s30, s30, 1
    s_cbranch_scc1 K_FAIL
    s_waitcnt vmcnt(0)
G_LS1_C:
    v_lshrrev_b32 v21, 4, v21
    v_min_u32 v21, v20, v21
    v_cmp_eq_u32 vcc, 0, v21
    s_cbranch_vccnz G_LS1
    v_mov_b32 v21, 147456
    ds_write_b32 v21, v20 offset:4
    s_waitcnt lgkmcnt(0)
G_LS1_B:
    s_barrier
    v_mov_b32 v21, 147456
    ds_read_b32 v20, v21 offset:4
    s_waitcnt lgkmcnt(0)
    v_readfirstlane_b32 s4, v20
    s_nop 3
    s_and_b32 s4, s4, 2097152
    s_add_u32 s8, s44, s4
    s_addc_u32 s9, s45, 0
    s_and_b32 s9, s9, 0xffff
    s_mul_i32 s80, s77, 4
    s_mul_i32 s71, s72, 1
    s_add_u32 s80, s80, s71
    s_lshl_b32 s80, s80, 5
    s_mul_i32 s71, s78, 1
    s_add_u32 s80, s80, s71
    s_lshr_b32 s71, s73, 1
    s_add_u32 s80, s80, s71
    s_lshl_b32 s80, s80, 14
    s_and_b32 s71, s73, 1
    s_lshl_b32 s71, s71, 11
    s_add_u32 s80, s80, s71
    s_add_u32 s80, s80, 4194304
    v_lshlrev_b32 v14, 4, v0
    v_cvt_pk_bf16_f32 v32, v128, v129
    v_cvt_pk_bf16_f32 v33, v130, v131
    v_cvt_pk_bf16_f32 v34, v132, v133
    v_cvt_pk_bf16_f32 v35, v134, v135
    buffer_store_dwordx4 v[32:35], v14, s[8:11], s80 offen offset:0 sc1
    v_cvt_pk_bf16_f32 v36, v136, v137
    v_cvt_pk_bf16_f32 v37, v138, v139
    v_cvt_pk_bf16_f32 v38, v140, v141
    v_cvt_pk_bf16_f32 v39, v142, v143
    buffer_store_dwordx4 v[36:39], v14, s[8:11], s80 offen offset:1024 sc1
    s_add_u32 s80, s80, 4096
    v_cvt_pk_bf16_f32 v40, v144, v145
    v_cvt_pk_bf16_f32 v41, v146, v147
    v_cvt_pk_bf16_f32 v42, v148, v149
    v_cvt_pk_bf16_f32 v43, v150, v151
    buffer_store_dwordx4 v[40:43], v14, s[8:11], s80 offen offset:0 sc1
    v_cvt_pk_bf16_f32 v44, v152, v153
    v_cvt_pk_bf16_f32 v45, v154, v155
    v_cvt_pk_bf16_f32 v46, v156, v157
    v_cvt_pk_bf16_f32 v47, v158, v159
    buffer_store_dwordx4 v[44:47], v14, s[8:11], s80 offen offset:1024 sc1
    s_add_u32 s80, s80, 520192
    s_branch G_DONE
G1S_V:
    s_barrier
    s_add_u32 m0, s74, 0
    s_add_u32 s71, s68, 0
    buffer_load_dwordx4 v1, s[60:63], s71 offen lds
    s_add_u32 m0, s74, 8192
    s_add_u32 s71, s68, 131072
    buffer_load_dwordx4 v1, s[60:63], s71 offen lds
    s_add_u32 m0, s74, 16384
    s_add_u32 s71, s69, 0
    buffer_load_dwordx4 v2, s[64:67], s71 offen lds
    s_add_u32 m0, s74, 24576
    s_add_u32 s71, s69, 262144
    buffer_load_dwordx4 v2, s[64:67], s71 offen lds
    s_add_u32 s68, s68, 128
    s_add_u32 s69, s69, 524288
    s_add_u32 s75, s75, 1
    s_cmp_eq_u32 s75, 4
    s_cselect_b32 s75, 0, s75
    s_cselect_b32 s71, 0xfffe0000, 0
    s_add_u32 s71, s71, 32768
    s_add_u32 s74, s74, s71
    s_add_u32 m0, s74, 0
    s_add_u32 s71, s68, 0
    buffer_load_dwordx4 v1, s[60:63], s71 offen lds
    s_add_u32 m0, s74, 8192
    s_add_u32 s71, s68, 131072
    buffer_load_dwordx4 v1, s[60:63], s71 offen lds
    s_add_u32 m0, s74, 16384
    s_add_u32 s71, s69, 0
    buffer_load_dwordx4 v2, s[64:67], s71 offen lds
    s_add_u32 m0, s74, 24576
    s_add_u32 s71, s69, 262144
    buffer_load_dwordx4 v2, s[64:67], s71 offen lds
    s_add_u32 s68, s68, 128
    s_add_u32 s69, s69, 524288
    s_add_u32 s75, s75, 1
    s_cmp_eq_u32 s75, 4
    s_cselect_b32 s75, 0, s75
    s_cselect_b32 s71, 0xfffe0000, 0
    s_add_u32 s71, s71, 32768
    s_add_u32 s74, s74, s71
    s_add_u32 m0, s74, 0
    s_add_u32 s71, s68, 0
    buffer_load_dwordx4 v1, s[60:63], s71 offen lds
    s_add_u32 m0, s74, 8192
    s_add_u32 s71, s68, 131072
    buffer_load_dwordx4 v1, s[60:63], s71 offen lds
    s_add_u32 m0, s74, 16384
    s_add_u32 s71, s69, 0
    buffer_load_dwordx4 v2, s[64:67], s71 offen lds
    s_add_u32 m0, s74, 24576
    s_add_u32 s71, s69, 262144
    buffer_load_dwordx4 v2, s[64:67], s71 offen lds
    s_add_u32 s68, s68, 128
    s_add_u32 s69, s69, 524288
    s_add_u32 s75, s75, 1
    s_cmp_eq_u32 s75, 4
    s_cselect_b32 s75, 0, s75
    s_cselect_b32 s71, 0xfffe0000, 0
    s_add_u32 s71, s71, 32768
    s_add_u32 s74, s74, s71
    s_add_u32 m0, s74, 0
    s_add_u32 s71, s68, 0
    buffer_load_dwordx4 v1, s[60:63], s71 offen lds
    s_add_u32 m0, s74, 8192
    s_add_u32 s71, s68, 131072
    buffer_load_dwordx4 v1, s[60:63], s71 offen lds
    s_add_u32 m0, s74, 16384
    s_add_u32 s71, s69, 0
    buffer_load_dwordx4 v2, s[64:67], s71 offen lds
    s_add_u32 m0, s74, 24576
    s_add_u32 s71, s69, 262144
    buffer_load_dwordx4 v2, s[64:67], s71 offen lds
    s_add_u32 s68, s68, 128
    s_add_u32 s69, s69, 524288
    s_add_u32 s75, s75, 1
    s_cmp_eq_u32 s75, 4
    s_cselect_b32 s75, 0, s75
    s_cselect_b32 s71, 0xfffe0000, 0
    s_add_u32 s71, s71, 32768
    s_add_u32 s74, s74, s71
    s_mov_b32 s70, 16
    v_mov_b32 v128, 0
    v_mov_b32 v129, 0
    v_mov_b32 v130, 0
    v_mov_b32 v131, 0
    v_mov_b32 v132, 0
    v_mov_b32 v133, 0
    v_mov_b32 v134, 0
    v_mov_b32 v135, 0
    v_mov_b32 v136, 0
    v_mov_b32 v137, 0
    v_mov_b32 v138, 0
    v_mov_b32 v139, 0
    v_mov_b32 v140, 0
    v_mov_b32 v141, 0
    v_mov_b32 v142, 0
    v_mov_b32 v143, 0
    v_mov_b32 v144, 0
    v_mov_b32 v145, 0
    v_mov_b32 v146, 0
    v_mov_b32 v147, 0
    v_mov_b32 v148, 0
    v_mov_b32 v149, 0
    v_mov_b32 v150, 0
    v_mov_b32 v151, 0
    v_mov_b32 v152, 0
    v_mov_b32 v153, 0
    v_mov_b32 v154, 0
    v_mov_b32 v155, 0
    v_mov_b32 v156, 0
    v_mov_b32 v157, 0
    v_mov_b32 v158, 0
    v_mov_b32 v159, 0
    s_waitcnt vmcnt(12)
    s_barrier
    s_cmp_lg_u32 s76, 0
    s_cbranch_scc1 G1S_VF_H0
    buffer_load_dwordx2 v[20:21], off, s[16:19], 0 offset:72 sc1
G1S_VF_H0:
    s_cmp_eq_u32 s31, 0
    s_cbranch_scc1 G1S_VF_HS
    s_mov_b64 exec, 1
    s_bfe_u32 s4, s31, 0x7000a
    s_mul_i32 s4, s4, s52
    s_and_b32 s5, s31, 0x3ff
    s_add_u32 s4, s4, s5
    s_lshl_b32 s4, s4, 7
    s_add_u32 s4, s4, 124780544
    s_lshr_b32 s5, s31, 20
    v_mov_b32 v28, s5
    buffer_atomic_add v28, off, s[8:11], s4 sc1
    s_mov_b64 exec, -1
    s_mov_b32 s31, 0
G1S_VF_HS:
    ds_read_b128 v[32:35], v4 offset:0
    ds_read_b64_tr_b16 v[40:41], v6 offset:0
    ds_read_b64_tr_b16 v[42:43], v6 offset:1024
    ds_read_b64_tr_b16 v[44:45], v7 offset:0
    ds_read_b64_tr_b16 v[46:47], v7 offset:1024
    ds_read_b64_tr_b16 v[48:49], v8 offset:0
    ds_read_b64_tr_b16 v[50:51], v8 offset:1024
    ds_read_b64_tr_b16 v[52:53], v9 offset:0
    ds_read_b64_tr_b16 v[54:55], v9 offset:1024
    ds_read_b128 v[36:39], v4 offset:2048
G1S_VF_LOOP:
    s_waitcnt lgkmcnt(0)
    v_mfma_f32_16x16x32_bf16 v[128:131], v[32:35], v[40:43], v[128:131]
    ds_read_b128 v[56:59], v5 offset:0
    ds_read_b64_tr_b16 v[64:65], v6 offset:8192
    ds_read_b64_tr_b16 v[66:67], v6 offset:9216
    v_mfma_f32_16x16x32_bf16 v[132:135], v[32:35], v[44:47], v[132:135]
    ds_read_b64_tr_b16 v[68:69], v7 offset:8192
    ds_read_b64_tr_b16 v[70:71], v7 offset:9216
    ds_read_b64_tr_b16 v[72:73], v8 offset:8192
    v_mfma_f32_16x16x32_bf16 v[136:139], v[32:35], v[48:51], v[136:139]
    ds_read_b64_tr_b16 v[74:75], v8 offset:9216
    ds_read_b64_tr_b16 v[76:77], v9 offset:8192
    ds_read_b64_tr_b16 v[78:79], v9 offset:9216
    v_mfma_f32_16x16x32_bf16 v[140:143], v[32:35], v[52:55], v[140:143]
    ds_read_b128 v[60:63], v5 offset:2048
    s_add_u32 s59, s59, 1
    s_cmp_eq_u32 s59, 4
    s_cselect_b32 s59, 0, s59
    s_cselect_b32 s71, 0xfffe0000, 0
    s_add_u32 s71, s71, 32768
    v_add_u32 v4, s71, v4
    v_mfma_f32_16x16x32_bf16 v[156:159], v[36:39], v[52:55], v[156:159]
    v_add_u32 v5, s71, v5
    v_add_u32 v6, s71, v6
    v_add_u32 v7, s71, v7
    v_mfma_f32_16x16x32_bf16 v[152:155], v[36:39], v[48:51], v[152:155]
    v_add_u32 v8, s71, v8
    v_add_u32 v9, s71, v9
    s_sub_u32 s70, s70, 1
    v_mfma_f32_16x16x32_bf16 v[148:151], v[36:39], v[44:47], v[148:151]
    v_mfma_f32_16x16x32_bf16 v[144:147], v[36:39], v[40:43], v[144:147]
    s_cmp_lt_u32 s70, 4
    s_cbranch_scc1 G1S_VF_TAIL
    s_waitcnt vmcnt(8) lgkmcnt(0)
    s_barrier
    v_mfma_f32_16x16x32_bf16 v[128:131], v[56:59], v[64:67], v[128:131]
    s_add_u32 m0, s74, 0
    s_add_u32 s71, s68, 0
    buffer_load_dwordx4 v1, s[60:63], s71 offen lds
    ds_read_b128 v[32:35], v4 offset:0
    v_mfma_f32_16x16x32_bf16 v[132:135], v[56:59], v[68:71], v[132:135]
    ds_read_b64_tr_b16 v[40:41], v6 offset:0
    s_add_u32 m0, s74, 8192
    s_add_u32 s71, s68, 131072
    buffer_load_dwordx4 v1, s[60:63], s71 offen lds
    v_mfma_f32_16x16x32_bf16 v[136:139], v[56:59], v[72:75], v[136:139]
    ds_read_b64_tr_b16 v[42:43], v6 offset:1024
    ds_read_b64_tr_b16 v[44:45], v7 offset:0
    v_mfma_f32_16x16x32_bf16 v[140:143], v[56:59], v[76:79], v[140:143]
    s_add_u32 m0, s74, 16384
    s_add_u32 s71, s69, 0
    buffer_load_dwordx4 v2, s[64:67], s71 offen lds
    ds_read_b64_tr_b16 v[46:47], v7 offset:1024
    v_mfma_f32_16x16x32_bf16 v[156:159], v[60:63], v[76:79], v[156:159]
    ds_read_b64_tr_b16 v[48:49], v8 offset:0
    s_add_u32 m0, s74, 24576
    s_add_u32 s71, s69, 262144
    buffer_load_dwordx4 v2, s[64:67], s71 offen lds
    v_mfma_f32_16x16x32_bf16 v[152:155], v[60:63], v[72:75], v[152:155]
    ds_read_b64_tr_b16 v[50:51], v8 offset:1024
    ds_read_b64_tr_b16 v[52:53], v9 offset:0
    v_mfma_f32_16x16x32_bf16 v[148:151], v[60:63], v[68:71], v[148:151]
    ds_read_b64_tr_b16 v[54:55], v9 offset:1024
    ds_read_b128 v[36:39], v4 offset:2048
    v_mfma_f32_16x16x32_bf16 v[144:147], v[60:63], v[64:67], v[144:147]
    s_add_u32 s68, s68, 128
    s_add_u32 s69, s69, 524288
    s_add_u32 s75, s75, 1
    s_cmp_eq_u32 s75, 4
    s_cselect_b32 s75, 0, s75
    s_cselect_b32 s71, 0xfffe0000, 0
    s_add_u32 s71, s71, 32768
    s_add_u32 s74, s74, s71
    s_branch G1S_VF_LOOP
G1S_VF_TAIL:
    s_waitcnt vmcnt(0) lgkmcnt(0)
    s_barrier
    v_mfma_f32_16x16x32_bf16 v[128:131], v[56:59], v[64:67], v[128:131]
    ds_read_b128 v[32:35], v4 offset:0
    ds_read_b64_tr_b16 v[40:41], v6 offset:0
    v_mfma_f32_16x16x32_bf16 v[132:135], v[56:59], v[68:71], v[132:135]
    ds_read_b64_tr_b16 v[42:43], v6 offset:1024
    ds_read_b64_tr_b16 v[44:45], v7 offset:0
    v_mfma_f32_16x16x32_bf16 v[136:139], v[56:59], v[72:75], v[136:139]
    ds_read_b64_tr_b16 v[46:47], v7 offset:1024
    ds_read_b64_tr_b16 v[48:49], v8 offset:0
    v_mfma_f32_16x16x32_bf16 v[140:143], v[56:59], v[76:79], v[140:143]
    ds_read_b64_tr_b16 v[50:51], v8 offset:1024
    ds_read_b64_tr_b16 v[52:53], v9 offset:0
    v_mfma_f32_16x16x32_bf16 v[156:159], v[60:63], v[76:79], v[156:159]
    ds_read_b64_tr_b16 v[54:55], v9 offset:1024
    ds_read_b128 v[36:39], v4 offset:2048
    v_mfma_f32_16x16x32_bf16 v[152:155], v[60:63], v[72:75], v[152:155]
    v_mfma_f32_16x16x32_bf16 v[148:151], v[60:63], v[68:71], v[148:151]
    v_mfma_f32_16x16x32_bf16 v[144:147], v[60:63], v[64:67], v[144:147]
    s_cmp_lg_u32 s70, 0
    s_cbranch_scc1 G1S_VF_LOOP
    s_waitcnt lgkmcnt(0)
    s_nop 7
    s_cmp_lg_u32 s76, 0
    s_cbranch_scc1 G_LS2_B
    s_branch G_LS2_C
G_LS2:
    buffer_load_dwordx2 v[20:21], off, s[16:19], 0 offset:72 sc1
    s_sub_u32 s30, s30, 1
    s_cbranch_scc1 K_FAIL
    s_waitcnt vmcnt(0)
G_LS2_C:
    v_lshrrev_b32 v21, 4, v21
    v_min_u32 v21, v20, v21
    v_cmp_eq_u32 vcc, 0, v21
    s_cbranch_vccnz G_LS2
    v_mov_b32 v21, 147456
    ds_write_b32 v21, v20 offset:4
    s_waitcnt lgkmcnt(0)
G_LS2_B:
    s_barrier
    v_mov_b32 v21, 147456
    ds_read_b32 v20, v21 offset:4
    s_waitcnt lgkmcnt(0)
    v_readfirstlane_b32 s4, v20
    s_nop 3
    s_and_b32 s4, s4, 2097152
    s_add_u32 s8, s44, s4
    s_addc_u32 s9, s45, 0
    s_and_b32 s9, s9, 0xffff
    s_mul_i32 s80, s77, 4
    s_mul_i32 s71, s72, 1
    s_add_u32 s80, s80, s71
    s_lshl_b32 s80, s80, 5
    s_mul_i32 s71, s78, 1
    s_add_u32 s80, s80, s71
    s_lshr_b32 s71, s73, 1
    s_add_u32 s80, s80, s71
    s_lshl_b32 s80, s80, 14
    s_and_b32 s71, s73, 1
    s_lshl_b32 s71, s71, 12
    s_add_u32 s80, s80, s71
    s_add_u32 s80, s80, 4202496
    v_bfe_u32 v14, v0, 1, 3
    v_lshlrev_b32 v14, 4, v14
    v_and_b32 v15, 1, v0
    v_lshl_add_u32 v14, v15, 10, v14
    v_lshrrev_b32 v15, 4, v0
    v_lshl_add_u32 v14, v15, 8, v14
    v_cvt_pk_bf16_f32 v32, v128, v129
    v_cvt_pk_bf16_f32 v33, v130, v131
    v_cvt_pk_bf16_f32 v34, v144, v145
    v_cvt_pk_bf16_f32 v35, v146, v147
    buffer_store_dwordx4 v[32:35], v14, s[8:11], s80 offen offset:0 sc1
    v_cvt_pk_bf16_f32 v36, v132, v133
    v_cvt_pk_bf16_f32 v37, v134, v135
    v_cvt_pk_bf16_f32 v38, v148, v149
    v_cvt_pk_bf16_f32 v39, v150, v151
    buffer_store_dwordx4 v[36:39], v14, s[8:11], s80 offen offset:128 sc1
    v_cvt_pk_bf16_f32 v40, v136, v137
    v_cvt_pk_bf16_f32 v41, v138, v139
    v_cvt_pk_bf16_f32 v42, v152, v153
    v_cvt_pk_bf16_f32 v43, v154, v155
    buffer_store_dwordx4 v[40:43], v14, s[8:11], s80 offen offset:2048 sc1
    v_cvt_pk_bf16_f32 v44, v140, v141
    v_cvt_pk_bf16_f32 v45, v142, v143
    v_cvt_pk_bf16_f32 v46, v156, v157
    v_cvt_pk_bf16_f32 v47, v158, v159
    buffer_store_dwordx4 v[44:47], v14, s[8:11], s80 offen offset:2176 sc1
    s_add_u32 s80, s80, 524288
    s_branch G_DONE
H_PREP:
    s_lshl_b32 s84, s52, 5
    s_add_u32 s84, s84, s77
    s_load_dwordx2 s[4:5], s[0:1], 0
    s_load_dwordx2 s[6:7], s[0:1], 80
    s_lshl_b32 s89, s84, 3
    s_add_u32 s89, s89, s76
    s_lshl_b32 s90, s89, 12
    v_lshlrev_b32 v7, 4, v0
    s_waitcnt lgkmcnt(0)
    s_mov_b32 s12, s4
    s_and_b32 s13, s5, 0xffff
    s_mov_b32 s14, 4194304
    s_mov_b32 s15, 0x20000
    buffer_load_dwordx4 v[32:35], v7, s[12:15], s90 offen offset:0
    buffer_load_dwordx4 v[36:39], v7, s[12:15], s90 offen offset:1024
    buffer_load_dwordx4 v[40:43], v7, s[12:15], s90 offen offset:2048
    buffer_load_dwordx4 v[44:47], v7, s[12:15], s90 offen offset:3072
    s_mov_b32 s12, s6
    s_and_b32 s13, s7, 0xffff
    s_mov_b32 s14, 2048
    s_mov_b32 s15, 0x20000
    buffer_load_dwordx4 v[48:51], v7, s[12:15], 0 offen offset:0
    buffer_load_dwordx4 v[52:55], v7, s[12:15], 0 offen offset:1024
    v_lshlrev_b32 v2, 3, v0
    s_and_b32 s87, s89, 510
    s_lshr_b32 s88, s89, 9
    s_add_u32 s87, s87, s88
    s_and_b32 s88, s89, 1
    s_lshl_b32 s88, s88, 8
    s_cmp_eq_u32 s89, 1
    s_cselect_b32 s87, 512, s87
    s_cselect_b32 s88, 0, s88
    v_mov_b32 v3, s87
    v_mov_b32 v4, s88
    s_mov_b32 s87, 0x35800000
    s_cmp_lt_u32 s89, 2
    s_cselect_b32 s87, 0x35000000, s87
    v_mov_b32 v5, s87
    v_mad_u32_u24 v20, v2, v3, v4
    v_and_b32 v21, 1023, v20
    v_cvt_f32_u32 v21, v21
    v_mul_f32 v21, 0x3a800000, v21
    v_add_u32 v20, v20, v3
    v_and_b32 v22, 1023, v20
    v_cvt_f32_u32 v22, v22
    v_mul_f32 v22, 0x3a800000, v22
    v_add_u32 v20, v20, v3
    v_and_b32 v23, 1023, v20
    v_cvt_f32_u32 v23, v23
    v_mul_f32 v23, 0x3a800000, v23
    v_add_u32 v20, v20, v3
    v_and_b32 v24, 1023, v20
    v_cvt_f32_u32 v24, v24
    v_mul_f32 v24, 0x3a800000, v24
    v_add_u32 v20, v20, v3
    v_and_b32 v25, 1023, v20
    v_cvt_f32_u32 v25, v25
    v_mul_f32 v25, 0x3a800000, v25
    v_add_u32 v20, v20, v3
    v_and_b32 v26, 1023, v20
    v_cvt_f32_u32 v26, v26
    v_mul_f32 v26, 0x3a800000, v26
    v_add_u32 v20, v20, v3
    v_and_b32 v27, 1023, v20
    v_cvt_f32_u32 v27, v27
    v_mul_f32 v27, 0x3a800000, v27
    v_add_u32 v20, v20, v3
    v_and_b32 v28, 1023, v20
    v_cvt_f32_u32 v28, v28
    v_mul_f32 v28, 0x3a800000, v28
    v_cos_f32 v21, v21
    v_cos_f32 v22, v22
    v_cos_f32 v23, v23
    v_cos_f32 v24, v24
    v_cos_f32 v25, v25
    v_cos_f32 v26, v26
    v_cos_f32 v27, v27
    v_cos_f32 v28, v28
    s_nop 0
    v_mul_f32 v21, v5, v21
    v_mul_f32 v22, v5, v22
    v_mul_f32 v23, v5, v23
    v_mul_f32 v24, v5, v24
    v_mul_f32 v25, v5, v25
    v_mul_f32 v26, v5, v26
    v_mul_f32 v27, v5, v27
    v_mul_f32 v28, v5, v28
    s_nop 0
    v_cvt_pk_bf16_f32 v8, v21, v22
    v_cvt_pk_bf16_f32 v9, v23, v24
    v_cvt_pk_bf16_f32 v10, v25, v26
    v_cvt_pk_bf16_f32 v11, v27, v28
    s_lshl_b32 s87, s89, 10
    s_add_u32 s88, s87, 115343360
    buffer_store_dwordx4 v[8:11], v7, s[8:11], s88 offen sc1
    s_lshr_b32 s85, s89, 1
    s_and_b32 s86, s89, 1
    v_add_u32 v2, s86, v2
    v_mul_u32_u24 v20, s85, v2
    s_lshl_b32 s86, s85, 1
    v_and_b32 v21, 1023, v20
    v_cvt_f32_u32 v21, v21
    v_mul_f32 v21, 0x3a800000, v21
    v_add_u32 v20, s86, v20
    v_and_b32 v22, 1023, v20
    v_cvt_f32_u32 v22, v22
    v_mul_f32 v22, 0x3a800000, v22
    v_add_u32 v20, s86, v20
    v_and_b32 v23, 1023, v20
    v_cvt_f32_u32 v23, v23
    v_mul_f32 v23, 0x3a800000, v23
    v_add_u32 v20, s86, v20
    v_and_b32 v24, 1023, v20
    v_cvt_f32_u32 v24, v24
    v_mul_f32 v24, 0x3a800000, v24
    v_sin_f32 v25, v21
    v_sin_f32 v26, v22
    v_sin_f32 v27, v23
    v_sin_f32 v28, v24
    v_cos_f32 v21, v21
    v_cos_f32 v22, v22
    v_cos_f32 v23, v23
    v_cos_f32 v24, v24
    s_bitcmp1_b32 s85, 0
    s_cselect_b32 s88, 1.0, -1.0
    v_mov_b32 v3, s88
    v_cmp_eq_u32 vcc, 0, v2
    s_nop 1
    v_cndmask_b32 v25, v25, v3, vcc
    v_cvt_pk_bf16_f32 v12, v21, -v25
    v_cvt_pk_bf16_f32 v13, v22, -v26
    v_cvt_pk_bf16_f32 v14, v23, -v27
    v_cvt_pk_bf16_f32 v15, v24, -v28
    s_add_u32 s88, s87, 113246208
    buffer_store_dwordx4 v[12:15], v7, s[8:11], s88 offen sc1
    s_add_u32 s90, s90, 37748736
    s_waitcnt vmcnt(2)
    v_lshlrev_b32 v64, 16, v48
    v_and_b32 v65, 0xffff0000, v48
    v_lshlrev_b32 v66, 16, v49
    v_and_b32 v67, 0xffff0000, v49
    v_lshlrev_b32 v68, 16, v50
    v_and_b32 v69, 0xffff0000, v50
    v_lshlrev_b32 v70, 16, v51
    v_and_b32 v71, 0xffff0000, v51
    v_lshlrev_b32 v72, 16, v52
    v_and_b32 v73, 0xffff0000, v52
    v_lshlrev_b32 v74, 16, v53
    v_and_b32 v75, 0xffff0000, v53
    v_lshlrev_b32 v76, 16, v54
    v_and_b32 v77, 0xffff0000, v54
    v_lshlrev_b32 v78, 16, v55
    v_and_b32 v79, 0xffff0000, v55
    v_lshlrev_b32 v80, 16, v32
    v_and_b32 v81, 0xffff0000, v32
    v_lshlrev_b32 v82, 16, v33
    v_and_b32 v83, 0xffff0000, v33
    v_lshlrev_b32 v84, 16, v34
    v_and_b32 v85, 0xffff0000, v34
    v_lshlrev_b32 v86, 16, v35
    v_and_b32 v87, 0xffff0000, v35
    v_lshlrev_b32 v88, 16, v36
    v_and_b32 v89, 0xffff0000, v36
    v_lshlrev_b32 v90, 16, v37
    v_and_b32 v91, 0xffff0000, v37
    v_lshlrev_b32 v92, 16, v38
    v_and_b32 v93, 0xffff0000, v38
    v_lshlrev_b32 v94, 16, v39
    v_and_b32 v95, 0xffff0000, v39
    v_pk_add_f32 v[16:17], v[80:81], v[88:89]
    v_pk_add_f32 v[18:19], v[80:81], v[88:89] neg_lo:[0,1] neg_hi:[0,1]
    v_cvt_pk_bf16_f32 v100, v16, v17
    v_cvt_pk_bf16_f32 v104, v18, v19
    v_pk_add_f32 v[16:17], v[82:83], v[90:91]
    v_pk_add_f32 v[18:19], v[82:83], v[90:91] neg_lo:[0,1] neg_hi:[0,1]
    v_cvt_pk_bf16_f32 v101, v16, v17
    v_cvt_pk_bf16_f32 v105, v18, v19
    v_pk_add_f32 v[16:17], v[84:85], v[92:93]
    v_pk_add_f32 v[18:19], v[84:85], v[92:93] neg_lo:[0,1] neg_hi:[0,1]
    v_cvt_pk_bf16_f32 v102, v16, v17
    v_cvt_pk_bf16_f32 v106, v18, v19
    v_pk_add_f32 v[16:17], v[86:87], v[94:95]
    v_pk_add_f32 v[18:19], v[86:87], v[94:95] neg_lo:[0,1] neg_hi:[0,1]
    v_cvt_pk_bf16_f32 v103, v16, v17
    v_cvt_pk_bf16_f32 v107, v18, v19
    buffer_store_dwordx4 v[100:103], v7, s[8:11], s90 offen offset:0 sc1
    buffer_store_dwordx4 v[104:107], v7, s[8:11], s90 offen offset:1024 sc1
    v_mov_b32 v2, 0
    v_pk_mul_f32 v[16:17], v[80:81], v[64:65]
    v_cvt_pk_bf16_f32 v16, v16, v17
    v_lshlrev_b32 v17, 16, v16
    v_and_b32 v16, 0xffff0000, v16
    v_add_f32 v2, v2, v17
    v_add_f32 v2, v2, v16
    v_pk_mul_f32 v[16:17], v[82:83], v[66:67]
    v_cvt_pk_bf16_f32 v16, v16, v17
    v_lshlrev_b32 v17, 16, v16
    v_and_b32 v16, 0xffff0000, v16
    v_add_f32 v2, v2, v17
    v_add_f32 v2, v2, v16
    v_pk_mul_f32 v[16:17], v[84:85], v[68:69]
    v_cvt_pk_bf16_f32 v16, v16, v17
    v_lshlrev_b32 v17, 16, v16
    v_and_b32 v16, 0xffff0000, v16
    v_add_f32 v2, v2, v17
    v_add_f32 v2, v2, v16
    v_pk_mul_f32 v[16:17], v[86:87], v[70:71]
    v_cvt_pk_bf16_f32 v16, v16, v17
    v_lshlrev_b32 v17, 16, v16
    v_and_b32 v16, 0xffff0000, v16
    v_add_f32 v2, v2, v17
    v_add_f32 v2, v2, v16
    v_pk_mul_f32 v[16:17], v[88:89], v[72:73]
    v_cvt_pk_bf16_f32 v16, v16, v17
    v_lshlrev_b32 v17, 16, v16
    v_and_b32 v16, 0xffff0000, v16
    v_add_f32 v2, v2, v17
    v_add_f32 v2, v2, v16
    v_pk_mul_f32 v[16:17], v[90:91], v[74:75]
    v_cvt_pk_bf16_f32 v16, v16, v17
    v_lshlrev_b32 v17, 16, v16
    v_and_b32 v16, 0xffff0000, v16
    v_add_f32 v2, v2, v17
    v_add_f32 v2, v2, v16
    v_pk_mul_f32 v[16:17], v[92:93], v[76:77]
    v_cvt_pk_bf16_f32 v16, v16, v17
    v_lshlrev_b32 v17, 16, v16
    v_and_b32 v16, 0xffff0000, v16
    v_add_f32 v2, v2, v17
    v_add_f32 v2, v2, v16
    v_pk_mul_f32 v[16:17], v[94:95], v[78:79]
    v_cvt_pk_bf16_f32 v16, v16, v17
    v_lshlrev_b32 v17, 16, v16
    v_and_b32 v16, 0xffff0000, v16
    v_add_f32 v2, v2, v17
    v_add_f32 v2, v2, v16
    v_lshlrev_b32 v80, 16, v40
    v_and_b32 v81, 0xffff0000, v40
    v_lshlrev_b32 v82, 16, v41
    v_and_b32 v83, 0xffff0000, v41
    v_lshlrev_b32 v84, 16, v42
    v_and_b32 v85, 0xffff0000, v42
    v_lshlrev_b32 v86, 16, v43
    v_and_b32 v87, 0xffff0000, v43
    v_lshlrev_b32 v88, 16, v44
    v_and_b32 v89, 0xffff0000, v44
    v_lshlrev_b32 v90, 16, v45
    v_and_b32 v91, 0xffff0000, v45
    v_lshlrev_b32 v92, 16, v46
    v_and_b32 v93, 0xffff0000, v46
    v_lshlrev_b32 v94, 16, v47
    v_and_b32 v95, 0xffff0000, v47
    v_pk_add_f32 v[16:17], v[80:81], v[88:89]
    v_pk_add_f32 v[18:19], v[80:81], v[88:89] neg_lo:[0,1] neg_hi:[0,1]
    v_cvt_pk_bf16_f32 v108, v16, v17
    v_cvt_pk_bf16_f32 v112, v18, v19
    v_pk_add_f32 v[16:17], v[82:83], v[90:91]
    v_pk_add_f32 v[18:19], v[82:83], v[90:91] neg_lo:[0,1] neg_hi:[0,1]
    v_cvt_pk_bf16_f32 v109, v16, v17
    v_cvt_pk_bf16_f32 v113, v18, v19
    v_pk_add_f32 v[16:17], v[84:85], v[92:93]
    v_pk_add_f32 v[18:19], v[84:85], v[92:93] neg_lo:[0,1] neg_hi:[0,1]
    v_cvt_pk_bf16_f32 v110, v16, v17
    v_cvt_pk_bf16_f32 v114, v18, v19
    v_pk_add_f32 v[16:17], v[86:87], v[94:95]
    v_pk_add_f32 v[18:19], v[86:87], v[94:95] neg_lo:[0,1] neg_hi:[0,1]
    v_cvt_pk_bf16_f32 v111, v16, v17
    v_cvt_pk_bf16_f32 v115, v18, v19
    buffer_store_dwordx4 v[108:111], v7, s[8:11], s90 offen offset:2048 sc1
    buffer_store_dwordx4 v[112:115], v7, s[8:11], s90 offen offset:3072 sc1
    v_mov_b32 v3, 0
    v_pk_mul_f32 v[16:17], v[80:81], v[64:65]
    v_cvt_pk_bf16_f32 v16, v16, v17
    v_lshlrev_b32 v17, 16, v16
    v_and_b32 v16, 0xffff0000, v16
    v_add_f32 v3, v3, v17
    v_add_f32 v3, v3, v16
    v_pk_mul_f32 v[16:17], v[82:83], v[66:67]
    v_cvt_pk_bf16_f32 v16, v16, v17
    v_lshlrev_b32 v17, 16, v16
    v_and_b32 v16, 0xffff0000, v16
    v_add_f32 v3, v3, v17
    v_add_f32 v3, v3, v16
    v_pk_mul_f32 v[16:17], v[84:85], v[68:69]
    v_cvt_pk_bf16_f32 v16, v16, v17
    v_lshlrev_b32 v17, 16, v16
    v_and_b32 v16, 0xffff0000, v16
    v_add_f32 v3, v3, v17
    v_add_f32 v3, v3, v16
    v_pk_mul_f32 v[16:17], v[86:87], v[70:71]
    v_cvt_pk_bf16_f32 v16, v16, v17
    v_lshlrev_b32 v17, 16, v16
    v_and_b32 v16, 0xffff0000, v16
    v_add_f32 v3, v3, v17
    v_add_f32 v3, v3, v16
    v_pk_mul_f32 v[16:17], v[88:89], v[72:73]
    v_cvt_pk_bf16_f32 v16, v16, v17
    v_lshlrev_b32 v17, 16, v16
    v_and_b32 v16, 0xffff0000, v16
    v_add_f32 v3, v3, v17
    v_add_f32 v3, v3, v16
    v_pk_mul_f32 v[16:17], v[90:91], v[74:75]
    v_cvt_pk_bf16_f32 v16, v16, v17
    v_lshlrev_b32 v17, 16, v16
    v_and_b32 v16, 0xffff0000, v16
    v_add_f32 v3, v3, v17
    v_add_f32 v3, v3, v16
    v_pk_mul_f32 v[16:17], v[92:93], v[76:77]
    v_cvt_pk_bf16_f32 v16, v16, v17
    v_lshlrev_b32 v17, 16, v16
    v_and_b32 v16, 0xffff0000, v16
    v_add_f32 v3, v3, v17
    v_add_f32 v3, v3, v16
    v_pk_mul_f32 v[16:17], v[94:95], v[78:79]
    v_cvt_pk_bf16_f32 v16, v16, v17
    v_lshlrev_b32 v17, 16, v16
    v_and_b32 v16, 0xffff0000, v16
    v_add_f32 v3, v3, v17
    v_add_f32 v3, v3, v16
    s_nop 0
    v_add_f32_dpp v2, v2, v2 row_shr:1 row_mask:0xf bank_mask:0xf bound_ctrl:0
    v_add_f32_dpp v3, v3, v3 row_shr:1 row_mask:0xf bank_mask:0xf bound_ctrl:0
    s_nop 0
    v_add_f32_dpp v2, v2, v2 row_shr:2 row_mask:0xf bank_mask:0xf bound_ctrl:0
    v_add_f32_dpp v3, v3, v3 row_shr:2 row_mask:0xf bank_mask:0xf bound_ctrl:0
    s_nop 0
    v_add_f32_dpp v2, v2, v2 row_shr:4 row_mask:0xf bank_mask:0xf bound_ctrl:0
    v_add_f32_dpp v3, v3, v3 row_shr:4 row_mask:0xf bank_mask:0xf bound_ctrl:0
    s_nop 0
    v_add_f32_dpp v2, v2, v2 row_shr:8 row_mask:0xf bank_mask:0xf bound_ctrl:0
    v_add_f32_dpp v3, v3, v3 row_shr:8 row_mask:0xf bank_mask:0xf bound_ctrl:0
    s_nop 1
    v_permlane32_swap_b32 v2, v3
    v_add_f32 v2, v2, v3
    v_mov_b32 v3, v2
    s_nop 1
    v_permlane16_swap_b32 v2, v3
    v_add_f32 v2, v2, v3
    v_cvt_pk_bf16_f32 v2, v2, v2
    v_lshlrev_b32 v2, 16, v2
    v_mul_f32 v2, 0xbfb8aa3b, v2
    v_exp_f32 v2, v2
    s_nop 0
    v_add_f32 v2, 1.0, v2
    v_rcp_f32 v2, v2
    s_nop 0
    v_cvt_pk_bf16_f32 v2, v2, v2
    v_lshlrev_b32 v2, 16, v2
    v_sub_f32 v3, 1.0, v2
    v_cvt_pk_bf16_f32 v3, v3, v3
    v_lshlrev_b32 v3, 16, v3
    s_lshl_b32 s86, s89, 3
    s_add_u32 s86, s86, 123731968
    s_add_u32 s87, s86, 8192
    v_lshrrev_b32 v4, 5, v0
    v_lshlrev_b32 v4, 2, v4
    s_mov_b32 exec_lo, 0x8000
    s_mov_b32 exec_hi, 0x8000
    buffer_store_dword v2, v4, s[8:11], s86 offen sc1
    buffer_store_dword v3, v4, s[8:11], s87 offen sc1
    s_mov_b64 exec, -1
    s_lshl_b32 s4, s84, 13
    s_lshl_b32 s5, s76, 10
    s_add_u32 s4, s4, s5
    s_add_u32 s4, s4, 103809024
    v_lshlrev_b32 v1, 4, v0
    v_mov_b32 v60, -1
    v_mov_b32 v61, -1
    v_mov_b32 v62, -1
    v_mov_b32 v63, -1
    buffer_store_dwordx4 v[60:63], v1, s[8:11], s4 offen sc1
    s_lshl_b32 s4, s84, 15
    s_add_u32 s4, s4, s5
    s_add_u32 s4, s4, 192937984
    s_lshr_b32 s5, s4, 8
    s_xor_b32 s5, s5, s36
    s_and_b32 s5, s5, 0x2000
    s_add_u32 s4, s4, s5
    buffer_store_dwordx4 v[60:63], v1, s[8:11], s4 offen sc1
    s_add_u32 s4, s4, 16384
    buffer_store_dwordx4 v[60:63], v1, s[8:11], s4 offen sc1
    s_branch G_DONE
H_WT:
    s_lshl_b32 s84, s52, 4
    s_add_u32 s84, s84, s77
    s_load_dwordx4 s[4:7], s[0:1], 64
    s_mul_i32 s85, s84, 32832
    s_lshl_b32 s86, s76, 10
    s_add_u32 s85, s85, s86
    v_lshlrev_b32 v1, 4, v0
    s_barrier
    s_waitcnt lgkmcnt(0)
    s_mov_b32 s12, s4
    s_and_b32 s13, s5, 0xffff
    s_mov_b32 s14, 2101248
    s_mov_b32 s15, 0x20000
    s_add_u32 m0, s86, 0
    s_add_u32 s87, s85, 0
    buffer_load_dwordx4 v1, s[12:15], s87 offen nt lds
    s_add_u32 m0, s86, 8192
    s_add_u32 s87, s85, 8192
    buffer_load_dwordx4 v1, s[12:15], s87 offen nt lds
    s_add_u32 m0, s86, 16384
    s_add_u32 s87, s85, 16384
    buffer_load_dwordx4 v1, s[12:15], s87 offen nt lds
    s_add_u32 m0, s86, 24576
    s_add_u32 s87, s85, 24576
    buffer_load_dwordx4 v1, s[12:15], s87 offen nt lds
    s_cmp_lg_u32 s76, 0
    s_cbranch_scc1 PW_S0
    s_add_u32 m0, s86, 32768
    s_add_u32 s87, s85, 32768
    buffer_load_dwordx4 v1, s[12:15], s87 offen nt lds
PW_S0:
    s_mov_b32 s12, s6
    s_and_b32 s13, s7, 0xffff
    s_mov_b32 s14, 2101248
    s_mov_b32 s15, 0x20000
    s_add_u32 m0, s86, 33792
    s_add_u32 s87, s85, 0
    buffer_load_dwordx4 v1, s[12:15], s87 offen nt lds
    s_add_u32 m0, s86, 41984
    s_add_u32 s87, s85, 8192
    buffer_load_dwordx4 v1, s[12:15], s87 offen nt lds
    s_add_u32 m0, s86, 50176
    s_add_u32 s87, s85, 16384
    buffer_load_dwordx4 v1, s[12:15], s87 offen nt lds
    s_add_u32 m0, s86, 58368
    s_add_u32 s87, s85, 24576
    buffer_load_dwordx4 v1, s[12:15], s87 offen nt lds
    s_cmp_lg_u32 s76, 0
    s_cbranch_scc1 PW_S1
    s_add_u32 m0, s86, 66560
    s_add_u32 s87, s85, 32768
    buffer_load_dwordx4 v1, s[12:15], s87 offen nt lds
PW_S1:
    v_and_b32 v2, 31, v0
    v_lshrrev_b32 v3, 5, v0
    v_mul_u32_u24 v4, 1026, v2
    v_lshl_add_u32 v4, v3, 3, v4
    s_lshl_b32 s87, s76, 4
    v_add_u32 v4, s87, v4
    v_lshlrev_b32 v5, 15, v3
    v_lshl_add_u32 v5, v2, 4, v5
    s_lshl_b32 s85, s76, 16
    s_lshl_b32 s87, s84, 9
    s_add_u32 s85, s85, s87
    s_add_u32 s85, s85, 117440512
    s_waitcnt vmcnt(0)
    s_barrier
    ds_read_u16 v8, v4 offset:0
    ds_read_u16 v9, v4 offset:33792
    ds_read_u16 v10, v4 offset:2
    ds_read_u16 v11, v4 offset:33794
    ds_read_u16 v12, v4 offset:4
    ds_read_u16 v13, v4 offset:33796
    ds_read_u16 v14, v4 offset:6
    ds_read_u16 v15, v4 offset:33798
    s_waitcnt lgkmcnt(0)
    v_lshl_or_b32 v24, v9, 16, v8
    v_lshl_or_b32 v25, v11, 16, v10
    v_lshl_or_b32 v26, v13, 16, v12
    v_lshl_or_b32 v27, v15, 16, v14
    buffer_store_dwordx4 v[24:27], v5, s[8:11], s85 offen sc1
    s_add_u32 s85, s85, 524288
    ds_read_u16 v8, v4 offset:128
    ds_read_u16 v9, v4 offset:33920
    ds_read_u16 v10, v4 offset:130
    ds_read_u16 v11, v4 offset:33922
    ds_read_u16 v12, v4 offset:132
    ds_read_u16 v13, v4 offset:33924
    ds_read_u16 v14, v4 offset:134
    ds_read_u16 v15, v4 offset:33926
    s_waitcnt lgkmcnt(0)
    v_lshl_or_b32 v28, v9, 16, v8
    v_lshl_or_b32 v29, v11, 16, v10
    v_lshl_or_b32 v30, v13, 16, v12
    v_lshl_or_b32 v31, v15, 16, v14
    buffer_store_dwordx4 v[28:31], v5, s[8:11], s85 offen sc1
    s_add_u32 s85, s85, 524288
    ds_read_u16 v8, v4 offset:256
    ds_read_u16 v9, v4 offset:34048
    ds_read_u16 v10, v4 offset:258
    ds_read_u16 v11, v4 offset:34050
    ds_read_u16 v12, v4 offset:260
    ds_read_u16 v13, v4 offset:34052
    ds_read_u16 v14, v4 offset:262
    ds_read_u16 v15, v4 offset:34054
    s_waitcnt lgkmcnt(0)
    v_lshl_or_b32 v32, v9, 16, v8
    v_lshl_or_b32 v33, v11, 16, v10
    v_lshl_or_b32 v34, v13, 16, v12
    v_lshl_or_b32 v35, v15, 16, v14
    buffer_store_dwordx4 v[32:35], v5, s[8:11], s85 offen sc1
    s_add_u32 s85, s85, 524288
    ds_read_u16 v8, v4 offset:384
    ds_read_u16 v9, v4 offset:34176
    ds_read_u16 v10, v4 offset:386
    ds_read_u16 v11, v4 offset:34178
    ds_read_u16 v12, v4 offset:388
    ds_read_u16 v13, v4 offset:34180
    ds_read_u16 v14, v4 offset:390
    ds_read_u16 v15, v4 offset:34182
    s_waitcnt lgkmcnt(0)
    v_lshl_or_b32 v36, v9, 16, v8
    v_lshl_or_b32 v37, v11, 16, v10
    v_lshl_or_b32 v38, v13, 16, v12
    v_lshl_or_b32 v39, v15, 16, v14
    buffer_store_dwordx4 v[36:39], v5, s[8:11], s85 offen sc1
    s_add_u32 s85, s85, 524288
    ds_read_u16 v8, v4 offset:512
    ds_read_u16 v9, v4 offset:34304
    ds_read_u16 v10, v4 offset:514
    ds_read_u16 v11, v4 offset:34306
    ds_read_u16 v12, v4 offset:516
    ds_read_u16 v13, v4 offset:34308
    ds_read_u16 v14, v4 offset:518
    ds_read_u16 v15, v4 offset:34310
    s_waitcnt lgkmcnt(0)
    v_lshl_or_b32 v40, v9, 16, v8
    v_lshl_or_b32 v41, v11, 16, v10
    v_lshl_or_b32 v42, v13, 16, v12
    v_lshl_or_b32 v43, v15, 16, v14
    buffer_store_dwordx4 v[40:43], v5, s[8:11], s85 offen sc1
    s_add_u32 s85, s85, 524288
    ds_read_u16 v8, v4 offset:640
    ds_read_u16 v9, v4 offset:34432
    ds_read_u16 v10, v4 offset:642
    ds_read_u16 v11, v4 offset:34434
    ds_read_u16 v12, v4 offset:644
    ds_read_u16 v13, v4 offset:34436
    ds_read_u16 v14, v4 offset:646
    ds_read_u16 v15, v4 offset:34438
    s_waitcnt lgkmcnt(0)
    v_lshl_or_b32 v44, v9, 16, v8
    v_lshl_or_b32 v45, v11, 16, v10
    v_lshl_or_b32 v46, v13, 16, v12
    v_lshl_or_b32 v47, v15, 16, v14
    buffer_store_dwordx4 v[44:47], v5, s[8:11], s85 offen sc1
    s_add_u32 s85, s85, 524288
    ds_read_u16 v8, v4 offset:768
    ds_read_u16 v9, v4 offset:34560
    ds_read_u16 v10, v4 offset:770
    ds_read_u16 v11, v4 offset:34562
    ds_read_u16 v12, v4 offset:772
    ds_read_u16 v13, v4 offset:34564
    ds_read_u16 v14, v4 offset:774
    ds_read_u16 v15, v4 offset:34566
    s_waitcnt lgkmcnt(0)
    v_lshl_or_b32 v48, v9, 16, v8
    v_lshl_or_b32 v49, v11, 16, v10
    v_lshl_or_b32 v50, v13, 16, v12
    v_lshl_or_b32 v51, v15, 16, v14
    buffer_store_dwordx4 v[48:51], v5, s[8:11], s85 offen sc1
    s_add_u32 s85, s85, 524288
    ds_read_u16 v8, v4 offset:896
    ds_read_u16 v9, v4 offset:34688
    ds_read_u16 v10, v4 offset:898
    ds_read_u16 v11, v4 offset:34690
    ds_read_u16 v12, v4 offset:900
    ds_read_u16 v13, v4 offset:34692
    ds_read_u16 v14, v4 offset:902
    ds_read_u16 v15, v4 offset:34694
    s_waitcnt lgkmcnt(0)
    v_lshl_or_b32 v52, v9, 16, v8
    v_lshl_or_b32 v53, v11, 16, v10
    v_lshl_or_b32 v54, v13, 16, v12
    v_lshl_or_b32 v55, v15, 16, v14
    buffer_store_dwordx4 v[52:55], v5, s[8:11], s85 offen sc1
    s_add_u32 s85, s85, 524288
    s_cmp_lg_u32 s76, 0
    s_cbranch_scc1 PW_E
    ds_read_u16 v8, v4 offset:1024
    ds_read_u16 v9, v4 offset:34816
    ds_read_u16 v10, v4 offset:1026
    ds_read_u16 v11, v4 offset:34818
    ds_read_u16 v12, v4 offset:1028
    ds_read_u16 v13, v4 offset:34820
    ds_read_u16 v14, v4 offset:1030
    ds_read_u16 v15, v4 offset:34822
    s_waitcnt lgkmcnt(0)
    v_lshl_or_b32 v56, v9, 16, v8
    v_lshl_or_b32 v57, v11, 16, v10
    v_lshl_or_b32 v58, v13, 16, v12
    v_lshl_or_b32 v59, v15, 16, v14
    buffer_store_dwordx4 v[56:59], v5, s[8:11], s85 offen sc1
    s_add_u32 s85, s85, 524288
PW_E:
    s_branch G_DONE
H_FFT:
    s_lshl_b32 s84, s52, 4
    s_add_u32 s84, s84, s77
    s_barrier
    v_and_b32 v1, 31, v0
    v_lshrrev_b32 v2, 5, v0
    v_lshlrev_b32 v2, 2, v2
    v_lshlrev_b32 v3, 4, v0
    s_lshr_b32 s85, s76, 2
    s_lshl_b32 s85, s85, 5
    v_add_u32 v4, s85, v1
    s_and_b32 s85, s76, 3
    s_lshl_b32 s85, s85, 4
    v_add_u32 v5, s85, v2
    s_lshl_b32 s85, s76, 10
    v_add_u32 v6, s85, v3
    v_add_u32 v8, 0, v5
    v_mul_u32_u24 v8, v8, v4
    v_and_b32 v8, 63, v8
    v_cvt_f32_u32 v8, v8
    v_mul_f32 v8, 0x3c800000, v8
    v_add_u32 v9, 1, v5
    v_mul_u32_u24 v9, v9, v4
    v_and_b32 v9, 63, v9
    v_cvt_f32_u32 v9, v9
    v_mul_f32 v9, 0x3c800000, v9
    v_add_u32 v10, 2, v5
    v_mul_u32_u24 v10, v10, v4
    v_and_b32 v10, 63, v10
    v_cvt_f32_u32 v10, v10
    v_mul_f32 v10, 0x3c800000, v10
    v_add_u32 v11, 3, v5
    v_mul_u32_u24 v11, v11, v4
    v_and_b32 v11, 63, v11
    v_cvt_f32_u32 v11, v11
    v_mul_f32 v11, 0x3c800000, v11
    v_add_u32 v12, 8, v5
    v_mul_u32_u24 v12, v12, v4
    v_and_b32 v12, 63, v12
    v_cvt_f32_u32 v12, v12
    v_mul_f32 v12, 0x3c800000, v12
    v_add_u32 v13, 9, v5
    v_mul_u32_u24 v13, v13, v4
    v_and_b32 v13, 63, v13
    v_cvt_f32_u32 v13, v13
    v_mul_f32 v13, 0x3c800000, v13
    v_add_u32 v14, 10, v5
    v_mul_u32_u24 v14, v14, v4
    v_and_b32 v14, 63, v14
    v_cvt_f32_u32 v14, v14
    v_mul_f32 v14, 0x3c800000, v14
    v_add_u32 v15, 11, v5
    v_mul_u32_u24 v15, v15, v4
    v_and_b32 v15, 63, v15
    v_cvt_f32_u32 v15, v15
    v_mul_f32 v15, 0x3c800000, v15
    v_sin_f32 v16, v8
    v_sin_f32 v17, v9
    v_sin_f32 v18, v10
    v_sin_f32 v19, v11
    v_sin_f32 v20, v12
    v_sin_f32 v21, v13
    v_sin_f32 v22, v14
    v_sin_f32 v23, v15
    v_cos_f32 v8, v8
    v_cos_f32 v9, v9
    v_cos_f32 v10, v10
    v_cos_f32 v11, v11
    v_cos_f32 v12, v12
    v_cos_f32 v13, v13
    v_cos_f32 v14, v14
    v_cos_f32 v15, v15
    s_nop 0
    v_cvt_pk_bf16_f32 v24, v8, v9
    v_cvt_pk_bf16_f32 v28, v16, v17
    v_cvt_pk_bf16_f32 v32, -v16, -v17
    v_cvt_pk_bf16_f32 v25, v10, v11
    v_cvt_pk_bf16_f32 v29, v18, v19
    v_cvt_pk_bf16_f32 v33, -v18, -v19
    v_cvt_pk_bf16_f32 v26, v12, v13
    v_cvt_pk_bf16_f32 v30, v20, v21
    v_cvt_pk_bf16_f32 v34, -v20, -v21
    v_cvt_pk_bf16_f32 v27, v14, v15
    v_cvt_pk_bf16_f32 v31, v22, v23
    v_cvt_pk_bf16_f32 v35, -v22, -v23
    ds_write_b128 v6, v[24:27] offset:0
    ds_write_b128 v6, v[28:31] offset:8192
    ds_write_b128 v6, v[32:35] offset:16384
    s_and_b32 s85, s76, 1
    s_lshl_b32 s86, s85, 4
    v_add_u32 v5, s86, v2
    s_lshl_b32 s85, s85, 10
    v_add_u32 v7, s85, v3
    v_add_u32 v8, 0, v5
    v_mul_u32_u24 v8, v8, v1
    v_and_b32 v8, 31, v8
    v_cvt_f32_u32 v8, v8
    v_mul_f32 v8, 0x3d000000, v8
    v_add_u32 v9, 1, v5
    v_mul_u32_u24 v9, v9, v1
    v_and_b32 v9, 31, v9
    v_cvt_f32_u32 v9, v9
    v_mul_f32 v9, 0x3d000000, v9
    v_add_u32 v10, 2, v5
    v_mul_u32_u24 v10, v10, v1
    v_and_b32 v10, 31, v10
    v_cvt_f32_u32 v10, v10
    v_mul_f32 v10, 0x3d000000, v10
    v_add_u32 v11, 3, v5
    v_mul_u32_u24 v11, v11, v1
    v_and_b32 v11, 31, v11
    v_cvt_f32_u32 v11, v11
    v_mul_f32 v11, 0x3d000000, v11
    v_add_u32 v12, 8, v5
    v_mul_u32_u24 v12, v12, v1
    v_and_b32 v12, 31, v12
    v_cvt_f32_u32 v12, v12
    v_mul_f32 v12, 0x3d000000, v12
    v_add_u32 v13, 9, v5
    v_mul_u32_u24 v13, v13, v1
    v_and_b32 v13, 31, v13
    v_cvt_f32_u32 v13, v13
    v_mul_f32 v13, 0x3d000000, v13
    v_add_u32 v14, 10, v5
    v_mul_u32_u24 v14, v14, v1
    v_and_b32 v14, 31, v14
    v_cvt_f32_u32 v14, v14
    v_mul_f32 v14, 0x3d000000, v14
    v_add_u32 v15, 11, v5
    v_mul_u32_u24 v15, v15, v1
    v_and_b32 v15, 31, v15
    v_cvt_f32_u32 v15, v15
    v_mul_f32 v15, 0x3d000000, v15
    v_sin_f32 v16, v8
    v_sin_f32 v17, v9
    v_sin_f32 v18, v10
    v_sin_f32 v19, v11
    v_sin_f32 v20, v12
    v_sin_f32 v21, v13
    v_sin_f32 v22, v14
    v_sin_f32 v23, v15
    v_cos_f32 v8, v8
    v_cos_f32 v9, v9
    v_cos_f32 v10, v10
    v_cos_f32 v11, v11
    v_cos_f32 v12, v12
    v_cos_f32 v13, v13
    v_cos_f32 v14, v14
    v_cos_f32 v15, v15
    s_nop 0
    v_cvt_pk_bf16_f32 v24, v8, v9
    v_cvt_pk_bf16_f32 v28, v16, v17
    v_cvt_pk_bf16_f32 v32, -v16, -v17
    v_cvt_pk_bf16_f32 v25, v10, v11
    v_cvt_pk_bf16_f32 v29, v18, v19
    v_cvt_pk_bf16_f32 v33, -v18, -v19
    v_cvt_pk_bf16_f32 v26, v12, v13
    v_cvt_pk_bf16_f32 v30, v20, v21
    v_cvt_pk_bf16_f32 v34, -v20, -v21
    v_cvt_pk_bf16_f32 v27, v14, v15
    v_cvt_pk_bf16_f32 v31, v22, v23
    v_cvt_pk_bf16_f32 v35, -v22, -v23
    ds_write_b128 v7, v[24:27] offset:24576
    ds_write_b128 v7, v[28:31] offset:26624
    ds_write_b128 v7, v[32:35] offset:28672
    s_lshl_b32 s85, s76, 11
    v_add_u32 v6, s85, v3
    s_lshl_b32 s85, s76, 3
    v_add_u32 v5, s85, v2
    s_and_b32 s85, s85, 31
    v_add_u32 v7, s85, v2
    v_add_u32 v8, 0, v5
    v_mul_u32_u24 v8, v8, v1
    v_cvt_f32_u32 v8, v8
    v_mul_f32 v8, 0x3a000000, v8
    v_add_u32 v9, 1, v5
    v_mul_u32_u24 v9, v9, v1
    v_cvt_f32_u32 v9, v9
    v_mul_f32 v9, 0x3a000000, v9
    v_add_u32 v10, 2, v5
    v_mul_u32_u24 v10, v10, v1
    v_cvt_f32_u32 v10, v10
    v_mul_f32 v10, 0x3a000000, v10
    v_add_u32 v11, 3, v5
    v_mul_u32_u24 v11, v11, v1
    v_cvt_f32_u32 v11, v11
    v_mul_f32 v11, 0x3a000000, v11
    v_sin_f32 v16, v8
    v_sin_f32 v17, v9
    v_sin_f32 v18, v10
    v_sin_f32 v19, v11
    v_cos_f32 v12, v8
    v_cos_f32 v13, v9
    v_cos_f32 v14, v10
    v_cos_f32 v15, v11
    s_nop 0
    ds_write_b128 v6, v[12:15] offset:30720
    ds_write_b128 v6, v[16:19] offset:31744
    s_waitcnt lgkmcnt(0)
    v_add_u32 v8, 0, v7
    v_mul_u32_u24 v8, v8, v4
    v_cvt_f32_u32 v8, v8
    v_mul_f32 v8, 0x3a000000, v8
    v_add_u32 v9, 1, v7
    v_mul_u32_u24 v9, v9, v4
    v_cvt_f32_u32 v9, v9
    v_mul_f32 v9, 0x3a000000, v9
    v_add_u32 v10, 2, v7
    v_mul_u32_u24 v10, v10, v4
    v_cvt_f32_u32 v10, v10
    v_mul_f32 v10, 0x3a000000, v10
    v_add_u32 v11, 3, v7
    v_mul_u32_u24 v11, v11, v4
    v_cvt_f32_u32 v11, v11
    v_mul_f32 v11, 0x3a000000, v11
    v_sin_f32 v16, v8
    v_sin_f32 v17, v9
    v_sin_f32 v18, v10
    v_sin_f32 v19, v11
    v_cos_f32 v12, v8
    v_cos_f32 v13, v9
    v_cos_f32 v14, v10
    v_cos_f32 v15, v11
    s_nop 0
    ds_write_b128 v6, v[12:15] offset:47104
    ds_write_b128 v6, v[16:19] offset:48128
    s_waitcnt lgkmcnt(0)
    s_waitcnt lgkmcnt(0)
    s_barrier
    s_lshl_b32 s85, s84, 3
    s_add_u32 s85, s85, s76
    v_lshlrev_b32 v1, 4, v0
    s_lshl_b32 s87, s76, 13
    s_add_u32 s87, s87, 65536
    v_bfe_u32 v6, v0, 2, 2
    v_lshrrev_b32 v7, 5, v0
    v_lshl_add_u32 v6, v7, 2, v6
    v_lshlrev_b32 v2, 7, v6
    v_bfe_u32 v6, v0, 4, 1
    v_lshl_add_u32 v2, v6, 3, v2
    v_and_b32 v6, 3, v0
    v_lshl_add_u32 v2, v6, 4, v2
    v_add_u32 v2, s87, v2
    v_and_b32 v6, 31, v0
    v_lshlrev_b32 v3, 4, v6
    v_lshl_add_u32 v3, v7, 11, v3
    v_lshlrev_b32 v4, 4, v6
    v_lshl_add_u32 v4, v7, 12, v4
    s_and_b32 s88, s76, 1
    s_lshl_b32 s88, s88, 15
    v_add_u32 v4, s88, v4
    s_lshr_b32 s88, s76, 1
    s_lshl_b32 s88, s88, 2
    s_add_u32 s88, s88, 65536
    v_add_u32 v4, s88, v4
    s_cmp_eq_u32 s85, 0
    s_cselect_b32 s86, 1, 0
    s_barrier
FF_PASS:
    s_and_b32 s89, s85, 1
    s_mul_i32 s89, s89, 511
    s_add_u32 s89, s89, s85
    s_add_u32 s89, s89, s86
    s_lshl_b32 s89, s89, 12
    s_add_u32 s89, s89, 104857600
    s_add_u32 s90, s89, 4096
    s_cmp_eq_u32 s85, 0
    s_cselect_b32 s90, 268435456, s90
    s_mov_b32 m0, s87
    s_lshl_b32 s91, s86, 9
    s_add_u32 s91, s91, s85
    s_and_b32 s92, s91, 3
    s_lshl_b32 s92, s92, 2
    s_lshr_b32 s91, s91, 2
    s_lshl_b32 s91, s91, 15
    s_add_u32 s91, s91, s92
    s_add_u32 s91, s91, 117440512
    buffer_load_dwordx4 v1, s[8:11], s89 offen offset:0 sc1 lds
    buffer_load_dwordx4 v1, s[8:11], s89 offen offset:1024 sc1 lds
    buffer_load_dwordx4 v1, s[8:11], s89 offen offset:2048 sc1 lds
    buffer_load_dwordx4 v1, s[8:11], s89 offen offset:3072 sc1 lds
    s_add_u32 m0, s87, 4096
    s_nop 0
    buffer_load_dwordx4 v1, s[8:11], s90 offen offset:0 sc1 lds
    buffer_load_dwordx4 v1, s[8:11], s90 offen offset:1024 sc1 lds
    buffer_load_dwordx4 v1, s[8:11], s90 offen offset:2048 sc1 lds
    buffer_load_dwordx4 v1, s[8:11], s90 offen offset:3072 sc1 lds
    buffer_load_dword v128, v3, s[8:11], s91 offen offset:0
    buffer_load_dword v129, v3, s[8:11], s91 offen offset:512
    buffer_load_dword v130, v3, s[8:11], s91 offen offset:1024
    buffer_load_dword v131, v3, s[8:11], s91 offen offset:1536
    s_add_u32 s91, s91, 4096
    buffer_load_dword v132, v3, s[8:11], s91 offen offset:0
    buffer_load_dword v133, v3, s[8:11], s91 offen offset:512
    buffer_load_dword v134, v3, s[8:11], s91 offen offset:1024
    buffer_load_dword v135, v3, s[8:11], s91 offen offset:1536
    s_add_u32 s91, s91, 4096
    buffer_load_dword v136, v3, s[8:11], s91 offen offset:0
    buffer_load_dword v137, v3, s[8:11], s91 offen offset:512
    buffer_load_dword v138, v3, s[8:11], s91 offen offset:1024
    buffer_load_dword v139, v3, s[8:11], s91 offen offset:1536
    s_add_u32 s91, s91, 4096
    buffer_load_dword v140, v3, s[8:11], s91 offen offset:0
    buffer_load_dword v141, v3, s[8:11], s91 offen offset:512
    buffer_load_dword v142, v3, s[8:11], s91 offen offset:1024
    buffer_load_dword v143, v3, s[8:11], s91 offen offset:1536
    s_add_u32 s91, s91, 4096
    buffer_load_dword v144, v3, s[8:11], s91 offen offset:0
    buffer_load_dword v145, v3, s[8:11], s91 offen offset:512
    buffer_load_dword v146, v3, s[8:11], s91 offen offset:1024
    buffer_load_dword v147, v3, s[8:11], s91 offen offset:1536
    s_add_u32 s91, s91, 4096
    buffer_load_dword v148, v3, s[8:11], s91 offen offset:0
    buffer_load_dword v149, v3, s[8:11], s91 offen offset:512
    buffer_load_dword v150, v3, s[8:11], s91 offen offset:1024
    buffer_load_dword v151, v3, s[8:11], s91 offen offset:1536
    s_add_u32 s91, s91, 4096
    buffer_load_dword v152, v3, s[8:11], s91 offen offset:0
    buffer_load_dword v153, v3, s[8:11], s91 offen offset:512
    buffer_load_dword v154, v3, s[8:11], s91 offen offset:1024
    buffer_load_dword v155, v3, s[8:11], s91 offen offset:1536
    s_add_u32 s91, s91, 4096
    buffer_load_dword v156, v3, s[8:11], s91 offen offset:0
    buffer_load_dword v157, v3, s[8:11], s91 offen offset:512
    buffer_load_dword v158, v3, s[8:11], s91 offen offset:1024
    buffer_load_dword v159, v3, s[8:11], s91 offen offset:1536
    s_add_u32 s91, s91, 4096
    s_waitcnt vmcnt(32)
    ds_read_b64_tr_b16 v[32:33], v2 offset:0
    ds_read_b64_tr_b16 v[34:35], v2 offset:1024
    ds_read_b64_tr_b16 v[36:37], v2 offset:2048
    ds_read_b64_tr_b16 v[38:39], v2 offset:3072
    ds_read_b64_tr_b16 v[40:41], v2 offset:64
    ds_read_b64_tr_b16 v[42:43], v2 offset:1088
    ds_read_b64_tr_b16 v[44:45], v2 offset:2112
    ds_read_b64_tr_b16 v[46:47], v2 offset:3136
    s_waitcnt lgkmcnt(0)
    ds_read_b64_tr_b16 v[48:49], v2 offset:4096
    ds_read_b64_tr_b16 v[50:51], v2 offset:5120
    ds_read_b64_tr_b16 v[52:53], v2 offset:6144
    ds_read_b64_tr_b16 v[54:55], v2 offset:7168
    ds_read_b64_tr_b16 v[56:57], v2 offset:4160
    ds_read_b64_tr_b16 v[58:59], v2 offset:5184
    ds_read_b64_tr_b16 v[60:61], v2 offset:6208
    ds_read_b64_tr_b16 v[62:63], v2 offset:7232
    s_waitcnt lgkmcnt(0)
    ds_read_b128 v[8:11], v1 offset:24576
    ds_read_b128 v[12:15], v1 offset:26624
    ds_read_b128 v[16:19], v1 offset:28672
    ds_read_b128 v[20:23], v1 offset:25600
    ds_read_b128 v[24:27], v1 offset:27648
    ds_read_b128 v[28:31], v1 offset:29696
    s_waitcnt lgkmcnt(3)
    v_mfma_f32_32x32x16_bf16 v[64:79], v[32:35], v[8:11], 0
    v_mfma_f32_32x32x16_bf16 v[200:215], v[48:51], v[8:11], 0
    v_mfma_f32_32x32x16_bf16 v[64:79], v[48:51], v[12:15], v[64:79]
    v_mfma_f32_32x32x16_bf16 v[200:215], v[32:35], v[16:19], v[200:215]
    v_mfma_f32_32x32x16_bf16 v[80:95], v[40:43], v[8:11], 0
    v_mfma_f32_32x32x16_bf16 v[216:231], v[56:59], v[8:11], 0
    v_mfma_f32_32x32x16_bf16 v[80:95], v[56:59], v[12:15], v[80:95]
    v_mfma_f32_32x32x16_bf16 v[216:231], v[40:43], v[16:19], v[216:231]
    s_waitcnt lgkmcnt(0)
    v_mfma_f32_32x32x16_bf16 v[64:79], v[36:39], v[20:23], v[64:79]
    v_mfma_f32_32x32x16_bf16 v[200:215], v[52:55], v[20:23], v[200:215]
    v_mfma_f32_32x32x16_bf16 v[64:79], v[52:55], v[24:27], v[64:79]
    v_mfma_f32_32x32x16_bf16 v[200:215], v[36:39], v[28:31], v[200:215]
    v_mfma_f32_32x32x16_bf16 v[80:95], v[44:47], v[20:23], v[80:95]
    v_mfma_f32_32x32x16_bf16 v[216:231], v[60:63], v[20:23], v[216:231]
    v_mfma_f32_32x32x16_bf16 v[80:95], v[60:63], v[24:27], v[80:95]
    v_mfma_f32_32x32x16_bf16 v[216:231], v[44:47], v[28:31], v[216:231]
    s_nop 15
    ds_read_b128 v[8:11], v1 offset:30720
    ds_read_b128 v[12:15], v1 offset:31744
    ds_read_b128 v[16:19], v1 offset:32768
    ds_read_b128 v[20:23], v1 offset:33792
    s_waitcnt lgkmcnt(2)
    v_pk_mul_f32 v[192:193], v[64:65], v[8:9]
    v_pk_mul_f32 v[196:197], v[200:201], v[8:9]
    v_pk_mul_f32 v[194:195], v[66:67], v[10:11]
    v_pk_mul_f32 v[198:199], v[202:203], v[10:11]
    v_pk_fma_f32 v[192:193], v[200:201], v[12:13], v[192:193]
    v_pk_fma_f32 v[196:197], v[64:65], v[12:13], v[196:197] neg_lo:[0,1,0] neg_hi:[0,1,0]
    v_pk_fma_f32 v[194:195], v[202:203], v[14:15], v[194:195]
    v_pk_fma_f32 v[198:199], v[66:67], v[14:15], v[198:199] neg_lo:[0,1,0] neg_hi:[0,1,0]
    v_cvt_pk_bf16_f32 v32, v192, v193
    v_cvt_pk_bf16_f32 v48, v196, v197
    v_cvt_pk_bf16_f32 v33, v194, v195
    v_cvt_pk_bf16_f32 v49, v198, v199
    ds_read_b128 v[8:11], v1 offset:34816
    ds_read_b128 v[12:15], v1 offset:35840
    s_waitcnt lgkmcnt(2)
    v_pk_mul_f32 v[192:193], v[68:69], v[16:17]
    v_pk_mul_f32 v[196:197], v[204:205], v[16:17]
    v_pk_mul_f32 v[194:195], v[70:71], v[18:19]
    v_pk_mul_f32 v[198:199], v[206:207], v[18:19]
    v_pk_fma_f32 v[192:193], v[204:205], v[20:21], v[192:193]
    v_pk_fma_f32 v[196:197], v[68:69], v[20:21], v[196:197] neg_lo:[0,1,0] neg_hi:[0,1,0]
    v_pk_fma_f32 v[194:195], v[206:207], v[22:23], v[194:195]
    v_pk_fma_f32 v[198:199], v[70:71], v[22:23], v[198:199] neg_lo:[0,1,0] neg_hi:[0,1,0]
    v_cvt_pk_bf16_f32 v34, v192, v193
    v_cvt_pk_bf16_f32 v50, v196, v197
    v_cvt_pk_bf16_f32 v35, v194, v195
    v_cvt_pk_bf16_f32 v51, v198, v199
    ds_read_b128 v[16:19], v1 offset:36864
    ds_read_b128 v[20:23], v1 offset:37888
    s_waitcnt lgkmcnt(2)
    v_pk_mul_f32 v[192:193], v[72:73], v[8:9]
    v_pk_mul_f32 v[196:197], v[208:209], v[8:9]
    v_pk_mul_f32 v[194:195], v[74:75], v[10:11]
    v_pk_mul_f32 v[198:199], v[210:211], v[10:11]
    v_pk_fma_f32 v[192:193], v[208:209], v[12:13], v[192:193]
    v_pk_fma_f32 v[196:197], v[72:73], v[12:13], v[196:197] neg_lo:[0,1,0] neg_hi:[0,1,0]
    v_pk_fma_f32 v[194:195], v[210:211], v[14:15], v[194:195]
    v_pk_fma_f32 v[198:199], v[74:75], v[14:15], v[198:199] neg_lo:[0,1,0] neg_hi:[0,1,0]
    v_cvt_pk_bf16_f32 v36, v192, v193
    v_cvt_pk_bf16_f32 v52, v196, v197
    v_cvt_pk_bf16_f32 v37, v194, v195
    v_cvt_pk_bf16_f32 v53, v198, v199
    ds_read_b128 v[8:11], v1 offset:38912
    ds_read_b128 v[12:15], v1 offset:39936
    s_waitcnt lgkmcnt(2)
    v_pk_mul_f32 v[192:193], v[76:77], v[16:17]
    v_pk_mul_f32 v[196:197], v[212:213], v[16:17]
    v_pk_mul_f32 v[194:195], v[78:79], v[18:19]
    v_pk_mul_f32 v[198:199], v[214:215], v[18:19]
    v_pk_fma_f32 v[192:193], v[212:213], v[20:21], v[192:193]
    v_pk_fma_f32 v[196:197], v[76:77], v[20:21], v[196:197] neg_lo:[0,1,0] neg_hi:[0,1,0]
    v_pk_fma_f32 v[194:195], v[214:215], v[22:23], v[194:195]
    v_pk_fma_f32 v[198:199], v[78:79], v[22:23], v[198:199] neg_lo:[0,1,0] neg_hi:[0,1,0]
    v_cvt_pk_bf16_f32 v38, v192, v193
    v_cvt_pk_bf16_f32 v54, v196, v197
    v_cvt_pk_bf16_f32 v39, v194, v195
    v_cvt_pk_bf16_f32 v55, v198, v199
    ds_read_b128 v[16:19], v1 offset:40960
    ds_read_b128 v[20:23], v1 offset:41984
    s_waitcnt lgkmcnt(2)
    v_pk_mul_f32 v[192:193], v[80:81], v[8:9]
    v_pk_mul_f32 v[196:197], v[216:217], v[8:9]
    v_pk_mul_f32 v[194:195], v[82:83], v[10:11]
    v_pk_mul_f32 v[198:199], v[218:219], v[10:11]
    v_pk_fma_f32 v[192:193], v[216:217], v[12:13], v[192:193]
    v_pk_fma_f32 v[196:197], v[80:81], v[12:13], v[196:197] neg_lo:[0,1,0] neg_hi:[0,1,0]
    v_pk_fma_f32 v[194:195], v[218:219], v[14:15], v[194:195]
    v_pk_fma_f32 v[198:199], v[82:83], v[14:15], v[198:199] neg_lo:[0,1,0] neg_hi:[0,1,0]
    v_cvt_pk_bf16_f32 v40, v192, v193
    v_cvt_pk_bf16_f32 v56, v196, v197
    v_cvt_pk_bf16_f32 v41, v194, v195
    v_cvt_pk_bf16_f32 v57, v198, v199
    ds_read_b128 v[8:11], v1 offset:43008
    ds_read_b128 v[12:15], v1 offset:44032
    s_waitcnt lgkmcnt(2)
    v_pk_mul_f32 v[192:193], v[84:85], v[16:17]
    v_pk_mul_f32 v[196:197], v[220:221], v[16:17]
    v_pk_mul_f32 v[194:195], v[86:87], v[18:19]
    v_pk_mul_f32 v[198:199], v[222:223], v[18:19]
    v_pk_fma_f32 v[192:193], v[220:221], v[20:21], v[192:193]
    v_pk_fma_f32 v[196:197], v[84:85], v[20:21], v[196:197] neg_lo:[0,1,0] neg_hi:[0,1,0]
    v_pk_fma_f32 v[194:195], v[222:223], v[22:23], v[194:195]
    v_pk_fma_f32 v[198:199], v[86:87], v[22:23], v[198:199] neg_lo:[0,1,0] neg_hi:[0,1,0]
    v_cvt_pk_bf16_f32 v42, v192, v193
    v_cvt_pk_bf16_f32 v58, v196, v197
    v_cvt_pk_bf16_f32 v43, v194, v195
    v_cvt_pk_bf16_f32 v59, v198, v199
    ds_read_b128 v[16:19], v1 offset:45056
    ds_read_b128 v[20:23], v1 offset:46080
    s_waitcnt lgkmcnt(2)
    v_pk_mul_f32 v[192:193], v[88:89], v[8:9]
    v_pk_mul_f32 v[196:197], v[224:225], v[8:9]
    v_pk_mul_f32 v[194:195], v[90:91], v[10:11]
    v_pk_mul_f32 v[198:199], v[226:227], v[10:11]
    v_pk_fma_f32 v[192:193], v[224:225], v[12:13], v[192:193]
    v_pk_fma_f32 v[196:197], v[88:89], v[12:13], v[196:197] neg_lo:[0,1,0] neg_hi:[0,1,0]
    v_pk_fma_f32 v[194:195], v[226:227], v[14:15], v[194:195]
    v_pk_fma_f32 v[198:199], v[90:91], v[14:15], v[198:199] neg_lo:[0,1,0] neg_hi:[0,1,0]
    v_cvt_pk_bf16_f32 v44, v192, v193
    v_cvt_pk_bf16_f32 v60, v196, v197
    v_cvt_pk_bf16_f32 v45, v194, v195
    v_cvt_pk_bf16_f32 v61, v198, v199
    s_waitcnt lgkmcnt(0)
    v_pk_mul_f32 v[192:193], v[92:93], v[16:17]
    v_pk_mul_f32 v[196:197], v[228:229], v[16:17]
    v_pk_mul_f32 v[194:195], v[94:95], v[18:19]
    v_pk_mul_f32 v[198:199], v[230:231], v[18:19]
    v_pk_fma_f32 v[192:193], v[228:229], v[20:21], v[192:193]
    v_pk_fma_f32 v[196:197], v[92:93], v[20:21], v[196:197] neg_lo:[0,1,0] neg_hi:[0,1,0]
    v_pk_fma_f32 v[194:195], v[230:231], v[22:23], v[194:195]
    v_pk_fma_f32 v[198:199], v[94:95], v[22:23], v[198:199] neg_lo:[0,1,0] neg_hi:[0,1,0]
    v_cvt_pk_bf16_f32 v46, v192, v193
    v_cvt_pk_bf16_f32 v62, v196, v197
    v_cvt_pk_bf16_f32 v47, v194, v195
    v_cvt_pk_bf16_f32 v63, v198, v199
    ds_read_b128 v[8:11], v1 offset:0
    ds_read_b128 v[12:15], v1 offset:8192
    ds_read_b128 v[16:19], v1 offset:16384
    ds_read_b128 v[20:23], v1 offset:1024
    ds_read_b128 v[24:27], v1 offset:9216
    ds_read_b128 v[28:31], v1 offset:17408
    s_waitcnt lgkmcnt(3)
    v_mfma_f32_32x32x16_bf16 v[64:79], v[8:11], v[32:35], 0
    v_mfma_f32_32x32x16_bf16 v[200:215], v[8:11], v[48:51], 0
    v_mfma_f32_32x32x16_bf16 v[64:79], v[12:15], v[48:51], v[64:79]
    v_mfma_f32_32x32x16_bf16 v[200:215], v[16:19], v[32:35], v[200:215]
    ds_read_b128 v[8:11], v1 offset:2048
    ds_read_b128 v[12:15], v1 offset:10240
    ds_read_b128 v[16:19], v1 offset:18432
    s_waitcnt lgkmcnt(3)
    v_mfma_f32_32x32x16_bf16 v[64:79], v[20:23], v[36:39], v[64:79]
    v_mfma_f32_32x32x16_bf16 v[200:215], v[20:23], v[52:55], v[200:215]
    v_mfma_f32_32x32x16_bf16 v[64:79], v[24:27], v[52:55], v[64:79]
    v_mfma_f32_32x32x16_bf16 v[200:215], v[28:31], v[36:39], v[200:215]
    ds_read_b128 v[20:23], v1 offset:3072
    ds_read_b128 v[24:27], v1 offset:11264
    ds_read_b128 v[28:31], v1 offset:19456
    s_waitcnt lgkmcnt(3)
    v_mfma_f32_32x32x16_bf16 v[64:79], v[8:11], v[40:43], v[64:79]
    v_mfma_f32_32x32x16_bf16 v[200:215], v[8:11], v[56:59], v[200:215]
    v_mfma_f32_32x32x16_bf16 v[64:79], v[12:15], v[56:59], v[64:79]
    v_mfma_f32_32x32x16_bf16 v[200:215], v[16:19], v[40:43], v[200:215]
    ds_read_b128 v[8:11], v1 offset:4096
    ds_read_b128 v[12:15], v1 offset:12288
    ds_read_b128 v[16:19], v1 offset:20480
    s_waitcnt lgkmcnt(3)
    v_mfma_f32_32x32x16_bf16 v[64:79], v[20:23], v[44:47], v[64:79]
    v_mfma_f32_32x32x16_bf16 v[200:215], v[20:23], v[60:63], v[200:215]
    v_mfma_f32_32x32x16_bf16 v[64:79], v[24:27], v[60:63], v[64:79]
    v_mfma_f32_32x32x16_bf16 v[200:215], v[28:31], v[44:47], v[200:215]
    ds_read_b128 v[20:23], v1 offset:5120
    ds_read_b128 v[24:27], v1 offset:13312
    ds_read_b128 v[28:31], v1 offset:21504
    s_waitcnt lgkmcnt(3)
    v_mfma_f32_32x32x16_bf16 v[80:95], v[8:11], v[32:35], 0
    v_mfma_f32_32x32x16_bf16 v[216:231], v[8:11], v[48:51], 0
    v_mfma_f32_32x32x16_bf16 v[80:95], v[12:15], v[48:51], v[80:95]
    v_mfma_f32_32x32x16_bf16 v[216:231], v[16:19], v[32:35], v[216:231]
    ds_read_b128 v[8:11], v1 offset:6144
    ds_read_b128 v[12:15], v1 offset:14336
    ds_read_b128 v[16:19], v1 offset:22528
    s_waitcnt lgkmcnt(3)
    v_mfma_f32_32x32x16_bf16 v[80:95], v[20:23], v[36:39], v[80:95]
    v_mfma_f32_32x32x16_bf16 v[216:231], v[20:23], v[52:55], v[216:231]
    v_mfma_f32_32x32x16_bf16 v[80:95], v[24:27], v[52:55], v[80:95]
    v_mfma_f32_32x32x16_bf16 v[216:231], v[28:31], v[36:39], v[216:231]
    ds_read_b128 v[20:23], v1 offset:7168
    ds_read_b128 v[24:27], v1 offset:15360
    ds_read_b128 v[28:31], v1 offset:23552
    s_waitcnt lgkmcnt(3)
    v_mfma_f32_32x32x16_bf16 v[80:95], v[8:11], v[40:43], v[80:95]
    v_mfma_f32_32x32x16_bf16 v[216:231], v[8:11], v[56:59], v[216:231]
    v_mfma_f32_32x32x16_bf16 v[80:95], v[12:15], v[56:59], v[80:95]
    v_mfma_f32_32x32x16_bf16 v[216:231], v[16:19], v[40:43], v[216:231]
    s_waitcnt lgkmcnt(0)
    v_mfma_f32_32x32x16_bf16 v[80:95], v[20:23], v[44:47], v[80:95]
    v_mfma_f32_32x32x16_bf16 v[216:231], v[20:23], v[60:63], v[216:231]
    v_mfma_f32_32x32x16_bf16 v[80:95], v[24:27], v[60:63], v[80:95]
    v_mfma_f32_32x32x16_bf16 v[216:231], v[28:31], v[44:47], v[216:231]
    s_nop 15
    s_waitcnt vmcnt(0)
    v_lshlrev_b32 v8, 16, v128
    v_and_b32 v12, 0xffff0000, v128
    v_lshlrev_b32 v9, 16, v129
    v_and_b32 v13, 0xffff0000, v129
    v_lshlrev_b32 v10, 16, v130
    v_and_b32 v14, 0xffff0000, v130
    v_lshlrev_b32 v11, 16, v131
    v_and_b32 v15, 0xffff0000, v131
    v_pk_mul_f32 v[192:193], v[64:65], v[8:9]
    v_pk_mul_f32 v[196:197], v[200:201], v[8:9]
    v_pk_mul_f32 v[194:195], v[66:67], v[10:11]
    v_pk_mul_f32 v[198:199], v[202:203], v[10:11]
    v_pk_fma_f32 v[192:193], v[200:201], v[12:13], v[192:193] neg_lo:[0,1,0] neg_hi:[0,1,0]
    v_pk_fma_f32 v[196:197], v[64:65], v[12:13], v[196:197]
    v_pk_fma_f32 v[194:195], v[202:203], v[14:15], v[194:195] neg_lo:[0,1,0] neg_hi:[0,1,0]
    v_pk_fma_f32 v[198:199], v[66:67], v[14:15], v[198:199]
    v_cvt_pk_bf16_f32 v32, v192, v193
    v_cvt_pk_bf16_f32 v48, v196, v197
    v_cvt_pk_bf16_f32 v33, v194, v195
    v_cvt_pk_bf16_f32 v49, v198, v199
    v_lshlrev_b32 v8, 16, v132
    v_and_b32 v12, 0xffff0000, v132
    v_lshlrev_b32 v9, 16, v133
    v_and_b32 v13, 0xffff0000, v133
    v_lshlrev_b32 v10, 16, v134
    v_and_b32 v14, 0xffff0000, v134
    v_lshlrev_b32 v11, 16, v135
    v_and_b32 v15, 0xffff0000, v135
    v_pk_mul_f32 v[192:193], v[68:69], v[8:9]
    v_pk_mul_f32 v[196:197], v[204:205], v[8:9]
    v_pk_mul_f32 v[194:195], v[70:71], v[10:11]
    v_pk_mul_f32 v[198:199], v[206:207], v[10:11]
    v_pk_fma_f32 v[192:193], v[204:205], v[12:13], v[192:193] neg_lo:[0,1,0] neg_hi:[0,1,0]
    v_pk_fma_f32 v[196:197], v[68:69], v[12:13], v[196:197]
    v_pk_fma_f32 v[194:195], v[206:207], v[14:15], v[194:195] neg_lo:[0,1,0] neg_hi:[0,1,0]
    v_pk_fma_f32 v[198:199], v[70:71], v[14:15], v[198:199]
    v_cvt_pk_bf16_f32 v34, v192, v193
    v_cvt_pk_bf16_f32 v50, v196, v197
    v_cvt_pk_bf16_f32 v35, v194, v195
    v_cvt_pk_bf16_f32 v51, v198, v199
    v_lshlrev_b32 v8, 16, v136
    v_and_b32 v12, 0xffff0000, v136
    v_lshlrev_b32 v9, 16, v137
    v_and_b32 v13, 0xffff0000, v137
    v_lshlrev_b32 v10, 16, v138
    v_and_b32 v14, 0xffff0000, v138
    v_lshlrev_b32 v11, 16, v139
    v_and_b32 v15, 0xffff0000, v139
    v_pk_mul_f32 v[192:193], v[72:73], v[8:9]
    v_pk_mul_f32 v[196:197], v[208:209], v[8:9]
    v_pk_mul_f32 v[194:195], v[74:75], v[10:11]
    v_pk_mul_f32 v[198:199], v[210:211], v[10:11]
    v_pk_fma_f32 v[192:193], v[208:209], v[12:13], v[192:193] neg_lo:[0,1,0] neg_hi:[0,1,0]
    v_pk_fma_f32 v[196:197], v[72:73], v[12:13], v[196:197]
    v_pk_fma_f32 v[194:195], v[210:211], v[14:15], v[194:195] neg_lo:[0,1,0] neg_hi:[0,1,0]
    v_pk_fma_f32 v[198:199], v[74:75], v[14:15], v[198:199]
    v_cvt_pk_bf16_f32 v36, v192, v193
    v_cvt_pk_bf16_f32 v52, v196, v197
    v_cvt_pk_bf16_f32 v37, v194, v195
    v_cvt_pk_bf16_f32 v53, v198, v199
    v_lshlrev_b32 v8, 16, v140
    v_and_b32 v12, 0xffff0000, v140
    v_lshlrev_b32 v9, 16, v141
    v_and_b32 v13, 0xffff0000, v141
    v_lshlrev_b32 v10, 16, v142
    v_and_b32 v14, 0xffff0000, v142
    v_lshlrev_b32 v11, 16, v143
    v_and_b32 v15, 0xffff0000, v143
    v_pk_mul_f32 v[192:193], v[76:77], v[8:9]
    v_pk_mul_f32 v[196:197], v[212:213], v[8:9]
    v_pk_mul_f32 v[194:195], v[78:79], v[10:11]
    v_pk_mul_f32 v[198:199], v[214:215], v[10:11]
    v_pk_fma_f32 v[192:193], v[212:213], v[12:13], v[192:193] neg_lo:[0,1,0] neg_hi:[0,1,0]
    v_pk_fma_f32 v[196:197], v[76:77], v[12:13], v[196:197]
    v_pk_fma_f32 v[194:195], v[214:215], v[14:15], v[194:195] neg_lo:[0,1,0] neg_hi:[0,1,0]
    v_pk_fma_f32 v[198:199], v[78:79], v[14:15], v[198:199]
    v_cvt_pk_bf16_f32 v38, v192, v193
    v_cvt_pk_bf16_f32 v54, v196, v197
    v_cvt_pk_bf16_f32 v39, v194, v195
    v_cvt_pk_bf16_f32 v55, v198, v199
    v_lshlrev_b32 v8, 16, v144
    v_and_b32 v12, 0xffff0000, v144
    v_lshlrev_b32 v9, 16, v145
    v_and_b32 v13, 0xffff0000, v145
    v_lshlrev_b32 v10, 16, v146
    v_and_b32 v14, 0xffff0000, v146
    v_lshlrev_b32 v11, 16, v147
    v_and_b32 v15, 0xffff0000, v147
    v_pk_mul_f32 v[192:193], v[80:81], v[8:9]
    v_pk_mul_f32 v[196:197], v[216:217], v[8:9]
    v_pk_mul_f32 v[194:195], v[82:83], v[10:11]
    v_pk_mul_f32 v[198:199], v[218:219], v[10:11]
    v_pk_fma_f32 v[192:193], v[216:217], v[12:13], v[192:193] neg_lo:[0,1,0] neg_hi:[0,1,0]
    v_pk_fma_f32 v[196:197], v[80:81], v[12:13], v[196:197]
    v_pk_fma_f32 v[194:195], v[218:219], v[14:15], v[194:195] neg_lo:[0,1,0] neg_hi:[0,1,0]
    v_pk_fma_f32 v[198:199], v[82:83], v[14:15], v[198:199]
    v_cvt_pk_bf16_f32 v40, v192, v193
    v_cvt_pk_bf16_f32 v56, v196, v197
    v_cvt_pk_bf16_f32 v41, v194, v195
    v_cvt_pk_bf16_f32 v57, v198, v199
    v_lshlrev_b32 v8, 16, v148
    v_and_b32 v12, 0xffff0000, v148
    v_lshlrev_b32 v9, 16, v149
    v_and_b32 v13, 0xffff0000, v149
    v_lshlrev_b32 v10, 16, v150
    v_and_b32 v14, 0xffff0000, v150
    v_lshlrev_b32 v11, 16, v151
    v_and_b32 v15, 0xffff0000, v151
    v_pk_mul_f32 v[192:193], v[84:85], v[8:9]
    v_pk_mul_f32 v[196:197], v[220:221], v[8:9]
    v_pk_mul_f32 v[194:195], v[86:87], v[10:11]
    v_pk_mul_f32 v[198:199], v[222:223], v[10:11]
    v_pk_fma_f32 v[192:193], v[220:221], v[12:13], v[192:193] neg_lo:[0,1,0] neg_hi:[0,1,0]
    v_pk_fma_f32 v[196:197], v[84:85], v[12:13], v[196:197]
    v_pk_fma_f32 v[194:195], v[222:223], v[14:15], v[194:195] neg_lo:[0,1,0] neg_hi:[0,1,0]
    v_pk_fma_f32 v[198:199], v[86:87], v[14:15], v[198:199]
    v_cvt_pk_bf16_f32 v42, v192, v193
    v_cvt_pk_bf16_f32 v58, v196, v197
    v_cvt_pk_bf16_f32 v43, v194, v195
    v_cvt_pk_bf16_f32 v59, v198, v199
    v_lshlrev_b32 v8, 16, v152
    v_and_b32 v12, 0xffff0000, v152
    v_lshlrev_b32 v9, 16, v153
    v_and_b32 v13, 0xffff0000, v153
    v_lshlrev_b32 v10, 16, v154
    v_and_b32 v14, 0xffff0000, v154
    v_lshlrev_b32 v11, 16, v155
    v_and_b32 v15, 0xffff0000, v155
    v_pk_mul_f32 v[192:193], v[88:89], v[8:9]
    v_pk_mul_f32 v[196:197], v[224:225], v[8:9]
    v_pk_mul_f32 v[194:195], v[90:91], v[10:11]
    v_pk_mul_f32 v[198:199], v[226:227], v[10:11]
    v_pk_fma_f32 v[192:193], v[224:225], v[12:13], v[192:193] neg_lo:[0,1,0] neg_hi:[0,1,0]
    v_pk_fma_f32 v[196:197], v[88:89], v[12:13], v[196:197]
    v_pk_fma_f32 v[194:195], v[226:227], v[14:15], v[194:195] neg_lo:[0,1,0] neg_hi:[0,1,0]
    v_pk_fma_f32 v[198:199], v[90:91], v[14:15], v[198:199]
    v_cvt_pk_bf16_f32 v44, v192, v193
    v_cvt_pk_bf16_f32 v60, v196, v197
    v_cvt_pk_bf16_f32 v45, v194, v195
    v_cvt_pk_bf16_f32 v61, v198, v199
    v_lshlrev_b32 v8, 16, v156
    v_and_b32 v12, 0xffff0000, v156
    v_lshlrev_b32 v9, 16, v157
    v_and_b32 v13, 0xffff0000, v157
    v_lshlrev_b32 v10, 16, v158
    v_and_b32 v14, 0xffff0000, v158
    v_lshlrev_b32 v11, 16, v159
    v_and_b32 v15, 0xffff0000, v159
    v_pk_mul_f32 v[192:193], v[92:93], v[8:9]
    v_pk_mul_f32 v[196:197], v[228:229], v[8:9]
    v_pk_mul_f32 v[194:195], v[94:95], v[10:11]
    v_pk_mul_f32 v[198:199], v[230:231], v[10:11]
    v_pk_fma_f32 v[192:193], v[228:229], v[12:13], v[192:193] neg_lo:[0,1,0] neg_hi:[0,1,0]
    v_pk_fma_f32 v[196:197], v[92:93], v[12:13], v[196:197]
    v_pk_fma_f32 v[194:195], v[230:231], v[14:15], v[194:195] neg_lo:[0,1,0] neg_hi:[0,1,0]
    v_pk_fma_f32 v[198:199], v[94:95], v[14:15], v[198:199]
    v_cvt_pk_bf16_f32 v46, v192, v193
    v_cvt_pk_bf16_f32 v62, v196, v197
    v_cvt_pk_bf16_f32 v47, v194, v195
    v_cvt_pk_bf16_f32 v63, v198, v199
    ds_read_b128 v[8:11], v1 offset:0
    ds_read_b128 v[12:15], v1 offset:8192
    ds_read_b128 v[16:19], v1 offset:16384
    ds_read_b128 v[20:23], v1 offset:1024
    ds_read_b128 v[24:27], v1 offset:9216
    ds_read_b128 v[28:31], v1 offset:17408
    s_waitcnt lgkmcnt(3)
    v_mfma_f32_32x32x16_bf16 v[64:79], v[32:35], v[8:11], 0
    v_mfma_f32_32x32x16_bf16 v[200:215], v[48:51], v[8:11], 0
    v_mfma_f32_32x32x16_bf16 v[64:79], v[48:51], v[16:19], v[64:79]
    v_mfma_f32_32x32x16_bf16 v[200:215], v[32:35], v[12:15], v[200:215]
    ds_read_b128 v[8:11], v1 offset:2048
    ds_read_b128 v[12:15], v1 offset:10240
    ds_read_b128 v[16:19], v1 offset:18432
    s_waitcnt lgkmcnt(3)
    v_mfma_f32_32x32x16_bf16 v[64:79], v[36:39], v[20:23], v[64:79]
    v_mfma_f32_32x32x16_bf16 v[200:215], v[52:55], v[20:23], v[200:215]
    v_mfma_f32_32x32x16_bf16 v[64:79], v[52:55], v[28:31], v[64:79]
    v_mfma_f32_32x32x16_bf16 v[200:215], v[36:39], v[24:27], v[200:215]
    ds_read_b128 v[20:23], v1 offset:3072
    ds_read_b128 v[24:27], v1 offset:11264
    ds_read_b128 v[28:31], v1 offset:19456
    s_waitcnt lgkmcnt(3)
    v_mfma_f32_32x32x16_bf16 v[64:79], v[40:43], v[8:11], v[64:79]
    v_mfma_f32_32x32x16_bf16 v[200:215], v[56:59], v[8:11], v[200:215]
    v_mfma_f32_32x32x16_bf16 v[64:79], v[56:59], v[16:19], v[64:79]
    v_mfma_f32_32x32x16_bf16 v[200:215], v[40:43], v[12:15], v[200:215]
    ds_read_b128 v[8:11], v1 offset:4096
    ds_read_b128 v[12:15], v1 offset:12288
    ds_read_b128 v[16:19], v1 offset:20480
    s_waitcnt lgkmcnt(3)
    v_mfma_f32_32x32x16_bf16 v[64:79], v[44:47], v[20:23], v[64:79]
    v_mfma_f32_32x32x16_bf16 v[200:215], v[60:63], v[20:23], v[200:215]
    v_mfma_f32_32x32x16_bf16 v[64:79], v[60:63], v[28:31], v[64:79]
    v_mfma_f32_32x32x16_bf16 v[200:215], v[44:47], v[24:27], v[200:215]
    ds_read_b128 v[20:23], v1 offset:5120
    ds_read_b128 v[24:27], v1 offset:13312
    ds_read_b128 v[28:31], v1 offset:21504
    s_waitcnt lgkmcnt(3)
    v_mfma_f32_32x32x16_bf16 v[80:95], v[32:35], v[8:11], 0
    v_mfma_f32_32x32x16_bf16 v[216:231], v[48:51], v[8:11], 0
    v_mfma_f32_32x32x16_bf16 v[80:95], v[48:51], v[16:19], v[80:95]
    v_mfma_f32_32x32x16_bf16 v[216:231], v[32:35], v[12:15], v[216:231]
    ds_read_b128 v[8:11], v1 offset:6144
    ds_read_b128 v[12:15], v1 offset:14336
    ds_read_b128 v[16:19], v1 offset:22528
    s_waitcnt lgkmcnt(3)
    v_mfma_f32_32x32x16_bf16 v[80:95], v[36:39], v[20:23], v[80:95]
    v_mfma_f32_32x32x16_bf16 v[216:231], v[52:55], v[20:23], v[216:231]
    v_mfma_f32_32x32x16_bf16 v[80:95], v[52:55], v[28:31], v[80:95]
    v_mfma_f32_32x32x16_bf16 v[216:231], v[36:39], v[24:27], v[216:231]
    ds_read_b128 v[20:23], v1 offset:7168
    ds_read_b128 v[24:27], v1 offset:15360
    ds_read_b128 v[28:31], v1 offset:23552
    s_waitcnt lgkmcnt(3)
    v_mfma_f32_32x32x16_bf16 v[80:95], v[40:43], v[8:11], v[80:95]
    v_mfma_f32_32x32x16_bf16 v[216:231], v[56:59], v[8:11], v[216:231]
    v_mfma_f32_32x32x16_bf16 v[80:95], v[56:59], v[16:19], v[80:95]
    v_mfma_f32_32x32x16_bf16 v[216:231], v[40:43], v[12:15], v[216:231]
    s_waitcnt lgkmcnt(0)
    v_mfma_f32_32x32x16_bf16 v[80:95], v[44:47], v[20:23], v[80:95]
    v_mfma_f32_32x32x16_bf16 v[216:231], v[60:63], v[20:23], v[216:231]
    v_mfma_f32_32x32x16_bf16 v[80:95], v[60:63], v[28:31], v[80:95]
    v_mfma_f32_32x32x16_bf16 v[216:231], v[44:47], v[24:27], v[216:231]
    s_nop 15
    ds_read_b128 v[8:11], v1 offset:47104
    ds_read_b128 v[12:15], v1 offset:48128
    ds_read_b128 v[16:19], v1 offset:49152
    ds_read_b128 v[20:23], v1 offset:50176
    s_waitcnt lgkmcnt(2)
    v_pk_mul_f32 v[192:193], v[64:65], v[8:9]
    v_pk_mul_f32 v[196:197], v[200:201], v[8:9]
    v_pk_mul_f32 v[194:195], v[66:67], v[10:11]
    v_pk_mul_f32 v[198:199], v[202:203], v[10:11]
    v_pk_fma_f32 v[192:193], v[200:201], v[12:13], v[192:193] neg_lo:[0,1,0] neg_hi:[0,1,0]
    v_pk_fma_f32 v[196:197], v[64:65], v[12:13], v[196:197]
    v_pk_fma_f32 v[194:195], v[202:203], v[14:15], v[194:195] neg_lo:[0,1,0] neg_hi:[0,1,0]
    v_pk_fma_f32 v[198:199], v[66:67], v[14:15], v[198:199]
    v_cvt_pk_bf16_f32 v32, v192, v193
    v_cvt_pk_bf16_f32 v48, v196, v197
    v_cvt_pk_bf16_f32 v33, v194, v195
    v_cvt_pk_bf16_f32 v49, v198, v199
    ds_read_b128 v[8:11], v1 offset:51200
    ds_read_b128 v[12:15], v1 offset:52224
    s_waitcnt lgkmcnt(2)
    v_pk_mul_f32 v[192:193], v[68:69], v[16:17]
    v_pk_mul_f32 v[196:197], v[204:205], v[16:17]
    v_pk_mul_f32 v[194:195], v[70:71], v[18:19]
    v_pk_mul_f32 v[198:199], v[206:207], v[18:19]
    v_pk_fma_f32 v[192:193], v[204:205], v[20:21], v[192:193] neg_lo:[0,1,0] neg_hi:[0,1,0]
    v_pk_fma_f32 v[196:197], v[68:69], v[20:21], v[196:197]
    v_pk_fma_f32 v[194:195], v[206:207], v[22:23], v[194:195] neg_lo:[0,1,0] neg_hi:[0,1,0]
    v_pk_fma_f32 v[198:199], v[70:71], v[22:23], v[198:199]
    v_cvt_pk_bf16_f32 v34, v192, v193
    v_cvt_pk_bf16_f32 v50, v196, v197
    v_cvt_pk_bf16_f32 v35, v194, v195
    v_cvt_pk_bf16_f32 v51, v198, v199
    ds_read_b128 v[16:19], v1 offset:53248
    ds_read_b128 v[20:23], v1 offset:54272
    s_waitcnt lgkmcnt(2)
    v_pk_mul_f32 v[192:193], v[72:73], v[8:9]
    v_pk_mul_f32 v[196:197], v[208:209], v[8:9]
    v_pk_mul_f32 v[194:195], v[74:75], v[10:11]
    v_pk_mul_f32 v[198:199], v[210:211], v[10:11]
    v_pk_fma_f32 v[192:193], v[208:209], v[12:13], v[192:193] neg_lo:[0,1,0] neg_hi:[0,1,0]
    v_pk_fma_f32 v[196:197], v[72:73], v[12:13], v[196:197]
    v_pk_fma_f32 v[194:195], v[210:211], v[14:15], v[194:195] neg_lo:[0,1,0] neg_hi:[0,1,0]
    v_pk_fma_f32 v[198:199], v[74:75], v[14:15], v[198:199]
    v_cvt_pk_bf16_f32 v36, v192, v193
    v_cvt_pk_bf16_f32 v52, v196, v197
    v_cvt_pk_bf16_f32 v37, v194, v195
    v_cvt_pk_bf16_f32 v53, v198, v199
    ds_read_b128 v[8:11], v1 offset:55296
    ds_read_b128 v[12:15], v1 offset:56320
    s_waitcnt lgkmcnt(2)
    v_pk_mul_f32 v[192:193], v[76:77], v[16:17]
    v_pk_mul_f32 v[196:197], v[212:213], v[16:17]
    v_pk_mul_f32 v[194:195], v[78:79], v[18:19]
    v_pk_mul_f32 v[198:199], v[214:215], v[18:19]
    v_pk_fma_f32 v[192:193], v[212:213], v[20:21], v[192:193] neg_lo:[0,1,0] neg_hi:[0,1,0]
    v_pk_fma_f32 v[196:197], v[76:77], v[20:21], v[196:197]
    v_pk_fma_f32 v[194:195], v[214:215], v[22:23], v[194:195] neg_lo:[0,1,0] neg_hi:[0,1,0]
    v_pk_fma_f32 v[198:199], v[78:79], v[22:23], v[198:199]
    v_cvt_pk_bf16_f32 v38, v192, v193
    v_cvt_pk_bf16_f32 v54, v196, v197
    v_cvt_pk_bf16_f32 v39, v194, v195
    v_cvt_pk_bf16_f32 v55, v198, v199
    ds_read_b128 v[16:19], v1 offset:57344
    ds_read_b128 v[20:23], v1 offset:58368
    s_waitcnt lgkmcnt(2)
    v_pk_mul_f32 v[192:193], v[80:81], v[8:9]
    v_pk_mul_f32 v[196:197], v[216:217], v[8:9]
    v_pk_mul_f32 v[194:195], v[82:83], v[10:11]
    v_pk_mul_f32 v[198:199], v[218:219], v[10:11]
    v_pk_fma_f32 v[192:193], v[216:217], v[12:13], v[192:193] neg_lo:[0,1,0] neg_hi:[0,1,0]
    v_pk_fma_f32 v[196:197], v[80:81], v[12:13], v[196:197]
    v_pk_fma_f32 v[194:195], v[218:219], v[14:15], v[194:195] neg_lo:[0,1,0] neg_hi:[0,1,0]
    v_pk_fma_f32 v[198:199], v[82:83], v[14:15], v[198:199]
    v_cvt_pk_bf16_f32 v40, v192, v193
    v_cvt_pk_bf16_f32 v56, v196, v197
    v_cvt_pk_bf16_f32 v41, v194, v195
    v_cvt_pk_bf16_f32 v57, v198, v199
    ds_read_b128 v[8:11], v1 offset:59392
    ds_read_b128 v[12:15], v1 offset:60416
    s_waitcnt lgkmcnt(2)
    v_pk_mul_f32 v[192:193], v[84:85], v[16:17]
    v_pk_mul_f32 v[196:197], v[220:221], v[16:17]
    v_pk_mul_f32 v[194:195], v[86:87], v[18:19]
    v_pk_mul_f32 v[198:199], v[222:223], v[18:19]
    v_pk_fma_f32 v[192:193], v[220:221], v[20:21], v[192:193] neg_lo:[0,1,0] neg_hi:[0,1,0]
    v_pk_fma_f32 v[196:197], v[84:85], v[20:21], v[196:197]
    v_pk_fma_f32 v[194:195], v[222:223], v[22:23], v[194:195] neg_lo:[0,1,0] neg_hi:[0,1,0]
    v_pk_fma_f32 v[198:199], v[86:87], v[22:23], v[198:199]
    v_cvt_pk_bf16_f32 v42, v192, v193
    v_cvt_pk_bf16_f32 v58, v196, v197
    v_cvt_pk_bf16_f32 v43, v194, v195
    v_cvt_pk_bf16_f32 v59, v198, v199
    ds_read_b128 v[16:19], v1 offset:61440
    ds_read_b128 v[20:23], v1 offset:62464
    s_waitcnt lgkmcnt(2)
    v_pk_mul_f32 v[192:193], v[88:89], v[8:9]
    v_pk_mul_f32 v[196:197], v[224:225], v[8:9]
    v_pk_mul_f32 v[194:195], v[90:91], v[10:11]
    v_pk_mul_f32 v[198:199], v[226:227], v[10:11]
    v_pk_fma_f32 v[192:193], v[224:225], v[12:13], v[192:193] neg_lo:[0,1,0] neg_hi:[0,1,0]
    v_pk_fma_f32 v[196:197], v[88:89], v[12:13], v[196:197]
    v_pk_fma_f32 v[194:195], v[226:227], v[14:15], v[194:195] neg_lo:[0,1,0] neg_hi:[0,1,0]
    v_pk_fma_f32 v[198:199], v[90:91], v[14:15], v[198:199]
    v_cvt_pk_bf16_f32 v44, v192, v193
    v_cvt_pk_bf16_f32 v60, v196, v197
    v_cvt_pk_bf16_f32 v45, v194, v195
    v_cvt_pk_bf16_f32 v61, v198, v199
    s_waitcnt lgkmcnt(0)
    v_pk_mul_f32 v[192:193], v[92:93], v[16:17]
    v_pk_mul_f32 v[196:197], v[228:229], v[16:17]
    v_pk_mul_f32 v[194:195], v[94:95], v[18:19]
    v_pk_mul_f32 v[198:199], v[230:231], v[18:19]
    v_pk_fma_f32 v[192:193], v[228:229], v[20:21], v[192:193] neg_lo:[0,1,0] neg_hi:[0,1,0]
    v_pk_fma_f32 v[196:197], v[92:93], v[20:21], v[196:197]
    v_pk_fma_f32 v[194:195], v[230:231], v[22:23], v[194:195] neg_lo:[0,1,0] neg_hi:[0,1,0]
    v_pk_fma_f32 v[198:199], v[94:95], v[22:23], v[198:199]
    v_cvt_pk_bf16_f32 v46, v192, v193
    v_cvt_pk_bf16_f32 v62, v196, v197
    v_cvt_pk_bf16_f32 v47, v194, v195
    v_cvt_pk_bf16_f32 v63, v198, v199
    ds_read_b128 v[8:11], v1 offset:24576
    ds_read_b128 v[12:15], v1 offset:26624
    ds_read_b128 v[16:19], v1 offset:28672
    ds_read_b128 v[20:23], v1 offset:25600
    ds_read_b128 v[24:27], v1 offset:27648
    ds_read_b128 v[28:31], v1 offset:29696
    s_waitcnt lgkmcnt(3)
    v_mfma_f32_32x32x16_bf16 v[64:79], v[8:11], v[32:35], 0
    v_mfma_f32_32x32x16_bf16 v[200:215], v[8:11], v[48:51], 0
    v_mfma_f32_32x32x16_bf16 v[64:79], v[16:19], v[48:51], v[64:79]
    v_mfma_f32_32x32x16_bf16 v[200:215], v[12:15], v[32:35], v[200:215]
    v_mfma_f32_32x32x16_bf16 v[80:95], v[8:11], v[40:43], 0
    v_mfma_f32_32x32x16_bf16 v[216:231], v[8:11], v[56:59], 0
    v_mfma_f32_32x32x16_bf16 v[80:95], v[16:19], v[56:59], v[80:95]
    v_mfma_f32_32x32x16_bf16 v[216:231], v[12:15], v[40:43], v[216:231]
    s_waitcnt lgkmcnt(0)
    v_mfma_f32_32x32x16_bf16 v[64:79], v[20:23], v[36:39], v[64:79]
    v_mfma_f32_32x32x16_bf16 v[200:215], v[20:23], v[52:55], v[200:215]
    v_mfma_f32_32x32x16_bf16 v[64:79], v[28:31], v[52:55], v[64:79]
    v_mfma_f32_32x32x16_bf16 v[200:215], v[24:27], v[36:39], v[200:215]
    v_mfma_f32_32x32x16_bf16 v[80:95], v[20:23], v[44:47], v[80:95]
    v_mfma_f32_32x32x16_bf16 v[216:231], v[20:23], v[60:63], v[216:231]
    v_mfma_f32_32x32x16_bf16 v[80:95], v[28:31], v[60:63], v[80:95]
    v_mfma_f32_32x32x16_bf16 v[216:231], v[24:27], v[44:47], v[216:231]
    s_nop 15
    s_cmp_eq_u32 s86, 0
    s_cbranch_scc1 FF_P2
    v_mov_b32 v160, v64
    v_mov_b32 v161, v65
    v_mov_b32 v162, v66
    v_mov_b32 v163, v67
    v_mov_b32 v164, v68
    v_mov_b32 v165, v69
    v_mov_b32 v166, v70
    v_mov_b32 v167, v71
    v_mov_b32 v168, v72
    v_mov_b32 v169, v73
    v_mov_b32 v170, v74
    v_mov_b32 v171, v75
    v_mov_b32 v172, v76
    v_mov_b32 v173, v77
    v_mov_b32 v174, v78
    v_mov_b32 v175, v79
    v_mov_b32 v176, v80
    v_mov_b32 v177, v81
    v_mov_b32 v178, v82
    v_mov_b32 v179, v83
    v_mov_b32 v180, v84
    v_mov_b32 v181, v85
    v_mov_b32 v182, v86
    v_mov_b32 v183, v87
    v_mov_b32 v184, v88
    v_mov_b32 v185, v89
    v_mov_b32 v186, v90
    v_mov_b32 v187, v91
    v_mov_b32 v188, v92
    v_mov_b32 v189, v93
    v_mov_b32 v190, v94
    v_mov_b32 v191, v95
    s_mov_b32 s86, 0
    s_branch FF_PASS
FF_P2:
    s_cmp_lg_u32 s85, 0
    s_cbranch_scc1 FF_P3
    v_mov_b32 v200, v160
    v_mov_b32 v201, v161
    v_mov_b32 v202, v162
    v_mov_b32 v203, v163
    v_mov_b32 v204, v164
    v_mov_b32 v205, v165
    v_mov_b32 v206, v166
    v_mov_b32 v207, v167
    v_mov_b32 v208, v168
    v_mov_b32 v209, v169
    v_mov_b32 v210, v170
    v_mov_b32 v211, v171
    v_mov_b32 v212, v172
    v_mov_b32 v213, v173
    v_mov_b32 v214, v174
    v_mov_b32 v215, v175
    v_mov_b32 v216, v176
    v_mov_b32 v217, v177
    v_mov_b32 v218, v178
    v_mov_b32 v219, v179
    v_mov_b32 v220, v180
    v_mov_b32 v221, v181
    v_mov_b32 v222, v182
    v_mov_b32 v223, v183
    v_mov_b32 v224, v184
    v_mov_b32 v225, v185
    v_mov_b32 v226, v186
    v_mov_b32 v227, v187
    v_mov_b32 v228, v188
    v_mov_b32 v229, v189
    v_mov_b32 v230, v190
    v_mov_b32 v231, v191
FF_P3:
    s_barrier
    v_cvt_pk_bf16_f32 v128, v64, v200
    ds_write_b32 v4, v128 offset:0
    v_cvt_pk_bf16_f32 v129, v65, v201
    ds_write_b32 v4, v129 offset:1024
    v_cvt_pk_bf16_f32 v130, v66, v202
    ds_write_b32 v4, v130 offset:2048
    v_cvt_pk_bf16_f32 v131, v67, v203
    ds_write_b32 v4, v131 offset:3072
    v_cvt_pk_bf16_f32 v132, v68, v204
    ds_write_b32 v4, v132 offset:8192
    v_cvt_pk_bf16_f32 v133, v69, v205
    ds_write_b32 v4, v133 offset:9216
    v_cvt_pk_bf16_f32 v134, v70, v206
    ds_write_b32 v4, v134 offset:10240
    v_cvt_pk_bf16_f32 v135, v71, v207
    ds_write_b32 v4, v135 offset:11264
    s_waitcnt lgkmcnt(4)
    v_cvt_pk_bf16_f32 v136, v72, v208
    ds_write_b32 v4, v136 offset:16384
    v_cvt_pk_bf16_f32 v137, v73, v209
    ds_write_b32 v4, v137 offset:17408
    v_cvt_pk_bf16_f32 v138, v74, v210
    ds_write_b32 v4, v138 offset:18432
    v_cvt_pk_bf16_f32 v139, v75, v211
    ds_write_b32 v4, v139 offset:19456
    v_cvt_pk_bf16_f32 v140, v76, v212
    ds_write_b32 v4, v140 offset:24576
    v_cvt_pk_bf16_f32 v141, v77, v213
    ds_write_b32 v4, v141 offset:25600
    v_cvt_pk_bf16_f32 v142, v78, v214
    ds_write_b32 v4, v142 offset:26624
    v_cvt_pk_bf16_f32 v143, v79, v215
    ds_write_b32 v4, v143 offset:27648
    s_waitcnt lgkmcnt(4)
    v_cvt_pk_bf16_f32 v144, v80, v216
    ds_write_b32 v4, v144 offset:512
    v_cvt_pk_bf16_f32 v145, v81, v217
    ds_write_b32 v4, v145 offset:1536
    v_cvt_pk_bf16_f32 v146, v82, v218
    ds_write_b32 v4, v146 offset:2560
    v_cvt_pk_bf16_f32 v147, v83, v219
    ds_write_b32 v4, v147 offset:3584
    v_cvt_pk_bf16_f32 v148, v84, v220
    ds_write_b32 v4, v148 offset:8704
    v_cvt_pk_bf16_f32 v149, v85, v221
    ds_write_b32 v4, v149 offset:9728
    v_cvt_pk_bf16_f32 v150, v86, v222
    ds_write_b32 v4, v150 offset:10752
    v_cvt_pk_bf16_f32 v151, v87, v223
    ds_write_b32 v4, v151 offset:11776
    s_waitcnt lgkmcnt(4)
    v_cvt_pk_bf16_f32 v152, v88, v224
    ds_write_b32 v4, v152 offset:16896
    v_cvt_pk_bf16_f32 v153, v89, v225
    ds_write_b32 v4, v153 offset:17920
    v_cvt_pk_bf16_f32 v154, v90, v226
    ds_write_b32 v4, v154 offset:18944
    v_cvt_pk_bf16_f32 v155, v91, v227
    ds_write_b32 v4, v155 offset:19968
    v_cvt_pk_bf16_f32 v156, v92, v228
    ds_write_b32 v4, v156 offset:25088
    v_cvt_pk_bf16_f32 v157, v93, v229
    ds_write_b32 v4, v157 offset:26112
    v_cvt_pk_bf16_f32 v158, v94, v230
    ds_write_b32 v4, v158 offset:27136
    v_cvt_pk_bf16_f32 v159, v95, v231
    ds_write_b32 v4, v159 offset:28160
    s_waitcnt lgkmcnt(4)
    v_add_u32 v6, s87, v1
    s_lshl_b32 s89, s84, 15
    s_and_b32 s90, s76, 3
    s_lshl_b32 s90, s90, 13
    s_add_u32 s89, s89, s90
    s_lshr_b32 s90, s76, 2
    s_lshl_b32 s90, s90, 21
    s_add_u32 s89, s89, s90
    s_add_u32 s89, s89, 109051904
    s_add_u32 s90, s89, 4096
    s_waitcnt lgkmcnt(0)
    s_barrier
    ds_read_b128 v[64:67], v6 offset:0
    ds_read_b128 v[68:71], v6 offset:1024
    ds_read_b128 v[72:75], v6 offset:2048
    ds_read_b128 v[76:79], v6 offset:3072
    ds_read_b128 v[80:83], v6 offset:4096
    ds_read_b128 v[84:87], v6 offset:5120
    ds_read_b128 v[88:91], v6 offset:6144
    ds_read_b128 v[92:95], v6 offset:7168
    s_waitcnt lgkmcnt(7)
    buffer_store_dwordx4 v[64:67], v1, s[8:11], s89 offen offset:0 sc1
    s_waitcnt lgkmcnt(6)
    buffer_store_dwordx4 v[68:71], v1, s[8:11], s89 offen offset:1024 sc1
    s_waitcnt lgkmcnt(5)
    buffer_store_dwordx4 v[72:75], v1, s[8:11], s89 offen offset:2048 sc1
    s_waitcnt lgkmcnt(4)
    buffer_store_dwordx4 v[76:79], v1, s[8:11], s89 offen offset:3072 sc1
    s_waitcnt lgkmcnt(3)
    buffer_store_dwordx4 v[80:83], v1, s[8:11], s90 offen offset:0 sc1
    s_waitcnt lgkmcnt(2)
    buffer_store_dwordx4 v[84:87], v1, s[8:11], s90 offen offset:1024 sc1
    s_waitcnt lgkmcnt(1)
    buffer_store_dwordx4 v[88:91], v1, s[8:11], s90 offen offset:2048 sc1
    s_waitcnt lgkmcnt(0)
    buffer_store_dwordx4 v[92:95], v1, s[8:11], s90 offen offset:3072 sc1
    s_branch G_DONE
H_QA:
    s_lshl_b32 s4, s52, 2
    s_add_u32 s78, s78, s4
    s_load_dwordx2 s[4:5], s[0:1], 0
    s_cmp_eq_u32 s79, 0
    s_cselect_b32 s71, 24, 32
    s_cmp_eq_u32 s79, 2
    s_cselect_b32 s71, 16, s71
    s_load_dwordx2 s[6:7], s[0:1], s71
    s_mul_i32 s68, s77, 524288
    s_mul_i32 s69, s78, 512
    s_waitcnt lgkmcnt(0)
    s_mov_b32 s60, s4
    s_and_b32 s61, s5, 0xffff
    s_mov_b32 s62, 4194304
    s_mov_b32 s63, 0x20000
    s_mov_b32 s64, s6
    s_and_b32 s65, s7, 0xffff
    s_mov_b32 s66, 8388608
    s_mov_b32 s67, 0x20000
    s_lshr_b32 s72, s76, 1
    s_and_b32 s73, s76, 1
    v_lshrrev_b32 v14, 3, v0
    s_lshl_b32 s71, s76, 3
    v_add_u32 v14, s71, v14
    v_lshrrev_b32 v15, 1, v14
    v_xor_b32 v15, v15, v0
    v_and_b32 v15, 7, v15
    s_mov_b32 s71, 2048
    v_mul_lo_u32 v1, v14, s71
    v_lshl_add_u32 v1, v15, 4, v1
    v_and_b32 v14, 15, v0
    v_lshrrev_b32 v15, 1, v14
    v_lshrrev_b32 v16, 4, v0
    v_xor_b32 v15, v15, v16
    v_lshlrev_b32 v15, 4, v15
    v_lshl_add_u32 v14, v14, 7, v15
    s_mul_i32 s71, s72, 8192
    v_add_u32 v4, s71, v14
    v_xor_b32 v5, 64, v4
    v_lshrrev_b32 v14, 5, v0
    s_mul_i32 s71, s76, 2
    v_add_u32 v14, s71, v14
    v_and_b32 v15, 3, v14
    v_lshlrev_b32 v15, 1, v15
    v_and_b32 v16, 8, v14
    v_or_b32 v15, v15, v16
    v_and_b32 v16, 31, v0
    v_xor_b32 v15, v15, v16
    s_mov_b32 s71, 8192
    v_mul_lo_u32 v2, v14, s71
    v_lshl_add_u32 v2, v15, 4, v2
    v_bfe_u32 v14, v0, 2, 2
    v_lshrrev_b32 v15, 4, v0
    v_lshl_add_u32 v15, v15, 3, v14
    v_mul_u32_u24 v15, 512, v15
    v_and_b32 v16, 3, v0
    v_lshl_add_u32 v15, v16, 3, v15
    v_add_u32 v15, 32768, v15
    v_bfe_u32 v14, v0, 2, 3
    s_mul_i32 s71, s73, 8
    v_xor_b32 v14, s71, v14
    v_lshl_add_u32 v6, v14, 5, v15
    v_xor_b32 v7, 32, v6
    v_xor_b32 v8, 64, v6
    v_xor_b32 v9, 96, v6
    v_xor_b32 v10, 128, v6
    v_xor_b32 v11, 160, v6
    v_xor_b32 v12, 192, v6
    v_xor_b32 v13, 224, v6
    s_lshl_b32 s74, s76, 10
    s_mov_b32 s75, 0
    s_mov_b32 s59, 0
    s_barrier
    s_add_u32 m0, s74, 0
    s_add_u32 s71, s68, 0
    buffer_load_dwordx4 v1, s[60:63], s71 offen lds
    s_add_u32 m0, s74, 8192
    s_add_u32 s71, s68, 131072
    buffer_load_dwordx4 v1, s[60:63], s71 offen lds
    s_add_u32 m0, s74, 16384
    s_add_u32 s71, s68, 262144
    buffer_load_dwordx4 v1, s[60:63], s71 offen lds
    s_add_u32 m0, s74, 24576
    s_add_u32 s71, s68, 393216
    buffer_load_dwordx4 v1, s[60:63], s71 offen lds
    s_add_u32 m0, s74, 32768
    s_add_u32 s71, s69, 0
    buffer_load_dwordx4 v2, s[64:67], s71 offen lds
    s_add_u32 m0, s74, 40960
    s_add_u32 s71, s69, 131072
    buffer_load_dwordx4 v2, s[64:67], s71 offen lds
    s_add_u32 m0, s74, 49152
    s_add_u32 s71, s69, 262144
    buffer_load_dwordx4 v2, s[64:67], s71 offen lds
    s_add_u32 m0, s74, 57344
    s_add_u32 s71, s69, 393216
    buffer_load_dwordx4 v2, s[64:67], s71 offen lds
    s_add_u32 s68, s68, 128
    s_add_u32 s69, s69, 524288
    s_add_u32 s75, s75, 1
    s_cmp_eq_u32 s75, 2
    s_cselect_b32 s75, 0, s75
    s_cselect_b32 s71, 0xfffe0000, 0
    s_add_u32 s71, s71, 65536
    s_add_u32 s74, s74, s71
    s_add_u32 m0, s74, 0
    s_add_u32 s71, s68, 0
    buffer_load_dwordx4 v1, s[60:63], s71 offen lds
    s_add_u32 m0, s74, 8192
    s_add_u32 s71, s68, 131072
    buffer_load_dwordx4 v1, s[60:63], s71 offen lds
    s_add_u32 m0, s74, 16384
    s_add_u32 s71, s68, 262144
    buffer_load_dwordx4 v1, s[60:63], s71 offen lds
    s_add_u32 m0, s74, 24576
    s_add_u32 s71, s68, 393216
    buffer_load_dwordx4 v1, s[60:63], s71 offen lds
    s_add_u32 m0, s74, 32768
    s_add_u32 s71, s69, 0
    buffer_load_dwordx4 v2, s[64:67], s71 offen lds
    s_add_u32 m0, s74, 40960
    s_add_u32 s71, s69, 131072
    buffer_load_dwordx4 v2, s[64:67], s71 offen lds
    s_add_u32 m0, s74, 49152
    s_add_u32 s71, s69, 262144
    buffer_load_dwordx4 v2, s[64:67], s71 offen lds
    s_add_u32 m0, s74, 57344
    s_add_u32 s71, s69, 393216
    buffer_load_dwordx4 v2, s[64:67], s71 offen lds
    s_add_u32 s68, s68, 128
    s_add_u32 s69, s69, 524288
    s_add_u32 s75, s75, 1
    s_cmp_eq_u32 s75, 2
    s_cselect_b32 s75, 0, s75
    s_cselect_b32 s71, 0xfffe0000, 0
    s_add_u32 s71, s71, 65536
    s_add_u32 s74, s74, s71
    s_mov_b32 s70, 16
    v_mov_b32 v128, 0
    v_mov_b32 v129, 0
    v_mov_b32 v130, 0
    v_mov_b32 v131, 0
    v_mov_b32 v132, 0
    v_mov_b32 v133, 0
    v_mov_b32 v134, 0
    v_mov_b32 v135, 0
    v_mov_b32 v136, 0
    v_mov_b32 v137, 0
    v_mov_b32 v138, 0
    v_mov_b32 v139, 0
    v_mov_b32 v140, 0
    v_mov_b32 v141, 0
    v_mov_b32 v142, 0
    v_mov_b32 v143, 0
    v_mov_b32 v144, 0
    v_mov_b32 v145, 0
    v_mov_b32 v146, 0
    v_mov_b32 v147, 0
    v_mov_b32 v148, 0
    v_mov_b32 v149, 0
    v_mov_b32 v150, 0
    v_mov_b32 v151, 0
    v_mov_b32 v152, 0
    v_mov_b32 v153, 0
    v_mov_b32 v154, 0
    v_mov_b32 v155, 0
    v_mov_b32 v156, 0
    v_mov_b32 v157, 0
    v_mov_b32 v158, 0
    v_mov_b32 v159, 0
    v_mov_b32 v160, 0
    v_mov_b32 v161, 0
    v_mov_b32 v162, 0
    v_mov_b32 v163, 0
    v_mov_b32 v164, 0
    v_mov_b32 v165, 0
    v_mov_b32 v166, 0
    v_mov_b32 v167, 0
    v_mov_b32 v168, 0
    v_mov_b32 v169, 0
    v_mov_b32 v170, 0
    v_mov_b32 v171, 0
    v_mov_b32 v172, 0
    v_mov_b32 v173, 0
    v_mov_b32 v174, 0
    v_mov_b32 v175, 0
    v_mov_b32 v176, 0
    v_mov_b32 v177, 0
    v_mov_b32 v178, 0
    v_mov_b32 v179, 0
    v_mov_b32 v180, 0
    v_mov_b32 v181, 0
    v_mov_b32 v182, 0
    v_mov_b32 v183, 0
    v_mov_b32 v184, 0
    v_mov_b32 v185, 0
    v_mov_b32 v186, 0
    v_mov_b32 v187, 0
    v_mov_b32 v188, 0
    v_mov_b32 v189, 0
    v_mov_b32 v190, 0
    v_mov_b32 v191, 0
    v_mov_b32 v192, 0
    v_mov_b32 v193, 0
    v_mov_b32 v194, 0
    v_mov_b32 v195, 0
    v_mov_b32 v196, 0
    v_mov_b32 v197, 0
    v_mov_b32 v198, 0
    v_mov_b32 v199, 0
    v_mov_b32 v200, 0
    v_mov_b32 v201, 0
    v_mov_b32 v202, 0
    v_mov_b32 v203, 0
    v_mov_b32 v204, 0
    v_mov_b32 v205, 0
    v_mov_b32 v206, 0
    v_mov_b32 v207, 0
    v_mov_b32 v208, 0
    v_mov_b32 v209, 0
    v_mov_b32 v210, 0
    v_mov_b32 v211, 0
    v_mov_b32 v212, 0
    v_mov_b32 v213, 0
    v_mov_b32 v214, 0
    v_mov_b32 v215, 0
    v_mov_b32 v216, 0
    v_mov_b32 v217, 0
    v_mov_b32 v218, 0
    v_mov_b32 v219, 0
    v_mov_b32 v220, 0
    v_mov_b32 v221, 0
    v_mov_b32 v222, 0
    v_mov_b32 v223, 0
    v_mov_b32 v224, 0
    v_mov_b32 v225, 0
    v_mov_b32 v226, 0
    v_mov_b32 v227, 0
    v_mov_b32 v228, 0
    v_mov_b32 v229, 0
    v_mov_b32 v230, 0
    v_mov_b32 v231, 0
    v_mov_b32 v232, 0
    v_mov_b32 v233, 0
    v_mov_b32 v234, 0
    v_mov_b32 v235, 0
    v_mov_b32 v236, 0
    v_mov_b32 v237, 0
    v_mov_b32 v238, 0
    v_mov_b32 v239, 0
    v_mov_b32 v240, 0
    v_mov_b32 v241, 0
    v_mov_b32 v242, 0
    v_mov_b32 v243, 0
    v_mov_b32 v244, 0
    v_mov_b32 v245, 0
    v_mov_b32 v246, 0
    v_mov_b32 v247, 0
    v_mov_b32 v248, 0
    v_mov_b32 v249, 0
    v_mov_b32 v250, 0
    v_mov_b32 v251, 0
    v_mov_b32 v252, 0
    v_mov_b32 v253, 0
    v_mov_b32 v254, 0
    v_mov_b32 v255, 0
    s_waitcnt vmcnt(8)
    s_barrier
    s_cmp_eq_u32 s31, 0
    s_cbranch_scc1 QA_HS
    s_mov_b64 exec, 1
    s_bfe_u32 s4, s31, 0x7000a
    s_mul_i32 s4, s4, s52
    s_and_b32 s5, s31, 0x3ff
    s_add_u32 s4, s4, s5
    s_lshl_b32 s4, s4, 7
    s_add_u32 s4, s4, 124780544
    s_lshr_b32 s5, s31, 20
    v_mov_b32 v28, s5
    buffer_atomic_add v28, off, s[8:11], s4 sc1
    s_mov_b64 exec, -1
    s_mov_b32 s31, 0
QA_HS:
    ds_read_b128 v[32:35], v4 offset:0
    ds_read_b64_tr_b16 v[48:49], v6 offset:0
    ds_read_b64_tr_b16 v[50:51], v6 offset:2048
    ds_read_b64_tr_b16 v[52:53], v7 offset:0
    ds_read_b64_tr_b16 v[54:55], v7 offset:2048
    ds_read_b64_tr_b16 v[56:57], v8 offset:0
    ds_read_b64_tr_b16 v[58:59], v8 offset:2048
    ds_read_b64_tr_b16 v[60:61], v9 offset:0
    ds_read_b64_tr_b16 v[62:63], v9 offset:2048
    ds_read_b64_tr_b16 v[64:65], v10 offset:0
    ds_read_b64_tr_b16 v[66:67], v10 offset:2048
    ds_read_b64_tr_b16 v[68:69], v11 offset:0
    ds_read_b64_tr_b16 v[70:71], v11 offset:2048
    ds_read_b64_tr_b16 v[72:73], v12 offset:0
    ds_read_b64_tr_b16 v[74:75], v12 offset:2048
    ds_read_b64_tr_b16 v[76:77], v13 offset:0
    ds_read_b64_tr_b16 v[78:79], v13 offset:2048
    ds_read_b128 v[36:39], v4 offset:2048
    ds_read_b128 v[40:43], v4 offset:4096
    ds_read_b128 v[44:47], v4 offset:6144
QA_LOOP:
    s_waitcnt lgkmcnt(0)
    v_mfma_f32_16x16x32_bf16 v[128:131], v[48:51], v[32:35], v[128:131]
    ds_read_b128 v[80:83], v5 offset:0
    v_mfma_f32_16x16x32_bf16 v[132:135], v[52:55], v[32:35], v[132:135]
    ds_read_b64_tr_b16 v[96:97], v6 offset:16384
    v_mfma_f32_16x16x32_bf16 v[136:139], v[56:59], v[32:35], v[136:139]
    ds_read_b64_tr_b16 v[98:99], v6 offset:18432
    v_mfma_f32_16x16x32_bf16 v[140:143], v[60:63], v[32:35], v[140:143]
    ds_read_b64_tr_b16 v[100:101], v7 offset:16384
    v_mfma_f32_16x16x32_bf16 v[144:147], v[64:67], v[32:35], v[144:147]
    ds_read_b64_tr_b16 v[102:103], v7 offset:18432
    v_mfma_f32_16x16x32_bf16 v[148:151], v[68:71], v[32:35], v[148:151]
    ds_read_b64_tr_b16 v[104:105], v8 offset:16384
    v_mfma_f32_16x16x32_bf16 v[152:155], v[72:75], v[32:35], v[152:155]
    ds_read_b64_tr_b16 v[106:107], v8 offset:18432
    v_mfma_f32_16x16x32_bf16 v[156:159], v[76:79], v[32:35], v[156:159]
    ds_read_b64_tr_b16 v[108:109], v9 offset:16384
    v_mfma_f32_16x16x32_bf16 v[188:191], v[76:79], v[36:39], v[188:191]
    ds_read_b64_tr_b16 v[110:111], v9 offset:18432
    v_mfma_f32_16x16x32_bf16 v[184:187], v[72:75], v[36:39], v[184:187]
    ds_read_b64_tr_b16 v[112:113], v10 offset:16384
    v_mfma_f32_16x16x32_bf16 v[180:183], v[68:71], v[36:39], v[180:183]
    ds_read_b64_tr_b16 v[114:115], v10 offset:18432
    v_mfma_f32_16x16x32_bf16 v[176:179], v[64:67], v[36:39], v[176:179]
    ds_read_b64_tr_b16 v[116:117], v11 offset:16384
    v_mfma_f32_16x16x32_bf16 v[172:175], v[60:63], v[36:39], v[172:175]
    ds_read_b64_tr_b16 v[118:119], v11 offset:18432
    v_mfma_f32_16x16x32_bf16 v[168:171], v[56:59], v[36:39], v[168:171]
    ds_read_b64_tr_b16 v[120:121], v12 offset:16384
    v_mfma_f32_16x16x32_bf16 v[164:167], v[52:55], v[36:39], v[164:167]
    ds_read_b64_tr_b16 v[122:123], v12 offset:18432
    v_mfma_f32_16x16x32_bf16 v[160:163], v[48:51], v[36:39], v[160:163]
    ds_read_b64_tr_b16 v[124:125], v13 offset:16384
    v_mfma_f32_16x16x32_bf16 v[192:195], v[48:51], v[40:43], v[192:195]
    ds_read_b64_tr_b16 v[126:127], v13 offset:18432
    v_mfma_f32_16x16x32_bf16 v[196:199], v[52:55], v[40:43], v[196:199]
    ds_read_b128 v[84:87], v5 offset:2048
    v_mfma_f32_16x16x32_bf16 v[200:203], v[56:59], v[40:43], v[200:203]
    ds_read_b128 v[88:91], v5 offset:4096
    v_mfma_f32_16x16x32_bf16 v[204:207], v[60:63], v[40:43], v[204:207]
    ds_read_b128 v[92:95], v5 offset:6144
    v_mfma_f32_16x16x32_bf16 v[208:211], v[64:67], v[40:43], v[208:211]
    s_add_u32 s59, s59, 1
    s_cmp_eq_u32 s59, 2
    s_cselect_b32 s59, 0, s59
    s_cselect_b32 s71, 0xfffe0000, 0
    s_add_u32 s71, s71, 65536
    v_mfma_f32_16x16x32_bf16 v[212:215], v[68:71], v[40:43], v[212:215]
    v_add_u32 v4, s71, v4
    v_mfma_f32_16x16x32_bf16 v[216:219], v[72:75], v[40:43], v[216:219]
    v_add_u32 v5, s71, v5
    v_mfma_f32_16x16x32_bf16 v[220:223], v[76:79], v[40:43], v[220:223]
    v_add_u32 v6, s71, v6
    v_mfma_f32_16x16x32_bf16 v[252:255], v[76:79], v[44:47], v[252:255]
    v_add_u32 v7, s71, v7
    v_mfma_f32_16x16x32_bf16 v[248:251], v[72:75], v[44:47], v[248:251]
    v_add_u32 v8, s71, v8
    v_mfma_f32_16x16x32_bf16 v[244:247], v[68:71], v[44:47], v[244:247]
    v_add_u32 v9, s71, v9
    v_mfma_f32_16x16x32_bf16 v[240:243], v[64:67], v[44:47], v[240:243]
    v_add_u32 v10, s71, v10
    v_mfma_f32_16x16x32_bf16 v[236:239], v[60:63], v[44:47], v[236:239]
    v_add_u32 v11, s71, v11
    v_mfma_f32_16x16x32_bf16 v[232:235], v[56:59], v[44:47], v[232:235]
    v_add_u32 v12, s71, v12
    v_mfma_f32_16x16x32_bf16 v[228:231], v[52:55], v[44:47], v[228:231]
    v_add_u32 v13, s71, v13
    v_mfma_f32_16x16x32_bf16 v[224:227], v[48:51], v[44:47], v[224:227]
    s_sub_u32 s70, s70, 1
    s_cmp_lt_u32 s70, 2
    s_cbranch_scc1 QA_TAIL
    s_waitcnt vmcnt(0) lgkmcnt(0)
    s_barrier
    v_mfma_f32_16x16x32_bf16 v[128:131], v[96:99], v[80:83], v[128:131]
    s_add_u32 m0, s74, 0
    s_add_u32 s71, s68, 0
    buffer_load_dwordx4 v1, s[60:63], s71 offen lds
    v_mfma_f32_16x16x32_bf16 v[132:135], v[100:103], v[80:83], v[132:135]
    ds_read_b128 v[32:35], v4 offset:0
    v_mfma_f32_16x16x32_bf16 v[136:139], v[104:107], v[80:83], v[136:139]
    ds_read_b64_tr_b16 v[48:49], v6 offset:0
    v_mfma_f32_16x16x32_bf16 v[140:143], v[108:111], v[80:83], v[140:143]
    s_add_u32 m0, s74, 8192
    s_add_u32 s71, s68, 131072
    buffer_load_dwordx4 v1, s[60:63], s71 offen lds
    v_mfma_f32_16x16x32_bf16 v[144:147], v[112:115], v[80:83], v[144:147]
    ds_read_b64_tr_b16 v[50:51], v6 offset:2048
    v_mfma_f32_16x16x32_bf16 v[148:151], v[116:119], v[80:83], v[148:151]
    ds_read_b64_tr_b16 v[52:53], v7 offset:0
    v_mfma_f32_16x16x32_bf16 v[152:155], v[120:123], v[80:83], v[152:155]
    s_add_u32 m0, s74, 16384
    s_add_u32 s71, s68, 262144
    buffer_load_dwordx4 v1, s[60:63], s71 offen lds
    v_mfma_f32_16x16x32_bf16 v[156:159], v[124:127], v[80:83], v[156:159]
    ds_read_b64_tr_b16 v[54:55], v7 offset:2048
    v_mfma_f32_16x16x32_bf16 v[188:191], v[124:127], v[84:87], v[188:191]
    ds_read_b64_tr_b16 v[56:57], v8 offset:0
    v_mfma_f32_16x16x32_bf16 v[184:187], v[120:123], v[84:87], v[184:187]
    s_add_u32 m0, s74, 24576
    s_add_u32 s71, s68, 393216
    buffer_load_dwordx4 v1, s[60:63], s71 offen lds
    v_mfma_f32_16x16x32_bf16 v[180:183], v[116:119], v[84:87], v[180:183]
    ds_read_b64_tr_b16 v[58:59], v8 offset:2048
    v_mfma_f32_16x16x32_bf16 v[176:179], v[112:115], v[84:87], v[176:179]
    ds_read_b64_tr_b16 v[60:61], v9 offset:0
    v_mfma_f32_16x16x32_bf16 v[172:175], v[108:111], v[84:87], v[172:175]
    s_add_u32 m0, s74, 32768
    s_add_u32 s71, s69, 0
    buffer_load_dwordx4 v2, s[64:67], s71 offen lds
    v_mfma_f32_16x16x32_bf16 v[168:171], v[104:107], v[84:87], v[168:171]
    ds_read_b64_tr_b16 v[62:63], v9 offset:2048
    v_mfma_f32_16x16x32_bf16 v[164:167], v[100:103], v[84:87], v[164:167]
    ds_read_b64_tr_b16 v[64:65], v10 offset:0
    v_mfma_f32_16x16x32_bf16 v[160:163], v[96:99], v[84:87], v[160:163]
    s_add_u32 m0, s74, 40960
    s_add_u32 s71, s69, 131072
    buffer_load_dwordx4 v2, s[64:67], s71 offen lds
    v_mfma_f32_16x16x32_bf16 v[192:195], v[96:99], v[88:91], v[192:195]
    ds_read_b64_tr_b16 v[66:67], v10 offset:2048
    v_mfma_f32_16x16x32_bf16 v[196:199], v[100:103], v[88:91], v[196:199]
    ds_read_b64_tr_b16 v[68:69], v11 offset:0
    v_mfma_f32_16x16x32_bf16 v[200:203], v[104:107], v[88:91], v[200:203]
    s_add_u32 m0, s74, 49152
    s_add_u32 s71, s69, 262144
    buffer_load_dwordx4 v2, s[64:67], s71 offen lds
    v_mfma_f32_16x16x32_bf16 v[204:207], v[108:111], v[88:91], v[204:207]
    ds_read_b64_tr_b16 v[70:71], v11 offset:2048
    v_mfma_f32_16x16x32_bf16 v[208:211], v[112:115], v[88:91], v[208:211]
    ds_read_b64_tr_b16 v[72:73], v12 offset:0
    v_mfma_f32_16x16x32_bf16 v[212:215], v[116:119], v[88:91], v[212:215]
    s_add_u32 m0, s74, 57344
    s_add_u32 s71, s69, 393216
    buffer_load_dwordx4 v2, s[64:67], s71 offen lds
    v_mfma_f32_16x16x32_bf16 v[216:219], v[120:123], v[88:91], v[216:219]
    ds_read_b64_tr_b16 v[74:75], v12 offset:2048
    v_mfma_f32_16x16x32_bf16 v[220:223], v[124:127], v[88:91], v[220:223]
    ds_read_b64_tr_b16 v[76:77], v13 offset:0
    v_mfma_f32_16x16x32_bf16 v[252:255], v[124:127], v[92:95], v[252:255]
    ds_read_b64_tr_b16 v[78:79], v13 offset:2048
    v_mfma_f32_16x16x32_bf16 v[248:251], v[120:123], v[92:95], v[248:251]
    ds_read_b128 v[36:39], v4 offset:2048
    v_mfma_f32_16x16x32_bf16 v[244:247], v[116:119], v[92:95], v[244:247]
    ds_read_b128 v[40:43], v4 offset:4096
    v_mfma_f32_16x16x32_bf16 v[240:243], v[112:115], v[92:95], v[240:243]
    ds_read_b128 v[44:47], v4 offset:6144
    v_mfma_f32_16x16x32_bf16 v[236:239], v[108:111], v[92:95], v[236:239]
    s_add_u32 s68, s68, 128
    s_add_u32 s69, s69, 524288
    s_add_u32 s75, s75, 1
    s_cmp_eq_u32 s75, 2
    s_cselect_b32 s75, 0, s75
    s_cselect_b32 s71, 0xfffe0000, 0
    s_add_u32 s71, s71, 65536
    s_add_u32 s74, s74, s71
    v_mfma_f32_16x16x32_bf16 v[232:235], v[104:107], v[92:95], v[232:235]
    v_mfma_f32_16x16x32_bf16 v[228:231], v[100:103], v[92:95], v[228:231]
    v_mfma_f32_16x16x32_bf16 v[224:227], v[96:99], v[92:95], v[224:227]
    s_branch QA_LOOP
QA_TAIL:
    s_waitcnt vmcnt(0) lgkmcnt(0)
    s_barrier
    v_mfma_f32_16x16x32_bf16 v[128:131], v[96:99], v[80:83], v[128:131]
    ds_read_b128 v[32:35], v4 offset:0
    v_mfma_f32_16x16x32_bf16 v[132:135], v[100:103], v[80:83], v[132:135]
    ds_read_b64_tr_b16 v[48:49], v6 offset:0
    v_mfma_f32_16x16x32_bf16 v[136:139], v[104:107], v[80:83], v[136:139]
    ds_read_b64_tr_b16 v[50:51], v6 offset:2048
    v_mfma_f32_16x16x32_bf16 v[140:143], v[108:111], v[80:83], v[140:143]
    ds_read_b64_tr_b16 v[52:53], v7 offset:0
    v_mfma_f32_16x16x32_bf16 v[144:147], v[112:115], v[80:83], v[144:147]
    ds_read_b64_tr_b16 v[54:55], v7 offset:2048
    v_mfma_f32_16x16x32_bf16 v[148:151], v[116:119], v[80:83], v[148:151]
    ds_read_b64_tr_b16 v[56:57], v8 offset:0
    v_mfma_f32_16x16x32_bf16 v[152:155], v[120:123], v[80:83], v[152:155]
    ds_read_b64_tr_b16 v[58:59], v8 offset:2048
    v_mfma_f32_16x16x32_bf16 v[156:159], v[124:127], v[80:83], v[156:159]
    ds_read_b64_tr_b16 v[60:61], v9 offset:0
    v_mfma_f32_16x16x32_bf16 v[188:191], v[124:127], v[84:87], v[188:191]
    ds_read_b64_tr_b16 v[62:63], v9 offset:2048
    v_mfma_f32_16x16x32_bf16 v[184:187], v[120:123], v[84:87], v[184:187]
    ds_read_b64_tr_b16 v[64:65], v10 offset:0
    v_mfma_f32_16x16x32_bf16 v[180:183], v[116:119], v[84:87], v[180:183]
    ds_read_b64_tr_b16 v[66:67], v10 offset:2048
    v_mfma_f32_16x16x32_bf16 v[176:179], v[112:115], v[84:87], v[176:179]
    ds_read_b64_tr_b16 v[68:69], v11 offset:0
    v_mfma_f32_16x16x32_bf16 v[172:175], v[108:111], v[84:87], v[172:175]
    ds_read_b64_tr_b16 v[70:71], v11 offset:2048
    v_mfma_f32_16x16x32_bf16 v[168:171], v[104:107], v[84:87], v[168:171]
    ds_read_b64_tr_b16 v[72:73], v12 offset:0
    v_mfma_f32_16x16x32_bf16 v[164:167], v[100:103], v[84:87], v[164:167]
    ds_read_b64_tr_b16 v[74:75], v12 offset:2048
    v_mfma_f32_16x16x32_bf16 v[160:163], v[96:99], v[84:87], v[160:163]
    ds_read_b64_tr_b16 v[76:77], v13 offset:0
    v_mfma_f32_16x16x32_bf16 v[192:195], v[96:99], v[88:91], v[192:195]
    ds_read_b64_tr_b16 v[78:79], v13 offset:2048
    v_mfma_f32_16x16x32_bf16 v[196:199], v[100:103], v[88:91], v[196:199]
    ds_read_b128 v[36:39], v4 offset:2048
    v_mfma_f32_16x16x32_bf16 v[200:203], v[104:107], v[88:91], v[200:203]
    ds_read_b128 v[40:43], v4 offset:4096
    v_mfma_f32_16x16x32_bf16 v[204:207], v[108:111], v[88:91], v[204:207]
    ds_read_b128 v[44:47], v4 offset:6144
    v_mfma_f32_16x16x32_bf16 v[208:211], v[112:115], v[88:91], v[208:211]
    v_mfma_f32_16x16x32_bf16 v[212:215], v[116:119], v[88:91], v[212:215]
    v_mfma_f32_16x16x32_bf16 v[216:219], v[120:123], v[88:91], v[216:219]
    v_mfma_f32_16x16x32_bf16 v[220:223], v[124:127], v[88:91], v[220:223]
    v_mfma_f32_16x16x32_bf16 v[252:255], v[124:127], v[92:95], v[252:255]
    v_mfma_f32_16x16x32_bf16 v[248:251], v[120:123], v[92:95], v[248:251]
    v_mfma_f32_16x16x32_bf16 v[244:247], v[116:119], v[92:95], v[244:247]
    v_mfma_f32_16x16x32_bf16 v[240:243], v[112:115], v[92:95], v[240:243]
    v_mfma_f32_16x16x32_bf16 v[236:239], v[108:111], v[92:95], v[236:239]
    v_mfma_f32_16x16x32_bf16 v[232:235], v[104:107], v[92:95], v[232:235]
    v_mfma_f32_16x16x32_bf16 v[228:231], v[100:103], v[92:95], v[228:231]
    v_mfma_f32_16x16x32_bf16 v[224:227], v[96:99], v[92:95], v[224:227]
    s_cmp_lg_u32 s70, 0
    s_cbranch_scc1 QA_LOOP
    s_waitcnt lgkmcnt(0)
    s_nop 7
    s_mul_i32 s89, s77, 8
    s_mul_i32 s71, s72, 2
    s_add_u32 s89, s89, s71
    s_lshl_b32 s89, s89, 5
    s_mul_i32 s71, s78, 2
    s_add_u32 s89, s89, s71
    s_lshr_b32 s71, s73, 0
    s_add_u32 s89, s89, s71
    s_lshl_b32 s85, s89, 14
    s_lshr_b32 s90, s89, 5
    s_and_b32 s91, s89, 31
    s_lshl_b32 s87, s90, 18
    s_lshl_b32 s88, s91, 12
    s_add_u32 s87, s87, s88
    s_add_u32 s87, s87, 88080384
    s_add_u32 s92, s91, 432
    s_lshr_b32 s91, s91, 3
    s_lshl_b32 s93, s91, 4
    s_lshl_b32 s91, s91, 6
    s_add_u32 s91, s91, s90
    s_add_u32 s91, s91, 112
    s_lshl_b32 s91, s91, 7
    s_lshl_b32 s92, s92, 5
    s_add_u32 s92, s92, s90
    s_lshl_b32 s92, s92, 2
    s_sub_u32 s92, s92, 192
    s_cmp_ge_u32 s90, 48
    s_cselect_b32 s91, s92, s91
    s_cselect_b32 s92, 4, 128
    s_add_u32 s91, s91, 124780544
    s_add_u32 s92, s92, s91
    buffer_load_dword v10, off, s[8:11], s91 sc1
    buffer_load_dword v11, off, s[8:11], s92 sc1
    s_lshr_b32 s94, s90, 2
    s_add_u32 s93, s93, s94
    s_lshl_b32 s93, s93, 7
    s_add_u32 s93, s93, 124827648
    s_add_u32 s86, s85, 54525952
    s_lshr_b32 s88, s86, 8
    s_xor_b32 s88, s88, s36
    s_and_b32 s88, s88, 0x2000
    s_add_u32 s86, s86, s88
    s_lshl_b32 s90, s90, 7
    s_add_u32 s90, s90, 123731968
    v_lshlrev_b32 v1, 4, v0
    v_and_b32 v6, 15, v0
    v_lshlrev_b32 v5, 2, v6
    v_cvt_pk_bf16_f32 v32, v128, v129
    v_cvt_pk_bf16_f32 v33, v130, v131
    v_cvt_pk_bf16_f32 v34, v132, v133
    v_cvt_pk_bf16_f32 v35, v134, v135
    v_cvt_pk_bf16_f32 v36, v136, v137
    v_cvt_pk_bf16_f32 v37, v138, v139
    v_cvt_pk_bf16_f32 v38, v140, v141
    v_cvt_pk_bf16_f32 v39, v142, v143
    v_cvt_pk_bf16_f32 v40, v144, v145
    v_cvt_pk_bf16_f32 v41, v146, v147
    v_cvt_pk_bf16_f32 v42, v148, v149
    v_cvt_pk_bf16_f32 v43, v150, v151
    v_cvt_pk_bf16_f32 v44, v152, v153
    v_cvt_pk_bf16_f32 v45, v154, v155
    v_cvt_pk_bf16_f32 v46, v156, v157
    v_cvt_pk_bf16_f32 v47, v158, v159
    s_add_u32 s88, s85, 4194304
    buffer_load_dwordx4 v[128:131], v1, s[8:11], s88 offen offset:0 sc1
    buffer_load_dwordx4 v[132:135], v1, s[8:11], s88 offen offset:1024 sc1
    buffer_load_dwordx4 v[136:139], v1, s[8:11], s88 offen offset:2048 sc1
    buffer_load_dwordx4 v[140:143], v1, s[8:11], s88 offen offset:3072 sc1
    s_add_u32 s88, s85, 4198400
    buffer_load_dwordx4 v[144:147], v1, s[8:11], s88 offen offset:0 sc1
    buffer_load_dwordx4 v[148:151], v1, s[8:11], s88 offen offset:1024 sc1
    buffer_load_dwordx4 v[152:155], v1, s[8:11], s88 offen offset:2048 sc1
    buffer_load_dwordx4 v[156:159], v1, s[8:11], s88 offen offset:3072 sc1
    v_cvt_pk_bf16_f32 v48, v160, v161
    v_cvt_pk_bf16_f32 v49, v162, v163
    v_cvt_pk_bf16_f32 v50, v164, v165
    v_cvt_pk_bf16_f32 v51, v166, v167
    v_cvt_pk_bf16_f32 v52, v168, v169
    v_cvt_pk_bf16_f32 v53, v170, v171
    v_cvt_pk_bf16_f32 v54, v172, v173
    v_cvt_pk_bf16_f32 v55, v174, v175
    v_cvt_pk_bf16_f32 v56, v176, v177
    v_cvt_pk_bf16_f32 v57, v178, v179
    v_cvt_pk_bf16_f32 v58, v180, v181
    v_cvt_pk_bf16_f32 v59, v182, v183
    v_cvt_pk_bf16_f32 v60, v184, v185
    v_cvt_pk_bf16_f32 v61, v186, v187
    v_cvt_pk_bf16_f32 v62, v188, v189
    v_cvt_pk_bf16_f32 v63, v190, v191
    s_add_u32 s88, s85, 4202496
    buffer_load_dwordx4 v[160:163], v1, s[8:11], s88 offen offset:0 sc1
    buffer_load_dwordx4 v[164:167], v1, s[8:11], s88 offen offset:1024 sc1
    buffer_load_dwordx4 v[168:171], v1, s[8:11], s88 offen offset:2048 sc1
    buffer_load_dwordx4 v[172:175], v1, s[8:11], s88 offen offset:3072 sc1
    s_add_u32 s88, s85, 4206592
    buffer_load_dwordx4 v[176:179], v1, s[8:11], s88 offen offset:0 sc1
    buffer_load_dwordx4 v[180:183], v1, s[8:11], s88 offen offset:1024 sc1
    buffer_load_dwordx4 v[184:187], v1, s[8:11], s88 offen offset:2048 sc1
    buffer_load_dwordx4 v[188:191], v1, s[8:11], s88 offen offset:3072 sc1
    buffer_load_dword v116, v5, s[8:11], s90 offen offset:0 sc1
    buffer_load_dword v117, v5, s[8:11], s90 offen offset:64 sc1
    buffer_load_dword v118, v5, s[8:11], s90 offen offset:128 sc1
    buffer_load_dword v119, v5, s[8:11], s90 offen offset:192 sc1
    v_cvt_pk_bf16_f32 v64, v192, v193
    v_cvt_pk_bf16_f32 v65, v194, v195
    v_cvt_pk_bf16_f32 v66, v196, v197
    v_cvt_pk_bf16_f32 v67, v198, v199
    v_cvt_pk_bf16_f32 v68, v200, v201
    v_cvt_pk_bf16_f32 v69, v202, v203
    v_cvt_pk_bf16_f32 v70, v204, v205
    v_cvt_pk_bf16_f32 v71, v206, v207
    v_cvt_pk_bf16_f32 v72, v208, v209
    v_cvt_pk_bf16_f32 v73, v210, v211
    v_cvt_pk_bf16_f32 v74, v212, v213
    v_cvt_pk_bf16_f32 v75, v214, v215
    v_cvt_pk_bf16_f32 v76, v216, v217
    v_cvt_pk_bf16_f32 v77, v218, v219
    v_cvt_pk_bf16_f32 v78, v220, v221
    v_cvt_pk_bf16_f32 v79, v222, v223
    v_cvt_pk_bf16_f32 v80, v224, v225
    v_cvt_pk_bf16_f32 v81, v226, v227
    v_cvt_pk_bf16_f32 v82, v228, v229
    v_cvt_pk_bf16_f32 v83, v230, v231
    v_cvt_pk_bf16_f32 v84, v232, v233
    v_cvt_pk_bf16_f32 v85, v234, v235
    v_cvt_pk_bf16_f32 v86, v236, v237
    v_cvt_pk_bf16_f32 v87, v238, v239
    v_cvt_pk_bf16_f32 v88, v240, v241
    v_cvt_pk_bf16_f32 v89, v242, v243
    v_cvt_pk_bf16_f32 v90, v244, v245
    v_cvt_pk_bf16_f32 v91, v246, v247
    v_cvt_pk_bf16_f32 v92, v248, v249
    v_cvt_pk_bf16_f32 v93, v250, v251
    v_cvt_pk_bf16_f32 v94, v252, v253
    v_cvt_pk_bf16_f32 v95, v254, v255
    v_or_b32 v2, 128, v1
    v_and_b32 v3, 511, v1
    s_waitcnt vmcnt(20)
QA_P0:
    v_cmp_gt_u32 vcc, 64, v10
    s_cbranch_vccz QA_P0_D
    s_sleep 1
    s_cmp_ge_u32 s77, 6
    s_cbranch_scc1 QA_P0_Q
    s_sleep 12
QA_P0_Q:
    buffer_load_dword v10, off, s[8:11], s91 sc1
    s_sub_u32 s30, s30, 1
    s_cbranch_scc1 K_FAIL
    s_waitcnt vmcnt(0)
    s_branch QA_P0
QA_P0_D:
    s_add_u32 s88, s86, 0
    buffer_load_dwordx4 v[192:195], v2, s[8:11], s88 offen offset:0 sc1
    buffer_load_dwordx4 v[196:199], v2, s[8:11], s88 offen offset:1024 sc1
    buffer_load_dwordx4 v[200:203], v2, s[8:11], s88 offen offset:2048 sc1
    buffer_load_dwordx4 v[204:207], v2, s[8:11], s88 offen offset:3072 sc1
    s_add_u32 s88, s86, 4096
    buffer_load_dwordx4 v[208:211], v3, s[8:11], s88 offen offset:0 sc1
    buffer_load_dwordx4 v[212:215], v3, s[8:11], s88 offen offset:512 sc1
    buffer_load_dwordx4 v[216:219], v3, s[8:11], s88 offen offset:1024 sc1
    buffer_load_dwordx4 v[220:223], v3, s[8:11], s88 offen offset:1536 sc1
    v_lshrrev_b32 v7, 4, v0
    v_lshlrev_b32 v7, 2, v7
    v_sub_u32 v6, v6, v7
    v_mov_b32 v9, 0xff800000
    v_cmp_gt_i32 vcc, 0, v6
    s_nop 1
    v_cndmask_b32 v108, 0, v9, vcc
    v_cmp_gt_i32 vcc, 1, v6
    s_nop 1
    v_cndmask_b32 v109, 0, v9, vcc
    v_cmp_gt_i32 vcc, 2, v6
    s_nop 1
    v_cndmask_b32 v110, 0, v9, vcc
    v_cmp_gt_i32 vcc, 3, v6
    s_nop 1
    v_cndmask_b32 v111, 0, v9, vcc
    v_cmp_gt_u32 vcc, 32, v0
    s_nop 1
    v_cndmask_b32 v112, 0, v9, vcc
    v_cndmask_b32 v113, 0, v9, vcc
    v_cndmask_b32 v114, 0, v9, vcc
    v_cndmask_b32 v115, 0, v9, vcc
    v_mov_b32 v16, 0x3f803f80
    v_mov_b32 v17, 0x3f803f80
    v_mov_b32 v18, 0x3f803f80
    v_mov_b32 v19, 0x3f803f80
    s_mov_b32 s40, 0x3e0293ee
    s_mov_b32 s41, 0xbe0293ee
    s_waitcnt vmcnt(4)
    v_mfma_f32_16x16x32_bf16 v[96:99], v[192:195], v[32:35], v[112:115]
    v_mfma_f32_16x16x32_bf16 v[100:103], v[128:131], v[32:35], v[108:111]
    v_mfma_f32_16x16x32_bf16 v[96:99], v[196:199], v[36:39], v[96:99]
    v_mfma_f32_16x16x32_bf16 v[100:103], v[132:135], v[36:39], v[100:103]
    v_mfma_f32_16x16x32_bf16 v[96:99], v[200:203], v[40:43], v[96:99]
    v_mfma_f32_16x16x32_bf16 v[100:103], v[136:139], v[40:43], v[100:103]
    v_mfma_f32_16x16x32_bf16 v[96:99], v[204:207], v[44:47], v[96:99]
    v_mfma_f32_16x16x32_bf16 v[100:103], v[140:143], v[44:47], v[100:103]
    s_nop 7
    v_max3_f32 v6, v96, v97, v98
    v_max3_f32 v8, v99, v100, v101
    v_max3_f32 v6, v6, v102, v103
    v_max_f32 v7, v6, v8
    v_max_f32 v6, v6, v8
    s_nop 1
    v_permlane32_swap_b32 v6, v7
    v_max_f32 v8, v6, v7
    v_max_f32 v6, v6, v7
    s_nop 1
    v_permlane16_swap_b32 v6, v8
    v_max_f32 v6, v6, v8
    v_mul_f32 v8, s41, v6
    v_pk_mul_f32 v[96:97], v[96:97], s[40:41] op_sel_hi:[1,0]
    v_pk_mul_f32 v[98:99], v[98:99], s[40:41] op_sel_hi:[1,0]
    v_pk_mul_f32 v[100:101], v[100:101], s[40:41] op_sel_hi:[1,0]
    v_pk_mul_f32 v[102:103], v[102:103], s[40:41] op_sel_hi:[1,0]
    v_pk_add_f32 v[96:97], v[96:97], v[8:9] op_sel_hi:[1,0]
    v_pk_add_f32 v[98:99], v[98:99], v[8:9] op_sel_hi:[1,0]
    v_pk_add_f32 v[100:101], v[100:101], v[8:9] op_sel_hi:[1,0]
    v_pk_add_f32 v[102:103], v[102:103], v[8:9] op_sel_hi:[1,0]
    v_exp_f32 v96, v96
    v_exp_f32 v97, v97
    v_exp_f32 v98, v98
    v_exp_f32 v99, v99
    v_exp_f32 v100, v100
    v_exp_f32 v101, v101
    v_exp_f32 v102, v102
    v_exp_f32 v103, v103
    v_cvt_pk_bf16_f32 v24, v96, v97
    v_cvt_pk_bf16_f32 v25, v98, v99
    v_cvt_pk_bf16_f32 v26, v100, v101
    v_cvt_pk_bf16_f32 v27, v102, v103
    v_mov_b32 v28, 0
    v_mov_b32 v29, 0
    s_waitcnt vmcnt(0)
    v_mfma_f32_16x16x16_bf16 v[20:23], v[16:17], v[24:25], 0
    v_mfma_f32_16x16x16_bf16 v[224:227], v[208:209], v[24:25], 0
    v_mfma_f32_16x16x16_bf16 v[228:231], v[210:211], v[24:25], 0
    v_mfma_f32_16x16x16_bf16 v[232:235], v[212:213], v[24:25], 0
    v_mfma_f32_16x16x16_bf16 v[236:239], v[214:215], v[24:25], 0
    v_mfma_f32_16x16x16_bf16 v[240:243], v[216:217], v[24:25], 0
    v_mfma_f32_16x16x16_bf16 v[244:247], v[218:219], v[24:25], 0
    v_mfma_f32_16x16x16_bf16 v[248:251], v[220:221], v[24:25], 0
    v_mfma_f32_16x16x16_bf16 v[252:255], v[222:223], v[24:25], 0
    v_mfma_f32_16x16x32_bf16 v[20:23], v[16:19], v[26:29], v[20:23]
    v_mfma_f32_16x16x32_bf16 v[224:227], v[160:163], v[26:29], v[224:227]
    v_mfma_f32_16x16x32_bf16 v[228:231], v[164:167], v[26:29], v[228:231]
    v_mfma_f32_16x16x32_bf16 v[232:235], v[168:171], v[26:29], v[232:235]
    v_mfma_f32_16x16x32_bf16 v[236:239], v[172:175], v[26:29], v[236:239]
    v_mfma_f32_16x16x32_bf16 v[240:243], v[176:179], v[26:29], v[240:243]
    v_mfma_f32_16x16x32_bf16 v[244:247], v[180:183], v[26:29], v[244:247]
    v_mfma_f32_16x16x32_bf16 v[248:251], v[184:187], v[26:29], v[248:251]
    v_mfma_f32_16x16x32_bf16 v[252:255], v[188:191], v[26:29], v[252:255]
    v_rcp_f32 v20, v20
    s_nop 0
    v_mul_f32 v20, v20, v116
    v_pk_mul_f32 v[224:225], v[224:225], v[20:21] op_sel_hi:[1,0]
    v_pk_mul_f32 v[226:227], v[226:227], v[20:21] op_sel_hi:[1,0]
    v_pk_mul_f32 v[228:229], v[228:229], v[20:21] op_sel_hi:[1,0]
    v_pk_mul_f32 v[230:231], v[230:231], v[20:21] op_sel_hi:[1,0]
    v_pk_mul_f32 v[232:233], v[232:233], v[20:21] op_sel_hi:[1,0]
    v_pk_mul_f32 v[234:235], v[234:235], v[20:21] op_sel_hi:[1,0]
    v_pk_mul_f32 v[236:237], v[236:237], v[20:21] op_sel_hi:[1,0]
    v_pk_mul_f32 v[238:239], v[238:239], v[20:21] op_sel_hi:[1,0]
    v_pk_mul_f32 v[240:241], v[240:241], v[20:21] op_sel_hi:[1,0]
    v_pk_mul_f32 v[242:243], v[242:243], v[20:21] op_sel_hi:[1,0]
    v_pk_mul_f32 v[244:245], v[244:245], v[20:21] op_sel_hi:[1,0]
    v_pk_mul_f32 v[246:247], v[246:247], v[20:21] op_sel_hi:[1,0]
    v_pk_mul_f32 v[248:249], v[248:249], v[20:21] op_sel_hi:[1,0]
    v_pk_mul_f32 v[250:251], v[250:251], v[20:21] op_sel_hi:[1,0]
    v_pk_mul_f32 v[252:253], v[252:253], v[20:21] op_sel_hi:[1,0]
    v_pk_mul_f32 v[254:255], v[254:255], v[20:21] op_sel_hi:[1,0]
    v_cvt_pk_bf16_f32 v224, v224, v228
    v_cvt_pk_bf16_f32 v225, v225, v229
    v_cvt_pk_bf16_f32 v226, v226, v230
    v_cvt_pk_bf16_f32 v227, v227, v231
    v_min_u32 v224, -2, v224
    v_min_u32 v225, -2, v225
    v_min_u32 v226, -2, v226
    v_min_u32 v227, -2, v227
    buffer_store_dwordx4 v[224:227], v1, s[8:11], s87 offen offset:0 sc1
    v_cvt_pk_bf16_f32 v232, v232, v236
    v_cvt_pk_bf16_f32 v233, v233, v237
    v_cvt_pk_bf16_f32 v234, v234, v238
    v_cvt_pk_bf16_f32 v235, v235, v239
    v_min_u32 v232, -2, v232
    v_min_u32 v233, -2, v233
    v_min_u32 v234, -2, v234
    v_min_u32 v235, -2, v235
    buffer_store_dwordx4 v[232:235], v1, s[8:11], s87 offen offset:1024 sc1
    v_cvt_pk_bf16_f32 v240, v240, v244
    v_cvt_pk_bf16_f32 v241, v241, v245
    v_cvt_pk_bf16_f32 v242, v242, v246
    v_cvt_pk_bf16_f32 v243, v243, v247
    v_min_u32 v240, -2, v240
    v_min_u32 v241, -2, v241
    v_min_u32 v242, -2, v242
    v_min_u32 v243, -2, v243
    buffer_store_dwordx4 v[240:243], v1, s[8:11], s87 offen offset:2048 sc1
    v_cvt_pk_bf16_f32 v248, v248, v252
    v_cvt_pk_bf16_f32 v249, v249, v253
    v_cvt_pk_bf16_f32 v250, v250, v254
    v_cvt_pk_bf16_f32 v251, v251, v255
    v_min_u32 v248, -2, v248
    v_min_u32 v249, -2, v249
    v_min_u32 v250, -2, v250
    v_min_u32 v251, -2, v251
    buffer_store_dwordx4 v[248:251], v1, s[8:11], s87 offen offset:3072 sc1
    s_add_u32 s87, s87, 131072
    v_mfma_f32_16x16x32_bf16 v[96:99], v[192:195], v[48:51], v[112:115]
    v_mfma_f32_16x16x32_bf16 v[100:103], v[128:131], v[48:51], 0
    v_mfma_f32_16x16x32_bf16 v[104:107], v[144:147], v[48:51], v[108:111]
    v_mfma_f32_16x16x32_bf16 v[96:99], v[196:199], v[52:55], v[96:99]
    v_mfma_f32_16x16x32_bf16 v[100:103], v[132:135], v[52:55], v[100:103]
    v_mfma_f32_16x16x32_bf16 v[104:107], v[148:151], v[52:55], v[104:107]
    v_mfma_f32_16x16x32_bf16 v[96:99], v[200:203], v[56:59], v[96:99]
    v_mfma_f32_16x16x32_bf16 v[100:103], v[136:139], v[56:59], v[100:103]
    v_mfma_f32_16x16x32_bf16 v[104:107], v[152:155], v[56:59], v[104:107]
    v_mfma_f32_16x16x32_bf16 v[96:99], v[204:207], v[60:63], v[96:99]
    v_mfma_f32_16x16x32_bf16 v[100:103], v[140:143], v[60:63], v[100:103]
    v_mfma_f32_16x16x32_bf16 v[104:107], v[156:159], v[60:63], v[104:107]
    v_readfirstlane_b32 s89, v11
    s_add_u32 s88, s85, 4718592
    buffer_load_dwordx4 v[128:131], v1, s[8:11], s88 offen offset:0 sc1
    buffer_load_dwordx4 v[132:135], v1, s[8:11], s88 offen offset:1024 sc1
    buffer_load_dwordx4 v[136:139], v1, s[8:11], s88 offen offset:2048 sc1
    buffer_load_dwordx4 v[140:143], v1, s[8:11], s88 offen offset:3072 sc1
    s_add_u32 s88, s85, 4722688
    buffer_load_dwordx4 v[144:147], v1, s[8:11], s88 offen offset:0 sc1
    buffer_load_dwordx4 v[148:151], v1, s[8:11], s88 offen offset:1024 sc1
    buffer_load_dwordx4 v[152:155], v1, s[8:11], s88 offen offset:2048 sc1
    buffer_load_dwordx4 v[156:159], v1, s[8:11], s88 offen offset:3072 sc1
    s_lshr_b32 s89, s89, 6
    s_cbranch_scc0 QA_N1
    s_add_u32 s88, s86, 524288
    buffer_load_dwordx4 v[192:195], v2, s[8:11], s88 offen offset:0 sc1
    buffer_load_dwordx4 v[196:199], v2, s[8:11], s88 offen offset:1024 sc1
    buffer_load_dwordx4 v[200:203], v2, s[8:11], s88 offen offset:2048 sc1
    buffer_load_dwordx4 v[204:207], v2, s[8:11], s88 offen offset:3072 sc1
QA_N1:
    v_max3_f32 v6, v96, v97, v98
    v_max3_f32 v8, v99, v100, v101
    v_max3_f32 v6, v6, v102, v103
    v_max3_f32 v8, v8, v104, v105
    v_max3_f32 v6, v6, v106, v107
    v_max_f32 v7, v6, v8
    v_max_f32 v6, v6, v8
    s_nop 1
    v_permlane32_swap_b32 v6, v7
    v_max_f32 v8, v6, v7
    v_max_f32 v6, v6, v7
    s_nop 1
    v_permlane16_swap_b32 v6, v8
    v_max_f32 v6, v6, v8
    v_mul_f32 v8, s41, v6
    v_pk_mul_f32 v[96:97], v[96:97], s[40:41] op_sel_hi:[1,0]
    v_pk_mul_f32 v[98:99], v[98:99], s[40:41] op_sel_hi:[1,0]
    v_pk_mul_f32 v[100:101], v[100:101], s[40:41] op_sel_hi:[1,0]
    v_pk_mul_f32 v[102:103], v[102:103], s[40:41] op_sel_hi:[1,0]
    v_pk_mul_f32 v[104:105], v[104:105], s[40:41] op_sel_hi:[1,0]
    v_pk_mul_f32 v[106:107], v[106:107], s[40:41] op_sel_hi:[1,0]
    v_pk_add_f32 v[96:97], v[96:97], v[8:9] op_sel_hi:[1,0]
    v_pk_add_f32 v[98:99], v[98:99], v[8:9] op_sel_hi:[1,0]
    v_pk_add_f32 v[100:101], v[100:101], v[8:9] op_sel_hi:[1,0]
    v_pk_add_f32 v[102:103], v[102:103], v[8:9] op_sel_hi:[1,0]
    v_pk_add_f32 v[104:105], v[104:105], v[8:9] op_sel_hi:[1,0]
    v_pk_add_f32 v[106:107], v[106:107], v[8:9] op_sel_hi:[1,0]
    v_exp_f32 v96, v96
    v_exp_f32 v97, v97
    v_exp_f32 v98, v98
    v_exp_f32 v99, v99
    v_exp_f32 v100, v100
    v_exp_f32 v101, v101
    v_exp_f32 v102, v102
    v_exp_f32 v103, v103
    v_exp_f32 v104, v104
    v_exp_f32 v105, v105
    v_exp_f32 v106, v106
    v_exp_f32 v107, v107
    v_cvt_pk_bf16_f32 v24, v96, v97
    v_cvt_pk_bf16_f32 v25, v98, v99
    v_cvt_pk_bf16_f32 v26, v100, v101
    v_cvt_pk_bf16_f32 v27, v102, v103
    v_cvt_pk_bf16_f32 v28, v104, v105
    v_cvt_pk_bf16_f32 v29, v106, v107
    v_mfma_f32_16x16x16_bf16 v[20:23], v[16:17], v[24:25], 0
    v_mfma_f32_16x16x16_bf16 v[224:227], v[208:209], v[24:25], 0
    v_mfma_f32_16x16x16_bf16 v[228:231], v[210:211], v[24:25], 0
    v_mfma_f32_16x16x16_bf16 v[232:235], v[212:213], v[24:25], 0
    v_mfma_f32_16x16x16_bf16 v[236:239], v[214:215], v[24:25], 0
    v_mfma_f32_16x16x16_bf16 v[240:243], v[216:217], v[24:25], 0
    v_mfma_f32_16x16x16_bf16 v[244:247], v[218:219], v[24:25], 0
    v_mfma_f32_16x16x16_bf16 v[248:251], v[220:221], v[24:25], 0
    v_mfma_f32_16x16x16_bf16 v[252:255], v[222:223], v[24:25], 0
    v_mfma_f32_16x16x32_bf16 v[20:23], v[16:19], v[26:29], v[20:23]
    v_mfma_f32_16x16x32_bf16 v[224:227], v[160:163], v[26:29], v[224:227]
    v_mfma_f32_16x16x32_bf16 v[228:231], v[164:167], v[26:29], v[228:231]
    v_mfma_f32_16x16x32_bf16 v[232:235], v[168:171], v[26:29], v[232:235]
    v_mfma_f32_16x16x32_bf16 v[236:239], v[172:175], v[26:29], v[236:239]
    v_mfma_f32_16x16x32_bf16 v[240:243], v[176:179], v[26:29], v[240:243]
    v_mfma_f32_16x16x32_bf16 v[244:247], v[180:183], v[26:29], v[244:247]
    v_mfma_f32_16x16x32_bf16 v[248:251], v[184:187], v[26:29], v[248:251]
    v_mfma_f32_16x16x32_bf16 v[252:255], v[188:191], v[26:29], v[252:255]
    s_add_u32 s88, s85, 4726784
    buffer_load_dwordx4 v[160:163], v1, s[8:11], s88 offen offset:0 sc1
    buffer_load_dwordx4 v[164:167], v1, s[8:11], s88 offen offset:1024 sc1
    buffer_load_dwordx4 v[168:171], v1, s[8:11], s88 offen offset:2048 sc1
    buffer_load_dwordx4 v[172:175], v1, s[8:11], s88 offen offset:3072 sc1
    s_add_u32 s88, s85, 4730880
    buffer_load_dwordx4 v[176:179], v1, s[8:11], s88 offen offset:0 sc1
    buffer_load_dwordx4 v[180:183], v1, s[8:11], s88 offen offset:1024 sc1
    buffer_load_dwordx4 v[184:187], v1, s[8:11], s88 offen offset:2048 sc1
    buffer_load_dwordx4 v[188:191], v1, s[8:11], s88 offen offset:3072 sc1
    s_cmp_eq_u32 s89, 0
    s_cbranch_scc1 QA_N2
    s_add_u32 s88, s86, 528384
    buffer_load_dwordx4 v[208:211], v3, s[8:11], s88 offen offset:0 sc1
    buffer_load_dwordx4 v[212:215], v3, s[8:11], s88 offen offset:512 sc1
    buffer_load_dwordx4 v[216:219], v3, s[8:11], s88 offen offset:1024 sc1
    buffer_load_dwordx4 v[220:223], v3, s[8:11], s88 offen offset:1536 sc1
QA_N2:
    v_rcp_f32 v20, v20
    s_nop 0
    v_mul_f32 v20, v20, v117
    v_pk_mul_f32 v[224:225], v[224:225], v[20:21] op_sel_hi:[1,0]
    v_pk_mul_f32 v[226:227], v[226:227], v[20:21] op_sel_hi:[1,0]
    v_pk_mul_f32 v[228:229], v[228:229], v[20:21] op_sel_hi:[1,0]
    v_pk_mul_f32 v[230:231], v[230:231], v[20:21] op_sel_hi:[1,0]
    v_pk_mul_f32 v[232:233], v[232:233], v[20:21] op_sel_hi:[1,0]
    v_pk_mul_f32 v[234:235], v[234:235], v[20:21] op_sel_hi:[1,0]
    v_pk_mul_f32 v[236:237], v[236:237], v[20:21] op_sel_hi:[1,0]
    v_pk_mul_f32 v[238:239], v[238:239], v[20:21] op_sel_hi:[1,0]
    v_pk_mul_f32 v[240:241], v[240:241], v[20:21] op_sel_hi:[1,0]
    v_pk_mul_f32 v[242:243], v[242:243], v[20:21] op_sel_hi:[1,0]
    v_pk_mul_f32 v[244:245], v[244:245], v[20:21] op_sel_hi:[1,0]
    v_pk_mul_f32 v[246:247], v[246:247], v[20:21] op_sel_hi:[1,0]
    v_pk_mul_f32 v[248:249], v[248:249], v[20:21] op_sel_hi:[1,0]
    v_pk_mul_f32 v[250:251], v[250:251], v[20:21] op_sel_hi:[1,0]
    v_pk_mul_f32 v[252:253], v[252:253], v[20:21] op_sel_hi:[1,0]
    v_pk_mul_f32 v[254:255], v[254:255], v[20:21] op_sel_hi:[1,0]
    v_cvt_pk_bf16_f32 v224, v224, v228
    v_cvt_pk_bf16_f32 v225, v225, v229
    v_cvt_pk_bf16_f32 v226, v226, v230
    v_cvt_pk_bf16_f32 v227, v227, v231
    v_min_u32 v224, -2, v224
    v_min_u32 v225, -2, v225
    v_min_u32 v226, -2, v226
    v_min_u32 v227, -2, v227
    buffer_store_dwordx4 v[224:227], v1, s[8:11], s87 offen offset:0 sc1
    v_cvt_pk_bf16_f32 v232, v232, v236
    v_cvt_pk_bf16_f32 v233, v233, v237
    v_cvt_pk_bf16_f32 v234, v234, v238
    v_cvt_pk_bf16_f32 v235, v235, v239
    v_min_u32 v232, -2, v232
    v_min_u32 v233, -2, v233
    v_min_u32 v234, -2, v234
    v_min_u32 v235, -2, v235
    buffer_store_dwordx4 v[232:235], v1, s[8:11], s87 offen offset:1024 sc1
    v_cvt_pk_bf16_f32 v240, v240, v244
    v_cvt_pk_bf16_f32 v241, v241, v245
    v_cvt_pk_bf16_f32 v242, v242, v246
    v_cvt_pk_bf16_f32 v243, v243, v247
    v_min_u32 v240, -2, v240
    v_min_u32 v241, -2, v241
    v_min_u32 v242, -2, v242
    v_min_u32 v243, -2, v243
    buffer_store_dwordx4 v[240:243], v1, s[8:11], s87 offen offset:2048 sc1
    v_cvt_pk_bf16_f32 v248, v248, v252
    v_cvt_pk_bf16_f32 v249, v249, v253
    v_cvt_pk_bf16_f32 v250, v250, v254
    v_cvt_pk_bf16_f32 v251, v251, v255
    v_min_u32 v248, -2, v248
    v_min_u32 v249, -2, v249
    v_min_u32 v250, -2, v250
    v_min_u32 v251, -2, v251
    buffer_store_dwordx4 v[248:251], v1, s[8:11], s87 offen offset:3072 sc1
    s_add_u32 s87, s87, 131072
    s_cmp_lg_u32 s89, 0
    s_cbranch_scc1 QA_E1
    s_waitcnt vmcnt(63)
QA_P1:
    v_cmp_gt_u32 vcc, 64, v11
    s_cbranch_vccz QA_P1_D
    s_sleep 1
    s_cmp_ge_u32 s77, 6
    s_cbranch_scc1 QA_P1_Q
    s_sleep 12
QA_P1_Q:
    buffer_load_dword v11, off, s[8:11], s92 sc1
    s_sub_u32 s30, s30, 1
    s_cbranch_scc1 K_FAIL
    s_waitcnt vmcnt(0)
    s_branch QA_P1
QA_P1_D:
    s_add_u32 s88, s86, 524288
    buffer_load_dwordx4 v[192:195], v2, s[8:11], s88 offen offset:0 sc1
    buffer_load_dwordx4 v[196:199], v2, s[8:11], s88 offen offset:1024 sc1
    buffer_load_dwordx4 v[200:203], v2, s[8:11], s88 offen offset:2048 sc1
    buffer_load_dwordx4 v[204:207], v2, s[8:11], s88 offen offset:3072 sc1
    s_add_u32 s88, s86, 528384
    buffer_load_dwordx4 v[208:211], v3, s[8:11], s88 offen offset:0 sc1
    buffer_load_dwordx4 v[212:215], v3, s[8:11], s88 offen offset:512 sc1
    buffer_load_dwordx4 v[216:219], v3, s[8:11], s88 offen offset:1024 sc1
    buffer_load_dwordx4 v[220:223], v3, s[8:11], s88 offen offset:1536 sc1
    s_waitcnt vmcnt(0)
QA_E1:
    s_waitcnt vmcnt(16)
    v_mfma_f32_16x16x32_bf16 v[96:99], v[192:195], v[64:67], v[112:115]
    v_mfma_f32_16x16x32_bf16 v[100:103], v[128:131], v[64:67], v[108:111]
    v_mfma_f32_16x16x32_bf16 v[96:99], v[196:199], v[68:71], v[96:99]
    v_mfma_f32_16x16x32_bf16 v[100:103], v[132:135], v[68:71], v[100:103]
    v_mfma_f32_16x16x32_bf16 v[96:99], v[200:203], v[72:75], v[96:99]
    v_mfma_f32_16x16x32_bf16 v[100:103], v[136:139], v[72:75], v[100:103]
    v_mfma_f32_16x16x32_bf16 v[96:99], v[204:207], v[76:79], v[96:99]
    v_mfma_f32_16x16x32_bf16 v[100:103], v[140:143], v[76:79], v[100:103]
    s_nop 7
    v_max3_f32 v6, v96, v97, v98
    v_max3_f32 v8, v99, v100, v101
    v_max3_f32 v6, v6, v102, v103
    v_max_f32 v7, v6, v8
    v_max_f32 v6, v6, v8
    s_nop 1
    v_permlane32_swap_b32 v6, v7
    v_max_f32 v8, v6, v7
    v_max_f32 v6, v6, v7
    s_nop 1
    v_permlane16_swap_b32 v6, v8
    v_max_f32 v6, v6, v8
    v_mul_f32 v8, s41, v6
    v_pk_mul_f32 v[96:97], v[96:97], s[40:41] op_sel_hi:[1,0]
    v_pk_mul_f32 v[98:99], v[98:99], s[40:41] op_sel_hi:[1,0]
    v_pk_mul_f32 v[100:101], v[100:101], s[40:41] op_sel_hi:[1,0]
    v_pk_mul_f32 v[102:103], v[102:103], s[40:41] op_sel_hi:[1,0]
    v_pk_add_f32 v[96:97], v[96:97], v[8:9] op_sel_hi:[1,0]
    v_pk_add_f32 v[98:99], v[98:99], v[8:9] op_sel_hi:[1,0]
    v_pk_add_f32 v[100:101], v[100:101], v[8:9] op_sel_hi:[1,0]
    v_pk_add_f32 v[102:103], v[102:103], v[8:9] op_sel_hi:[1,0]
    v_exp_f32 v96, v96
    v_exp_f32 v97, v97
    v_exp_f32 v98, v98
    v_exp_f32 v99, v99
    v_exp_f32 v100, v100
    v_exp_f32 v101, v101
    v_exp_f32 v102, v102
    v_exp_f32 v103, v103
    v_cvt_pk_bf16_f32 v24, v96, v97
    v_cvt_pk_bf16_f32 v25, v98, v99
    v_cvt_pk_bf16_f32 v26, v100, v101
    v_cvt_pk_bf16_f32 v27, v102, v103
    v_mov_b32 v28, 0
    v_mov_b32 v29, 0
    s_waitcnt vmcnt(4)
    v_mfma_f32_16x16x16_bf16 v[20:23], v[16:17], v[24:25], 0
    v_mfma_f32_16x16x16_bf16 v[224:227], v[208:209], v[24:25], 0
    v_mfma_f32_16x16x16_bf16 v[228:231], v[210:211], v[24:25], 0
    v_mfma_f32_16x16x16_bf16 v[232:235], v[212:213], v[24:25], 0
    v_mfma_f32_16x16x16_bf16 v[236:239], v[214:215], v[24:25], 0
    v_mfma_f32_16x16x16_bf16 v[240:243], v[216:217], v[24:25], 0
    v_mfma_f32_16x16x16_bf16 v[244:247], v[218:219], v[24:25], 0
    v_mfma_f32_16x16x16_bf16 v[248:251], v[220:221], v[24:25], 0
    v_mfma_f32_16x16x16_bf16 v[252:255], v[222:223], v[24:25], 0
    v_mfma_f32_16x16x32_bf16 v[20:23], v[16:19], v[26:29], v[20:23]
    v_mfma_f32_16x16x32_bf16 v[224:227], v[160:163], v[26:29], v[224:227]
    v_mfma_f32_16x16x32_bf16 v[228:231], v[164:167], v[26:29], v[228:231]
    v_mfma_f32_16x16x32_bf16 v[232:235], v[168:171], v[26:29], v[232:235]
    v_mfma_f32_16x16x32_bf16 v[236:239], v[172:175], v[26:29], v[236:239]
    v_mfma_f32_16x16x32_bf16 v[240:243], v[176:179], v[26:29], v[240:243]
    v_mfma_f32_16x16x32_bf16 v[244:247], v[180:183], v[26:29], v[244:247]
    v_mfma_f32_16x16x32_bf16 v[248:251], v[184:187], v[26:29], v[248:251]
    v_mfma_f32_16x16x32_bf16 v[252:255], v[188:191], v[26:29], v[252:255]
    v_rcp_f32 v20, v20
    s_nop 0
    v_mul_f32 v20, v20, v118
    v_pk_mul_f32 v[224:225], v[224:225], v[20:21] op_sel_hi:[1,0]
    v_pk_mul_f32 v[226:227], v[226:227], v[20:21] op_sel_hi:[1,0]
    v_pk_mul_f32 v[228:229], v[228:229], v[20:21] op_sel_hi:[1,0]
    v_pk_mul_f32 v[230:231], v[230:231], v[20:21] op_sel_hi:[1,0]
    v_pk_mul_f32 v[232:233], v[232:233], v[20:21] op_sel_hi:[1,0]
    v_pk_mul_f32 v[234:235], v[234:235], v[20:21] op_sel_hi:[1,0]
    v_pk_mul_f32 v[236:237], v[236:237], v[20:21] op_sel_hi:[1,0]
    v_pk_mul_f32 v[238:239], v[238:239], v[20:21] op_sel_hi:[1,0]
    v_pk_mul_f32 v[240:241], v[240:241], v[20:21] op_sel_hi:[1,0]
    v_pk_mul_f32 v[242:243], v[242:243], v[20:21] op_sel_hi:[1,0]
    v_pk_mul_f32 v[244:245], v[244:245], v[20:21] op_sel_hi:[1,0]
    v_pk_mul_f32 v[246:247], v[246:247], v[20:21] op_sel_hi:[1,0]
    v_pk_mul_f32 v[248:249], v[248:249], v[20:21] op_sel_hi:[1,0]
    v_pk_mul_f32 v[250:251], v[250:251], v[20:21] op_sel_hi:[1,0]
    v_pk_mul_f32 v[252:253], v[252:253], v[20:21] op_sel_hi:[1,0]
    v_pk_mul_f32 v[254:255], v[254:255], v[20:21] op_sel_hi:[1,0]
    v_cvt_pk_bf16_f32 v224, v224, v228
    v_cvt_pk_bf16_f32 v225, v225, v229
    v_cvt_pk_bf16_f32 v226, v226, v230
    v_cvt_pk_bf16_f32 v227, v227, v231
    v_min_u32 v224, -2, v224
    v_min_u32 v225, -2, v225
    v_min_u32 v226, -2, v226
    v_min_u32 v227, -2, v227
    buffer_store_dwordx4 v[224:227], v1, s[8:11], s87 offen offset:0 sc1
    v_cvt_pk_bf16_f32 v232, v232, v236
    v_cvt_pk_bf16_f32 v233, v233, v237
    v_cvt_pk_bf16_f32 v234, v234, v238
    v_cvt_pk_bf16_f32 v235, v235, v239
    v_min_u32 v232, -2, v232
    v_min_u32 v233, -2, v233
    v_min_u32 v234, -2, v234
    v_min_u32 v235, -2, v235
    buffer_store_dwordx4 v[232:235], v1, s[8:11], s87 offen offset:1024 sc1
    v_cvt_pk_bf16_f32 v240, v240, v244
    v_cvt_pk_bf16_f32 v241, v241, v245
    v_cvt_pk_bf16_f32 v242, v242, v246
    v_cvt_pk_bf16_f32 v243, v243, v247
    v_min_u32 v240, -2, v240
    v_min_u32 v241, -2, v241
    v_min_u32 v242, -2, v242
    v_min_u32 v243, -2, v243
    buffer_store_dwordx4 v[240:243], v1, s[8:11], s87 offen offset:2048 sc1
    v_cvt_pk_bf16_f32 v248, v248, v252
    v_cvt_pk_bf16_f32 v249, v249, v253
    v_cvt_pk_bf16_f32 v250, v250, v254
    v_cvt_pk_bf16_f32 v251, v251, v255
    v_min_u32 v248, -2, v248
    v_min_u32 v249, -2, v249
    v_min_u32 v250, -2, v250
    v_min_u32 v251, -2, v251
    buffer_store_dwordx4 v[248:251], v1, s[8:11], s87 offen offset:3072 sc1
    s_add_u32 s87, s87, 131072
    v_mfma_f32_16x16x32_bf16 v[96:99], v[192:195], v[80:83], v[112:115]
    v_mfma_f32_16x16x32_bf16 v[100:103], v[128:131], v[80:83], 0
    v_mfma_f32_16x16x32_bf16 v[104:107], v[144:147], v[80:83], v[108:111]
    v_mfma_f32_16x16x32_bf16 v[96:99], v[196:199], v[84:87], v[96:99]
    v_mfma_f32_16x16x32_bf16 v[100:103], v[132:135], v[84:87], v[100:103]
    v_mfma_f32_16x16x32_bf16 v[104:107], v[148:151], v[84:87], v[104:107]
    v_mfma_f32_16x16x32_bf16 v[96:99], v[200:203], v[88:91], v[96:99]
    v_mfma_f32_16x16x32_bf16 v[100:103], v[136:139], v[88:91], v[100:103]
    v_mfma_f32_16x16x32_bf16 v[104:107], v[152:155], v[88:91], v[104:107]
    v_mfma_f32_16x16x32_bf16 v[96:99], v[204:207], v[92:95], v[96:99]
    v_mfma_f32_16x16x32_bf16 v[100:103], v[140:143], v[92:95], v[100:103]
    v_mfma_f32_16x16x32_bf16 v[104:107], v[156:159], v[92:95], v[104:107]
    s_nop 7
    v_max3_f32 v6, v96, v97, v98
    v_max3_f32 v8, v99, v100, v101
    v_max3_f32 v6, v6, v102, v103
    v_max3_f32 v8, v8, v104, v105
    v_max3_f32 v6, v6, v106, v107
    v_max_f32 v7, v6, v8
    v_max_f32 v6, v6, v8
    s_nop 1
    v_permlane32_swap_b32 v6, v7
    v_max_f32 v8, v6, v7
    v_max_f32 v6, v6, v7
    s_nop 1
    v_permlane16_swap_b32 v6, v8
    v_max_f32 v6, v6, v8
    v_mul_f32 v8, s41, v6
    v_pk_mul_f32 v[96:97], v[96:97], s[40:41] op_sel_hi:[1,0]
    v_pk_mul_f32 v[98:99], v[98:99], s[40:41] op_sel_hi:[1,0]
    v_pk_mul_f32 v[100:101], v[100:101], s[40:41] op_sel_hi:[1,0]
    v_pk_mul_f32 v[102:103], v[102:103], s[40:41] op_sel_hi:[1,0]
    v_pk_mul_f32 v[104:105], v[104:105], s[40:41] op_sel_hi:[1,0]
    v_pk_mul_f32 v[106:107], v[106:107], s[40:41] op_sel_hi:[1,0]
    v_pk_add_f32 v[96:97], v[96:97], v[8:9] op_sel_hi:[1,0]
    v_pk_add_f32 v[98:99], v[98:99], v[8:9] op_sel_hi:[1,0]
    v_pk_add_f32 v[100:101], v[100:101], v[8:9] op_sel_hi:[1,0]
    v_pk_add_f32 v[102:103], v[102:103], v[8:9] op_sel_hi:[1,0]
    v_pk_add_f32 v[104:105], v[104:105], v[8:9] op_sel_hi:[1,0]
    v_pk_add_f32 v[106:107], v[106:107], v[8:9] op_sel_hi:[1,0]
    v_exp_f32 v96, v96
    v_exp_f32 v97, v97
    v_exp_f32 v98, v98
    v_exp_f32 v99, v99
    v_exp_f32 v100, v100
    v_exp_f32 v101, v101
    v_exp_f32 v102, v102
    v_exp_f32 v103, v103
    v_exp_f32 v104, v104
    v_exp_f32 v105, v105
    v_exp_f32 v106, v106
    v_exp_f32 v107, v107
    v_cvt_pk_bf16_f32 v24, v96, v97
    v_cvt_pk_bf16_f32 v25, v98, v99
    v_cvt_pk_bf16_f32 v26, v100, v101
    v_cvt_pk_bf16_f32 v27, v102, v103
    v_cvt_pk_bf16_f32 v28, v104, v105
    v_cvt_pk_bf16_f32 v29, v106, v107
    v_mfma_f32_16x16x16_bf16 v[20:23], v[16:17], v[24:25], 0
    v_mfma_f32_16x16x16_bf16 v[224:227], v[208:209], v[24:25], 0
    v_mfma_f32_16x16x16_bf16 v[228:231], v[210:211], v[24:25], 0
    v_mfma_f32_16x16x16_bf16 v[232:235], v[212:213], v[24:25], 0
    v_mfma_f32_16x16x16_bf16 v[236:239], v[214:215], v[24:25], 0
    v_mfma_f32_16x16x16_bf16 v[240:243], v[216:217], v[24:25], 0
    v_mfma_f32_16x16x16_bf16 v[244:247], v[218:219], v[24:25], 0
    v_mfma_f32_16x16x16_bf16 v[248:251], v[220:221], v[24:25], 0
    v_mfma_f32_16x16x16_bf16 v[252:255], v[222:223], v[24:25], 0
    v_mfma_f32_16x16x32_bf16 v[20:23], v[16:19], v[26:29], v[20:23]
    v_mfma_f32_16x16x32_bf16 v[224:227], v[160:163], v[26:29], v[224:227]
    v_mfma_f32_16x16x32_bf16 v[228:231], v[164:167], v[26:29], v[228:231]
    v_mfma_f32_16x16x32_bf16 v[232:235], v[168:171], v[26:29], v[232:235]
    v_mfma_f32_16x16x32_bf16 v[236:239], v[172:175], v[26:29], v[236:239]
    v_mfma_f32_16x16x32_bf16 v[240:243], v[176:179], v[26:29], v[240:243]
    v_mfma_f32_16x16x32_bf16 v[244:247], v[180:183], v[26:29], v[244:247]
    v_mfma_f32_16x16x32_bf16 v[248:251], v[184:187], v[26:29], v[248:251]
    v_mfma_f32_16x16x32_bf16 v[252:255], v[188:191], v[26:29], v[252:255]
    v_rcp_f32 v20, v20
    s_nop 0
    v_mul_f32 v20, v20, v119
    v_pk_mul_f32 v[224:225], v[224:225], v[20:21] op_sel_hi:[1,0]
    v_pk_mul_f32 v[226:227], v[226:227], v[20:21] op_sel_hi:[1,0]
    v_pk_mul_f32 v[228:229], v[228:229], v[20:21] op_sel_hi:[1,0]
    v_pk_mul_f32 v[230:231], v[230:231], v[20:21] op_sel_hi:[1,0]
    v_pk_mul_f32 v[232:233], v[232:233], v[20:21] op_sel_hi:[1,0]
    v_pk_mul_f32 v[234:235], v[234:235], v[20:21] op_sel_hi:[1,0]
    v_pk_mul_f32 v[236:237], v[236:237], v[20:21] op_sel_hi:[1,0]
    v_pk_mul_f32 v[238:239], v[238:239], v[20:21] op_sel_hi:[1,0]
    v_pk_mul_f32 v[240:241], v[240:241], v[20:21] op_sel_hi:[1,0]
    v_pk_mul_f32 v[242:243], v[242:243], v[20:21] op_sel_hi:[1,0]
    v_pk_mul_f32 v[244:245], v[244:245], v[20:21] op_sel_hi:[1,0]
    v_pk_mul_f32 v[246:247], v[246:247], v[20:21] op_sel_hi:[1,0]
    v_pk_mul_f32 v[248:249], v[248:249], v[20:21] op_sel_hi:[1,0]
    v_pk_mul_f32 v[250:251], v[250:251], v[20:21] op_sel_hi:[1,0]
    v_pk_mul_f32 v[252:253], v[252:253], v[20:21] op_sel_hi:[1,0]
    v_pk_mul_f32 v[254:255], v[254:255], v[20:21] op_sel_hi:[1,0]
    v_cvt_pk_bf16_f32 v224, v224, v228
    v_cvt_pk_bf16_f32 v225, v225, v229
    v_cvt_pk_bf16_f32 v226, v226, v230
    v_cvt_pk_bf16_f32 v227, v227, v231
    v_min_u32 v224, -2, v224
    v_min_u32 v225, -2, v225
    v_min_u32 v226, -2, v226
    v_min_u32 v227, -2, v227
    buffer_store_dwordx4 v[224:227], v1, s[8:11], s87 offen offset:0 sc1
    v_cvt_pk_bf16_f32 v232, v232, v236
    v_cvt_pk_bf16_f32 v233, v233, v237
    v_cvt_pk_bf16_f32 v234, v234, v238
    v_cvt_pk_bf16_f32 v235, v235, v239
    v_min_u32 v232, -2, v232
    v_min_u32 v233, -2, v233
    v_min_u32 v234, -2, v234
    v_min_u32 v235, -2, v235
    buffer_store_dwordx4 v[232:235], v1, s[8:11], s87 offen offset:1024 sc1
    v_cvt_pk_bf16_f32 v240, v240, v244
    v_cvt_pk_bf16_f32 v241, v241, v245
    v_cvt_pk_bf16_f32 v242, v242, v246
    v_cvt_pk_bf16_f32 v243, v243, v247
    v_min_u32 v240, -2, v240
    v_min_u32 v241, -2, v241
    v_min_u32 v242, -2, v242
    v_min_u32 v243, -2, v243
    buffer_store_dwordx4 v[240:243], v1, s[8:11], s87 offen offset:2048 sc1
    v_cvt_pk_bf16_f32 v248, v248, v252
    v_cvt_pk_bf16_f32 v249, v249, v253
    v_cvt_pk_bf16_f32 v250, v250, v254
    v_cvt_pk_bf16_f32 v251, v251, v255
    v_min_u32 v248, -2, v248
    v_min_u32 v249, -2, v249
    v_min_u32 v250, -2, v250
    v_min_u32 v251, -2, v251
    buffer_store_dwordx4 v[248:251], v1, s[8:11], s87 offen offset:3072 sc1
    s_add_u32 s87, s87, 131072
    v_mov_b32 v10, 1
    s_waitcnt vmcnt(0)
    s_mov_b64 exec, 1
    buffer_atomic_add v10, off, s[8:11], s93 sc1
    s_mov_b64 exec, -1
    s_barrier
    s_branch G_DONE
H_G2:
    s_and_b32 s94, s26, 255
    s_bfe_u32 s91, s26, 0x80008
    s_lshr_b32 s4, s26, 16
    s_mul_i32 s95, s4, s52
    s_add_u32 s95, s95, s27
    s_lshl_b32 s95, s95, 16
    s_add_u32 s95, s95, 125829120
    s_lshl_b32 s93, s52, 4
    s_add_u32 s93, s93, s79
    s_mov_b32 s60, s8
    s_mov_b32 s61, s9
    s_mov_b32 s62, s10
    s_mov_b32 s63, s11
    s_load_dwordx2 s[4:5], s[0:1], 40
    s_mul_i32 s68, s77, 2097152
    s_lshl_b32 s86, s93, 11
    s_add_u32 s68, s68, s86
    s_add_u32 s68, s68, 88080384
    s_mul_i32 s69, s78, 512
    s_lshl_b32 s86, s93, 17
    s_add_u32 s69, s69, s86
    s_waitcnt lgkmcnt(0)
    s_mov_b32 s64, s4
    s_and_b32 s65, s5, 0xffff
    s_mov_b32 s66, 8388608
    s_mov_b32 s67, 0x20000
    s_lshr_b32 s72, s76, 2
    s_and_b32 s73, s76, 3
    s_lshr_b32 s71, s76, 1
    s_mul_i32 s71, s71, 131072
    s_and_b32 s70, s76, 1
    s_lshl_b32 s70, s70, 10
    s_add_u32 s71, s71, s70
    v_lshl_add_u32 v1, v0, 4, s71
    s_mul_i32 s71, s72, 16384
    v_lshl_add_u32 v4, v0, 4, s71
    v_add_u32 v5, 1024, v4
    v_lshrrev_b32 v14, 5, v0
    s_mul_i32 s71, s76, 2
    v_add_u32 v14, s71, v14
    v_and_b32 v15, 3, v14
    v_lshlrev_b32 v15, 1, v15
    v_and_b32 v16, 8, v14
    v_or_b32 v15, v15, v16
    v_and_b32 v16, 31, v0
    v_xor_b32 v15, v15, v16
    s_mov_b32 s71, 2048
    v_mul_lo_u32 v2, v14, s71
    v_lshl_add_u32 v2, v15, 4, v2
    v_bfe_u32 v14, v0, 2, 2
    v_lshrrev_b32 v15, 4, v0
    v_lshl_add_u32 v15, v15, 3, v14
    v_mul_u32_u24 v15, 512, v15
    v_and_b32 v16, 3, v0
    v_lshl_add_u32 v15, v16, 3, v15
    v_add_u32 v15, 32768, v15
    v_bfe_u32 v14, v0, 2, 3
    s_mul_i32 s71, s73, 4
    v_xor_b32 v14, s71, v14
    v_lshl_add_u32 v6, v14, 5, v15
    v_xor_b32 v7, 32, v6
    v_xor_b32 v8, 64, v6
    v_xor_b32 v9, 96, v6
    s_lshl_b32 s74, s76, 10
    s_mov_b32 s75, 0
    s_mov_b32 s59, 0
    s_barrier
    s_add_u32 m0, s74, 0
    s_add_u32 s71, s68, 0
    buffer_load_dwordx4 v1, s[60:63], s71 offen sc1 lds
    s_add_u32 m0, s74, 8192
    s_add_u32 s71, s68, 524288
    buffer_load_dwordx4 v1, s[60:63], s71 offen sc1 lds
    s_add_u32 m0, s74, 16384
    s_add_u32 s71, s68, 1048576
    buffer_load_dwordx4 v1, s[60:63], s71 offen sc1 lds
    s_add_u32 m0, s74, 24576
    s_add_u32 s71, s68, 1572864
    buffer_load_dwordx4 v1, s[60:63], s71 offen sc1 lds
    s_add_u32 m0, s74, 32768
    s_add_u32 s71, s69, 0
    buffer_load_dwordx4 v2, s[64:67], s71 offen sc1 lds
    s_add_u32 m0, s74, 40960
    s_add_u32 s71, s69, 32768
    buffer_load_dwordx4 v2, s[64:67], s71 offen sc1 lds
    s_add_u32 m0, s74, 49152
    s_add_u32 s71, s69, 65536
    buffer_load_dwordx4 v2, s[64:67], s71 offen sc1 lds
    s_add_u32 m0, s74, 57344
    s_add_u32 s71, s69, 98304
    buffer_load_dwordx4 v2, s[64:67], s71 offen sc1 lds
    s_add_u32 s68, s68, 2048
    s_add_u32 s69, s69, 131072
    s_add_u32 s75, s75, 1
    s_cmp_eq_u32 s75, 2
    s_cselect_b32 s75, 0, s75
    s_cselect_b32 s71, 0xfffe0000, 0
    s_add_u32 s71, s71, 65536
    s_add_u32 s74, s74, s71
    s_add_u32 m0, s74, 0
    s_add_u32 s71, s68, 0
    buffer_load_dwordx4 v1, s[60:63], s71 offen sc1 lds
    s_add_u32 m0, s74, 8192
    s_add_u32 s71, s68, 524288
    buffer_load_dwordx4 v1, s[60:63], s71 offen sc1 lds
    s_add_u32 m0, s74, 16384
    s_add_u32 s71, s68, 1048576
    buffer_load_dwordx4 v1, s[60:63], s71 offen sc1 lds
    s_add_u32 m0, s74, 24576
    s_add_u32 s71, s68, 1572864
    buffer_load_dwordx4 v1, s[60:63], s71 offen sc1 lds
    s_add_u32 m0, s74, 32768
    s_add_u32 s71, s69, 0
    buffer_load_dwordx4 v2, s[64:67], s71 offen sc1 lds
    s_add_u32 m0, s74, 40960
    s_add_u32 s71, s69, 32768
    buffer_load_dwordx4 v2, s[64:67], s71 offen sc1 lds
    s_add_u32 m0, s74, 49152
    s_add_u32 s71, s69, 65536
    buffer_load_dwordx4 v2, s[64:67], s71 offen sc1 lds
    s_add_u32 m0, s74, 57344
    s_add_u32 s71, s69, 98304
    buffer_load_dwordx4 v2, s[64:67], s71 offen sc1 lds
    s_add_u32 s68, s68, 2048
    s_add_u32 s69, s69, 131072
    s_add_u32 s75, s75, 1
    s_cmp_eq_u32 s75, 2
    s_cselect_b32 s75, 0, s75
    s_cselect_b32 s71, 0xfffe0000, 0
    s_add_u32 s71, s71, 65536
    s_add_u32 s74, s74, s71
    s_mov_b32 s70, s94
    v_mov_b32 v128, 0
    v_mov_b32 v129, 0
    v_mov_b32 v130, 0
    v_mov_b32 v131, 0
    v_mov_b32 v132, 0
    v_mov_b32 v133, 0
    v_mov_b32 v134, 0
    v_mov_b32 v135, 0
    v_mov_b32 v136, 0
    v_mov_b32 v137, 0
    v_mov_b32 v138, 0
    v_mov_b32 v139, 0
    v_mov_b32 v140, 0
    v_mov_b32 v141, 0
    v_mov_b32 v142, 0
    v_mov_b32 v143, 0
    v_mov_b32 v144, 0
    v_mov_b32 v145, 0
    v_mov_b32 v146, 0
    v_mov_b32 v147, 0
    v_mov_b32 v148, 0
    v_mov_b32 v149, 0
    v_mov_b32 v150, 0
    v_mov_b32 v151, 0
    v_mov_b32 v152, 0
    v_mov_b32 v153, 0
    v_mov_b32 v154, 0
    v_mov_b32 v155, 0
    v_mov_b32 v156, 0
    v_mov_b32 v157, 0
    v_mov_b32 v158, 0
    v_mov_b32 v159, 0
    v_mov_b32 v160, 0
    v_mov_b32 v161, 0
    v_mov_b32 v162, 0
    v_mov_b32 v163, 0
    v_mov_b32 v164, 0
    v_mov_b32 v165, 0
    v_mov_b32 v166, 0
    v_mov_b32 v167, 0
    v_mov_b32 v168, 0
    v_mov_b32 v169, 0
    v_mov_b32 v170, 0
    v_mov_b32 v171, 0
    v_mov_b32 v172, 0
    v_mov_b32 v173, 0
    v_mov_b32 v174, 0
    v_mov_b32 v175, 0
    v_mov_b32 v176, 0
    v_mov_b32 v177, 0
    v_mov_b32 v178, 0
    v_mov_b32 v179, 0
    v_mov_b32 v180, 0
    v_mov_b32 v181, 0
    v_mov_b32 v182, 0
    v_mov_b32 v183, 0
    v_mov_b32 v184, 0
    v_mov_b32 v185, 0
    v_mov_b32 v186, 0
    v_mov_b32 v187, 0
    v_mov_b32 v188, 0
    v_mov_b32 v189, 0
    v_mov_b32 v190, 0
    v_mov_b32 v191, 0
    v_mov_b32 v192, 0
    v_mov_b32 v193, 0
    v_mov_b32 v194, 0
    v_mov_b32 v195, 0
    v_mov_b32 v196, 0
    v_mov_b32 v197, 0
    v_mov_b32 v198, 0
    v_mov_b32 v199, 0
    v_mov_b32 v200, 0
    v_mov_b32 v201, 0
    v_mov_b32 v202, 0
    v_mov_b32 v203, 0
    v_mov_b32 v204, 0
    v_mov_b32 v205, 0
    v_mov_b32 v206, 0
    v_mov_b32 v207, 0
    v_mov_b32 v208, 0
    v_mov_b32 v209, 0
    v_mov_b32 v210, 0
    v_mov_b32 v211, 0
    v_mov_b32 v212, 0
    v_mov_b32 v213, 0
    v_mov_b32 v214, 0
    v_mov_b32 v215, 0
    v_mov_b32 v216, 0
    v_mov_b32 v217, 0
    v_mov_b32 v218, 0
    v_mov_b32 v219, 0
    v_mov_b32 v220, 0
    v_mov_b32 v221, 0
    v_mov_b32 v222, 0
    v_mov_b32 v223, 0
    v_mov_b32 v224, 0
    v_mov_b32 v225, 0
    v_mov_b32 v226, 0
    v_mov_b32 v227, 0
    v_mov_b32 v228, 0
    v_mov_b32 v229, 0
    v_mov_b32 v230, 0
    v_mov_b32 v231, 0
    v_mov_b32 v232, 0
    v_mov_b32 v233, 0
    v_mov_b32 v234, 0
    v_mov_b32 v235, 0
    v_mov_b32 v236, 0
    v_mov_b32 v237, 0
    v_mov_b32 v238, 0
    v_mov_b32 v239, 0
    v_mov_b32 v240, 0
    v_mov_b32 v241, 0
    v_mov_b32 v242, 0
    v_mov_b32 v243, 0
    v_mov_b32 v244, 0
    v_mov_b32 v245, 0
    v_mov_b32 v246, 0
    v_mov_b32 v247, 0
    v_mov_b32 v248, 0
    v_mov_b32 v249, 0
    v_mov_b32 v250, 0
    v_mov_b32 v251, 0
    v_mov_b32 v252, 0
    v_mov_b32 v253, 0
    v_mov_b32 v254, 0
    v_mov_b32 v255, 0
    s_waitcnt vmcnt(8)
    s_barrier
    s_cmp_eq_u32 s31, 0
    s_cbranch_scc1 G2_O_HS
    s_mov_b64 exec, 1
    s_bfe_u32 s4, s31, 0x7000a
    s_mul_i32 s4, s4, s52
    s_and_b32 s5, s31, 0x3ff
    s_add_u32 s4, s4, s5
    s_lshl_b32 s4, s4, 7
    s_add_u32 s4, s4, 124780544
    s_lshr_b32 s5, s31, 20
    v_mov_b32 v28, s5
    buffer_atomic_add v28, off, s[8:11], s4 sc1
    s_mov_b64 exec, -1
    s_mov_b32 s31, 0
G2_O_HS:
    ds_read_b128 v[32:35], v4 offset:0
    ds_read_b64_tr_b16 v[64:65], v6 offset:0
    ds_read_b64_tr_b16 v[66:67], v6 offset:2048
    ds_read_b64_tr_b16 v[68:69], v7 offset:0
    ds_read_b64_tr_b16 v[70:71], v7 offset:2048
    ds_read_b64_tr_b16 v[72:73], v8 offset:0
    ds_read_b64_tr_b16 v[74:75], v8 offset:2048
    ds_read_b64_tr_b16 v[76:77], v9 offset:0
    ds_read_b64_tr_b16 v[78:79], v9 offset:2048
    ds_read_b128 v[36:39], v4 offset:2048
    ds_read_b128 v[40:43], v4 offset:4096
    ds_read_b128 v[44:47], v4 offset:6144
    ds_read_b128 v[48:51], v4 offset:8192
    ds_read_b128 v[52:55], v4 offset:10240
    ds_read_b128 v[56:59], v4 offset:12288
    ds_read_b128 v[60:63], v4 offset:14336
G2_O_LOOP:
    s_waitcnt lgkmcnt(0)
    v_mfma_f32_16x16x32_bf16 v[128:131], v[64:67], v[32:35], v[128:131]
    ds_read_b128 v[80:83], v5 offset:0
    v_mfma_f32_16x16x32_bf16 v[132:135], v[68:71], v[32:35], v[132:135]
    ds_read_b64_tr_b16 v[112:113], v6 offset:16384
    v_mfma_f32_16x16x32_bf16 v[136:139], v[72:75], v[32:35], v[136:139]
    ds_read_b64_tr_b16 v[114:115], v6 offset:18432
    v_mfma_f32_16x16x32_bf16 v[140:143], v[76:79], v[32:35], v[140:143]
    ds_read_b64_tr_b16 v[116:117], v7 offset:16384
    v_mfma_f32_16x16x32_bf16 v[156:159], v[76:79], v[36:39], v[156:159]
    ds_read_b64_tr_b16 v[118:119], v7 offset:18432
    v_mfma_f32_16x16x32_bf16 v[152:155], v[72:75], v[36:39], v[152:155]
    ds_read_b64_tr_b16 v[120:121], v8 offset:16384
    v_mfma_f32_16x16x32_bf16 v[148:151], v[68:71], v[36:39], v[148:151]
    ds_read_b64_tr_b16 v[122:123], v8 offset:18432
    v_mfma_f32_16x16x32_bf16 v[144:147], v[64:67], v[36:39], v[144:147]
    ds_read_b64_tr_b16 v[124:125], v9 offset:16384
    v_mfma_f32_16x16x32_bf16 v[160:163], v[64:67], v[40:43], v[160:163]
    ds_read_b64_tr_b16 v[126:127], v9 offset:18432
    v_mfma_f32_16x16x32_bf16 v[164:167], v[68:71], v[40:43], v[164:167]
    ds_read_b128 v[84:87], v5 offset:2048
    v_mfma_f32_16x16x32_bf16 v[168:171], v[72:75], v[40:43], v[168:171]
    ds_read_b128 v[88:91], v5 offset:4096
    v_mfma_f32_16x16x32_bf16 v[172:175], v[76:79], v[40:43], v[172:175]
    ds_read_b128 v[92:95], v5 offset:6144
    v_mfma_f32_16x16x32_bf16 v[188:191], v[76:79], v[44:47], v[188:191]
    ds_read_b128 v[96:99], v5 offset:8192
    v_mfma_f32_16x16x32_bf16 v[184:187], v[72:75], v[44:47], v[184:187]
    ds_read_b128 v[100:103], v5 offset:10240
    v_mfma_f32_16x16x32_bf16 v[180:183], v[68:71], v[44:47], v[180:183]
    ds_read_b128 v[104:107], v5 offset:12288
    v_mfma_f32_16x16x32_bf16 v[176:179], v[64:67], v[44:47], v[176:179]
    ds_read_b128 v[108:111], v5 offset:14336
    v_mfma_f32_16x16x32_bf16 v[192:195], v[64:67], v[48:51], v[192:195]
    s_add_u32 s59, s59, 1
    s_cmp_eq_u32 s59, 2
    s_cselect_b32 s59, 0, s59
    s_cselect_b32 s71, 0xfffe0000, 0
    s_add_u32 s71, s71, 65536
    v_mfma_f32_16x16x32_bf16 v[196:199], v[68:71], v[48:51], v[196:199]
    v_add_u32 v4, s71, v4
    v_mfma_f32_16x16x32_bf16 v[200:203], v[72:75], v[48:51], v[200:203]
    v_add_u32 v5, s71, v5
    v_mfma_f32_16x16x32_bf16 v[204:207], v[76:79], v[48:51], v[204:207]
    v_add_u32 v6, s71, v6
    v_mfma_f32_16x16x32_bf16 v[220:223], v[76:79], v[52:55], v[220:223]
    v_add_u32 v7, s71, v7
    v_mfma_f32_16x16x32_bf16 v[216:219], v[72:75], v[52:55], v[216:219]
    v_add_u32 v8, s71, v8
    v_mfma_f32_16x16x32_bf16 v[212:215], v[68:71], v[52:55], v[212:215]
    v_add_u32 v9, s71, v9
    v_mfma_f32_16x16x32_bf16 v[208:211], v[64:67], v[52:55], v[208:211]
    s_sub_u32 s70, s70, 1
    v_mfma_f32_16x16x32_bf16 v[224:227], v[64:67], v[56:59], v[224:227]
    v_mfma_f32_16x16x32_bf16 v[228:231], v[68:71], v[56:59], v[228:231]
    v_mfma_f32_16x16x32_bf16 v[232:235], v[72:75], v[56:59], v[232:235]
    v_mfma_f32_16x16x32_bf16 v[236:239], v[76:79], v[56:59], v[236:239]
    v_mfma_f32_16x16x32_bf16 v[252:255], v[76:79], v[60:63], v[252:255]
    v_mfma_f32_16x16x32_bf16 v[248:251], v[72:75], v[60:63], v[248:251]
    v_mfma_f32_16x16x32_bf16 v[244:247], v[68:71], v[60:63], v[244:247]
    v_mfma_f32_16x16x32_bf16 v[240:243], v[64:67], v[60:63], v[240:243]
    s_cmp_lt_u32 s70, 2
    s_cbranch_scc1 G2_O_TAIL
    s_waitcnt vmcnt(0) lgkmcnt(0)
    s_barrier
    v_mfma_f32_16x16x32_bf16 v[128:131], v[112:115], v[80:83], v[128:131]
    s_add_u32 m0, s74, 0
    s_add_u32 s71, s68, 0
    buffer_load_dwordx4 v1, s[60:63], s71 offen sc1 lds
    v_mfma_f32_16x16x32_bf16 v[132:135], v[116:119], v[80:83], v[132:135]
    ds_read_b128 v[32:35], v4 offset:0
    v_mfma_f32_16x16x32_bf16 v[136:139], v[120:123], v[80:83], v[136:139]
    ds_read_b64_tr_b16 v[64:65], v6 offset:0
    v_mfma_f32_16x16x32_bf16 v[140:143], v[124:127], v[80:83], v[140:143]
    s_add_u32 m0, s74, 8192
    s_add_u32 s71, s68, 524288
    buffer_load_dwordx4 v1, s[60:63], s71 offen sc1 lds
    v_mfma_f32_16x16x32_bf16 v[156:159], v[124:127], v[84:87], v[156:159]
    ds_read_b64_tr_b16 v[66:67], v6 offset:2048
    v_mfma_f32_16x16x32_bf16 v[152:155], v[120:123], v[84:87], v[152:155]
    ds_read_b64_tr_b16 v[68:69], v7 offset:0
    v_mfma_f32_16x16x32_bf16 v[148:151], v[116:119], v[84:87], v[148:151]
    s_add_u32 m0, s74, 16384
    s_add_u32 s71, s68, 1048576
    buffer_load_dwordx4 v1, s[60:63], s71 offen sc1 lds
    v_mfma_f32_16x16x32_bf16 v[144:147], v[112:115], v[84:87], v[144:147]
    ds_read_b64_tr_b16 v[70:71], v7 offset:2048
    v_mfma_f32_16x16x32_bf16 v[160:163], v[112:115], v[88:91], v[160:163]
    ds_read_b64_tr_b16 v[72:73], v8 offset:0
    v_mfma_f32_16x16x32_bf16 v[164:167], v[116:119], v[88:91], v[164:167]
    s_add_u32 m0, s74, 24576
    s_add_u32 s71, s68, 1572864
    buffer_load_dwordx4 v1, s[60:63], s71 offen sc1 lds
    v_mfma_f32_16x16x32_bf16 v[168:171], v[120:123], v[88:91], v[168:171]
    ds_read_b64_tr_b16 v[74:75], v8 offset:2048
    v_mfma_f32_16x16x32_bf16 v[172:175], v[124:127], v[88:91], v[172:175]
    ds_read_b64_tr_b16 v[76:77], v9 offset:0
    v_mfma_f32_16x16x32_bf16 v[188:191], v[124:127], v[92:95], v[188:191]
    s_add_u32 m0, s74, 32768
    s_add_u32 s71, s69, 0
    buffer_load_dwordx4 v2, s[64:67], s71 offen sc1 lds
    v_mfma_f32_16x16x32_bf16 v[184:187], v[120:123], v[92:95], v[184:187]
    ds_read_b64_tr_b16 v[78:79], v9 offset:2048
    v_mfma_f32_16x16x32_bf16 v[180:183], v[116:119], v[92:95], v[180:183]
    ds_read_b128 v[36:39], v4 offset:2048
    v_mfma_f32_16x16x32_bf16 v[176:179], v[112:115], v[92:95], v[176:179]
    s_add_u32 m0, s74, 40960
    s_add_u32 s71, s69, 32768
    buffer_load_dwordx4 v2, s[64:67], s71 offen sc1 lds
    v_mfma_f32_16x16x32_bf16 v[192:195], v[112:115], v[96:99], v[192:195]
    ds_read_b128 v[40:43], v4 offset:4096
    v_mfma_f32_16x16x32_bf16 v[196:199], v[116:119], v[96:99], v[196:199]
    ds_read_b128 v[44:47], v4 offset:6144
    v_mfma_f32_16x16x32_bf16 v[200:203], v[120:123], v[96:99], v[200:203]
    s_add_u32 m0, s74, 49152
    s_add_u32 s71, s69, 65536
    buffer_load_dwordx4 v2, s[64:67], s71 offen sc1 lds
    v_mfma_f32_16x16x32_bf16 v[204:207], v[124:127], v[96:99], v[204:207]
    ds_read_b128 v[48:51], v4 offset:8192
    v_mfma_f32_16x16x32_bf16 v[220:223], v[124:127], v[100:103], v[220:223]
    ds_read_b128 v[52:55], v4 offset:10240
    v_mfma_f32_16x16x32_bf16 v[216:219], v[120:123], v[100:103], v[216:219]
    s_add_u32 m0, s74, 57344
    s_add_u32 s71, s69, 98304
    buffer_load_dwordx4 v2, s[64:67], s71 offen sc1 lds
    v_mfma_f32_16x16x32_bf16 v[212:215], v[116:119], v[100:103], v[212:215]
    ds_read_b128 v[56:59], v4 offset:12288
    v_mfma_f32_16x16x32_bf16 v[208:211], v[112:115], v[100:103], v[208:211]
    ds_read_b128 v[60:63], v4 offset:14336
    v_mfma_f32_16x16x32_bf16 v[224:227], v[112:115], v[104:107], v[224:227]
    s_add_u32 s68, s68, 2048
    s_add_u32 s69, s69, 131072
    s_add_u32 s75, s75, 1
    s_cmp_eq_u32 s75, 2
    s_cselect_b32 s75, 0, s75
    s_cselect_b32 s71, 0xfffe0000, 0
    s_add_u32 s71, s71, 65536
    s_add_u32 s74, s74, s71
    v_mfma_f32_16x16x32_bf16 v[228:231], v[116:119], v[104:107], v[228:231]
    v_mfma_f32_16x16x32_bf16 v[232:235], v[120:123], v[104:107], v[232:235]
    v_mfma_f32_16x16x32_bf16 v[236:239], v[124:127], v[104:107], v[236:239]
    v_mfma_f32_16x16x32_bf16 v[252:255], v[124:127], v[108:111], v[252:255]
    v_mfma_f32_16x16x32_bf16 v[248:251], v[120:123], v[108:111], v[248:251]
    v_mfma_f32_16x16x32_bf16 v[244:247], v[116:119], v[108:111], v[244:247]
    v_mfma_f32_16x16x32_bf16 v[240:243], v[112:115], v[108:111], v[240:243]
    s_branch G2_O_LOOP
G2_O_TAIL:
    s_waitcnt vmcnt(0) lgkmcnt(0)
    s_barrier
    s_cmp_lg_u32 s76, 0
    s_cbranch_scc1 G2_O_HT0
    s_cmp_eq_u32 s70, 0
    s_cbranch_scc1 G2_O_HB
    v_mov_b32 v28, 1
    s_lshl_b32 s4, s52, 2
    s_mov_b64 exec, 1
    buffer_atomic_add v28, off, s[16:19], s4 offset:160 sc0 sc1
    s_mov_b64 exec, -1
    s_branch G2_O_HT0
G2_O_HB:
    v_readfirstlane_b32 s4, v28
    v_lshlrev_b32 v29, 2, v0
    s_nop 2
    s_add_u32 s4, s4, 32
    s_min_u32 s4, s4, 312
    s_lshl_b32 s4, s4, 5
    v_add_u32 v29, s4, v29
    s_mov_b64 exec, 15
    global_load_dword v29, v29, s[28:29] offset:4
    s_mov_b64 exec, -1
G2_O_HT0:
    v_mfma_f32_16x16x32_bf16 v[128:131], v[112:115], v[80:83], v[128:131]
    ds_read_b128 v[32:35], v4 offset:0
    v_mfma_f32_16x16x32_bf16 v[132:135], v[116:119], v[80:83], v[132:135]
    ds_read_b64_tr_b16 v[64:65], v6 offset:0
    v_mfma_f32_16x16x32_bf16 v[136:139], v[120:123], v[80:83], v[136:139]
    ds_read_b64_tr_b16 v[66:67], v6 offset:2048
    v_mfma_f32_16x16x32_bf16 v[140:143], v[124:127], v[80:83], v[140:143]
    ds_read_b64_tr_b16 v[68:69], v7 offset:0
    v_mfma_f32_16x16x32_bf16 v[156:159], v[124:127], v[84:87], v[156:159]
    ds_read_b64_tr_b16 v[70:71], v7 offset:2048
    v_mfma_f32_16x16x32_bf16 v[152:155], v[120:123], v[84:87], v[152:155]
    ds_read_b64_tr_b16 v[72:73], v8 offset:0
    v_mfma_f32_16x16x32_bf16 v[148:151], v[116:119], v[84:87], v[148:151]
    ds_read_b64_tr_b16 v[74:75], v8 offset:2048
    v_mfma_f32_16x16x32_bf16 v[144:147], v[112:115], v[84:87], v[144:147]
    ds_read_b64_tr_b16 v[76:77], v9 offset:0
    v_mfma_f32_16x16x32_bf16 v[160:163], v[112:115], v[88:91], v[160:163]
    ds_read_b64_tr_b16 v[78:79], v9 offset:2048
    v_mfma_f32_16x16x32_bf16 v[164:167], v[116:119], v[88:91], v[164:167]
    ds_read_b128 v[36:39], v4 offset:2048
    v_mfma_f32_16x16x32_bf16 v[168:171], v[120:123], v[88:91], v[168:171]
    ds_read_b128 v[40:43], v4 offset:4096
    v_mfma_f32_16x16x32_bf16 v[172:175], v[124:127], v[88:91], v[172:175]
    ds_read_b128 v[44:47], v4 offset:6144
    v_mfma_f32_16x16x32_bf16 v[188:191], v[124:127], v[92:95], v[188:191]
    ds_read_b128 v[48:51], v4 offset:8192
    v_mfma_f32_16x16x32_bf16 v[184:187], v[120:123], v[92:95], v[184:187]
    ds_read_b128 v[52:55], v4 offset:10240
    v_mfma_f32_16x16x32_bf16 v[180:183], v[116:119], v[92:95], v[180:183]
    ds_read_b128 v[56:59], v4 offset:12288
    v_mfma_f32_16x16x32_bf16 v[176:179], v[112:115], v[92:95], v[176:179]
    ds_read_b128 v[60:63], v4 offset:14336
    v_mfma_f32_16x16x32_bf16 v[192:195], v[112:115], v[96:99], v[192:195]
    v_mfma_f32_16x16x32_bf16 v[196:199], v[116:119], v[96:99], v[196:199]
    v_mfma_f32_16x16x32_bf16 v[200:203], v[120:123], v[96:99], v[200:203]
    v_mfma_f32_16x16x32_bf16 v[204:207], v[124:127], v[96:99], v[204:207]
    v_mfma_f32_16x16x32_bf16 v[220:223], v[124:127], v[100:103], v[220:223]
    v_mfma_f32_16x16x32_bf16 v[216:219], v[120:123], v[100:103], v[216:219]
    v_mfma_f32_16x16x32_bf16 v[212:215], v[116:119], v[100:103], v[212:215]
    v_mfma_f32_16x16x32_bf16 v[208:211], v[112:115], v[100:103], v[208:211]
    v_mfma_f32_16x16x32_bf16 v[224:227], v[112:115], v[104:107], v[224:227]
    v_mfma_f32_16x16x32_bf16 v[228:231], v[116:119], v[104:107], v[228:231]
    v_mfma_f32_16x16x32_bf16 v[232:235], v[120:123], v[104:107], v[232:235]
    v_mfma_f32_16x16x32_bf16 v[236:239], v[124:127], v[104:107], v[236:239]
    v_mfma_f32_16x16x32_bf16 v[252:255], v[124:127], v[108:111], v[252:255]
    v_mfma_f32_16x16x32_bf16 v[248:251], v[120:123], v[108:111], v[248:251]
    v_mfma_f32_16x16x32_bf16 v[244:247], v[116:119], v[108:111], v[244:247]
    v_mfma_f32_16x16x32_bf16 v[240:243], v[112:115], v[108:111], v[240:243]
    s_cmp_lg_u32 s70, 0
    s_cbranch_scc1 G2_O_LOOP
    s_cmp_lg_u32 s76, 0
    s_cbranch_scc1 G2_O_HT1
    s_waitcnt vmcnt(0)
    v_bfe_u32 v30, v29, 10, 7
    v_and_b32 v31, 0x3ff, v29
    v_mad_u32_u24 v30, v30, s52, v31
    v_lshlrev_b32 v30, 7, v30
    s_mov_b32 s4, 124780544
    s_mov_b64 exec, 15
    buffer_load_dword v30, v30, s[8:11], s4 offen sc1
    s_mov_b64 exec, -1
G2_O_HT1:
    s_waitcnt lgkmcnt(0)
    s_nop 7
G2_EP:
    s_and_b32 s85, s73, 1
    s_lshl_b32 s85, s85, 13
    s_add_u32 s85, s85, s95
    s_lshr_b32 s86, s73, 1
    s_mul_i32 s86, s86, s91
    s_lshl_b32 s86, s86, 16
    s_add_u32 s85, s85, s86
    s_mul_i32 s86, s72, 32768
    s_add_u32 s85, s85, s86
    v_lshlrev_b32 v14, 4, v0
    v_cvt_pk_bf16_f32 v32, v128, v129
    v_cvt_pk_bf16_f32 v34, v132, v133
    v_cvt_pk_bf16_f32 v33, v130, v131
    v_cvt_pk_bf16_f32 v35, v134, v135
    buffer_store_dwordx4 v[32:35], v14, s[8:11], s85 offen offset:0 sc1
    v_cvt_pk_bf16_f32 v36, v136, v137
    v_cvt_pk_bf16_f32 v38, v140, v141
    v_cvt_pk_bf16_f32 v37, v138, v139
    v_cvt_pk_bf16_f32 v39, v142, v143
    buffer_store_dwordx4 v[36:39], v14, s[8:11], s85 offen offset:1024 sc1
    v_cvt_pk_bf16_f32 v40, v144, v145
    v_cvt_pk_bf16_f32 v42, v148, v149
    v_cvt_pk_bf16_f32 v41, v146, v147
    v_cvt_pk_bf16_f32 v43, v150, v151
    buffer_store_dwordx4 v[40:43], v14, s[8:11], s85 offen offset:2048 sc1
    v_cvt_pk_bf16_f32 v44, v152, v153
    v_cvt_pk_bf16_f32 v46, v156, v157
    v_cvt_pk_bf16_f32 v45, v154, v155
    v_cvt_pk_bf16_f32 v47, v158, v159
    buffer_store_dwordx4 v[44:47], v14, s[8:11], s85 offen offset:3072 sc1
    s_add_u32 s85, s85, 4096
    v_cvt_pk_bf16_f32 v48, v160, v161
    v_cvt_pk_bf16_f32 v50, v164, v165
    v_cvt_pk_bf16_f32 v49, v162, v163
    v_cvt_pk_bf16_f32 v51, v166, v167
    buffer_store_dwordx4 v[48:51], v14, s[8:11], s85 offen offset:0 sc1
    v_cvt_pk_bf16_f32 v52, v168, v169
    v_cvt_pk_bf16_f32 v54, v172, v173
    v_cvt_pk_bf16_f32 v53, v170, v171
    v_cvt_pk_bf16_f32 v55, v174, v175
    buffer_store_dwordx4 v[52:55], v14, s[8:11], s85 offen offset:1024 sc1
    v_cvt_pk_bf16_f32 v56, v176, v177
    v_cvt_pk_bf16_f32 v58, v180, v181
    v_cvt_pk_bf16_f32 v57, v178, v179
    v_cvt_pk_bf16_f32 v59, v182, v183
    buffer_store_dwordx4 v[56:59], v14, s[8:11], s85 offen offset:2048 sc1
    v_cvt_pk_bf16_f32 v60, v184, v185
    v_cvt_pk_bf16_f32 v62, v188, v189
    v_cvt_pk_bf16_f32 v61, v186, v187
    v_cvt_pk_bf16_f32 v63, v190, v191
    buffer_store_dwordx4 v[60:63], v14, s[8:11], s85 offen offset:3072 sc1
    s_add_u32 s85, s85, 12288
    v_cvt_pk_bf16_f32 v32, v192, v193
    v_cvt_pk_bf16_f32 v34, v196, v197
    v_cvt_pk_bf16_f32 v33, v194, v195
    v_cvt_pk_bf16_f32 v35, v198, v199
    buffer_store_dwordx4 v[32:35], v14, s[8:11], s85 offen offset:0 sc1
    v_cvt_pk_bf16_f32 v36, v200, v201
    v_cvt_pk_bf16_f32 v38, v204, v205
    v_cvt_pk_bf16_f32 v37, v202, v203
    v_cvt_pk_bf16_f32 v39, v206, v207
    buffer_store_dwordx4 v[36:39], v14, s[8:11], s85 offen offset:1024 sc1
    v_cvt_pk_bf16_f32 v40, v208, v209
    v_cvt_pk_bf16_f32 v42, v212, v213
    v_cvt_pk_bf16_f32 v41, v210, v211
    v_cvt_pk_bf16_f32 v43, v214, v215
    buffer_store_dwordx4 v[40:43], v14, s[8:11], s85 offen offset:2048 sc1
    v_cvt_pk_bf16_f32 v44, v216, v217
    v_cvt_pk_bf16_f32 v46, v220, v221
    v_cvt_pk_bf16_f32 v45, v218, v219
    v_cvt_pk_bf16_f32 v47, v222, v223
    buffer_store_dwordx4 v[44:47], v14, s[8:11], s85 offen offset:3072 sc1
    s_add_u32 s85, s85, 4096
    v_cvt_pk_bf16_f32 v48, v224, v225
    v_cvt_pk_bf16_f32 v50, v228, v229
    v_cvt_pk_bf16_f32 v49, v226, v227
    v_cvt_pk_bf16_f32 v51, v230, v231
    buffer_store_dwordx4 v[48:51], v14, s[8:11], s85 offen offset:0 sc1
    v_cvt_pk_bf16_f32 v52, v232, v233
    v_cvt_pk_bf16_f32 v54, v236, v237
    v_cvt_pk_bf16_f32 v53, v234, v235
    v_cvt_pk_bf16_f32 v55, v238, v239
    buffer_store_dwordx4 v[52:55], v14, s[8:11], s85 offen offset:1024 sc1
    v_cvt_pk_bf16_f32 v56, v240, v241
    v_cvt_pk_bf16_f32 v58, v244, v245
    v_cvt_pk_bf16_f32 v57, v242, v243
    v_cvt_pk_bf16_f32 v59, v246, v247
    buffer_store_dwordx4 v[56:59], v14, s[8:11], s85 offen offset:2048 sc1
    v_cvt_pk_bf16_f32 v60, v248, v249
    v_cvt_pk_bf16_f32 v62, v252, v253
    v_cvt_pk_bf16_f32 v61, v250, v251
    v_cvt_pk_bf16_f32 v63, v254, v255
    buffer_store_dwordx4 v[60:63], v14, s[8:11], s85 offen offset:3072 sc1
    s_add_u32 s85, s85, 12288
    s_branch G_DONE2
H_G2N:
    s_and_b32 s94, s26, 255
    s_bfe_u32 s91, s26, 0x80008
    s_lshr_b32 s4, s26, 16
    s_mul_i32 s95, s4, s52
    s_add_u32 s95, s95, s27
    s_lshl_b32 s95, s95, 16
    s_add_u32 s95, s95, 125829120
    s_lshl_b32 s93, s52, 4
    s_add_u32 s93, s93, s79
    s_mov_b32 s60, s8
    s_mov_b32 s61, s9
    s_mov_b32 s62, s10
    s_mov_b32 s63, s11
    s_load_dwordx2 s[4:5], s[0:1], 40
    s_mul_i32 s68, s77, 2097152
    s_lshl_b32 s86, s93, 11
    s_add_u32 s68, s68, s86
    s_add_u32 s68, s68, 88080384
    s_mul_i32 s69, s78, 256
    s_lshl_b32 s86, s93, 17
    s_add_u32 s69, s69, s86
    s_waitcnt lgkmcnt(0)
    s_mov_b32 s64, s4
    s_and_b32 s65, s5, 0xffff
    s_mov_b32 s66, 8388608
    s_mov_b32 s67, 0x20000
    s_lshr_b32 s72, s76, 1
    s_and_b32 s73, s76, 1
    s_lshr_b32 s71, s76, 1
    s_mul_i32 s71, s71, 131072
    s_and_b32 s70, s76, 1
    s_lshl_b32 s70, s70, 10
    s_add_u32 s71, s71, s70
    v_lshl_add_u32 v1, v0, 4, s71
    s_mul_i32 s71, s72, 8192
    v_lshl_add_u32 v4, v0, 4, s71
    v_add_u32 v5, 1024, v4
    v_lshrrev_b32 v14, 4, v0
    s_mul_i32 s71, s76, 4
    v_add_u32 v14, s71, v14
    v_and_b32 v15, 3, v14
    v_lshlrev_b32 v15, 1, v15
    v_and_b32 v16, 8, v14
    v_or_b32 v15, v15, v16
    v_and_b32 v16, 15, v0
    v_xor_b32 v15, v15, v16
    s_mov_b32 s71, 2048
    v_mul_lo_u32 v2, v14, s71
    v_lshl_add_u32 v2, v15, 4, v2
    v_bfe_u32 v14, v0, 2, 2
    v_lshrrev_b32 v15, 4, v0
    v_lshl_add_u32 v15, v15, 3, v14
    v_mul_u32_u24 v15, 256, v15
    v_and_b32 v16, 3, v0
    v_lshl_add_u32 v15, v16, 3, v15
    v_add_u32 v15, 32768, v15
    v_bfe_u32 v14, v0, 2, 3
    s_mul_i32 s71, s73, 4
    v_xor_b32 v14, s71, v14
    v_lshl_add_u32 v6, v14, 5, v15
    v_xor_b32 v7, 32, v6
    v_xor_b32 v8, 64, v6
    v_xor_b32 v9, 96, v6
    s_lshl_b32 s74, s76, 10
    s_mov_b32 s75, 0
    s_mov_b32 s59, 0
    s_barrier
    s_add_u32 m0, s74, 0
    s_add_u32 s71, s68, 0
    buffer_load_dwordx4 v1, s[60:63], s71 offen sc1 lds
    s_add_u32 m0, s74, 8192
    s_add_u32 s71, s68, 524288
    buffer_load_dwordx4 v1, s[60:63], s71 offen sc1 lds
    s_add_u32 m0, s74, 16384
    s_add_u32 s71, s68, 1048576
    buffer_load_dwordx4 v1, s[60:63], s71 offen sc1 lds
    s_add_u32 m0, s74, 24576
    s_add_u32 s71, s68, 1572864
    buffer_load_dwordx4 v1, s[60:63], s71 offen sc1 lds
    s_add_u32 m0, s74, 32768
    s_add_u32 s71, s69, 0
    buffer_load_dwordx4 v2, s[64:67], s71 offen sc1 lds
    s_add_u32 m0, s74, 40960
    s_add_u32 s71, s69, 65536
    buffer_load_dwordx4 v2, s[64:67], s71 offen sc1 lds
    s_add_u32 s68, s68, 2048
    s_add_u32 s69, s69, 131072
    s_add_u32 s75, s75, 1
    s_cmp_eq_u32 s75, 3
    s_cselect_b32 s75, 0, s75
    s_cselect_b32 s71, 0xfffdc000, 0
    s_add_u32 s71, s71, 49152
    s_add_u32 s74, s74, s71
    s_add_u32 m0, s74, 0
    s_add_u32 s71, s68, 0
    buffer_load_dwordx4 v1, s[60:63], s71 offen sc1 lds
    s_add_u32 m0, s74, 8192
    s_add_u32 s71, s68, 524288
    buffer_load_dwordx4 v1, s[60:63], s71 offen sc1 lds
    s_add_u32 m0, s74, 16384
    s_add_u32 s71, s68, 1048576
    buffer_load_dwordx4 v1, s[60:63], s71 offen sc1 lds
    s_add_u32 m0, s74, 24576
    s_add_u32 s71, s68, 1572864
    buffer_load_dwordx4 v1, s[60:63], s71 offen sc1 lds
    s_add_u32 m0, s74, 32768
    s_add_u32 s71, s69, 0
    buffer_load_dwordx4 v2, s[64:67], s71 offen sc1 lds
    s_add_u32 m0, s74, 40960
    s_add_u32 s71, s69, 65536
    buffer_load_dwordx4 v2, s[64:67], s71 offen sc1 lds
    s_add_u32 s68, s68, 2048
    s_add_u32 s69, s69, 131072
    s_add_u32 s75, s75, 1
    s_cmp_eq_u32 s75, 3
    s_cselect_b32 s75, 0, s75
    s_cselect_b32 s71, 0xfffdc000, 0
    s_add_u32 s71, s71, 49152
    s_add_u32 s74, s74, s71
    s_add_u32 m0, s74, 0
    s_add_u32 s71, s68, 0
    buffer_load_dwordx4 v1, s[60:63], s71 offen sc1 lds
    s_add_u32 m0, s74, 8192
    s_add_u32 s71, s68, 524288
    buffer_load_dwordx4 v1, s[60:63], s71 offen sc1 lds
    s_add_u32 m0, s74, 16384
    s_add_u32 s71, s68, 1048576
    buffer_load_dwordx4 v1, s[60:63], s71 offen sc1 lds
    s_add_u32 m0, s74, 24576
    s_add_u32 s71, s68, 1572864
    buffer_load_dwordx4 v1, s[60:63], s71 offen sc1 lds
    s_add_u32 m0, s74, 32768
    s_add_u32 s71, s69, 0
    buffer_load_dwordx4 v2, s[64:67], s71 offen sc1 lds
    s_add_u32 m0, s74, 40960
    s_add_u32 s71, s69, 65536
    buffer_load_dwordx4 v2, s[64:67], s71 offen sc1 lds
    s_add_u32 s68, s68, 2048
    s_add_u32 s69, s69, 131072
    s_add_u32 s75, s75, 1
    s_cmp_eq_u32 s75, 3
    s_cselect_b32 s75, 0, s75
    s_cselect_b32 s71, 0xfffdc000, 0
    s_add_u32 s71, s71, 49152
    s_add_u32 s74, s74, s71
    s_mov_b32 s70, s94
    v_mov_b32 v128, 0
    v_mov_b32 v129, 0
    v_mov_b32 v130, 0
    v_mov_b32 v131, 0
    v_mov_b32 v132, 0
    v_mov_b32 v133, 0
    v_mov_b32 v134, 0
    v_mov_b32 v135, 0
    v_mov_b32 v136, 0
    v_mov_b32 v137, 0
    v_mov_b32 v138, 0
    v_mov_b32 v139, 0
    v_mov_b32 v140, 0
    v_mov_b32 v141, 0
    v_mov_b32 v142, 0
    v_mov_b32 v143, 0
    v_mov_b32 v144, 0
    v_mov_b32 v145, 0
    v_mov_b32 v146, 0
    v_mov_b32 v147, 0
    v_mov_b32 v148, 0
    v_mov_b32 v149, 0
    v_mov_b32 v150, 0
    v_mov_b32 v151, 0
    v_mov_b32 v152, 0
    v_mov_b32 v153, 0
    v_mov_b32 v154, 0
    v_mov_b32 v155, 0
    v_mov_b32 v156, 0
    v_mov_b32 v157, 0
    v_mov_b32 v158, 0
    v_mov_b32 v159, 0
    v_mov_b32 v160, 0
    v_mov_b32 v161, 0
    v_mov_b32 v162, 0
    v_mov_b32 v163, 0
    v_mov_b32 v164, 0
    v_mov_b32 v165, 0
    v_mov_b32 v166, 0
    v_mov_b32 v167, 0
    v_mov_b32 v168, 0
    v_mov_b32 v169, 0
    v_mov_b32 v170, 0
    v_mov_b32 v171, 0
    v_mov_b32 v172, 0
    v_mov_b32 v173, 0
    v_mov_b32 v174, 0
    v_mov_b32 v175, 0
    v_mov_b32 v176, 0
    v_mov_b32 v177, 0
    v_mov_b32 v178, 0
    v_mov_b32 v179, 0
    v_mov_b32 v180, 0
    v_mov_b32 v181, 0
    v_mov_b32 v182, 0
    v_mov_b32 v183, 0
    v_mov_b32 v184, 0
    v_mov_b32 v185, 0
    v_mov_b32 v186, 0
    v_mov_b32 v187, 0
    v_mov_b32 v188, 0
    v_mov_b32 v189, 0
    v_mov_b32 v190, 0
    v_mov_b32 v191, 0
    s_waitcnt vmcnt(12)
    s_barrier
    s_cmp_eq_u32 s31, 0
    s_cbranch_scc1 G2N_O_HS
    s_mov_b64 exec, 1
    s_bfe_u32 s4, s31, 0x7000a
    s_mul_i32 s4, s4, s52
    s_and_b32 s5, s31, 0x3ff
    s_add_u32 s4, s4, s5
    s_lshl_b32 s4, s4, 7
    s_add_u32 s4, s4, 124780544
    s_lshr_b32 s5, s31, 20
    v_mov_b32 v28, s5
    buffer_atomic_add v28, off, s[8:11], s4 sc1
    s_mov_b64 exec, -1
    s_mov_b32 s31, 0
G2N_O_HS:
    ds_read_b128 v[32:35], v4 offset:0
    ds_read_b64_tr_b16 v[48:49], v6 offset:0
    ds_read_b64_tr_b16 v[50:51], v6 offset:1024
    ds_read_b64_tr_b16 v[52:53], v7 offset:0
    ds_read_b64_tr_b16 v[54:55], v7 offset:1024
    ds_read_b64_tr_b16 v[56:57], v8 offset:0
    ds_read_b64_tr_b16 v[58:59], v8 offset:1024
    ds_read_b64_tr_b16 v[60:61], v9 offset:0
    ds_read_b64_tr_b16 v[62:63], v9 offset:1024
    ds_read_b128 v[36:39], v4 offset:2048
    ds_read_b128 v[40:43], v4 offset:4096
    ds_read_b128 v[44:47], v4 offset:6144
G2N_O_LOOP:
    s_waitcnt lgkmcnt(0)
    v_mfma_f32_16x16x32_bf16 v[128:131], v[48:51], v[32:35], v[128:131]
    ds_read_b128 v[64:67], v5 offset:0
    ds_read_b64_tr_b16 v[80:81], v6 offset:8192
    v_mfma_f32_16x16x32_bf16 v[132:135], v[52:55], v[32:35], v[132:135]
    ds_read_b64_tr_b16 v[82:83], v6 offset:9216
    ds_read_b64_tr_b16 v[84:85], v7 offset:8192
    v_mfma_f32_16x16x32_bf16 v[136:139], v[56:59], v[32:35], v[136:139]
    ds_read_b64_tr_b16 v[86:87], v7 offset:9216
    ds_read_b64_tr_b16 v[88:89], v8 offset:8192
    v_mfma_f32_16x16x32_bf16 v[140:143], v[60:63], v[32:35], v[140:143]
    ds_read_b64_tr_b16 v[90:91], v8 offset:9216
    ds_read_b64_tr_b16 v[92:93], v9 offset:8192
    v_mfma_f32_16x16x32_bf16 v[156:159], v[60:63], v[36:39], v[156:159]
    ds_read_b64_tr_b16 v[94:95], v9 offset:9216
    ds_read_b128 v[68:71], v5 offset:2048
    v_mfma_f32_16x16x32_bf16 v[152:155], v[56:59], v[36:39], v[152:155]
    ds_read_b128 v[72:75], v5 offset:4096
    ds_read_b128 v[76:79], v5 offset:6144
    v_mfma_f32_16x16x32_bf16 v[148:151], v[52:55], v[36:39], v[148:151]
    s_add_u32 s59, s59, 1
    s_cmp_eq_u32 s59, 3
    s_cselect_b32 s59, 0, s59
    s_cselect_b32 s71, 0xfffdc000, 0
    s_add_u32 s71, s71, 49152
    v_add_u32 v4, s71, v4
    v_mfma_f32_16x16x32_bf16 v[144:147], v[48:51], v[36:39], v[144:147]
    v_add_u32 v5, s71, v5
    v_add_u32 v6, s71, v6
    v_mfma_f32_16x16x32_bf16 v[160:163], v[48:51], v[40:43], v[160:163]
    v_add_u32 v7, s71, v7
    v_add_u32 v8, s71, v8
    v_mfma_f32_16x16x32_bf16 v[164:167], v[52:55], v[40:43], v[164:167]
    v_add_u32 v9, s71, v9
    s_sub_u32 s70, s70, 1
    v_mfma_f32_16x16x32_bf16 v[168:171], v[56:59], v[40:43], v[168:171]
    v_mfma_f32_16x16x32_bf16 v[172:175], v[60:63], v[40:43], v[172:175]
    v_mfma_f32_16x16x32_bf16 v[188:191], v[60:63], v[44:47], v[188:191]
    v_mfma_f32_16x16x32_bf16 v[184:187], v[56:59], v[44:47], v[184:187]
    v_mfma_f32_16x16x32_bf16 v[180:183], v[52:55], v[44:47], v[180:183]
    v_mfma_f32_16x16x32_bf16 v[176:179], v[48:51], v[44:47], v[176:179]
    s_cmp_lt_u32 s70, 3
    s_cbranch_scc1 G2N_O_TAIL
    s_waitcnt vmcnt(6) lgkmcnt(0)
    s_barrier
    v_mfma_f32_16x16x32_bf16 v[128:131], v[80:83], v[64:67], v[128:131]
    s_add_u32 m0, s74, 0
    s_add_u32 s71, s68, 0
    buffer_load_dwordx4 v1, s[60:63], s71 offen sc1 lds
    ds_read_b128 v[32:35], v4 offset:0
    v_mfma_f32_16x16x32_bf16 v[132:135], v[84:87], v[64:67], v[132:135]
    ds_read_b64_tr_b16 v[48:49], v6 offset:0
    s_add_u32 m0, s74, 8192
    s_add_u32 s71, s68, 524288
    buffer_load_dwordx4 v1, s[60:63], s71 offen sc1 lds
    v_mfma_f32_16x16x32_bf16 v[136:139], v[88:91], v[64:67], v[136:139]
    ds_read_b64_tr_b16 v[50:51], v6 offset:1024
    ds_read_b64_tr_b16 v[52:53], v7 offset:0
    v_mfma_f32_16x16x32_bf16 v[140:143], v[92:95], v[64:67], v[140:143]
    s_add_u32 m0, s74, 16384
    s_add_u32 s71, s68, 1048576
    buffer_load_dwordx4 v1, s[60:63], s71 offen sc1 lds
    ds_read_b64_tr_b16 v[54:55], v7 offset:1024
    v_mfma_f32_16x16x32_bf16 v[156:159], v[92:95], v[68:71], v[156:159]
    ds_read_b64_tr_b16 v[56:57], v8 offset:0
    s_add_u32 m0, s74, 24576
    s_add_u32 s71, s68, 1572864
    buffer_load_dwordx4 v1, s[60:63], s71 offen sc1 lds
    v_mfma_f32_16x16x32_bf16 v[152:155], v[88:91], v[68:71], v[152:155]
    ds_read_b64_tr_b16 v[58:59], v8 offset:1024
    ds_read_b64_tr_b16 v[60:61], v9 offset:0
    v_mfma_f32_16x16x32_bf16 v[148:151], v[84:87], v[68:71], v[148:151]
    s_add_u32 m0, s74, 32768
    s_add_u32 s71, s69, 0
    buffer_load_dwordx4 v2, s[64:67], s71 offen sc1 lds
    ds_read_b64_tr_b16 v[62:63], v9 offset:1024
    v_mfma_f32_16x16x32_bf16 v[144:147], v[80:83], v[68:71], v[144:147]
    ds_read_b128 v[36:39], v4 offset:2048
    s_add_u32 m0, s74, 40960
    s_add_u32 s71, s69, 65536
    buffer_load_dwordx4 v2, s[64:67], s71 offen sc1 lds
    v_mfma_f32_16x16x32_bf16 v[160:163], v[80:83], v[72:75], v[160:163]
    ds_read_b128 v[40:43], v4 offset:4096
    ds_read_b128 v[44:47], v4 offset:6144
    v_mfma_f32_16x16x32_bf16 v[164:167], v[84:87], v[72:75], v[164:167]
    s_add_u32 s68, s68, 2048
    s_add_u32 s69, s69, 131072
    s_add_u32 s75, s75, 1
    s_cmp_eq_u32 s75, 3
    s_cselect_b32 s75, 0, s75
    s_cselect_b32 s71, 0xfffdc000, 0
    s_add_u32 s71, s71, 49152
    s_add_u32 s74, s74, s71
    v_mfma_f32_16x16x32_bf16 v[168:171], v[88:91], v[72:75], v[168:171]
    v_mfma_f32_16x16x32_bf16 v[172:175], v[92:95], v[72:75], v[172:175]
    v_mfma_f32_16x16x32_bf16 v[188:191], v[92:95], v[76:79], v[188:191]
    v_mfma_f32_16x16x32_bf16 v[184:187], v[88:91], v[76:79], v[184:187]
    v_mfma_f32_16x16x32_bf16 v[180:183], v[84:87], v[76:79], v[180:183]
    v_mfma_f32_16x16x32_bf16 v[176:179], v[80:83], v[76:79], v[176:179]
    s_branch G2N_O_LOOP
G2N_O_TAIL:
    s_waitcnt vmcnt(0) lgkmcnt(0)
    s_barrier
    v_mfma_f32_16x16x32_bf16 v[128:131], v[80:83], v[64:67], v[128:131]
    ds_read_b128 v[32:35], v4 offset:0
    v_mfma_f32_16x16x32_bf16 v[132:135], v[84:87], v[64:67], v[132:135]
    ds_read_b64_tr_b16 v[48:49], v6 offset:0
    v_mfma_f32_16x16x32_bf16 v[136:139], v[88:91], v[64:67], v[136:139]
    ds_read_b64_tr_b16 v[50:51], v6 offset:1024
    v_mfma_f32_16x16x32_bf16 v[140:143], v[92:95], v[64:67], v[140:143]
    ds_read_b64_tr_b16 v[52:53], v7 offset:0
    v_mfma_f32_16x16x32_bf16 v[156:159], v[92:95], v[68:71], v[156:159]
    ds_read_b64_tr_b16 v[54:55], v7 offset:1024
    v_mfma_f32_16x16x32_bf16 v[152:155], v[88:91], v[68:71], v[152:155]
    ds_read_b64_tr_b16 v[56:57], v8 offset:0
    v_mfma_f32_16x16x32_bf16 v[148:151], v[84:87], v[68:71], v[148:151]
    ds_read_b64_tr_b16 v[58:59], v8 offset:1024
    v_mfma_f32_16x16x32_bf16 v[144:147], v[80:83], v[68:71], v[144:147]
    ds_read_b64_tr_b16 v[60:61], v9 offset:0
    v_mfma_f32_16x16x32_bf16 v[160:163], v[80:83], v[72:75], v[160:163]
    ds_read_b64_tr_b16 v[62:63], v9 offset:1024
    v_mfma_f32_16x16x32_bf16 v[164:167], v[84:87], v[72:75], v[164:167]
    ds_read_b128 v[36:39], v4 offset:2048
    v_mfma_f32_16x16x32_bf16 v[168:171], v[88:91], v[72:75], v[168:171]
    ds_read_b128 v[40:43], v4 offset:4096
    v_mfma_f32_16x16x32_bf16 v[172:175], v[92:95], v[72:75], v[172:175]
    ds_read_b128 v[44:47], v4 offset:6144
    v_mfma_f32_16x16x32_bf16 v[188:191], v[92:95], v[76:79], v[188:191]
    v_mfma_f32_16x16x32_bf16 v[184:187], v[88:91], v[76:79], v[184:187]
    v_mfma_f32_16x16x32_bf16 v[180:183], v[84:87], v[76:79], v[180:183]
    v_mfma_f32_16x16x32_bf16 v[176:179], v[80:83], v[76:79], v[176:179]
    s_cmp_lg_u32 s70, 0
    s_cbranch_scc1 G2N_O_LOOP
    s_waitcnt lgkmcnt(0)
    s_nop 7
G2N_EP:
    s_and_b32 s85, s73, 1
    s_lshl_b32 s85, s85, 13
    s_add_u32 s85, s85, s95
    s_mul_i32 s86, s72, 16384
    s_add_u32 s85, s85, s86
    v_lshlrev_b32 v14, 4, v0
    v_cvt_pk_bf16_f32 v32, v128, v129
    v_cvt_pk_bf16_f32 v34, v132, v133
    v_cvt_pk_bf16_f32 v33, v130, v131
    v_cvt_pk_bf16_f32 v35, v134, v135
    buffer_store_dwordx4 v[32:35], v14, s[8:11], s85 offen offset:0 sc1
    v_cvt_pk_bf16_f32 v36, v136, v137
    v_cvt_pk_bf16_f32 v38, v140, v141
    v_cvt_pk_bf16_f32 v37, v138, v139
    v_cvt_pk_bf16_f32 v39, v142, v143
    buffer_store_dwordx4 v[36:39], v14, s[8:11], s85 offen offset:1024 sc1
    v_cvt_pk_bf16_f32 v40, v144, v145
    v_cvt_pk_bf16_f32 v42, v148, v149
    v_cvt_pk_bf16_f32 v41, v146, v147
    v_cvt_pk_bf16_f32 v43, v150, v151
    buffer_store_dwordx4 v[40:43], v14, s[8:11], s85 offen offset:2048 sc1
    v_cvt_pk_bf16_f32 v44, v152, v153
    v_cvt_pk_bf16_f32 v46, v156, v157
    v_cvt_pk_bf16_f32 v45, v154, v155
    v_cvt_pk_bf16_f32 v47, v158, v159
    buffer_store_dwordx4 v[44:47], v14, s[8:11], s85 offen offset:3072 sc1
    s_add_u32 s85, s85, 4096
    v_cvt_pk_bf16_f32 v48, v160, v161
    v_cvt_pk_bf16_f32 v50, v164, v165
    v_cvt_pk_bf16_f32 v49, v162, v163
    v_cvt_pk_bf16_f32 v51, v166, v167
    buffer_store_dwordx4 v[48:51], v14, s[8:11], s85 offen offset:0 sc1
    v_cvt_pk_bf16_f32 v52, v168, v169
    v_cvt_pk_bf16_f32 v54, v172, v173
    v_cvt_pk_bf16_f32 v53, v170, v171
    v_cvt_pk_bf16_f32 v55, v174, v175
    buffer_store_dwordx4 v[52:55], v14, s[8:11], s85 offen offset:1024 sc1
    v_cvt_pk_bf16_f32 v56, v176, v177
    v_cvt_pk_bf16_f32 v58, v180, v181
    v_cvt_pk_bf16_f32 v57, v178, v179
    v_cvt_pk_bf16_f32 v59, v182, v183
    buffer_store_dwordx4 v[56:59], v14, s[8:11], s85 offen offset:2048 sc1
    v_cvt_pk_bf16_f32 v60, v184, v185
    v_cvt_pk_bf16_f32 v62, v188, v189
    v_cvt_pk_bf16_f32 v61, v186, v187
    v_cvt_pk_bf16_f32 v63, v190, v191
    buffer_store_dwordx4 v[60:63], v14, s[8:11], s85 offen offset:3072 sc1
    s_add_u32 s85, s85, 12288
    s_branch G_DONE
H_G2S:
    s_and_b32 s94, s26, 255
    s_bfe_u32 s91, s26, 0x80008
    s_lshr_b32 s4, s26, 16
    s_mul_i32 s95, s4, s52
    s_add_u32 s95, s95, s27
    s_lshl_b32 s95, s95, 16
    s_add_u32 s95, s95, 125829120
    s_lshl_b32 s93, s52, 4
    s_add_u32 s93, s93, s79
    s_mov_b32 s60, s8
    s_mov_b32 s61, s9
    s_mov_b32 s62, s10
    s_mov_b32 s63, s11
    s_load_dwordx2 s[4:5], s[0:1], 40
    s_mul_i32 s68, s77, 1048576
    s_lshl_b32 s86, s93, 11
    s_add_u32 s68, s68, s86
    s_add_u32 s68, s68, 88080384
    s_mul_i32 s69, s78, 256
    s_lshl_b32 s86, s93, 17
    s_add_u32 s69, s69, s86
    s_waitcnt lgkmcnt(0)
    s_mov_b32 s64, s4
    s_and_b32 s65, s5, 0xffff
    s_mov_b32 s66, 8388608
    s_mov_b32 s67, 0x20000
    s_lshr_b32 s72, s76, 1
    s_and_b32 s73, s76, 1
    s_lshr_b32 s71, s76, 1
    s_mul_i32 s71, s71, 131072
    s_and_b32 s70, s76, 1
    s_lshl_b32 s70, s70, 10
    s_add_u32 s71, s71, s70
    v_lshl_add_u32 v1, v0, 4, s71
    s_mul_i32 s71, s72, 4096
    v_lshl_add_u32 v4, v0, 4, s71
    v_add_u32 v5, 1024, v4
    v_lshrrev_b32 v14, 4, v0
    s_mul_i32 s71, s76, 4
    v_add_u32 v14, s71, v14
    v_and_b32 v15, 3, v14
    v_lshlrev_b32 v15, 1, v15
    v_and_b32 v16, 8, v14
    v_or_b32 v15, v15, v16
    v_and_b32 v16, 15, v0
    v_xor_b32 v15, v15, v16
    s_mov_b32 s71, 2048
    v_mul_lo_u32 v2, v14, s71
    v_lshl_add_u32 v2, v15, 4, v2
    v_bfe_u32 v14, v0, 2, 2
    v_lshrrev_b32 v15, 4, v0
    v_lshl_add_u32 v15, v15, 3, v14
    v_mul_u32_u24 v15, 256, v15
    v_and_b32 v16, 3, v0
    v_lshl_add_u32 v15, v16, 3, v15
    v_add_u32 v15, 16384, v15
    v_bfe_u32 v14, v0, 2, 3
    s_mul_i32 s71, s73, 4
    v_xor_b32 v14, s71, v14
    v_lshl_add_u32 v6, v14, 5, v15
    v_xor_b32 v7, 32, v6
    v_xor_b32 v8, 64, v6
    v_xor_b32 v9, 96, v6
    s_lshl_b32 s74, s76, 10
    s_mov_b32 s75, 0
    s_mov_b32 s59, 0
    s_barrier
    s_add_u32 m0, s74, 0
    s_add_u32 s71, s68, 0
    buffer_load_dwordx4 v1, s[60:63], s71 offen sc1 lds
    s_add_u32 m0, s74, 8192
    s_add_u32 s71, s68, 524288
    buffer_load_dwordx4 v1, s[60:63], s71 offen sc1 lds
    s_add_u32 m0, s74, 16384
    s_add_u32 s71, s69, 0
    buffer_load_dwordx4 v2, s[64:67], s71 offen sc1 lds
    s_add_u32 m0, s74, 24576
    s_add_u32 s71, s69, 65536
    buffer_load_dwordx4 v2, s[64:67], s71 offen sc1 lds
    s_add_u32 s68, s68, 2048
    s_add_u32 s69, s69, 131072
    s_add_u32 s75, s75, 1
    s_cmp_eq_u32 s75, 4
    s_cselect_b32 s75, 0, s75
    s_cselect_b32 s71, 0xfffe0000, 0
    s_add_u32 s71, s71, 32768
    s_add_u32 s74, s74, s71
    s_add_u32 m0, s74, 0
    s_add_u32 s71, s68, 0
    buffer_load_dwordx4 v1, s[60:63], s71 offen sc1 lds
    s_add_u32 m0, s74, 8192
    s_add_u32 s71, s68, 524288
    buffer_load_dwordx4 v1, s[60:63], s71 offen sc1 lds
    s_add_u32 m0, s74, 16384
    s_add_u32 s71, s69, 0
    buffer_load_dwordx4 v2, s[64:67], s71 offen sc1 lds
    s_add_u32 m0, s74, 24576
    s_add_u32 s71, s69, 65536
    buffer_load_dwordx4 v2, s[64:67], s71 offen sc1 lds
    s_add_u32 s68, s68, 2048
    s_add_u32 s69, s69, 131072
    s_add_u32 s75, s75, 1
    s_cmp_eq_u32 s75, 4
    s_cselect_b32 s75, 0, s75
    s_cselect_b32 s71, 0xfffe0000, 0
    s_add_u32 s71, s71, 32768
    s_add_u32 s74, s74, s71
    s_add_u32 m0, s74, 0
    s_add_u32 s71, s68, 0
    buffer_load_dwordx4 v1, s[60:63], s71 offen sc1 lds
    s_add_u32 m0, s74, 8192
    s_add_u32 s71, s68, 524288
    buffer_load_dwordx4 v1, s[60:63], s71 offen sc1 lds
    s_add_u32 m0, s74, 16384
    s_add_u32 s71, s69, 0
    buffer_load_dwordx4 v2, s[64:67], s71 offen sc1 lds
    s_add_u32 m0, s74, 24576
    s_add_u32 s71, s69, 65536
    buffer_load_dwordx4 v2, s[64:67], s71 offen sc1 lds
    s_add_u32 s68, s68, 2048
    s_add_u32 s69, s69, 131072
    s_add_u32 s75, s75, 1
    s_cmp_eq_u32 s75, 4
    s_cselect_b32 s75, 0, s75
    s_cselect_b32 s71, 0xfffe0000, 0
    s_add_u32 s71, s71, 32768
    s_add_u32 s74, s74, s71
    s_add_u32 m0, s74, 0
    s_add_u32 s71, s68, 0
    buffer_load_dwordx4 v1, s[60:63], s71 offen sc1 lds
    s_add_u32 m0, s74, 8192
    s_add_u32 s71, s68, 524288
    buffer_load_dwordx4 v1, s[60:63], s71 offen sc1 lds
    s_add_u32 m0, s74, 16384
    s_add_u32 s71, s69, 0
    buffer_load_dwordx4 v2, s[64:67], s71 offen sc1 lds
    s_add_u32 m0, s74, 24576
    s_add_u32 s71, s69, 65536
    buffer_load_dwordx4 v2, s[64:67], s71 offen sc1 lds
    s_add_u32 s68, s68, 2048
    s_add_u32 s69, s69, 131072
    s_add_u32 s75, s75, 1
    s_cmp_eq_u32 s75, 4
    s_cselect_b32 s75, 0, s75
    s_cselect_b32 s71, 0xfffe0000, 0
    s_add_u32 s71, s71, 32768
    s_add_u32 s74, s74, s71
    s_mov_b32 s70, s94
    v_mov_b32 v128, 0
    v_mov_b32 v129, 0
    v_mov_b32 v130, 0
    v_mov_b32 v131, 0
    v_mov_b32 v132, 0
    v_mov_b32 v133, 0
    v_mov_b32 v134, 0
    v_mov_b32 v135, 0
    v_mov_b32 v136, 0
    v_mov_b32 v137, 0
    v_mov_b32 v138, 0
    v_mov_b32 v139, 0
    v_mov_b32 v140, 0
    v_mov_b32 v141, 0
    v_mov_b32 v142, 0
    v_mov_b32 v143, 0
    v_mov_b32 v144, 0
    v_mov_b32 v145, 0
    v_mov_b32 v146, 0
    v_mov_b32 v147, 0
    v_mov_b32 v148, 0
    v_mov_b32 v149, 0
    v_mov_b32 v150, 0
    v_mov_b32 v151, 0
    v_mov_b32 v152, 0
    v_mov_b32 v153, 0
    v_mov_b32 v154, 0
    v_mov_b32 v155, 0
    v_mov_b32 v156, 0
    v_mov_b32 v157, 0
    v_mov_b32 v158, 0
    v_mov_b32 v159, 0
    s_waitcnt vmcnt(12)
    s_barrier
    s_cmp_eq_u32 s31, 0
    s_cbranch_scc1 G2S_O_HS
    s_mov_b64 exec, 1
    s_bfe_u32 s4, s31, 0x7000a
    s_mul_i32 s4, s4, s52
    s_and_b32 s5, s31, 0x3ff
    s_add_u32 s4, s4, s5
    s_lshl_b32 s4, s4, 7
    s_add_u32 s4, s4, 124780544
    s_lshr_b32 s5, s31, 20
    v_mov_b32 v28, s5
    buffer_atomic_add v28, off, s[8:11], s4 sc1
    s_mov_b64 exec, -1
    s_mov_b32 s31, 0
G2S_O_HS:
    ds_read_b128 v[32:35], v4 offset:0
    ds_read_b64_tr_b16 v[40:41], v6 offset:0
    ds_read_b64_tr_b16 v[42:43], v6 offset:1024
    ds_read_b64_tr_b16 v[44:45], v7 offset:0
    ds_read_b64_tr_b16 v[46:47], v7 offset:1024
    ds_read_b64_tr_b16 v[48:49], v8 offset:0
    ds_read_b64_tr_b16 v[50:51], v8 offset:1024
    ds_read_b64_tr_b16 v[52:53], v9 offset:0
    ds_read_b64_tr_b16 v[54:55], v9 offset:1024
    ds_read_b128 v[36:39], v4 offset:2048
G2S_O_LOOP:
    s_waitcnt lgkmcnt(0)
    v_mfma_f32_16x16x32_bf16 v[128:131], v[40:43], v[32:35], v[128:131]
    ds_read_b128 v[56:59], v5 offset:0
    ds_read_b64_tr_b16 v[64:65], v6 offset:8192
    ds_read_b64_tr_b16 v[66:67], v6 offset:9216
    v_mfma_f32_16x16x32_bf16 v[132:135], v[44:47], v[32:35], v[132:135]
    ds_read_b64_tr_b16 v[68:69], v7 offset:8192
    ds_read_b64_tr_b16 v[70:71], v7 offset:9216
    ds_read_b64_tr_b16 v[72:73], v8 offset:8192
    v_mfma_f32_16x16x32_bf16 v[136:139], v[48:51], v[32:35], v[136:139]
    ds_read_b64_tr_b16 v[74:75], v8 offset:9216
    ds_read_b64_tr_b16 v[76:77], v9 offset:8192
    ds_read_b64_tr_b16 v[78:79], v9 offset:9216
    v_mfma_f32_16x16x32_bf16 v[140:143], v[52:55], v[32:35], v[140:143]
    ds_read_b128 v[60:63], v5 offset:2048
    s_add_u32 s59, s59, 1
    s_cmp_eq_u32 s59, 4
    s_cselect_b32 s59, 0, s59
    s_cselect_b32 s71, 0xfffe0000, 0
    s_add_u32 s71, s71, 32768
    v_add_u32 v4, s71, v4
    v_mfma_f32_16x16x32_bf16 v[156:159], v[52:55], v[36:39], v[156:159]
    v_add_u32 v5, s71, v5
    v_add_u32 v6, s71, v6
    v_add_u32 v7, s71, v7
    v_mfma_f32_16x16x32_bf16 v[152:155], v[48:51], v[36:39], v[152:155]
    v_add_u32 v8, s71, v8
    v_add_u32 v9, s71, v9
    s_sub_u32 s70, s70, 1
    v_mfma_f32_16x16x32_bf16 v[148:151], v[44:47], v[36:39], v[148:151]
    v_mfma_f32_16x16x32_bf16 v[144:147], v[40:43], v[36:39], v[144:147]
    s_cmp_lt_u32 s70, 4
    s_cbranch_scc1 G2S_O_TAIL
    s_waitcnt vmcnt(8) lgkmcnt(0)
    s_barrier
    v_mfma_f32_16x16x32_bf16 v[128:131], v[64:67], v[56:59], v[128:131]
    s_add_u32 m0, s74, 0
    s_add_u32 s71, s68, 0
    buffer_load_dwordx4 v1, s[60:63], s71 offen sc1 lds
    ds_read_b128 v[32:35], v4 offset:0
    v_mfma_f32_16x16x32_bf16 v[132:135], v[68:71], v[56:59], v[132:135]
    ds_read_b64_tr_b16 v[40:41], v6 offset:0
    s_add_u32 m0, s74, 8192
    s_add_u32 s71, s68, 524288
    buffer_load_dwordx4 v1, s[60:63], s71 offen sc1 lds
    v_mfma_f32_16x16x32_bf16 v[136:139], v[72:75], v[56:59], v[136:139]
    ds_read_b64_tr_b16 v[42:43], v6 offset:1024
    ds_read_b64_tr_b16 v[44:45], v7 offset:0
    v_mfma_f32_16x16x32_bf16 v[140:143], v[76:79], v[56:59], v[140:143]
    s_add_u32 m0, s74, 16384
    s_add_u32 s71, s69, 0
    buffer_load_dwordx4 v2, s[64:67], s71 offen sc1 lds
    ds_read_b64_tr_b16 v[46:47], v7 offset:1024
    v_mfma_f32_16x16x32_bf16 v[156:159], v[76:79], v[60:63], v[156:159]
    ds_read_b64_tr_b16 v[48:49], v8 offset:0
    s_add_u32 m0, s74, 24576
    s_add_u32 s71, s69, 65536
    buffer_load_dwordx4 v2, s[64:67], s71 offen sc1 lds
    v_mfma_f32_16x16x32_bf16 v[152:155], v[72:75], v[60:63], v[152:155]
    ds_read_b64_tr_b16 v[50:51], v8 offset:1024
    ds_read_b64_tr_b16 v[52:53], v9 offset:0
    v_mfma_f32_16x16x32_bf16 v[148:151], v[68:71], v[60:63], v[148:151]
    ds_read_b64_tr_b16 v[54:55], v9 offset:1024
    ds_read_b128 v[36:39], v4 offset:2048
    v_mfma_f32_16x16x32_bf16 v[144:147], v[64:67], v[60:63], v[144:147]
    s_add_u32 s68, s68, 2048
    s_add_u32 s69, s69, 131072
    s_add_u32 s75, s75, 1
    s_cmp_eq_u32 s75, 4
    s_cselect_b32 s75, 0, s75
    s_cselect_b32 s71, 0xfffe0000, 0
    s_add_u32 s71, s71, 32768
    s_add_u32 s74, s74, s71
    s_branch G2S_O_LOOP
G2S_O_TAIL:
    s_waitcnt vmcnt(0) lgkmcnt(0)
    s_barrier
    v_mfma_f32_16x16x32_bf16 v[128:131], v[64:67], v[56:59], v[128:131]
    ds_read_b128 v[32:35], v4 offset:0
    ds_read_b64_tr_b16 v[40:41], v6 offset:0
    v_mfma_f32_16x16x32_bf16 v[132:135], v[68:71], v[56:59], v[132:135]
    ds_read_b64_tr_b16 v[42:43], v6 offset:1024
    ds_read_b64_tr_b16 v[44:45], v7 offset:0
    v_mfma_f32_16x16x32_bf16 v[136:139], v[72:75], v[56:59], v[136:139]
    ds_read_b64_tr_b16 v[46:47], v7 offset:1024
    ds_read_b64_tr_b16 v[48:49], v8 offset:0
    v_mfma_f32_16x16x32_bf16 v[140:143], v[76:79], v[56:59], v[140:143]
    ds_read_b64_tr_b16 v[50:51], v8 offset:1024
    ds_read_b64_tr_b16 v[52:53], v9 offset:0
    v_mfma_f32_16x16x32_bf16 v[156:159], v[76:79], v[60:63], v[156:159]
    ds_read_b64_tr_b16 v[54:55], v9 offset:1024
    ds_read_b128 v[36:39], v4 offset:2048
    v_mfma_f32_16x16x32_bf16 v[152:155], v[72:75], v[60:63], v[152:155]
    v_mfma_f32_16x16x32_bf16 v[148:151], v[68:71], v[60:63], v[148:151]
    v_mfma_f32_16x16x32_bf16 v[144:147], v[64:67], v[60:63], v[144:147]
    s_cmp_lg_u32 s70, 0
    s_cbranch_scc1 G2S_O_LOOP
    s_waitcnt lgkmcnt(0)
    s_nop 7
G2S_EP:
    s_and_b32 s85, s73, 1
    s_lshl_b32 s85, s85, 13
    s_add_u32 s85, s85, s95
    s_and_b32 s86, s77, 1
    s_lshl_b32 s86, s86, 15
    s_add_u32 s85, s85, s86
    s_lshr_b32 s86, s72, 1
    s_lshl_b32 s86, s86, 14
    s_add_u32 s85, s85, s86
    s_and_b32 s86, s72, 1
    s_lshl_b32 s86, s86, 12
    s_add_u32 s85, s85, s86
    v_lshlrev_b32 v14, 4, v0
    v_cvt_pk_bf16_f32 v32, v128, v129
    v_cvt_pk_bf16_f32 v34, v132, v133
    v_cvt_pk_bf16_f32 v33, v130, v131
    v_cvt_pk_bf16_f32 v35, v134, v135
    buffer_store_dwordx4 v[32:35], v14, s[8:11], s85 offen offset:0 sc1
    v_cvt_pk_bf16_f32 v36, v136, v137
    v_cvt_pk_bf16_f32 v38, v140, v141
    v_cvt_pk_bf16_f32 v37, v138, v139
    v_cvt_pk_bf16_f32 v39, v142, v143
    buffer_store_dwordx4 v[36:39], v14, s[8:11], s85 offen offset:1024 sc1
    v_cvt_pk_bf16_f32 v40, v144, v145
    v_cvt_pk_bf16_f32 v42, v148, v149
    v_cvt_pk_bf16_f32 v41, v146, v147
    v_cvt_pk_bf16_f32 v43, v150, v151
    buffer_store_dwordx4 v[40:43], v14, s[8:11], s85 offen offset:2048 sc1
    v_cvt_pk_bf16_f32 v44, v152, v153
    v_cvt_pk_bf16_f32 v46, v156, v157
    v_cvt_pk_bf16_f32 v45, v154, v155
    v_cvt_pk_bf16_f32 v47, v158, v159
    buffer_store_dwordx4 v[44:47], v14, s[8:11], s85 offen offset:3072 sc1
    s_add_u32 s85, s85, 4096
    s_branch G_DONE
H_Z:
    s_and_b32 s94, s26, 255
    s_bfe_u32 s91, s26, 0x80008
    s_lshr_b32 s4, s26, 16
    s_mul_i32 s95, s4, s52
    s_add_u32 s95, s95, s27
    s_lshl_b32 s95, s95, 16
    s_add_u32 s95, s95, 125829120
    s_lshl_b32 s93, s52, 4
    s_add_u32 s93, s93, s79
    s_mov_b32 s78, s52
    s_mov_b32 s60, s8
    s_mov_b32 s64, s8
    s_mov_b32 s61, s9
    s_mov_b32 s65, s9
    s_mov_b32 s62, s10
    s_mov_b32 s66, s10
    s_mov_b32 s63, s11
    s_mov_b32 s67, s11
    s_lshl_b32 s68, s77, 12
    s_add_u32 s68, s68, 109051904
    s_lshl_b32 s69, s78, 8
    s_add_u32 s69, s69, 115343360
    s_lshr_b32 s72, s76, 1
    s_and_b32 s73, s76, 1
    s_lshr_b32 s71, s76, 2
    s_mul_i32 s71, s71, 32768
    s_and_b32 s70, s76, 3
    s_lshl_b32 s70, s70, 10
    s_add_u32 s71, s71, s70
    v_lshl_add_u32 v1, v0, 4, s71
    v_and_b32 v14, 15, v0
    v_lshrrev_b32 v16, 4, v0
    v_mul_u32_u24 v16, 4096, v16
    v_lshl_add_u32 v14, v14, 4, v16
    s_mul_i32 s71, s72, 1024
    v_add_u32 v4, s71, v14
    v_add_u32 v5, 16384, v4
    v_lshrrev_b32 v14, 4, v0
    s_mul_i32 s71, s76, 4
    v_add_u32 v14, s71, v14
    v_and_b32 v15, 3, v14
    v_lshlrev_b32 v15, 1, v15
    v_and_b32 v16, 8, v14
    v_or_b32 v15, v15, v16
    v_and_b32 v16, 15, v0
    v_xor_b32 v15, v15, v16
    s_mov_b32 s71, 1024
    v_mul_lo_u32 v2, v14, s71
    v_lshl_add_u32 v2, v15, 4, v2
    v_bfe_u32 v14, v0, 2, 2
    v_lshrrev_b32 v15, 4, v0
    v_lshl_add_u32 v15, v15, 3, v14
    v_mul_u32_u24 v15, 256, v15
    v_and_b32 v16, 3, v0
    v_lshl_add_u32 v15, v16, 3, v15
    v_add_u32 v15, 32768, v15
    v_bfe_u32 v14, v0, 2, 3
    s_mul_i32 s71, s73, 4
    v_xor_b32 v14, s71, v14
    v_lshl_add_u32 v6, v14, 5, v15
    v_xor_b32 v7, 32, v6
    v_xor_b32 v8, 64, v6
    v_xor_b32 v9, 96, v6
    s_lshl_b32 s74, s76, 10
    s_mov_b32 s75, 0
    s_mov_b32 s59, 0
    s_lshl_b32 s85, s77, 10
    s_lshl_b32 s86, s72, 8
    s_add_u32 s86, s86, s85
    s_add_u32 s86, s86, 123740160
    v_and_b32 v3, 15, v0
    v_lshlrev_b32 v3, 2, v3
    buffer_load_dword v20, v3, s[8:11], s86 offen offset:0 sc1
    buffer_load_dword v22, v3, s[8:11], s86 offen offset:64 sc1
    buffer_load_dword v24, v3, s[8:11], s86 offen offset:128 sc1
    buffer_load_dword v26, v3, s[8:11], s86 offen offset:192 sc1
    s_barrier
    s_add_u32 m0, s74, 0
    s_add_u32 s71, s68, 0
    buffer_load_dwordx4 v1, s[60:63], s71 offen sc1 lds
    s_add_u32 m0, s74, 8192
    s_add_u32 s71, s68, 65536
    buffer_load_dwordx4 v1, s[60:63], s71 offen sc1 lds
    s_add_u32 m0, s74, 16384
    s_add_u32 s71, s68, 131072
    buffer_load_dwordx4 v1, s[60:63], s71 offen sc1 lds
    s_add_u32 m0, s74, 24576
    s_add_u32 s71, s68, 196608
    buffer_load_dwordx4 v1, s[60:63], s71 offen sc1 lds
    s_add_u32 m0, s74, 32768
    s_add_u32 s71, s69, 0
    buffer_load_dwordx4 v2, s[64:67], s71 offen sc1 lds
    s_add_u32 m0, s74, 40960
    s_add_u32 s71, s69, 32768
    buffer_load_dwordx4 v2, s[64:67], s71 offen sc1 lds
    s_add_u32 s68, s68, 262144
    s_add_u32 s69, s69, 65536
    s_add_u32 s75, s75, 1
    s_cmp_eq_u32 s75, 3
    s_cselect_b32 s75, 0, s75
    s_cselect_b32 s71, 0xfffdc000, 0
    s_add_u32 s71, s71, 49152
    s_add_u32 s74, s74, s71
    s_add_u32 m0, s74, 0
    s_add_u32 s71, s68, 0
    buffer_load_dwordx4 v1, s[60:63], s71 offen sc1 lds
    s_add_u32 m0, s74, 8192
    s_add_u32 s71, s68, 65536
    buffer_load_dwordx4 v1, s[60:63], s71 offen sc1 lds
    s_add_u32 m0, s74, 16384
    s_add_u32 s71, s68, 131072
    buffer_load_dwordx4 v1, s[60:63], s71 offen sc1 lds
    s_add_u32 m0, s74, 24576
    s_add_u32 s71, s68, 196608
    buffer_load_dwordx4 v1, s[60:63], s71 offen sc1 lds
    s_add_u32 m0, s74, 32768
    s_add_u32 s71, s69, 0
    buffer_load_dwordx4 v2, s[64:67], s71 offen sc1 lds
    s_add_u32 m0, s74, 40960
    s_add_u32 s71, s69, 32768
    buffer_load_dwordx4 v2, s[64:67], s71 offen sc1 lds
    s_add_u32 s68, s68, 262144
    s_add_u32 s69, s69, 65536
    s_add_u32 s75, s75, 1
    s_cmp_eq_u32 s75, 3
    s_cselect_b32 s75, 0, s75
    s_cselect_b32 s71, 0xfffdc000, 0
    s_add_u32 s71, s71, 49152
    s_add_u32 s74, s74, s71
    s_add_u32 m0, s74, 0
    s_add_u32 s71, s68, 0
    buffer_load_dwordx4 v1, s[60:63], s71 offen sc1 lds
    s_add_u32 m0, s74, 8192
    s_add_u32 s71, s68, 65536
    buffer_load_dwordx4 v1, s[60:63], s71 offen sc1 lds
    s_add_u32 m0, s74, 16384
    s_add_u32 s71, s68, 131072
    buffer_load_dwordx4 v1, s[60:63], s71 offen sc1 lds
    s_add_u32 m0, s74, 24576
    s_add_u32 s71, s68, 196608
    buffer_load_dwordx4 v1, s[60:63], s71 offen sc1 lds
    s_add_u32 m0, s74, 32768
    s_add_u32 s71, s69, 0
    buffer_load_dwordx4 v2, s[64:67], s71 offen sc1 lds
    s_add_u32 m0, s74, 40960
    s_add_u32 s71, s69, 32768
    buffer_load_dwordx4 v2, s[64:67], s71 offen sc1 lds
    s_add_u32 s68, s68, 262144
    s_add_u32 s69, s69, 65536
    s_add_u32 s75, s75, 1
    s_cmp_eq_u32 s75, 3
    s_cselect_b32 s75, 0, s75
    s_cselect_b32 s71, 0xfffdc000, 0
    s_add_u32 s71, s71, 49152
    s_add_u32 s74, s74, s71
    s_mov_b32 s70, 8
    v_mov_b32 v128, 0
    v_mov_b32 v129, 0
    v_mov_b32 v130, 0
    v_mov_b32 v131, 0
    v_mov_b32 v132, 0
    v_mov_b32 v133, 0
    v_mov_b32 v134, 0
    v_mov_b32 v135, 0
    v_mov_b32 v136, 0
    v_mov_b32 v137, 0
    v_mov_b32 v138, 0
    v_mov_b32 v139, 0
    v_mov_b32 v140, 0
    v_mov_b32 v141, 0
    v_mov_b32 v142, 0
    v_mov_b32 v143, 0
    v_mov_b32 v144, 0
    v_mov_b32 v145, 0
    v_mov_b32 v146, 0
    v_mov_b32 v147, 0
    v_mov_b32 v148, 0
    v_mov_b32 v149, 0
    v_mov_b32 v150, 0
    v_mov_b32 v151, 0
    v_mov_b32 v152, 0
    v_mov_b32 v153, 0
    v_mov_b32 v154, 0
    v_mov_b32 v155, 0
    v_mov_b32 v156, 0
    v_mov_b32 v157, 0
    v_mov_b32 v158, 0
    v_mov_b32 v159, 0
    v_mov_b32 v160, 0
    v_mov_b32 v161, 0
    v_mov_b32 v162, 0
    v_mov_b32 v163, 0
    v_mov_b32 v164, 0
    v_mov_b32 v165, 0
    v_mov_b32 v166, 0
    v_mov_b32 v167, 0
    v_mov_b32 v168, 0
    v_mov_b32 v169, 0
    v_mov_b32 v170, 0
    v_mov_b32 v171, 0
    v_mov_b32 v172, 0
    v_mov_b32 v173, 0
    v_mov_b32 v174, 0
    v_mov_b32 v175, 0
    v_mov_b32 v176, 0
    v_mov_b32 v177, 0
    v_mov_b32 v178, 0
    v_mov_b32 v179, 0
    v_mov_b32 v180, 0
    v_mov_b32 v181, 0
    v_mov_b32 v182, 0
    v_mov_b32 v183, 0
    v_mov_b32 v184, 0
    v_mov_b32 v185, 0
    v_mov_b32 v186, 0
    v_mov_b32 v187, 0
    v_mov_b32 v188, 0
    v_mov_b32 v189, 0
    v_mov_b32 v190, 0
    v_mov_b32 v191, 0
    s_waitcnt vmcnt(12)
    s_barrier
    s_cmp_eq_u32 s31, 0
    s_cbranch_scc1 ZZ_0_HS
    s_mov_b64 exec, 1
    s_bfe_u32 s4, s31, 0x7000a
    s_mul_i32 s4, s4, s52
    s_and_b32 s5, s31, 0x3ff
    s_add_u32 s4, s4, s5
    s_lshl_b32 s4, s4, 7
    s_add_u32 s4, s4, 124780544
    s_lshr_b32 s5, s31, 20
    v_mov_b32 v28, s5
    buffer_atomic_add v28, off, s[8:11], s4 sc1
    s_mov_b64 exec, -1
    s_mov_b32 s31, 0
ZZ_0_HS:
    ds_read_b128 v[32:35], v4 offset:0
    ds_read_b64_tr_b16 v[48:49], v6 offset:0
    ds_read_b64_tr_b16 v[50:51], v6 offset:1024
    ds_read_b64_tr_b16 v[52:53], v7 offset:0
    ds_read_b64_tr_b16 v[54:55], v7 offset:1024
    ds_read_b64_tr_b16 v[56:57], v8 offset:0
    ds_read_b64_tr_b16 v[58:59], v8 offset:1024
    ds_read_b64_tr_b16 v[60:61], v9 offset:0
    ds_read_b64_tr_b16 v[62:63], v9 offset:1024
    ds_read_b128 v[36:39], v4 offset:256
    ds_read_b128 v[40:43], v4 offset:512
    ds_read_b128 v[44:47], v4 offset:768
ZZ_0_LOOP:
    s_waitcnt lgkmcnt(0)
    v_mfma_f32_16x16x32_bf16 v[128:131], v[48:51], v[32:35], v[128:131]
    ds_read_b128 v[64:67], v5 offset:0
    ds_read_b64_tr_b16 v[80:81], v6 offset:8192
    v_mfma_f32_16x16x32_bf16 v[132:135], v[52:55], v[32:35], v[132:135]
    ds_read_b64_tr_b16 v[82:83], v6 offset:9216
    ds_read_b64_tr_b16 v[84:85], v7 offset:8192
    v_mfma_f32_16x16x32_bf16 v[136:139], v[56:59], v[32:35], v[136:139]
    ds_read_b64_tr_b16 v[86:87], v7 offset:9216
    ds_read_b64_tr_b16 v[88:89], v8 offset:8192
    v_mfma_f32_16x16x32_bf16 v[140:143], v[60:63], v[32:35], v[140:143]
    ds_read_b64_tr_b16 v[90:91], v8 offset:9216
    ds_read_b64_tr_b16 v[92:93], v9 offset:8192
    v_mfma_f32_16x16x32_bf16 v[156:159], v[60:63], v[36:39], v[156:159]
    ds_read_b64_tr_b16 v[94:95], v9 offset:9216
    ds_read_b128 v[68:71], v5 offset:256
    v_mfma_f32_16x16x32_bf16 v[152:155], v[56:59], v[36:39], v[152:155]
    ds_read_b128 v[72:75], v5 offset:512
    ds_read_b128 v[76:79], v5 offset:768
    v_mfma_f32_16x16x32_bf16 v[148:151], v[52:55], v[36:39], v[148:151]
    s_add_u32 s59, s59, 1
    s_cmp_eq_u32 s59, 3
    s_cselect_b32 s59, 0, s59
    s_cselect_b32 s71, 0xfffdc000, 0
    s_add_u32 s71, s71, 49152
    v_add_u32 v4, s71, v4
    v_mfma_f32_16x16x32_bf16 v[144:147], v[48:51], v[36:39], v[144:147]
    v_add_u32 v5, s71, v5
    v_add_u32 v6, s71, v6
    v_mfma_f32_16x16x32_bf16 v[160:163], v[48:51], v[40:43], v[160:163]
    v_add_u32 v7, s71, v7
    v_add_u32 v8, s71, v8
    v_mfma_f32_16x16x32_bf16 v[164:167], v[52:55], v[40:43], v[164:167]
    v_add_u32 v9, s71, v9
    s_sub_u32 s70, s70, 1
    v_mfma_f32_16x16x32_bf16 v[168:171], v[56:59], v[40:43], v[168:171]
    v_mfma_f32_16x16x32_bf16 v[172:175], v[60:63], v[40:43], v[172:175]
    v_mfma_f32_16x16x32_bf16 v[188:191], v[60:63], v[44:47], v[188:191]
    v_mfma_f32_16x16x32_bf16 v[184:187], v[56:59], v[44:47], v[184:187]
    v_mfma_f32_16x16x32_bf16 v[180:183], v[52:55], v[44:47], v[180:183]
    v_mfma_f32_16x16x32_bf16 v[176:179], v[48:51], v[44:47], v[176:179]
    s_cmp_lt_u32 s70, 3
    s_cbranch_scc1 ZZ_0_TAIL
    s_waitcnt vmcnt(6) lgkmcnt(0)
    s_barrier
    v_mfma_f32_16x16x32_bf16 v[128:131], v[80:83], v[64:67], v[128:131]
    s_add_u32 m0, s74, 0
    s_add_u32 s71, s68, 0
    buffer_load_dwordx4 v1, s[60:63], s71 offen sc1 lds
    ds_read_b128 v[32:35], v4 offset:0
    v_mfma_f32_16x16x32_bf16 v[132:135], v[84:87], v[64:67], v[132:135]
    ds_read_b64_tr_b16 v[48:49], v6 offset:0
    s_add_u32 m0, s74, 8192
    s_add_u32 s71, s68, 65536
    buffer_load_dwordx4 v1, s[60:63], s71 offen sc1 lds
    v_mfma_f32_16x16x32_bf16 v[136:139], v[88:91], v[64:67], v[136:139]
    ds_read_b64_tr_b16 v[50:51], v6 offset:1024
    ds_read_b64_tr_b16 v[52:53], v7 offset:0
    v_mfma_f32_16x16x32_bf16 v[140:143], v[92:95], v[64:67], v[140:143]
    s_add_u32 m0, s74, 16384
    s_add_u32 s71, s68, 131072
    buffer_load_dwordx4 v1, s[60:63], s71 offen sc1 lds
    ds_read_b64_tr_b16 v[54:55], v7 offset:1024
    v_mfma_f32_16x16x32_bf16 v[156:159], v[92:95], v[68:71], v[156:159]
    ds_read_b64_tr_b16 v[56:57], v8 offset:0
    s_add_u32 m0, s74, 24576
    s_add_u32 s71, s68, 196608
    buffer_load_dwordx4 v1, s[60:63], s71 offen sc1 lds
    v_mfma_f32_16x16x32_bf16 v[152:155], v[88:91], v[68:71], v[152:155]
    ds_read_b64_tr_b16 v[58:59], v8 offset:1024
    ds_read_b64_tr_b16 v[60:61], v9 offset:0
    v_mfma_f32_16x16x32_bf16 v[148:151], v[84:87], v[68:71], v[148:151]
    s_add_u32 m0, s74, 32768
    s_add_u32 s71, s69, 0
    buffer_load_dwordx4 v2, s[64:67], s71 offen sc1 lds
    ds_read_b64_tr_b16 v[62:63], v9 offset:1024
    v_mfma_f32_16x16x32_bf16 v[144:147], v[80:83], v[68:71], v[144:147]
    ds_read_b128 v[36:39], v4 offset:256
    s_add_u32 m0, s74, 40960
    s_add_u32 s71, s69, 32768
    buffer_load_dwordx4 v2, s[64:67], s71 offen sc1 lds
    v_mfma_f32_16x16x32_bf16 v[160:163], v[80:83], v[72:75], v[160:163]
    ds_read_b128 v[40:43], v4 offset:512
    ds_read_b128 v[44:47], v4 offset:768
    v_mfma_f32_16x16x32_bf16 v[164:167], v[84:87], v[72:75], v[164:167]
    s_add_u32 s68, s68, 262144
    s_add_u32 s69, s69, 65536
    s_add_u32 s75, s75, 1
    s_cmp_eq_u32 s75, 3
    s_cselect_b32 s75, 0, s75
    s_cselect_b32 s71, 0xfffdc000, 0
    s_add_u32 s71, s71, 49152
    s_add_u32 s74, s74, s71
    v_mfma_f32_16x16x32_bf16 v[168:171], v[88:91], v[72:75], v[168:171]
    v_mfma_f32_16x16x32_bf16 v[172:175], v[92:95], v[72:75], v[172:175]
    v_mfma_f32_16x16x32_bf16 v[188:191], v[92:95], v[76:79], v[188:191]
    v_mfma_f32_16x16x32_bf16 v[184:187], v[88:91], v[76:79], v[184:187]
    v_mfma_f32_16x16x32_bf16 v[180:183], v[84:87], v[76:79], v[180:183]
    v_mfma_f32_16x16x32_bf16 v[176:179], v[80:83], v[76:79], v[176:179]
    s_branch ZZ_0_LOOP
ZZ_0_TAIL:
    s_waitcnt vmcnt(0) lgkmcnt(0)
    s_barrier
    v_mfma_f32_16x16x32_bf16 v[128:131], v[80:83], v[64:67], v[128:131]
    ds_read_b128 v[32:35], v4 offset:0
    v_mfma_f32_16x16x32_bf16 v[132:135], v[84:87], v[64:67], v[132:135]
    ds_read_b64_tr_b16 v[48:49], v6 offset:0
    v_mfma_f32_16x16x32_bf16 v[136:139], v[88:91], v[64:67], v[136:139]
    ds_read_b64_tr_b16 v[50:51], v6 offset:1024
    v_mfma_f32_16x16x32_bf16 v[140:143], v[92:95], v[64:67], v[140:143]
    ds_read_b64_tr_b16 v[52:53], v7 offset:0
    v_mfma_f32_16x16x32_bf16 v[156:159], v[92:95], v[68:71], v[156:159]
    ds_read_b64_tr_b16 v[54:55], v7 offset:1024
    v_mfma_f32_16x16x32_bf16 v[152:155], v[88:91], v[68:71], v[152:155]
    ds_read_b64_tr_b16 v[56:57], v8 offset:0
    v_mfma_f32_16x16x32_bf16 v[148:151], v[84:87], v[68:71], v[148:151]
    ds_read_b64_tr_b16 v[58:59], v8 offset:1024
    v_mfma_f32_16x16x32_bf16 v[144:147], v[80:83], v[68:71], v[144:147]
    ds_read_b64_tr_b16 v[60:61], v9 offset:0
    v_mfma_f32_16x16x32_bf16 v[160:163], v[80:83], v[72:75], v[160:163]
    ds_read_b64_tr_b16 v[62:63], v9 offset:1024
    v_mfma_f32_16x16x32_bf16 v[164:167], v[84:87], v[72:75], v[164:167]
    ds_read_b128 v[36:39], v4 offset:256
    v_mfma_f32_16x16x32_bf16 v[168:171], v[88:91], v[72:75], v[168:171]
    ds_read_b128 v[40:43], v4 offset:512
    v_mfma_f32_16x16x32_bf16 v[172:175], v[92:95], v[72:75], v[172:175]
    ds_read_b128 v[44:47], v4 offset:768
    v_mfma_f32_16x16x32_bf16 v[188:191], v[92:95], v[76:79], v[188:191]
    v_mfma_f32_16x16x32_bf16 v[184:187], v[88:91], v[76:79], v[184:187]
    v_mfma_f32_16x16x32_bf16 v[180:183], v[84:87], v[76:79], v[180:183]
    v_mfma_f32_16x16x32_bf16 v[176:179], v[80:83], v[76:79], v[176:179]
    s_cmp_lg_u32 s70, 0
    s_cbranch_scc1 ZZ_0_LOOP
    s_waitcnt lgkmcnt(0)
    s_nop 7
    s_lshl_b32 s68, s77, 12
    s_add_u32 s68, s68, 111149056
    s_lshl_b32 s69, s78, 8
    s_add_u32 s69, s69, 115867648
    s_lshr_b32 s72, s76, 1
    s_and_b32 s73, s76, 1
    s_lshr_b32 s71, s76, 2
    s_mul_i32 s71, s71, 32768
    s_and_b32 s70, s76, 3
    s_lshl_b32 s70, s70, 10
    s_add_u32 s71, s71, s70
    v_lshl_add_u32 v1, v0, 4, s71
    v_and_b32 v14, 15, v0
    v_lshrrev_b32 v16, 4, v0
    v_mul_u32_u24 v16, 4096, v16
    v_lshl_add_u32 v14, v14, 4, v16
    s_mul_i32 s71, s72, 1024
    v_add_u32 v4, s71, v14
    v_add_u32 v5, 16384, v4
    v_lshrrev_b32 v14, 4, v0
    s_mul_i32 s71, s76, 4
    v_add_u32 v14, s71, v14
    v_and_b32 v15, 3, v14
    v_lshlrev_b32 v15, 1, v15
    v_and_b32 v16, 8, v14
    v_or_b32 v15, v15, v16
    v_and_b32 v16, 15, v0
    v_xor_b32 v15, v15, v16
    s_mov_b32 s71, 1024
    v_mul_lo_u32 v2, v14, s71
    v_lshl_add_u32 v2, v15, 4, v2
    v_bfe_u32 v14, v0, 2, 2
    v_lshrrev_b32 v15, 4, v0
    v_lshl_add_u32 v15, v15, 3, v14
    v_mul_u32_u24 v15, 256, v15
    v_and_b32 v16, 3, v0
    v_lshl_add_u32 v15, v16, 3, v15
    v_add_u32 v15, 32768, v15
    v_bfe_u32 v14, v0, 2, 3
    s_mul_i32 s71, s73, 4
    v_xor_b32 v14, s71, v14
    v_lshl_add_u32 v6, v14, 5, v15
    v_xor_b32 v7, 32, v6
    v_xor_b32 v8, 64, v6
    v_xor_b32 v9, 96, v6
    s_lshl_b32 s74, s76, 10
    s_mov_b32 s75, 0
    s_mov_b32 s59, 0
    s_barrier
    s_add_u32 m0, s74, 0
    s_add_u32 s71, s68, 0
    buffer_load_dwordx4 v1, s[60:63], s71 offen sc1 lds
    s_add_u32 m0, s74, 8192
    s_add_u32 s71, s68, 65536
    buffer_load_dwordx4 v1, s[60:63], s71 offen sc1 lds
    s_add_u32 m0, s74, 16384
    s_add_u32 s71, s68, 131072
    buffer_load_dwordx4 v1, s[60:63], s71 offen sc1 lds
    s_add_u32 m0, s74, 24576
    s_add_u32 s71, s68, 196608
    buffer_load_dwordx4 v1, s[60:63], s71 offen sc1 lds
    s_add_u32 m0, s74, 32768
    s_add_u32 s71, s69, 0
    buffer_load_dwordx4 v2, s[64:67], s71 offen sc1 lds
    s_add_u32 m0, s74, 40960
    s_add_u32 s71, s69, 32768
    buffer_load_dwordx4 v2, s[64:67], s71 offen sc1 lds
    s_add_u32 s68, s68, 262144
    s_add_u32 s69, s69, 65536
    s_add_u32 s75, s75, 1
    s_cmp_eq_u32 s75, 3
    s_cselect_b32 s75, 0, s75
    s_cselect_b32 s71, 0xfffdc000, 0
    s_add_u32 s71, s71, 49152
    s_add_u32 s74, s74, s71
    s_add_u32 m0, s74, 0
    s_add_u32 s71, s68, 0
    buffer_load_dwordx4 v1, s[60:63], s71 offen sc1 lds
    s_add_u32 m0, s74, 8192
    s_add_u32 s71, s68, 65536
    buffer_load_dwordx4 v1, s[60:63], s71 offen sc1 lds
    s_add_u32 m0, s74, 16384
    s_add_u32 s71, s68, 131072
    buffer_load_dwordx4 v1, s[60:63], s71 offen sc1 lds
    s_add_u32 m0, s74, 24576
    s_add_u32 s71, s68, 196608
    buffer_load_dwordx4 v1, s[60:63], s71 offen sc1 lds
    s_add_u32 m0, s74, 32768
    s_add_u32 s71, s69, 0
    buffer_load_dwordx4 v2, s[64:67], s71 offen sc1 lds
    s_add_u32 m0, s74, 40960
    s_add_u32 s71, s69, 32768
    buffer_load_dwordx4 v2, s[64:67], s71 offen sc1 lds
    s_add_u32 s68, s68, 262144
    s_add_u32 s69, s69, 65536
    s_add_u32 s75, s75, 1
    s_cmp_eq_u32 s75, 3
    s_cselect_b32 s75, 0, s75
    s_cselect_b32 s71, 0xfffdc000, 0
    s_add_u32 s71, s71, 49152
    s_add_u32 s74, s74, s71
    s_add_u32 m0, s74, 0
    s_add_u32 s71, s68, 0
    buffer_load_dwordx4 v1, s[60:63], s71 offen sc1 lds
    s_add_u32 m0, s74, 8192
    s_add_u32 s71, s68, 65536
    buffer_load_dwordx4 v1, s[60:63], s71 offen sc1 lds
    s_add_u32 m0, s74, 16384
    s_add_u32 s71, s68, 131072
    buffer_load_dwordx4 v1, s[60:63], s71 offen sc1 lds
    s_add_u32 m0, s74, 24576
    s_add_u32 s71, s68, 196608
    buffer_load_dwordx4 v1, s[60:63], s71 offen sc1 lds
    s_add_u32 m0, s74, 32768
    s_add_u32 s71, s69, 0
    buffer_load_dwordx4 v2, s[64:67], s71 offen sc1 lds
    s_add_u32 m0, s74, 40960
    s_add_u32 s71, s69, 32768
    buffer_load_dwordx4 v2, s[64:67], s71 offen sc1 lds
    s_add_u32 s68, s68, 262144
    s_add_u32 s69, s69, 65536
    s_add_u32 s75, s75, 1
    s_cmp_eq_u32 s75, 3
    s_cselect_b32 s75, 0, s75
    s_cselect_b32 s71, 0xfffdc000, 0
    s_add_u32 s71, s71, 49152
    s_add_u32 s74, s74, s71
    s_mov_b32 s70, 8
    v_mov_b32 v192, 0
    v_mov_b32 v193, 0
    v_mov_b32 v194, 0
    v_mov_b32 v195, 0
    v_mov_b32 v196, 0
    v_mov_b32 v197, 0
    v_mov_b32 v198, 0
    v_mov_b32 v199, 0
    v_mov_b32 v200, 0
    v_mov_b32 v201, 0
    v_mov_b32 v202, 0
    v_mov_b32 v203, 0
    v_mov_b32 v204, 0
    v_mov_b32 v205, 0
    v_mov_b32 v206, 0
    v_mov_b32 v207, 0
    v_mov_b32 v208, 0
    v_mov_b32 v209, 0
    v_mov_b32 v210, 0
    v_mov_b32 v211, 0
    v_mov_b32 v212, 0
    v_mov_b32 v213, 0
    v_mov_b32 v214, 0
    v_mov_b32 v215, 0
    v_mov_b32 v216, 0
    v_mov_b32 v217, 0
    v_mov_b32 v218, 0
    v_mov_b32 v219, 0
    v_mov_b32 v220, 0
    v_mov_b32 v221, 0
    v_mov_b32 v222, 0
    v_mov_b32 v223, 0
    v_mov_b32 v224, 0
    v_mov_b32 v225, 0
    v_mov_b32 v226, 0
    v_mov_b32 v227, 0
    v_mov_b32 v228, 0
    v_mov_b32 v229, 0
    v_mov_b32 v230, 0
    v_mov_b32 v231, 0
    v_mov_b32 v232, 0
    v_mov_b32 v233, 0
    v_mov_b32 v234, 0
    v_mov_b32 v235, 0
    v_mov_b32 v236, 0
    v_mov_b32 v237, 0
    v_mov_b32 v238, 0
    v_mov_b32 v239, 0
    v_mov_b32 v240, 0
    v_mov_b32 v241, 0
    v_mov_b32 v242, 0
    v_mov_b32 v243, 0
    v_mov_b32 v244, 0
    v_mov_b32 v245, 0
    v_mov_b32 v246, 0
    v_mov_b32 v247, 0
    v_mov_b32 v248, 0
    v_mov_b32 v249, 0
    v_mov_b32 v250, 0
    v_mov_b32 v251, 0
    v_mov_b32 v252, 0
    v_mov_b32 v253, 0
    v_mov_b32 v254, 0
    v_mov_b32 v255, 0
    s_waitcnt vmcnt(12)
    s_barrier
    s_cmp_eq_u32 s31, 0
    s_cbranch_scc1 ZZ_1_HS
    s_mov_b64 exec, 1
    s_bfe_u32 s4, s31, 0x7000a
    s_mul_i32 s4, s4, s52
    s_and_b32 s5, s31, 0x3ff
    s_add_u32 s4, s4, s5
    s_lshl_b32 s4, s4, 7
    s_add_u32 s4, s4, 124780544
    s_lshr_b32 s5, s31, 20
    v_mov_b32 v28, s5
    buffer_atomic_add v28, off, s[8:11], s4 sc1
    s_mov_b64 exec, -1
    s_mov_b32 s31, 0
ZZ_1_HS:
    ds_read_b128 v[32:35], v4 offset:0
    ds_read_b64_tr_b16 v[48:49], v6 offset:0
    ds_read_b64_tr_b16 v[50:51], v6 offset:1024
    ds_read_b64_tr_b16 v[52:53], v7 offset:0
    ds_read_b64_tr_b16 v[54:55], v7 offset:1024
    ds_read_b64_tr_b16 v[56:57], v8 offset:0
    ds_read_b64_tr_b16 v[58:59], v8 offset:1024
    ds_read_b64_tr_b16 v[60:61], v9 offset:0
    ds_read_b64_tr_b16 v[62:63], v9 offset:1024
    ds_read_b128 v[36:39], v4 offset:256
    ds_read_b128 v[40:43], v4 offset:512
    ds_read_b128 v[44:47], v4 offset:768
ZZ_1_LOOP:
    s_waitcnt lgkmcnt(0)
    v_mfma_f32_16x16x32_bf16 v[192:195], v[48:51], v[32:35], v[192:195]
    ds_read_b128 v[64:67], v5 offset:0
    ds_read_b64_tr_b16 v[80:81], v6 offset:8192
    v_mfma_f32_16x16x32_bf16 v[196:199], v[52:55], v[32:35], v[196:199]
    ds_read_b64_tr_b16 v[82:83], v6 offset:9216
    ds_read_b64_tr_b16 v[84:85], v7 offset:8192
    v_mfma_f32_16x16x32_bf16 v[200:203], v[56:59], v[32:35], v[200:203]
    ds_read_b64_tr_b16 v[86:87], v7 offset:9216
    ds_read_b64_tr_b16 v[88:89], v8 offset:8192
    v_mfma_f32_16x16x32_bf16 v[204:207], v[60:63], v[32:35], v[204:207]
    ds_read_b64_tr_b16 v[90:91], v8 offset:9216
    ds_read_b64_tr_b16 v[92:93], v9 offset:8192
    v_mfma_f32_16x16x32_bf16 v[220:223], v[60:63], v[36:39], v[220:223]
    ds_read_b64_tr_b16 v[94:95], v9 offset:9216
    ds_read_b128 v[68:71], v5 offset:256
    v_mfma_f32_16x16x32_bf16 v[216:219], v[56:59], v[36:39], v[216:219]
    ds_read_b128 v[72:75], v5 offset:512
    ds_read_b128 v[76:79], v5 offset:768
    v_mfma_f32_16x16x32_bf16 v[212:215], v[52:55], v[36:39], v[212:215]
    s_add_u32 s59, s59, 1
    s_cmp_eq_u32 s59, 3
    s_cselect_b32 s59, 0, s59
    s_cselect_b32 s71, 0xfffdc000, 0
    s_add_u32 s71, s71, 49152
    v_add_u32 v4, s71, v4
    v_mfma_f32_16x16x32_bf16 v[208:211], v[48:51], v[36:39], v[208:211]
    v_add_u32 v5, s71, v5
    v_add_u32 v6, s71, v6
    v_mfma_f32_16x16x32_bf16 v[224:227], v[48:51], v[40:43], v[224:227]
    v_add_u32 v7, s71, v7
    v_add_u32 v8, s71, v8
    v_mfma_f32_16x16x32_bf16 v[228:231], v[52:55], v[40:43], v[228:231]
    v_add_u32 v9, s71, v9
    s_sub_u32 s70, s70, 1
    v_mfma_f32_16x16x32_bf16 v[232:235], v[56:59], v[40:43], v[232:235]
    v_mfma_f32_16x16x32_bf16 v[236:239], v[60:63], v[40:43], v[236:239]
    v_mfma_f32_16x16x32_bf16 v[252:255], v[60:63], v[44:47], v[252:255]
    v_mfma_f32_16x16x32_bf16 v[248:251], v[56:59], v[44:47], v[248:251]
    v_mfma_f32_16x16x32_bf16 v[244:247], v[52:55], v[44:47], v[244:247]
    v_mfma_f32_16x16x32_bf16 v[240:243], v[48:51], v[44:47], v[240:243]
    s_cmp_lt_u32 s70, 3
    s_cbranch_scc1 ZZ_1_TAIL
    s_waitcnt vmcnt(6) lgkmcnt(0)
    s_barrier
    v_mfma_f32_16x16x32_bf16 v[192:195], v[80:83], v[64:67], v[192:195]
    s_add_u32 m0, s74, 0
    s_add_u32 s71, s68, 0
    buffer_load_dwordx4 v1, s[60:63], s71 offen sc1 lds
    ds_read_b128 v[32:35], v4 offset:0
    v_mfma_f32_16x16x32_bf16 v[196:199], v[84:87], v[64:67], v[196:199]
    ds_read_b64_tr_b16 v[48:49], v6 offset:0
    s_add_u32 m0, s74, 8192
    s_add_u32 s71, s68, 65536
    buffer_load_dwordx4 v1, s[60:63], s71 offen sc1 lds
    v_mfma_f32_16x16x32_bf16 v[200:203], v[88:91], v[64:67], v[200:203]
    ds_read_b64_tr_b16 v[50:51], v6 offset:1024
    ds_read_b64_tr_b16 v[52:53], v7 offset:0
    v_mfma_f32_16x16x32_bf16 v[204:207], v[92:95], v[64:67], v[204:207]
    s_add_u32 m0, s74, 16384
    s_add_u32 s71, s68, 131072
    buffer_load_dwordx4 v1, s[60:63], s71 offen sc1 lds
    ds_read_b64_tr_b16 v[54:55], v7 offset:1024
    v_mfma_f32_16x16x32_bf16 v[220:223], v[92:95], v[68:71], v[220:223]
    ds_read_b64_tr_b16 v[56:57], v8 offset:0
    s_add_u32 m0, s74, 24576
    s_add_u32 s71, s68, 196608
    buffer_load_dwordx4 v1, s[60:63], s71 offen sc1 lds
    v_mfma_f32_16x16x32_bf16 v[216:219], v[88:91], v[68:71], v[216:219]
    ds_read_b64_tr_b16 v[58:59], v8 offset:1024
    ds_read_b64_tr_b16 v[60:61], v9 offset:0
    v_mfma_f32_16x16x32_bf16 v[212:215], v[84:87], v[68:71], v[212:215]
    s_add_u32 m0, s74, 32768
    s_add_u32 s71, s69, 0
    buffer_load_dwordx4 v2, s[64:67], s71 offen sc1 lds
    ds_read_b64_tr_b16 v[62:63], v9 offset:1024
    v_mfma_f32_16x16x32_bf16 v[208:211], v[80:83], v[68:71], v[208:211]
    ds_read_b128 v[36:39], v4 offset:256
    s_add_u32 m0, s74, 40960
    s_add_u32 s71, s69, 32768
    buffer_load_dwordx4 v2, s[64:67], s71 offen sc1 lds
    v_mfma_f32_16x16x32_bf16 v[224:227], v[80:83], v[72:75], v[224:227]
    ds_read_b128 v[40:43], v4 offset:512
    ds_read_b128 v[44:47], v4 offset:768
    v_mfma_f32_16x16x32_bf16 v[228:231], v[84:87], v[72:75], v[228:231]
    s_add_u32 s68, s68, 262144
    s_add_u32 s69, s69, 65536
    s_add_u32 s75, s75, 1
    s_cmp_eq_u32 s75, 3
    s_cselect_b32 s75, 0, s75
    s_cselect_b32 s71, 0xfffdc000, 0
    s_add_u32 s71, s71, 49152
    s_add_u32 s74, s74, s71
    v_mfma_f32_16x16x32_bf16 v[232:235], v[88:91], v[72:75], v[232:235]
    v_mfma_f32_16x16x32_bf16 v[236:239], v[92:95], v[72:75], v[236:239]
    v_mfma_f32_16x16x32_bf16 v[252:255], v[92:95], v[76:79], v[252:255]
    v_mfma_f32_16x16x32_bf16 v[248:251], v[88:91], v[76:79], v[248:251]
    v_mfma_f32_16x16x32_bf16 v[244:247], v[84:87], v[76:79], v[244:247]
    v_mfma_f32_16x16x32_bf16 v[240:243], v[80:83], v[76:79], v[240:243]
    s_branch ZZ_1_LOOP
ZZ_1_TAIL:
    s_waitcnt vmcnt(0) lgkmcnt(0)
    s_barrier
    v_mfma_f32_16x16x32_bf16 v[192:195], v[80:83], v[64:67], v[192:195]
    ds_read_b128 v[32:35], v4 offset:0
    v_mfma_f32_16x16x32_bf16 v[196:199], v[84:87], v[64:67], v[196:199]
    ds_read_b64_tr_b16 v[48:49], v6 offset:0
    v_mfma_f32_16x16x32_bf16 v[200:203], v[88:91], v[64:67], v[200:203]
    ds_read_b64_tr_b16 v[50:51], v6 offset:1024
    v_mfma_f32_16x16x32_bf16 v[204:207], v[92:95], v[64:67], v[204:207]
    ds_read_b64_tr_b16 v[52:53], v7 offset:0
    v_mfma_f32_16x16x32_bf16 v[220:223], v[92:95], v[68:71], v[220:223]
    ds_read_b64_tr_b16 v[54:55], v7 offset:1024
    v_mfma_f32_16x16x32_bf16 v[216:219], v[88:91], v[68:71], v[216:219]
    ds_read_b64_tr_b16 v[56:57], v8 offset:0
    v_mfma_f32_16x16x32_bf16 v[212:215], v[84:87], v[68:71], v[212:215]
    ds_read_b64_tr_b16 v[58:59], v8 offset:1024
    v_mfma_f32_16x16x32_bf16 v[208:211], v[80:83], v[68:71], v[208:211]
    ds_read_b64_tr_b16 v[60:61], v9 offset:0
    v_mfma_f32_16x16x32_bf16 v[224:227], v[80:83], v[72:75], v[224:227]
    ds_read_b64_tr_b16 v[62:63], v9 offset:1024
    v_mfma_f32_16x16x32_bf16 v[228:231], v[84:87], v[72:75], v[228:231]
    ds_read_b128 v[36:39], v4 offset:256
    v_mfma_f32_16x16x32_bf16 v[232:235], v[88:91], v[72:75], v[232:235]
    ds_read_b128 v[40:43], v4 offset:512
    v_mfma_f32_16x16x32_bf16 v[236:239], v[92:95], v[72:75], v[236:239]
    ds_read_b128 v[44:47], v4 offset:768
    v_mfma_f32_16x16x32_bf16 v[252:255], v[92:95], v[76:79], v[252:255]
    v_mfma_f32_16x16x32_bf16 v[248:251], v[88:91], v[76:79], v[248:251]
    v_mfma_f32_16x16x32_bf16 v[244:247], v[84:87], v[76:79], v[244:247]
    v_mfma_f32_16x16x32_bf16 v[240:243], v[80:83], v[76:79], v[240:243]
    s_cmp_lg_u32 s70, 0
    s_cbranch_scc1 ZZ_1_LOOP
    s_waitcnt lgkmcnt(0)
    s_nop 7
    s_lshl_b32 s85, s76, 13
    s_add_u32 s85, s85, s95
    s_lshl_b32 s86, s91, 18
    s_add_u32 s86, s86, s85
    v_lshlrev_b32 v14, 4, v0
    v_pk_add_f32 v[96:97], v[128:129], v[192:193]
    v_pk_add_f32 v[192:193], v[128:129], v[192:193] neg_lo:[0,1] neg_hi:[0,1]
    v_pk_add_f32 v[98:99], v[130:131], v[194:195]
    v_pk_add_f32 v[194:195], v[130:131], v[194:195] neg_lo:[0,1] neg_hi:[0,1]
    v_pk_add_f32 v[100:101], v[132:133], v[196:197]
    v_pk_add_f32 v[196:197], v[132:133], v[196:197] neg_lo:[0,1] neg_hi:[0,1]
    v_pk_add_f32 v[102:103], v[134:135], v[198:199]
    v_pk_add_f32 v[198:199], v[134:135], v[198:199] neg_lo:[0,1] neg_hi:[0,1]
    v_pk_mul_f32 v[96:97], v[96:97], v[20:21] op_sel_hi:[1,0]
    v_pk_mul_f32 v[192:193], v[192:193], v[20:21] op_sel_hi:[1,0]
    v_pk_mul_f32 v[98:99], v[98:99], v[20:21] op_sel_hi:[1,0]
    v_pk_mul_f32 v[194:195], v[194:195], v[20:21] op_sel_hi:[1,0]
    v_pk_mul_f32 v[100:101], v[100:101], v[20:21] op_sel_hi:[1,0]
    v_pk_mul_f32 v[196:197], v[196:197], v[20:21] op_sel_hi:[1,0]
    v_pk_mul_f32 v[102:103], v[102:103], v[20:21] op_sel_hi:[1,0]
    v_pk_mul_f32 v[198:199], v[198:199], v[20:21] op_sel_hi:[1,0]
    v_cvt_pk_bf16_f32 v32, v96, v97
    v_cvt_pk_bf16_f32 v34, v100, v101
    v_cvt_pk_bf16_f32 v33, v98, v99
    v_cvt_pk_bf16_f32 v35, v102, v103
    buffer_store_dwordx4 v[32:35], v14, s[8:11], s85 offen offset:0 sc1
    v_cvt_pk_bf16_f32 v36, v192, v193
    v_cvt_pk_bf16_f32 v38, v196, v197
    v_cvt_pk_bf16_f32 v37, v194, v195
    v_cvt_pk_bf16_f32 v39, v198, v199
    buffer_store_dwordx4 v[36:39], v14, s[8:11], s86 offen offset:0 sc1
    v_pk_add_f32 v[96:97], v[136:137], v[200:201]
    v_pk_add_f32 v[200:201], v[136:137], v[200:201] neg_lo:[0,1] neg_hi:[0,1]
    v_pk_add_f32 v[98:99], v[138:139], v[202:203]
    v_pk_add_f32 v[202:203], v[138:139], v[202:203] neg_lo:[0,1] neg_hi:[0,1]
    v_pk_add_f32 v[100:101], v[140:141], v[204:205]
    v_pk_add_f32 v[204:205], v[140:141], v[204:205] neg_lo:[0,1] neg_hi:[0,1]
    v_pk_add_f32 v[102:103], v[142:143], v[206:207]
    v_pk_add_f32 v[206:207], v[142:143], v[206:207] neg_lo:[0,1] neg_hi:[0,1]
    v_pk_mul_f32 v[96:97], v[96:97], v[20:21] op_sel_hi:[1,0]
    v_pk_mul_f32 v[200:201], v[200:201], v[20:21] op_sel_hi:[1,0]
    v_pk_mul_f32 v[98:99], v[98:99], v[20:21] op_sel_hi:[1,0]
    v_pk_mul_f32 v[202:203], v[202:203], v[20:21] op_sel_hi:[1,0]
    v_pk_mul_f32 v[100:101], v[100:101], v[20:21] op_sel_hi:[1,0]
    v_pk_mul_f32 v[204:205], v[204:205], v[20:21] op_sel_hi:[1,0]
    v_pk_mul_f32 v[102:103], v[102:103], v[20:21] op_sel_hi:[1,0]
    v_pk_mul_f32 v[206:207], v[206:207], v[20:21] op_sel_hi:[1,0]
    v_cvt_pk_bf16_f32 v40, v96, v97
    v_cvt_pk_bf16_f32 v42, v100, v101
    v_cvt_pk_bf16_f32 v41, v98, v99
    v_cvt_pk_bf16_f32 v43, v102, v103
    buffer_store_dwordx4 v[40:43], v14, s[8:11], s85 offen offset:1024 sc1
    v_cvt_pk_bf16_f32 v44, v200, v201
    v_cvt_pk_bf16_f32 v46, v204, v205
    v_cvt_pk_bf16_f32 v45, v202, v203
    v_cvt_pk_bf16_f32 v47, v206, v207
    buffer_store_dwordx4 v[44:47], v14, s[8:11], s86 offen offset:1024 sc1
    v_pk_add_f32 v[96:97], v[144:145], v[208:209]
    v_pk_add_f32 v[208:209], v[144:145], v[208:209] neg_lo:[0,1] neg_hi:[0,1]
    v_pk_add_f32 v[98:99], v[146:147], v[210:211]
    v_pk_add_f32 v[210:211], v[146:147], v[210:211] neg_lo:[0,1] neg_hi:[0,1]
    v_pk_add_f32 v[100:101], v[148:149], v[212:213]
    v_pk_add_f32 v[212:213], v[148:149], v[212:213] neg_lo:[0,1] neg_hi:[0,1]
    v_pk_add_f32 v[102:103], v[150:151], v[214:215]
    v_pk_add_f32 v[214:215], v[150:151], v[214:215] neg_lo:[0,1] neg_hi:[0,1]
    v_pk_mul_f32 v[96:97], v[96:97], v[22:23] op_sel_hi:[1,0]
    v_pk_mul_f32 v[208:209], v[208:209], v[22:23] op_sel_hi:[1,0]
    v_pk_mul_f32 v[98:99], v[98:99], v[22:23] op_sel_hi:[1,0]
    v_pk_mul_f32 v[210:211], v[210:211], v[22:23] op_sel_hi:[1,0]
    v_pk_mul_f32 v[100:101], v[100:101], v[22:23] op_sel_hi:[1,0]
    v_pk_mul_f32 v[212:213], v[212:213], v[22:23] op_sel_hi:[1,0]
    v_pk_mul_f32 v[102:103], v[102:103], v[22:23] op_sel_hi:[1,0]
    v_pk_mul_f32 v[214:215], v[214:215], v[22:23] op_sel_hi:[1,0]
    v_cvt_pk_bf16_f32 v48, v96, v97
    v_cvt_pk_bf16_f32 v50, v100, v101
    v_cvt_pk_bf16_f32 v49, v98, v99
    v_cvt_pk_bf16_f32 v51, v102, v103
    buffer_store_dwordx4 v[48:51], v14, s[8:11], s85 offen offset:2048 sc1
    v_cvt_pk_bf16_f32 v52, v208, v209
    v_cvt_pk_bf16_f32 v54, v212, v213
    v_cvt_pk_bf16_f32 v53, v210, v211
    v_cvt_pk_bf16_f32 v55, v214, v215
    buffer_store_dwordx4 v[52:55], v14, s[8:11], s86 offen offset:2048 sc1
    v_pk_add_f32 v[96:97], v[152:153], v[216:217]
    v_pk_add_f32 v[216:217], v[152:153], v[216:217] neg_lo:[0,1] neg_hi:[0,1]
    v_pk_add_f32 v[98:99], v[154:155], v[218:219]
    v_pk_add_f32 v[218:219], v[154:155], v[218:219] neg_lo:[0,1] neg_hi:[0,1]
    v_pk_add_f32 v[100:101], v[156:157], v[220:221]
    v_pk_add_f32 v[220:221], v[156:157], v[220:221] neg_lo:[0,1] neg_hi:[0,1]
    v_pk_add_f32 v[102:103], v[158:159], v[222:223]
    v_pk_add_f32 v[222:223], v[158:159], v[222:223] neg_lo:[0,1] neg_hi:[0,1]
    v_pk_mul_f32 v[96:97], v[96:97], v[22:23] op_sel_hi:[1,0]
    v_pk_mul_f32 v[216:217], v[216:217], v[22:23] op_sel_hi:[1,0]
    v_pk_mul_f32 v[98:99], v[98:99], v[22:23] op_sel_hi:[1,0]
    v_pk_mul_f32 v[218:219], v[218:219], v[22:23] op_sel_hi:[1,0]
    v_pk_mul_f32 v[100:101], v[100:101], v[22:23] op_sel_hi:[1,0]
    v_pk_mul_f32 v[220:221], v[220:221], v[22:23] op_sel_hi:[1,0]
    v_pk_mul_f32 v[102:103], v[102:103], v[22:23] op_sel_hi:[1,0]
    v_pk_mul_f32 v[222:223], v[222:223], v[22:23] op_sel_hi:[1,0]
    v_cvt_pk_bf16_f32 v56, v96, v97
    v_cvt_pk_bf16_f32 v58, v100, v101
    v_cvt_pk_bf16_f32 v57, v98, v99
    v_cvt_pk_bf16_f32 v59, v102, v103
    buffer_store_dwordx4 v[56:59], v14, s[8:11], s85 offen offset:3072 sc1
    v_cvt_pk_bf16_f32 v60, v216, v217
    v_cvt_pk_bf16_f32 v62, v220, v221
    v_cvt_pk_bf16_f32 v61, v218, v219
    v_cvt_pk_bf16_f32 v63, v222, v223
    buffer_store_dwordx4 v[60:63], v14, s[8:11], s86 offen offset:3072 sc1
    s_add_u32 s85, s85, 4096
    s_add_u32 s86, s86, 4096
    v_pk_add_f32 v[96:97], v[160:161], v[224:225]
    v_pk_add_f32 v[224:225], v[160:161], v[224:225] neg_lo:[0,1] neg_hi:[0,1]
    v_pk_add_f32 v[98:99], v[162:163], v[226:227]
    v_pk_add_f32 v[226:227], v[162:163], v[226:227] neg_lo:[0,1] neg_hi:[0,1]
    v_pk_add_f32 v[100:101], v[164:165], v[228:229]
    v_pk_add_f32 v[228:229], v[164:165], v[228:229] neg_lo:[0,1] neg_hi:[0,1]
    v_pk_add_f32 v[102:103], v[166:167], v[230:231]
    v_pk_add_f32 v[230:231], v[166:167], v[230:231] neg_lo:[0,1] neg_hi:[0,1]
    v_pk_mul_f32 v[96:97], v[96:97], v[24:25] op_sel_hi:[1,0]
    v_pk_mul_f32 v[224:225], v[224:225], v[24:25] op_sel_hi:[1,0]
    v_pk_mul_f32 v[98:99], v[98:99], v[24:25] op_sel_hi:[1,0]
    v_pk_mul_f32 v[226:227], v[226:227], v[24:25] op_sel_hi:[1,0]
    v_pk_mul_f32 v[100:101], v[100:101], v[24:25] op_sel_hi:[1,0]
    v_pk_mul_f32 v[228:229], v[228:229], v[24:25] op_sel_hi:[1,0]
    v_pk_mul_f32 v[102:103], v[102:103], v[24:25] op_sel_hi:[1,0]
    v_pk_mul_f32 v[230:231], v[230:231], v[24:25] op_sel_hi:[1,0]
    v_cvt_pk_bf16_f32 v32, v96, v97
    v_cvt_pk_bf16_f32 v34, v100, v101
    v_cvt_pk_bf16_f32 v33, v98, v99
    v_cvt_pk_bf16_f32 v35, v102, v103
    buffer_store_dwordx4 v[32:35], v14, s[8:11], s85 offen offset:0 sc1
    v_cvt_pk_bf16_f32 v36, v224, v225
    v_cvt_pk_bf16_f32 v38, v228, v229
    v_cvt_pk_bf16_f32 v37, v226, v227
    v_cvt_pk_bf16_f32 v39, v230, v231
    buffer_store_dwordx4 v[36:39], v14, s[8:11], s86 offen offset:0 sc1
    v_pk_add_f32 v[96:97], v[168:169], v[232:233]
    v_pk_add_f32 v[232:233], v[168:169], v[232:233] neg_lo:[0,1] neg_hi:[0,1]
    v_pk_add_f32 v[98:99], v[170:171], v[234:235]
    v_pk_add_f32 v[234:235], v[170:171], v[234:235] neg_lo:[0,1] neg_hi:[0,1]
    v_pk_add_f32 v[100:101], v[172:173], v[236:237]
    v_pk_add_f32 v[236:237], v[172:173], v[236:237] neg_lo:[0,1] neg_hi:[0,1]
    v_pk_add_f32 v[102:103], v[174:175], v[238:239]
    v_pk_add_f32 v[238:239], v[174:175], v[238:239] neg_lo:[0,1] neg_hi:[0,1]
    v_pk_mul_f32 v[96:97], v[96:97], v[24:25] op_sel_hi:[1,0]
    v_pk_mul_f32 v[232:233], v[232:233], v[24:25] op_sel_hi:[1,0]
    v_pk_mul_f32 v[98:99], v[98:99], v[24:25] op_sel_hi:[1,0]
    v_pk_mul_f32 v[234:235], v[234:235], v[24:25] op_sel_hi:[1,0]
    v_pk_mul_f32 v[100:101], v[100:101], v[24:25] op_sel_hi:[1,0]
    v_pk_mul_f32 v[236:237], v[236:237], v[24:25] op_sel_hi:[1,0]
    v_pk_mul_f32 v[102:103], v[102:103], v[24:25] op_sel_hi:[1,0]
    v_pk_mul_f32 v[238:239], v[238:239], v[24:25] op_sel_hi:[1,0]
    v_cvt_pk_bf16_f32 v40, v96, v97
    v_cvt_pk_bf16_f32 v42, v100, v101
    v_cvt_pk_bf16_f32 v41, v98, v99
    v_cvt_pk_bf16_f32 v43, v102, v103
    buffer_store_dwordx4 v[40:43], v14, s[8:11], s85 offen offset:1024 sc1
    v_cvt_pk_bf16_f32 v44, v232, v233
    v_cvt_pk_bf16_f32 v46, v236, v237
    v_cvt_pk_bf16_f32 v45, v234, v235
    v_cvt_pk_bf16_f32 v47, v238, v239
    buffer_store_dwordx4 v[44:47], v14, s[8:11], s86 offen offset:1024 sc1
    v_pk_add_f32 v[96:97], v[176:177], v[240:241]
    v_pk_add_f32 v[240:241], v[176:177], v[240:241] neg_lo:[0,1] neg_hi:[0,1]
    v_pk_add_f32 v[98:99], v[178:179], v[242:243]
    v_pk_add_f32 v[242:243], v[178:179], v[242:243] neg_lo:[0,1] neg_hi:[0,1]
    v_pk_add_f32 v[100:101], v[180:181], v[244:245]
    v_pk_add_f32 v[244:245], v[180:181], v[244:245] neg_lo:[0,1] neg_hi:[0,1]
    v_pk_add_f32 v[102:103], v[182:183], v[246:247]
    v_pk_add_f32 v[246:247], v[182:183], v[246:247] neg_lo:[0,1] neg_hi:[0,1]
    v_pk_mul_f32 v[96:97], v[96:97], v[26:27] op_sel_hi:[1,0]
    v_pk_mul_f32 v[240:241], v[240:241], v[26:27] op_sel_hi:[1,0]
    v_pk_mul_f32 v[98:99], v[98:99], v[26:27] op_sel_hi:[1,0]
    v_pk_mul_f32 v[242:243], v[242:243], v[26:27] op_sel_hi:[1,0]
    v_pk_mul_f32 v[100:101], v[100:101], v[26:27] op_sel_hi:[1,0]
    v_pk_mul_f32 v[244:245], v[244:245], v[26:27] op_sel_hi:[1,0]
    v_pk_mul_f32 v[102:103], v[102:103], v[26:27] op_sel_hi:[1,0]
    v_pk_mul_f32 v[246:247], v[246:247], v[26:27] op_sel_hi:[1,0]
    v_cvt_pk_bf16_f32 v48, v96, v97
    v_cvt_pk_bf16_f32 v50, v100, v101
    v_cvt_pk_bf16_f32 v49, v98, v99
    v_cvt_pk_bf16_f32 v51, v102, v103
    buffer_store_dwordx4 v[48:51], v14, s[8:11], s85 offen offset:2048 sc1
    v_cvt_pk_bf16_f32 v52, v240, v241
    v_cvt_pk_bf16_f32 v54, v244, v245
    v_cvt_pk_bf16_f32 v53, v242, v243
    v_cvt_pk_bf16_f32 v55, v246, v247
    buffer_store_dwordx4 v[52:55], v14, s[8:11], s86 offen offset:2048 sc1
    v_pk_add_f32 v[96:97], v[184:185], v[248:249]
    v_pk_add_f32 v[248:249], v[184:185], v[248:249] neg_lo:[0,1] neg_hi:[0,1]
    v_pk_add_f32 v[98:99], v[186:187], v[250:251]
    v_pk_add_f32 v[250:251], v[186:187], v[250:251] neg_lo:[0,1] neg_hi:[0,1]
    v_pk_add_f32 v[100:101], v[188:189], v[252:253]
    v_pk_add_f32 v[252:253], v[188:189], v[252:253] neg_lo:[0,1] neg_hi:[0,1]
    v_pk_add_f32 v[102:103], v[190:191], v[254:255]
    v_pk_add_f32 v[254:255], v[190:191], v[254:255] neg_lo:[0,1] neg_hi:[0,1]
    v_pk_mul_f32 v[96:97], v[96:97], v[26:27] op_sel_hi:[1,0]
    v_pk_mul_f32 v[248:249], v[248:249], v[26:27] op_sel_hi:[1,0]
    v_pk_mul_f32 v[98:99], v[98:99], v[26:27] op_sel_hi:[1,0]
    v_pk_mul_f32 v[250:251], v[250:251], v[26:27] op_sel_hi:[1,0]
    v_pk_mul_f32 v[100:101], v[100:101], v[26:27] op_sel_hi:[1,0]
    v_pk_mul_f32 v[252:253], v[252:253], v[26:27] op_sel_hi:[1,0]
    v_pk_mul_f32 v[102:103], v[102:103], v[26:27] op_sel_hi:[1,0]
    v_pk_mul_f32 v[254:255], v[254:255], v[26:27] op_sel_hi:[1,0]
    v_cvt_pk_bf16_f32 v56, v96, v97
    v_cvt_pk_bf16_f32 v58, v100, v101
    v_cvt_pk_bf16_f32 v57, v98, v99
    v_cvt_pk_bf16_f32 v59, v102, v103
    buffer_store_dwordx4 v[56:59], v14, s[8:11], s85 offen offset:3072 sc1
    v_cvt_pk_bf16_f32 v60, v248, v249
    v_cvt_pk_bf16_f32 v62, v252, v253
    v_cvt_pk_bf16_f32 v61, v250, v251
    v_cvt_pk_bf16_f32 v63, v254, v255
    buffer_store_dwordx4 v[60:63], v14, s[8:11], s86 offen offset:3072 sc1
    s_branch G_DONE
H_RED:
    s_and_b32 s94, s26, 255
    s_bfe_u32 s91, s26, 0x80008
    s_lshr_b32 s4, s26, 16
    s_mul_i32 s95, s4, s52
    s_add_u32 s95, s95, s27
    s_lshl_b32 s95, s95, 16
    s_add_u32 s95, s95, 125829120
    s_lshl_b32 s93, s52, 4
    s_add_u32 s93, s93, s79
    s_mov_b32 s93, s79
    s_lshl_b32 s4, s52, 1
    s_add_u32 s78, s78, s4
    s_load_dwordx2 s[6:7], s[0:1], 88
    v_lshlrev_b32 v1, 4, v0
    s_add_u32 s93, s93, s76
    v_lshrrev_b32 v3, 2, v0
    v_lshlrev_b32 v2, 11, v3
    v_and_b32 v4, 3, v0
    v_lshl_add_u32 v2, v4, 4, v2
    v_lshlrev_b32 v3, 2, v3
    v_and_b32 v4, 1, v0
    v_lshl_add_u32 v3, v4, 7, v3
    v_and_b32 v4, 2, v0
    v_lshl_add_u32 v3, v4, 5, v3
    s_waitcnt lgkmcnt(0)
    s_mov_b32 s12, s6
    s_and_b32 s13, s7, 0xffff
    s_mov_b32 s14, 4194304
    s_mov_b32 s15, 0x20000
RD_L:
    s_lshl_b32 s85, s93, 10
    s_add_u32 s85, s85, s95
    buffer_load_dwordx4 v[64:67], v1, s[8:11], s85 offen sc1
    s_add_u32 s85, s85, 65536
    buffer_load_dwordx4 v[68:71], v1, s[8:11], s85 offen sc1
    s_add_u32 s85, s85, 65536
    s_cmp_le_u32 s91, 2
    s_cbranch_scc1 RD_LD
    buffer_load_dwordx4 v[72:75], v1, s[8:11], s85 offen sc1
    s_add_u32 s85, s85, 65536
    s_cmp_le_u32 s91, 3
    s_cbranch_scc1 RD_LD
    buffer_load_dwordx4 v[76:79], v1, s[8:11], s85 offen sc1
    s_add_u32 s85, s85, 65536
    s_cmp_le_u32 s91, 4
    s_cbranch_scc1 RD_LD
    buffer_load_dwordx4 v[80:83], v1, s[8:11], s85 offen sc1
    s_add_u32 s85, s85, 65536
    s_cmp_le_u32 s91, 5
    s_cbranch_scc1 RD_LD
    buffer_load_dwordx4 v[84:87], v1, s[8:11], s85 offen sc1
    s_add_u32 s85, s85, 65536
    s_cmp_le_u32 s91, 6
    s_cbranch_scc1 RD_LD
    buffer_load_dwordx4 v[88:91], v1, s[8:11], s85 offen sc1
    s_add_u32 s85, s85, 65536
    s_cmp_le_u32 s91, 7
    s_cbranch_scc1 RD_LD
    buffer_load_dwordx4 v[92:95], v1, s[8:11], s85 offen sc1
    s_add_u32 s85, s85, 65536
    s_cmp_le_u32 s91, 8
    s_cbranch_scc1 RD_LD
    buffer_load_dwordx4 v[96:99], v1, s[8:11], s85 offen sc1
    s_add_u32 s85, s85, 65536
    s_cmp_le_u32 s91, 9
    s_cbranch_scc1 RD_LD
    buffer_load_dwordx4 v[100:103], v1, s[8:11], s85 offen sc1
    s_add_u32 s85, s85, 65536
    s_cmp_le_u32 s91, 10
    s_cbranch_scc1 RD_LD
    buffer_load_dwordx4 v[104:107], v1, s[8:11], s85 offen sc1
    s_add_u32 s85, s85, 65536
    s_cmp_le_u32 s91, 11
    s_cbranch_scc1 RD_LD
    buffer_load_dwordx4 v[108:111], v1, s[8:11], s85 offen sc1
    s_add_u32 s85, s85, 65536
    s_cmp_le_u32 s91, 12
    s_cbranch_scc1 RD_LD
    buffer_load_dwordx4 v[112:115], v1, s[8:11], s85 offen sc1
    s_add_u32 s85, s85, 65536
    s_cmp_le_u32 s91, 13
    s_cbranch_scc1 RD_LD
    buffer_load_dwordx4 v[116:119], v1, s[8:11], s85 offen sc1
    s_add_u32 s85, s85, 65536
    s_cmp_le_u32 s91, 14
    s_cbranch_scc1 RD_LD
    buffer_load_dwordx4 v[120:123], v1, s[8:11], s85 offen sc1
    s_add_u32 s85, s85, 65536
    s_cmp_le_u32 s91, 15
    s_cbranch_scc1 RD_LD
    buffer_load_dwordx4 v[124:127], v1, s[8:11], s85 offen sc1
    s_add_u32 s85, s85, 65536
    s_cmp_le_u32 s91, 16
    s_cbranch_scc1 RD_LD
    buffer_load_dwordx4 v[128:131], v1, s[8:11], s85 offen sc1
    s_add_u32 s85, s85, 65536
RD_LD:
    s_lshl_b32 s85, s77, 19
    s_lshr_b32 s86, s93, 4
    s_lshl_b32 s86, s86, 17
    s_add_u32 s85, s85, s86
    s_and_b32 s86, s93, 6
    s_lshl_b32 s86, s86, 14
    s_add_u32 s85, s85, s86
    s_lshl_b32 s86, s78, 8
    s_add_u32 s85, s85, s86
    s_and_b32 s86, s93, 8
    s_lshl_b32 s86, s86, 4
    s_add_u32 s85, s85, s86
    s_and_b32 s86, s93, 1
    s_lshl_b32 s86, s86, 6
    s_add_u32 s85, s85, s86
    s_waitcnt vmcnt(0)
    v_lshlrev_b32 v16, 16, v64
    v_and_b32 v17, 0xffff0000, v64
    v_lshlrev_b32 v18, 16, v65
    v_and_b32 v19, 0xffff0000, v65
    v_lshlrev_b32 v20, 16, v66
    v_and_b32 v21, 0xffff0000, v66
    v_lshlrev_b32 v22, 16, v67
    v_and_b32 v23, 0xffff0000, v67
    v_lshlrev_b32 v24, 16, v68
    v_and_b32 v25, 0xffff0000, v68
    v_lshlrev_b32 v26, 16, v69
    v_and_b32 v27, 0xffff0000, v69
    v_lshlrev_b32 v28, 16, v70
    v_and_b32 v29, 0xffff0000, v70
    v_lshlrev_b32 v30, 16, v71
    v_and_b32 v31, 0xffff0000, v71
    v_pk_add_f32 v[16:17], v[16:17], v[24:25]
    v_pk_add_f32 v[18:19], v[18:19], v[26:27]
    v_pk_add_f32 v[20:21], v[20:21], v[28:29]
    v_pk_add_f32 v[22:23], v[22:23], v[30:31]
    s_cmp_le_u32 s91, 2
    s_cbranch_scc1 RD_AD
    v_lshlrev_b32 v24, 16, v72
    v_and_b32 v25, 0xffff0000, v72
    v_lshlrev_b32 v26, 16, v73
    v_and_b32 v27, 0xffff0000, v73
    v_lshlrev_b32 v28, 16, v74
    v_and_b32 v29, 0xffff0000, v74
    v_lshlrev_b32 v30, 16, v75
    v_and_b32 v31, 0xffff0000, v75
    v_pk_add_f32 v[16:17], v[16:17], v[24:25]
    v_pk_add_f32 v[18:19], v[18:19], v[26:27]
    v_pk_add_f32 v[20:21], v[20:21], v[28:29]
    v_pk_add_f32 v[22:23], v[22:23], v[30:31]
    s_cmp_le_u32 s91, 3
    s_cbranch_scc1 RD_AD
    v_lshlrev_b32 v24, 16, v76
    v_and_b32 v25, 0xffff0000, v76
    v_lshlrev_b32 v26, 16, v77
    v_and_b32 v27, 0xffff0000, v77
    v_lshlrev_b32 v28, 16, v78
    v_and_b32 v29, 0xffff0000, v78
    v_lshlrev_b32 v30, 16, v79
    v_and_b32 v31, 0xffff0000, v79
    v_pk_add_f32 v[16:17], v[16:17], v[24:25]
    v_pk_add_f32 v[18:19], v[18:19], v[26:27]
    v_pk_add_f32 v[20:21], v[20:21], v[28:29]
    v_pk_add_f32 v[22:23], v[22:23], v[30:31]
    s_cmp_le_u32 s91, 4
    s_cbranch_scc1 RD_AD
    v_lshlrev_b32 v24, 16, v80
    v_and_b32 v25, 0xffff0000, v80
    v_lshlrev_b32 v26, 16, v81
    v_and_b32 v27, 0xffff0000, v81
    v_lshlrev_b32 v28, 16, v82
    v_and_b32 v29, 0xffff0000, v82
    v_lshlrev_b32 v30, 16, v83
    v_and_b32 v31, 0xffff0000, v83
    v_pk_add_f32 v[16:17], v[16:17], v[24:25]
    v_pk_add_f32 v[18:19], v[18:19], v[26:27]
    v_pk_add_f32 v[20:21], v[20:21], v[28:29]
    v_pk_add_f32 v[22:23], v[22:23], v[30:31]
    s_cmp_le_u32 s91, 5
    s_cbranch_scc1 RD_AD
    v_lshlrev_b32 v24, 16, v84
    v_and_b32 v25, 0xffff0000, v84
    v_lshlrev_b32 v26, 16, v85
    v_and_b32 v27, 0xffff0000, v85
    v_lshlrev_b32 v28, 16, v86
    v_and_b32 v29, 0xffff0000, v86
    v_lshlrev_b32 v30, 16, v87
    v_and_b32 v31, 0xffff0000, v87
    v_pk_add_f32 v[16:17], v[16:17], v[24:25]
    v_pk_add_f32 v[18:19], v[18:19], v[26:27]
    v_pk_add_f32 v[20:21], v[20:21], v[28:29]
    v_pk_add_f32 v[22:23], v[22:23], v[30:31]
    s_cmp_le_u32 s91, 6
    s_cbranch_scc1 RD_AD
    v_lshlrev_b32 v24, 16, v88
    v_and_b32 v25, 0xffff0000, v88
    v_lshlrev_b32 v26, 16, v89
    v_and_b32 v27, 0xffff0000, v89
    v_lshlrev_b32 v28, 16, v90
    v_and_b32 v29, 0xffff0000, v90
    v_lshlrev_b32 v30, 16, v91
    v_and_b32 v31, 0xffff0000, v91
    v_pk_add_f32 v[16:17], v[16:17], v[24:25]
    v_pk_add_f32 v[18:19], v[18:19], v[26:27]
    v_pk_add_f32 v[20:21], v[20:21], v[28:29]
    v_pk_add_f32 v[22:23], v[22:23], v[30:31]
    s_cmp_le_u32 s91, 7
    s_cbranch_scc1 RD_AD
    v_lshlrev_b32 v24, 16, v92
    v_and_b32 v25, 0xffff0000, v92
    v_lshlrev_b32 v26, 16, v93
    v_and_b32 v27, 0xffff0000, v93
    v_lshlrev_b32 v28, 16, v94
    v_and_b32 v29, 0xffff0000, v94
    v_lshlrev_b32 v30, 16, v95
    v_and_b32 v31, 0xffff0000, v95
    v_pk_add_f32 v[16:17], v[16:17], v[24:25]
    v_pk_add_f32 v[18:19], v[18:19], v[26:27]
    v_pk_add_f32 v[20:21], v[20:21], v[28:29]
    v_pk_add_f32 v[22:23], v[22:23], v[30:31]
    s_cmp_le_u32 s91, 8
    s_cbranch_scc1 RD_AD
    v_lshlrev_b32 v24, 16, v96
    v_and_b32 v25, 0xffff0000, v96
    v_lshlrev_b32 v26, 16, v97
    v_and_b32 v27, 0xffff0000, v97
    v_lshlrev_b32 v28, 16, v98
    v_and_b32 v29, 0xffff0000, v98
    v_lshlrev_b32 v30, 16, v99
    v_and_b32 v31, 0xffff0000, v99
    v_pk_add_f32 v[16:17], v[16:17], v[24:25]
    v_pk_add_f32 v[18:19], v[18:19], v[26:27]
    v_pk_add_f32 v[20:21], v[20:21], v[28:29]
    v_pk_add_f32 v[22:23], v[22:23], v[30:31]
    s_cmp_le_u32 s91, 9
    s_cbranch_scc1 RD_AD
    v_lshlrev_b32 v24, 16, v100
    v_and_b32 v25, 0xffff0000, v100
    v_lshlrev_b32 v26, 16, v101
    v_and_b32 v27, 0xffff0000, v101
    v_lshlrev_b32 v28, 16, v102
    v_and_b32 v29, 0xffff0000, v102
    v_lshlrev_b32 v30, 16, v103
    v_and_b32 v31, 0xffff0000, v103
    v_pk_add_f32 v[16:17], v[16:17], v[24:25]
    v_pk_add_f32 v[18:19], v[18:19], v[26:27]
    v_pk_add_f32 v[20:21], v[20:21], v[28:29]
    v_pk_add_f32 v[22:23], v[22:23], v[30:31]
    s_cmp_le_u32 s91, 10
    s_cbranch_scc1 RD_AD
    v_lshlrev_b32 v24, 16, v104
    v_and_b32 v25, 0xffff0000, v104
    v_lshlrev_b32 v26, 16, v105
    v_and_b32 v27, 0xffff0000, v105
    v_lshlrev_b32 v28, 16, v106
    v_and_b32 v29, 0xffff0000, v106
    v_lshlrev_b32 v30, 16, v107
    v_and_b32 v31, 0xffff0000, v107
    v_pk_add_f32 v[16:17], v[16:17], v[24:25]
    v_pk_add_f32 v[18:19], v[18:19], v[26:27]
    v_pk_add_f32 v[20:21], v[20:21], v[28:29]
    v_pk_add_f32 v[22:23], v[22:23], v[30:31]
    s_cmp_le_u32 s91, 11
    s_cbranch_scc1 RD_AD
    v_lshlrev_b32 v24, 16, v108
    v_and_b32 v25, 0xffff0000, v108
    v_lshlrev_b32 v26, 16, v109
    v_and_b32 v27, 0xffff0000, v109
    v_lshlrev_b32 v28, 16, v110
    v_and_b32 v29, 0xffff0000, v110
    v_lshlrev_b32 v30, 16, v111
    v_and_b32 v31, 0xffff0000, v111
    v_pk_add_f32 v[16:17], v[16:17], v[24:25]
    v_pk_add_f32 v[18:19], v[18:19], v[26:27]
    v_pk_add_f32 v[20:21], v[20:21], v[28:29]
    v_pk_add_f32 v[22:23], v[22:23], v[30:31]
    s_cmp_le_u32 s91, 12
    s_cbranch_scc1 RD_AD
    v_lshlrev_b32 v24, 16, v112
    v_and_b32 v25, 0xffff0000, v112
    v_lshlrev_b32 v26, 16, v113
    v_and_b32 v27, 0xffff0000, v113
    v_lshlrev_b32 v28, 16, v114
    v_and_b32 v29, 0xffff0000, v114
    v_lshlrev_b32 v30, 16, v115
    v_and_b32 v31, 0xffff0000, v115
    v_pk_add_f32 v[16:17], v[16:17], v[24:25]
    v_pk_add_f32 v[18:19], v[18:19], v[26:27]
    v_pk_add_f32 v[20:21], v[20:21], v[28:29]
    v_pk_add_f32 v[22:23], v[22:23], v[30:31]
    s_cmp_le_u32 s91, 13
    s_cbranch_scc1 RD_AD
    v_lshlrev_b32 v24, 16, v116
    v_and_b32 v25, 0xffff0000, v116
    v_lshlrev_b32 v26, 16, v117
    v_and_b32 v27, 0xffff0000, v117
    v_lshlrev_b32 v28, 16, v118
    v_and_b32 v29, 0xffff0000, v118
    v_lshlrev_b32 v30, 16, v119
    v_and_b32 v31, 0xffff0000, v119
    v_pk_add_f32 v[16:17], v[16:17], v[24:25]
    v_pk_add_f32 v[18:19], v[18:19], v[26:27]
    v_pk_add_f32 v[20:21], v[20:21], v[28:29]
    v_pk_add_f32 v[22:23], v[22:23], v[30:31]
    s_cmp_le_u32 s91, 14
    s_cbranch_scc1 RD_AD
    v_lshlrev_b32 v24, 16, v120
    v_and_b32 v25, 0xffff0000, v120
    v_lshlrev_b32 v26, 16, v121
    v_and_b32 v27, 0xffff0000, v121
    v_lshlrev_b32 v28, 16, v122
    v_and_b32 v29, 0xffff0000, v122
    v_lshlrev_b32 v30, 16, v123
    v_and_b32 v31, 0xffff0000, v123
    v_pk_add_f32 v[16:17], v[16:17], v[24:25]
    v_pk_add_f32 v[18:19], v[18:19], v[26:27]
    v_pk_add_f32 v[20:21], v[20:21], v[28:29]
    v_pk_add_f32 v[22:23], v[22:23], v[30:31]
    s_cmp_le_u32 s91, 15
    s_cbranch_scc1 RD_AD
    v_lshlrev_b32 v24, 16, v124
    v_and_b32 v25, 0xffff0000, v124
    v_lshlrev_b32 v26, 16, v125
    v_and_b32 v27, 0xffff0000, v125
    v_lshlrev_b32 v28, 16, v126
    v_and_b32 v29, 0xffff0000, v126
    v_lshlrev_b32 v30, 16, v127
    v_and_b32 v31, 0xffff0000, v127
    v_pk_add_f32 v[16:17], v[16:17], v[24:25]
    v_pk_add_f32 v[18:19], v[18:19], v[26:27]
    v_pk_add_f32 v[20:21], v[20:21], v[28:29]
    v_pk_add_f32 v[22:23], v[22:23], v[30:31]
    s_cmp_le_u32 s91, 16
    s_cbranch_scc1 RD_AD
    v_lshlrev_b32 v24, 16, v128
    v_and_b32 v25, 0xffff0000, v128
    v_lshlrev_b32 v26, 16, v129
    v_and_b32 v27, 0xffff0000, v129
    v_lshlrev_b32 v28, 16, v130
    v_and_b32 v29, 0xffff0000, v130
    v_lshlrev_b32 v30, 16, v131
    v_and_b32 v31, 0xffff0000, v131
    v_pk_add_f32 v[16:17], v[16:17], v[24:25]
    v_pk_add_f32 v[18:19], v[18:19], v[26:27]
    v_pk_add_f32 v[20:21], v[20:21], v[28:29]
    v_pk_add_f32 v[22:23], v[22:23], v[30:31]
RD_AD:
    v_cvt_pk_bf16_f32 v8, v16, v17
    v_cvt_pk_bf16_f32 v10, v20, v21
    v_cvt_pk_bf16_f32 v9, v18, v19
    v_cvt_pk_bf16_f32 v11, v22, v23
    v_permlane16_swap_b32 v8, v10
    s_nop 0
    v_permlane16_swap_b32 v9, v11
    ds_bpermute_b32 v12, v3, v8
    ds_bpermute_b32 v13, v3, v9
    ds_bpermute_b32 v14, v3, v10
    ds_bpermute_b32 v15, v3, v11
    s_waitcnt lgkmcnt(0)
    buffer_store_dwordx4 v[12:15], v2, s[12:15], s85 offen
    s_add_u32 s93, s93, 8
    s_sub_u32 s94, s94, 1
    s_cmp_lg_u32 s94, 0
    s_cbranch_scc1 RD_L
    s_branch G_DONE
.p2align 6
.type G_TABLE,@object
G_TABLE:
.long 0x8,0x0,0x0,0x0,0x0,0x102000,0x0,0x0
.long 0x10008,0x0,0x0,0x0,0x0,0x102000,0x0,0x0
.long 0x20008,0x0,0x0,0x0,0x0,0x102000,0x0,0x0
.long 0x30008,0x0,0x0,0x0,0x0,0x102000,0x0,0x0
.long 0x40008,0x0,0x0,0x0,0x0,0x102000,0x0,0x0
.long 0x50008,0x0,0x0,0x0,0x0,0x102000,0x0,0x0
.long 0x60008,0x0,0x0,0x0,0x0,0x102000,0x0,0x0
.long 0x70008,0x0,0x0,0x0,0x0,0x102000,0x0,0x0
.long 0x1000008,0x0,0x0,0x0,0x0,0x102000,0x0,0x0
.long 0x1010008,0x0,0x0,0x0,0x0,0x102000,0x0,0x0
.long 0x1020008,0x0,0x0,0x0,0x0,0x102000,0x0,0x0
.long 0x1030008,0x0,0x0,0x0,0x0,0x102000,0x0,0x0
.long 0x1040008,0x0,0x0,0x0,0x0,0x102000,0x0,0x0
.long 0x1050008,0x0,0x0,0x0,0x0,0x102000,0x0,0x0
.long 0x1060008,0x0,0x0,0x0,0x0,0x102000,0x0,0x0
.long 0x1070008,0x0,0x0,0x0,0x0,0x102000,0x0,0x0
.long 0x108,0x0,0x0,0x0,0x0,0x102000,0x0,0x0
.long 0x10108,0x0,0x0,0x0,0x0,0x102000,0x0,0x0
.long 0x20108,0x0,0x0,0x0,0x0,0x102000,0x0,0x0
.long 0x30108,0x0,0x0,0x0,0x0,0x102000,0x0,0x0
.long 0x40108,0x0,0x0,0x0,0x0,0x102000,0x0,0x0
.long 0x50108,0x0,0x0,0x0,0x0,0x102000,0x0,0x0
.long 0x60108,0x0,0x0,0x0,0x0,0x102000,0x0,0x0
.long 0x70108,0x0,0x0,0x0,0x0,0x102000,0x0,0x0
.long 0x1000108,0x0,0x0,0x0,0x0,0x102000,0x0,0x0
.long 0x1010108,0x0,0x0,0x0,0x0,0x102000,0x0,0x0
.long 0x1020108,0x0,0x0,0x0,0x0,0x102000,0x0,0x0
.long 0x1030108,0x0,0x0,0x0,0x0,0x102000,0x0,0x0
.long 0x1040108,0x0,0x0,0x0,0x0,0x102000,0x0,0x0
.long 0x1050108,0x0,0x0,0x0,0x0,0x102000,0x0,0x0
.long 0x1060108,0x0,0x0,0x0,0x0,0x102000,0x0,0x0
.long 0x1070108,0x0,0x0,0x0,0x0,0x102000,0x0,0x0
.long 0x101,0x0,0x0,0x0,0x0,0x202001,0x0,0x0
.long 0x10101,0x0,0x0,0x0,0x0,0x202001,0x0,0x0
.long 0x20101,0x0,0x0,0x0,0x0,0x202001,0x0,0x0
.long 0x30101,0x0,0x0,0x0,0x0,0x202001,0x0,0x0
.long 0x40101,0x0,0x0,0x0,0x0,0x202001,0x0,0x0
.long 0x50101,0x0,0x0,0x0,0x0,0x202001,0x0,0x0
.long 0x60101,0x0,0x0,0x0,0x0,0x202001,0x0,0x0
.long 0x70101,0x0,0x0,0x0,0x0,0x202001,0x0,0x0
.long 0x1000101,0x0,0x0,0x0,0x0,0x202001,0x0,0x0
.long 0x1010101,0x0,0x0,0x0,0x0,0x202001,0x0,0x0
.long 0x1020101,0x0,0x0,0x0,0x0,0x202001,0x0,0x0
.long 0x1030101,0x0,0x0,0x0,0x0,0x202001,0x0,0x0
.long 0x1040101,0x0,0x0,0x0,0x0,0x202001,0x0,0x0
.long 0x1050101,0x0,0x0,0x0,0x0,0x202001,0x0,0x0
.long 0x1060101,0x0,0x0,0x0,0x0,0x202001,0x0,0x0
.long 0x1070101,0x0,0x0,0x0,0x0,0x202001,0x0,0x0
.long 0x200,0x0,0x0,0x0,0x0,0x402002,0x0,0x0
.long 0x10200,0x0,0x0,0x0,0x0,0x402002,0x0,0x0
.long 0x20200,0x0,0x0,0x0,0x0,0x402002,0x0,0x0
.long 0x30200,0x0,0x0,0x0,0x0,0x402002,0x0,0x0
.long 0x1000200,0x0,0x0,0x0,0x0,0x402002,0x0,0x0
.long 0x1010200,0x0,0x0,0x0,0x0,0x402002,0x0,0x0
.long 0x1020200,0x0,0x0,0x0,0x0,0x402002,0x0,0x0
.long 0x1030200,0x0,0x0,0x0,0x0,0x402002,0x0,0x0
.long 0x2,0x20000,0x0,0x0,0x0,0x100068,0x0,0x0
.long 0x102,0x20000,0x0,0x0,0x0,0x100068,0x0,0x0
.long 0x202,0x20000,0x0,0x0,0x0,0x100068,0x0,0x0
.long 0x302,0x20000,0x0,0x0,0x0,0x100068,0x0,0x0
.long 0x402,0x20000,0x0,0x0,0x0,0x100068,0x0,0x0
.long 0x502,0x20000,0x0,0x0,0x0,0x100068,0x0,0x0
.long 0x602,0x20000,0x0,0x0,0x0,0x100068,0x0,0x0
.long 0x702,0x20000,0x0,0x0,0x0,0x100068,0x0,0x0
.long 0x802,0x20000,0x0,0x0,0x0,0x100068,0x0,0x0
.long 0x902,0x20000,0x0,0x0,0x0,0x100068,0x0,0x0
.long 0xa02,0x20000,0x0,0x0,0x0,0x100068,0x0,0x0
.long 0xb02,0x20000,0x0,0x0,0x0,0x100068,0x0,0x0
.long 0xc02,0x20000,0x0,0x0,0x0,0x100068,0x0,0x0
.long 0xd02,0x20000,0x0,0x0,0x0,0x100068,0x0,0x0
.long 0xe02,0x20000,0x0,0x0,0x0,0x100068,0x0,0x0
.long 0xf02,0x20000,0x0,0x0,0x0,0x100068,0x0,0x0
.long 0x1002,0x20000,0x0,0x0,0x0,0x100068,0x0,0x0
.long 0x1102,0x20000,0x0,0x0,0x0,0x100068,0x0,0x0
.long 0x1202,0x20000,0x0,0x0,0x0,0x100068,0x0,0x0
.long 0x1302,0x20000,0x0,0x0,0x0,0x100068,0x0,0x0
.long 0x1402,0x20000,0x0,0x0,0x0,0x100068,0x0,0x0
.long 0x1502,0x20000,0x0,0x0,0x0,0x100068,0x0,0x0
.long 0x1602,0x20000,0x0,0x0,0x0,0x100068,0x0,0x0
.long 0x1702,0x20000,0x0,0x0,0x0,0x100068,0x0,0x0
.long 0x1802,0x20000,0x0,0x0,0x0,0x100068,0x0,0x0
.long 0x1902,0x20000,0x0,0x0,0x0,0x100068,0x0,0x0
.long 0x1a02,0x20000,0x0,0x0,0x0,0x100068,0x0,0x0
.long 0x1b02,0x20000,0x0,0x0,0x0,0x100068,0x0,0x0
.long 0x1c02,0x20000,0x0,0x0,0x0,0x100068,0x0,0x0
.long 0x1d02,0x20000,0x0,0x0,0x0,0x100068,0x0,0x0
.long 0x1e02,0x20000,0x0,0x0,0x0,0x100068,0x0,0x0
.long 0x1f02,0x20000,0x0,0x0,0x0,0x100068,0x0,0x0
.long 0x2000005,0x2002000,0x8000068,0x0,0x0,0x0,0x0,0x0
.long 0x2010005,0x2002000,0x8000068,0x0,0x0,0x0,0x0,0x0
.long 0x2020005,0x2002000,0x8000068,0x0,0x0,0x0,0x0,0x0
.long 0x2030005,0x2002000,0x8000068,0x0,0x0,0x0,0x0,0x0
.long 0x300,0x0,0x0,0x0,0x0,0x402003,0x0,0x0
.long 0x10300,0x0,0x0,0x0,0x0,0x402003,0x0,0x0
.long 0x20300,0x0,0x0,0x0,0x0,0x402003,0x0,0x0
.long 0x30300,0x0,0x0,0x0,0x0,0x402003,0x0,0x0
.long 0x1000300,0x0,0x0,0x0,0x0,0x402003,0x0,0x0
.long 0x1010300,0x0,0x0,0x0,0x0,0x402003,0x0,0x0
.long 0x1020300,0x0,0x0,0x0,0x0,0x402003,0x0,0x0
.long 0x1030300,0x0,0x0,0x0,0x0,0x402003,0x0,0x0
.long 0x3000000,0x8000068,0x0,0x0,0x0,0x10006a,0x0,0x0
.long 0x3000100,0x8000068,0x0,0x0,0x0,0x10006a,0x0,0x0
.long 0x3000200,0x8000068,0x0,0x0,0x0,0x10006a,0x0,0x0
.long 0x3000300,0x8000068,0x0,0x0,0x0,0x10006a,0x0,0x0
.long 0x3000400,0x8000068,0x0,0x0,0x0,0x10006a,0x0,0x0
.long 0x3000500,0x8000068,0x0,0x0,0x0,0x10006a,0x0,0x0
.long 0x3000600,0x8000068,0x0,0x0,0x0,0x10006a,0x0,0x0
.long 0x3000700,0x8000068,0x0,0x0,0x0,0x10006a,0x0,0x0
.long 0x400,0x0,0x0,0x0,0x0,0x402004,0x0,0x0
.long 0x10400,0x0,0x0,0x0,0x0,0x402004,0x0,0x0
.long 0x20400,0x0,0x0,0x0,0x0,0x402004,0x0,0x0
.long 0x30400,0x0,0x0,0x0,0x0,0x402004,0x0,0x0
.long 0x1000400,0x0,0x0,0x0,0x0,0x402004,0x0,0x0
.long 0x1010400,0x0,0x0,0x0,0x0,0x402004,0x0,0x0
.long 0x1020400,0x0,0x0,0x0,0x0,0x402004,0x0,0x0
.long 0x1030400,0x0,0x0,0x0,0x0,0x402004,0x0,0x0
.long 0x3,0x20000,0x0,0x0,0x0,0x100069,0x0,0x0
.long 0x103,0x20000,0x0,0x0,0x0,0x100069,0x0,0x0
.long 0x203,0x20000,0x0,0x0,0x0,0x100069,0x0,0x0
.long 0x303,0x20000,0x0,0x0,0x0,0x100069,0x0,0x0
.long 0x403,0x20000,0x0,0x0,0x0,0x100069,0x0,0x0
.long 0x503,0x20000,0x0,0x0,0x0,0x100069,0x0,0x0
.long 0x603,0x20000,0x0,0x0,0x0,0x100069,0x0,0x0
.long 0x703,0x20000,0x0,0x0,0x0,0x100069,0x0,0x0
.long 0x803,0x20000,0x0,0x0,0x0,0x100069,0x0,0x0
.long 0x903,0x20000,0x0,0x0,0x0,0x100069,0x0,0x0
.long 0xa03,0x20000,0x0,0x0,0x0,0x100069,0x0,0x0
.long 0xb03,0x20000,0x0,0x0,0x0,0x100069,0x0,0x0
.long 0xc03,0x20000,0x0,0x0,0x0,0x100069,0x0,0x0
.long 0xd03,0x20000,0x0,0x0,0x0,0x100069,0x0,0x0
.long 0xe03,0x20000,0x0,0x0,0x0,0x100069,0x0,0x0
.long 0xf03,0x20000,0x0,0x0,0x0,0x100069,0x0,0x0
.long 0x2000105,0x2002001,0x8000068,0x0,0x0,0x0,0x0,0x0
.long 0x2010105,0x2002001,0x8000068,0x0,0x0,0x0,0x0,0x0
.long 0x2020105,0x2002001,0x8000068,0x0,0x0,0x0,0x0,0x0
.long 0x2030105,0x2002001,0x8000068,0x0,0x0,0x0,0x0,0x0
.long 0x500,0x0,0x0,0x0,0x0,0x402005,0x0,0x0
.long 0x10500,0x0,0x0,0x0,0x0,0x402005,0x0,0x0
.long 0x20500,0x0,0x0,0x0,0x0,0x402005,0x0,0x0
.long 0x30500,0x0,0x0,0x0,0x0,0x402005,0x0,0x0
.long 0x1000500,0x0,0x0,0x0,0x0,0x402005,0x0,0x0
.long 0x1010500,0x0,0x0,0x0,0x0,0x402005,0x0,0x0
.long 0x1020500,0x0,0x0,0x0,0x0,0x402005,0x0,0x0
.long 0x1030500,0x0,0x0,0x0,0x0,0x402005,0x0,0x0
.long 0x4,0x202006a,0x4000069,0x0,0x0,0x10006b,0x0,0x0
.long 0x104,0x202006a,0x4000069,0x0,0x0,0x10006b,0x0,0x0
.long 0x204,0x202006a,0x4000069,0x0,0x0,0x10006b,0x0,0x0
.long 0x304,0x202006a,0x4000069,0x0,0x0,0x10006b,0x0,0x0
.long 0x600,0x0,0x0,0x0,0x0,0x402006,0x0,0x0
.long 0x10600,0x0,0x0,0x0,0x0,0x402006,0x0,0x0
.long 0x20600,0x0,0x0,0x0,0x0,0x402006,0x0,0x0
.long 0x30600,0x0,0x0,0x0,0x0,0x402006,0x0,0x0
.long 0x1000600,0x0,0x0,0x0,0x0,0x402006,0x0,0x0
.long 0x1010600,0x0,0x0,0x0,0x0,0x402006,0x0,0x0
.long 0x1020600,0x0,0x0,0x0,0x0,0x402006,0x0,0x0
.long 0x1030600,0x0,0x0,0x0,0x0,0x402006,0x0,0x0
.long 0x2000205,0x2002002,0x8000068,0x4010075,0x0,0x0,0x0,0x0
.long 0x2010205,0x2002002,0x8000068,0x4010075,0x0,0x0,0x0,0x0
.long 0x2020205,0x2002002,0x8000068,0x4010075,0x0,0x0,0x0,0x0
.long 0x2030205,0x2002002,0x8000068,0x4010075,0x0,0x0,0x0,0x0
.long 0x404,0x202006a,0x4000069,0x0,0x0,0x10006b,0x0,0x0
.long 0x504,0x202006a,0x4000069,0x0,0x0,0x10006b,0x0,0x0
.long 0x604,0x202006a,0x4000069,0x0,0x0,0x10006b,0x0,0x0
.long 0x704,0x202006a,0x4000069,0x0,0x0,0x10006b,0x0,0x0
.long 0x804,0x202006a,0x4000069,0x0,0x0,0x10006b,0x0,0x0
.long 0x904,0x202006a,0x4000069,0x0,0x0,0x10006b,0x0,0x0
.long 0xa04,0x202006a,0x4000069,0x0,0x0,0x10006b,0x0,0x0
.long 0xb04,0x202006a,0x4000069,0x0,0x0,0x10006b,0x0,0x0
.long 0x2000305,0x2002003,0x8000068,0x401007d,0x0,0x0,0x0,0x0
.long 0x2010305,0x2002003,0x8000068,0x401007d,0x0,0x0,0x0,0x0
.long 0x2020305,0x2002003,0x8000068,0x401007d,0x0,0x0,0x0,0x0
.long 0x2030305,0x2002003,0x8000068,0x401007d,0x0,0x0,0x0,0x0
.long 0x700,0x0,0x0,0x0,0x0,0x402007,0x0,0x0
.long 0x10700,0x0,0x0,0x0,0x0,0x402007,0x0,0x0
.long 0x20700,0x0,0x0,0x0,0x0,0x402007,0x0,0x0
.long 0x30700,0x0,0x0,0x0,0x0,0x402007,0x0,0x0
.long 0x1000700,0x0,0x0,0x0,0x0,0x402007,0x0,0x0
.long 0x1010700,0x0,0x0,0x0,0x0,0x402007,0x0,0x0
.long 0x1020700,0x0,0x0,0x0,0x0,0x402007,0x0,0x0
.long 0x1030700,0x0,0x0,0x0,0x0,0x402007,0x0,0x0
.long 0xc04,0x202006a,0x4000069,0x0,0x0,0x10006b,0x0,0x0
.long 0xd04,0x202006a,0x4000069,0x0,0x0,0x10006b,0x0,0x0
.long 0xe04,0x202006a,0x4000069,0x0,0x0,0x10006b,0x0,0x0
.long 0xf04,0x202006a,0x4000069,0x0,0x0,0x10006b,0x0,0x0
.long 0x2000405,0x2002004,0x8000068,0x4010085,0x0,0x0,0x0,0x0
.long 0x2010405,0x2002004,0x8000068,0x4010085,0x0,0x0,0x0,0x0
.long 0x2020405,0x2002004,0x8000068,0x4010085,0x0,0x0,0x0,0x0
.long 0x2030405,0x2002004,0x8000068,0x4010085,0x0,0x0,0x0,0x0
.long 0x6,0x1004170,0x1004171,0x0,0x0,0x400020,0x10510,0x1
.long 0x10006,0x1004170,0x1004171,0x0,0x0,0x400030,0x10510,0xb
.long 0x20006,0x1004170,0x1004171,0x0,0x0,0x400040,0x10510,0x15
.long 0x30006,0x1004170,0x1004171,0x0,0x0,0x400050,0x10510,0x1f
.long 0x2000505,0x2002005,0x8000068,0x401008d,0x0,0x0,0x0,0x0
.long 0x2010505,0x2002005,0x8000068,0x401008d,0x0,0x0,0x0,0x0
.long 0x2020505,0x2002005,0x8000068,0x401008d,0x0,0x0,0x0,0x0
.long 0x2030505,0x2002005,0x8000068,0x401008d,0x0,0x0,0x0,0x0
.long 0xb,0x400006b,0x8000068,0x0,0x0,0x1001d0,0x50500,0x0
.long 0x10b,0x400006b,0x8000068,0x0,0x0,0x1001d1,0x50500,0x28
.long 0x20b,0x400006b,0x8000068,0x0,0x0,0x1001d2,0x50500,0x50
.long 0x2000605,0x2002006,0x8000068,0x4010095,0x0,0x0,0x0,0x0
.long 0x2010605,0x2002006,0x8000068,0x4010095,0x0,0x0,0x0,0x0
.long 0x2020605,0x2002006,0x8000068,0x4010095,0x0,0x0,0x0,0x0
.long 0x2030605,0x2002006,0x8000068,0x4010095,0x0,0x0,0x0,0x0
.long 0x30b,0x400006b,0x8000068,0x0,0x0,0x1001d3,0x50500,0x78
.long 0x106,0x1004172,0x1004173,0x0,0x0,0x400022,0x10510,0x29
.long 0x10106,0x1004172,0x1004173,0x0,0x0,0x400032,0x10510,0x33
.long 0x20106,0x1004172,0x1004173,0x0,0x0,0x400042,0x10510,0x3d
.long 0x30106,0x1004172,0x1004173,0x0,0x0,0x400052,0x10510,0x47
.long 0x2000705,0x2002007,0x8000068,0x401009d,0x0,0x0,0x0,0x0
.long 0x2010705,0x2002007,0x8000068,0x401009d,0x0,0x0,0x0,0x0
.long 0x2020705,0x2002007,0x8000068,0x401009d,0x0,0x0,0x0,0x0
.long 0x2030705,0x2002007,0x8000068,0x401009d,0x0,0x0,0x0,0x0
.long 0x40b,0x400006b,0x8000068,0x0,0x0,0x1001d4,0x50500,0xa0
.long 0x50b,0x400006b,0x8000068,0x0,0x0,0x1001d5,0x90900,0xc8
.long 0x206,0x1004174,0x1004175,0x0,0x0,0x400024,0x10510,0x51
.long 0x10206,0x1004174,0x1004175,0x0,0x0,0x400034,0x10510,0x5b
.long 0x20206,0x1004174,0x1004175,0x0,0x0,0x400044,0x10510,0x65
.long 0x30206,0x1004174,0x1004175,0x0,0x0,0x400054,0x10510,0x6f
.long 0x60b,0x400006b,0x8000068,0x0,0x0,0x1001d6,0x90900,0x110
.long 0x306,0x1004176,0x1004177,0x0,0x0,0x400026,0x10510,0x79
.long 0x10306,0x1004176,0x1004177,0x0,0x0,0x400036,0x10510,0x83
.long 0x20306,0x1004176,0x1004177,0x0,0x0,0x400046,0x10510,0x8d
.long 0x30306,0x1004176,0x1004177,0x0,0x0,0x400056,0x10510,0x97
.long 0x406,0x1004178,0x1004179,0x0,0x0,0x400028,0x10510,0xa1
.long 0x10406,0x1004178,0x1004179,0x0,0x0,0x400038,0x10510,0xab
.long 0x20406,0x1004178,0x1004179,0x0,0x0,0x400048,0x10510,0xb5
.long 0x30406,0x1004178,0x1004179,0x0,0x0,0x400058,0x10510,0xbf
.long 0x70b,0x400006b,0x8000068,0x0,0x0,0x1001d7,0x90900,0x158
.long 0x506,0x100417a,0x100417b,0x0,0x0,0x40002a,0x20908,0xc9
.long 0x10506,0x100417a,0x100417b,0x0,0x0,0x40003a,0x20908,0xdb
.long 0x20506,0x100417a,0x100417b,0x0,0x0,0x40004a,0x20908,0xed
.long 0x30506,0x100417a,0x100417b,0x0,0x0,0x40005a,0x20908,0xff
.long 0x8000506,0x100417a,0x100417b,0x0,0x0,0x40002a,0x20908,0xca
.long 0x8010506,0x100417a,0x100417b,0x0,0x0,0x40003a,0x20908,0xdc
.long 0x8020506,0x100417a,0x100417b,0x0,0x0,0x40004a,0x20908,0xee
.long 0x8030506,0x100417a,0x100417b,0x0,0x0,0x40005a,0x20908,0x100
.long 0x7,0x1024020,0x4001d0,0x0,0x0,0x0,0xa0504,0x0
.long 0x20000007,0x1024020,0x4001d0,0x0,0x0,0x0,0xa0504,0x0
.long 0x10007,0x1024020,0x4001d0,0x0,0x0,0x0,0xa0504,0x5
.long 0x20010007,0x1024020,0x4001d0,0x0,0x0,0x0,0xa0504,0x5
.long 0x107,0x1024022,0x4001d1,0x0,0x0,0x0,0xa0504,0x28
.long 0x20000107,0x1024022,0x4001d1,0x0,0x0,0x0,0xa0504,0x28
.long 0x10107,0x1024022,0x4001d1,0x0,0x0,0x0,0xa0504,0x2d
.long 0x20010107,0x1024022,0x4001d1,0x0,0x0,0x0,0xa0504,0x2d
.long 0x207,0x1024024,0x4001d2,0x0,0x0,0x0,0xa0504,0x50
.long 0x20000207,0x1024024,0x4001d2,0x0,0x0,0x0,0xa0504,0x50
.long 0x10207,0x1024024,0x4001d2,0x0,0x0,0x0,0xa0504,0x55
.long 0x20010207,0x1024024,0x4001d2,0x0,0x0,0x0,0xa0504,0x55
.long 0x307,0x1024026,0x4001d3,0x0,0x0,0x0,0xa0504,0x78
.long 0x20000307,0x1024026,0x4001d3,0x0,0x0,0x0,0xa0504,0x78
.long 0x10307,0x1024026,0x4001d3,0x0,0x0,0x0,0xa0504,0x7d
.long 0x20010307,0x1024026,0x4001d3,0x0,0x0,0x0,0xa0504,0x7d
.long 0x606,0x104417c,0x100417d,0x0,0x0,0x40002c,0x20908,0x111
.long 0x10606,0x104417c,0x100417d,0x0,0x0,0x40003c,0x20908,0x123
.long 0x20606,0x104417c,0x100417d,0x0,0x0,0x40004c,0x20908,0x135
.long 0x30606,0x104417c,0x100417d,0x0,0x0,0x40005c,0x20908,0x147
.long 0x8000606,0x104417c,0x100417d,0x0,0x0,0x40002c,0x20908,0x112
.long 0x8010606,0x104417c,0x100417d,0x0,0x0,0x40003c,0x20908,0x124
.long 0x8020606,0x104417c,0x100417d,0x0,0x0,0x40004c,0x20908,0x136
.long 0x8030606,0x104417c,0x100417d,0x0,0x0,0x40005c,0x20908,0x148
.long 0x407,0x1024028,0x4001d4,0x0,0x0,0x0,0xa0504,0xa0
.long 0x20000407,0x1024028,0x4001d4,0x0,0x0,0x0,0xa0504,0xa0
.long 0x10407,0x1024028,0x4001d4,0x0,0x0,0x0,0xa0504,0xa5
.long 0x20010407,0x1024028,0x4001d4,0x0,0x0,0x0,0xa0504,0xa5
.long 0xe0a,0x104417e,0x0,0x0,0x0,0x20002e,0x20908,0x159
.long 0x10e0a,0x104417e,0x0,0x0,0x0,0x20002e,0x20908,0x162
.long 0x20e0a,0x104417e,0x0,0x0,0x0,0x20003e,0x20908,0x16b
.long 0x30e0a,0x104417e,0x0,0x0,0x0,0x20003e,0x20908,0x174
.long 0x40e0a,0x104417e,0x0,0x0,0x0,0x20004e,0x20908,0x17d
.long 0x50e0a,0x104417e,0x0,0x0,0x0,0x20004e,0x20908,0x186
.long 0x60e0a,0x104417e,0x0,0x0,0x0,0x20005e,0x20908,0x18f
.long 0x70e0a,0x104417e,0x0,0x0,0x0,0x20005e,0x20908,0x198
.long 0x8000e0a,0x104417e,0x0,0x0,0x0,0x20002e,0x20908,0x15a
.long 0x8010e0a,0x104417e,0x0,0x0,0x0,0x20002e,0x20908,0x163
.long 0x8020e0a,0x104417e,0x0,0x0,0x0,0x20003e,0x20908,0x16c
.long 0x8030e0a,0x104417e,0x0,0x0,0x0,0x20003e,0x20908,0x175
.long 0x8040e0a,0x104417e,0x0,0x0,0x0,0x20004e,0x20908,0x17e
.long 0x8050e0a,0x104417e,0x0,0x0,0x0,0x20004e,0x20908,0x187
.long 0x8060e0a,0x104417e,0x0,0x0,0x0,0x20005e,0x20908,0x190
.long 0x8070e0a,0x104417e,0x0,0x0,0x0,0x20005e,0x20908,0x199
.long 0x507,0x202402a,0x4001d5,0x0,0x0,0x0,0x120902,0xc8
.long 0x10000507,0x202402a,0x4001d5,0x0,0x0,0x0,0x120902,0xc8
.long 0x20000507,0x202402a,0x4001d5,0x0,0x0,0x0,0x120902,0xc8
.long 0x30000507,0x202402a,0x4001d5,0x0,0x0,0x0,0x120902,0xc8
.long 0x10507,0x202402a,0x4001d5,0x0,0x0,0x0,0x120902,0xd1
.long 0x10010507,0x202402a,0x4001d5,0x0,0x0,0x0,0x120902,0xd1
.long 0x20010507,0x202402a,0x4001d5,0x0,0x0,0x0,0x120902,0xd1
.long 0x30010507,0x202402a,0x4001d5,0x0,0x0,0x0,0x120902,0xd1
.long 0x607,0x206402c,0x4001d6,0x0,0x0,0x0,0x120901,0x110
.long 0x8000607,0x206402c,0x4001d6,0x0,0x0,0x0,0x120901,0x110
.long 0x10000607,0x206402c,0x4001d6,0x0,0x0,0x0,0x120901,0x110
.long 0x18000607,0x206402c,0x4001d6,0x0,0x0,0x0,0x120901,0x110
.long 0x20000607,0x206402c,0x4001d6,0x0,0x0,0x0,0x120901,0x110
.long 0x28000607,0x206402c,0x4001d6,0x0,0x0,0x0,0x120901,0x110
.long 0x30000607,0x206402c,0x4001d6,0x0,0x0,0x0,0x120901,0x110
.long 0x38000607,0x206402c,0x4001d6,0x0,0x0,0x0,0x120901,0x110
.long 0x10607,0x206402c,0x4001d6,0x0,0x0,0x0,0x120901,0x119
.long 0x8010607,0x206402c,0x4001d6,0x0,0x0,0x0,0x120901,0x119
.long 0x10010607,0x206402c,0x4001d6,0x0,0x0,0x0,0x120901,0x119
.long 0x18010607,0x206402c,0x4001d6,0x0,0x0,0x0,0x120901,0x119
.long 0x20010607,0x206402c,0x4001d6,0x0,0x0,0x0,0x120901,0x119
.long 0x28010607,0x206402c,0x4001d6,0x0,0x0,0x0,0x120901,0x119
.long 0x30010607,0x206402c,0x4001d6,0x0,0x0,0x0,0x120901,0x119
.long 0x38010607,0x206402c,0x4001d6,0x0,0x0,0x0,0x120901,0x119
.long 0x707,0x206402e,0x4001d7,0x0,0x0,0x0,0x120901,0x158
.long 0x8000707,0x206402e,0x4001d7,0x0,0x0,0x0,0x120901,0x158
.long 0x10000707,0x206402e,0x4001d7,0x0,0x0,0x0,0x120901,0x158
.long 0x18000707,0x206402e,0x4001d7,0x0,0x0,0x0,0x120901,0x158
.long 0x10707,0x206402e,0x4001d7,0x0,0x0,0x0,0x120901,0x161
.long 0x8010707,0x206402e,0x4001d7,0x0,0x0,0x0,0x120901,0x161
.long 0x10010707,0x206402e,0x4001d7,0x0,0x0,0x0,0x120901,0x161
.long 0x18010707,0x206402e,0x4001d7,0x0,0x0,0x0,0x120901,0x161
.long 0xff,0x20000,0x0,0x0,0x0,0x0,0x0,0x0
G_TABLE_END:
.section .rodata,"a"
.p2align 6
.amdhsa_kernel gated_mix__memory_aug_recurrent_mem_tr__spectral_gfnet__prompt_kernel
  .amdhsa_next_free_vgpr 256
  .amdhsa_next_free_sgpr 102
  .amdhsa_accum_offset 256
  .amdhsa_group_segment_fixed_size 0
  .amdhsa_kernarg_size 112
  .amdhsa_user_sgpr_count 2
  .amdhsa_user_sgpr_kernarg_segment_ptr 1
  .amdhsa_system_sgpr_workgroup_id_x 1
  .amdhsa_float_denorm_mode_32 3
  .amdhsa_float_denorm_mode_16_64 3
.end_amdhsa_kernel
```
